```python
import torch

def _softmax(x, axis=-1):
    return torch.softmax(x, dim=axis)

def _gelu(x):
    return torch.nn.functional.gelu(x, approximate='tanh')

def _silu(x):
    return torch.nn.functional.silu(x)

def _sigmoid(x):
    return torch.sigmoid(x)

def _layernorm(x, axis=-1, eps=1e-05):
    m = x.mean(dim=axis, keepdim=True)
    v = x.var(dim=axis, keepdim=True, unbiased=False)
    return (x - m) / torch.sqrt(v + eps)

def _scatter_add(tgt, idx, src, axis=0):
    return tgt.clone().index_add_(axis, idx, src)

def _segment_sum(src, seg, n):
    out = torch.zeros((n,) + src.shape[1:], dtype=src.dtype)
    return out.index_add_(0, seg, src)

def _pad(x, pw):
    flat = tuple((v for pair in reversed(pw) for v in pair))
    return torch.nn.functional.pad(x, flat)
kernel_name = 'standalone__conformer_family_branchformer__speech'

def setup_inputs():

    _w = lambda a: (lambda t: t.to(torch.bfloat16) if t.is_floating_point() else t)(torch.as_tensor(a))
    B, T, D, K = (2, 4000, 256, 5)
    s = float(D) ** (-0.5)
    return {'x': _w((lambda *s: torch.randn(*s, dtype=torch.bfloat16) * 0.05)(B, T, D)), 'w_q': _w((lambda *s: torch.randn(*s, dtype=torch.bfloat16) * 1.6)(D, D) * s), 'w_k': _w((lambda *s: torch.randn(*s, dtype=torch.bfloat16) * 1.6)(D, D) * s), 'w_v': _w((lambda *s: torch.randn(*s, dtype=torch.bfloat16) * 0.4)(D, D) * s), 'w_ao': _w((lambda *s: torch.randn(*s, dtype=torch.bfloat16) * 0.4)(D, D) * s), 'w_up': _w((lambda *s: torch.randn(*s, dtype=torch.bfloat16) * 0.8)(D, 2 * D) * s), 'dw': _w((lambda *s: torch.randn(*s, dtype=torch.bfloat16) * 0.8)(K, D) * (1.0 / K)), 'w_dn': _w((lambda *s: torch.randn(*s, dtype=torch.bfloat16) * 0.4)(D, D) * s), 'w_merge': _w((lambda *s: torch.randn(*s, dtype=torch.bfloat16) * 0.4)(2 * D, D) * s)}

def reference(x, w_q, w_k, w_v, w_ao, w_up, dw, w_dn, w_merge):
    B, T, D = x.shape
    K = dw.shape[0]
    xa = _layernorm(x, axis=-1)
    q = torch.einsum('btd,de->bte', xa, w_q)
    k = torch.einsum('btd,de->bte', xa, w_k)
    v = torch.einsum('btd,de->bte', xa, w_v)
    logits = torch.einsum('btd,bsd->bts', q, k) * float(D) ** (-0.5)
    attn = _softmax(logits, axis=-1)
    ya = torch.einsum('bts,bsd->btd', attn, v)
    ya = torch.einsum('btd,de->bte', ya, w_ao)
    xc = _layernorm(x, axis=-1)
    h = _gelu(torch.einsum('btd,de->bte', xc, w_up))
    u = h[..., :D].clone()
    g = _layernorm(h[..., D:], axis=-1)
    pad = K // 2
    gp = _pad(g, ((0, 0), (pad, pad), (0, 0)))
    conv = torch.zeros_like(g)
    for i in range(K):
        conv = conv + gp[:, i:i + T, :] * dw[i][None, None, :]
    yc = torch.einsum('btd,de->bte', u * conv, w_dn)
    merged = torch.concatenate([ya, yc], axis=-1)
    out = torch.einsum('btf,fd->btd', merged, w_merge)
    return x + out
```

```asm
; @launch grid=(256,1,1) block=(256,1,1) lds=163840
.amdgcn_target "amdgcn-amd-amdhsa--gfx950"
.text
.globl standalone__conformer_family_branchformer__speech_kernel
.p2align 8
.type standalone__conformer_family_branchformer__speech_kernel,@function
standalone__conformer_family_branchformer__speech_kernel:
s_cmp_ge_u32 s2, 256
s_cbranch_scc1 K2_END
s_load_dwordx16 s[36:51], s[0:1], 0
s_load_dwordx2 s[52:53], s[0:1], 64
s_load_dwordx2 s[54:55], s[0:1], 88
s_load_dwordx2 s[58:59], s[0:1], 80
s_load_dwordx2 s[100:101], s[0:1], 72
s_mov_b32 s98, 0
v_lshrrev_b32 v232, 6, v0
v_and_b32 v240, 63, v0
v_lshrrev_b32 v241, 5, v240
v_and_b32 v242, 31, v240
v_readfirstlane_b32 s28, v232
s_and_b32 s29, s28, 1
s_lshr_b32 s30, s28, 1
s_lshl_b32 s31, s28, 12
s_sub_u32 s35, s2, 125
s_cmp_lt_u32 s2, 125
s_cselect_b32 s35, s2, s35
s_lshl_b32 s33, s28, 1
v_add_u32 v234, 0, v241
v_and_b32 v234, 3, v234
v_lshlrev_b32 v234, 2, v234
s_add_u32 s34, s33, 0
s_and_b32 s34, s34, 3
v_or_b32 v234, s34, v234
v_xor_b32 v234, v242, v234
v_lshlrev_b32 v234, 4, v234
v_lshl_add_u32 v234, v241, 9, v234
v_add_u32 v228, s31, v234
v_add_u32 v234, 2, v241
v_and_b32 v234, 3, v234
v_lshlrev_b32 v234, 2, v234
s_add_u32 s34, s33, 0
s_and_b32 s34, s34, 3
v_or_b32 v234, s34, v234
v_xor_b32 v234, v242, v234
v_lshlrev_b32 v234, 4, v234
v_lshl_add_u32 v234, v241, 9, v234
v_add_u32 v229, s31, v234
v_add_u32 v234, 4, v241
v_and_b32 v234, 3, v234
v_lshlrev_b32 v234, 2, v234
s_add_u32 s34, s33, 1
s_and_b32 s34, s34, 3
v_or_b32 v234, s34, v234
v_xor_b32 v234, v242, v234
v_lshlrev_b32 v234, 4, v234
v_lshl_add_u32 v234, v241, 9, v234
v_add_u32 v230, s31, v234
v_add_u32 v234, 6, v241
v_and_b32 v234, 3, v234
v_lshlrev_b32 v234, 2, v234
s_add_u32 s34, s33, 1
s_and_b32 s34, s34, 3
v_or_b32 v234, s34, v234
v_xor_b32 v234, v242, v234
v_lshlrev_b32 v234, 4, v234
v_lshl_add_u32 v234, v241, 9, v234
v_add_u32 v231, s31, v234
s_waitcnt lgkmcnt(0)
s_mov_b32 s4, s58
s_mov_b32 s5, s59
s_mov_b32 s6, 256
s_mov_b32 s7, 0x20000
s_or_b32 s33, s2, s28
s_cmp_eq_u32 s33, 0
s_cbranch_scc0 K1_NOTAG
s_memrealtime s[56:57]
s_waitcnt lgkmcnt(0)
s_or_b32 s56, s56, 1
v_mov_b32 v234, s56
buffer_store_dword v234, off, s[4:7], 0 sc1
K1_NOTAG:
s_cmp_lt_u32 s2, 250
s_cbranch_scc0 K1_NOX
s_add_u32 s16, s36, 0x0
s_addc_u32 s17, s37, 0
s_mov_b32 s18, 0x3e8000
s_mov_b32 s19, 0x20000
s_lshl_b32 s32, s35, 15
s_add_u32 m0, s31, 0x20000
s_nop 0
buffer_load_dwordx4 v228, s[16:19], s32 offen offset:0 lds
buffer_load_dwordx4 v229, s[16:19], s32 offen offset:1024 lds
buffer_load_dwordx4 v230, s[16:19], s32 offen offset:2048 lds
buffer_load_dwordx4 v231, s[16:19], s32 offen offset:3072 lds
s_add_u32 m0, s31, 0x24000
s_add_u32 s32, s32, 16384
buffer_load_dwordx4 v228, s[16:19], s32 offen offset:0 lds
buffer_load_dwordx4 v229, s[16:19], s32 offen offset:1024 lds
buffer_load_dwordx4 v230, s[16:19], s32 offen offset:2048 lds
buffer_load_dwordx4 v231, s[16:19], s32 offen offset:3072 lds
v_lshlrev_b32 v232, 4, v240
s_cmp_lt_u32 s2, 128
s_cbranch_scc0 K1_NOX
s_lshr_b32 s33, s2, 3
s_lshl_b32 s33, s33, 2
s_add_u32 s33, s33, s28
s_getpc_b64 s[56:57]
K1_PCREF:
s_add_u32 s56, s56, K1_NOX-K1_PCREF
s_addc_u32 s57, s57, 0
s_lshl_b32 s34, s33, 10
v_add_u32 v233, s34, v232
s_cmp_lt_u32 s34, 61440
s_cbranch_scc0 K1_NOIPF
global_load_dwordx4 v[252:255], v233, s[56:57]
K1_NOIPF:
s_mov_b32 s8, s40
s_mov_b32 s9, s41
s_mov_b32 s10, 131072
s_mov_b32 s11, 0x20000
s_lshl_b32 s34, s33, 11
buffer_load_dwordx4 v[100:103], v232, s[8:11], s34 offen
buffer_load_dwordx4 v[104:107], v232, s[8:11], s34 offen offset:1024
s_mov_b32 s8, s46
s_mov_b32 s9, s47
s_mov_b32 s10, 262144
v_lshl_add_u32 v233, v241, 10, 0
v_lshl_add_u32 v233, v242, 4, v233
s_lshl_b32 s34, s33, 12
s_add_u32 s34, s34, 0
buffer_load_dwordx4 v[88:91], v233, s[8:11], s34 offen
buffer_load_dwordx4 v[92:95], v233, s[8:11], s34 offen offset:2048
s_mov_b32 s10, 131072
s_and_b32 s33, s2, 7
s_cmp_lt_u32 s33, 2
s_cbranch_scc1 K1_NOX
s_lshr_b32 s34, s2, 3
s_add_u32 s56, s52, 131072
s_addc_u32 s57, s53, 0
s_cmp_ge_u32 s33, 6
s_cselect_b32 s8, s50, s44
s_cselect_b32 s9, s51, s45
s_cselect_b32 s56, s56, s42
s_cselect_b32 s57, s57, s43
s_cmp_lt_u32 s34, 8
s_cselect_b32 s8, s8, s56
s_cselect_b32 s9, s9, s57
s_and_b32 s34, s34, 7
s_lshl_b32 s34, s34, 14
s_lshl_b32 s33, s28, 12
s_add_u32 s34, s34, s33
buffer_load_dwordx4 v[108:111], v232, s[8:11], s34 offen offset:0
buffer_load_dwordx4 v[112:115], v232, s[8:11], s34 offen offset:1024
buffer_load_dwordx4 v[116:119], v232, s[8:11], s34 offen offset:2048
buffer_load_dwordx4 v[120:123], v232, s[8:11], s34 offen offset:3072
K1_NOX:
s_cmp_lt_u32 s2, 125
s_cbranch_scc1 K1_UG
s_cmp_lt_u32 s2, 250
s_cbranch_scc1 K1_Q
s_cmp_lt_u32 s2, 254
s_cbranch_scc1 K1_W1
s_branch K1_W2
K1_Q:
v_mov_b32 v224, v228
v_mov_b32 v225, v229
v_mov_b32 v226, v230
v_mov_b32 v227, v231
s_add_u32 s8, s38, 0x0
s_addc_u32 s9, s39, 0
s_mov_b32 s10, 0x20000
s_mov_b32 s11, 0x20000
s_add_u32 s12, s40, 0x0
s_addc_u32 s13, s41, 0
s_mov_b32 s14, 0x20000
s_mov_b32 s15, 0x20000
s_add_u32 s20, s54, 0x0
s_addc_u32 s21, s55, 0
s_mov_b32 s22, 0x3e8000
s_mov_b32 s23, 0x20000
s_add_u32 s24, s54, 0x400000
s_addc_u32 s25, s55, 0
s_mov_b32 s26, 0x3e8000
s_mov_b32 s27, 0x20000
s_add_u32 m0, s31, 0x0
s_mov_b32 s32, 0x0
buffer_load_dwordx4 v224, s[8:11], s32 offen offset:0 lds
buffer_load_dwordx4 v225, s[8:11], s32 offen offset:1024 lds
buffer_load_dwordx4 v226, s[8:11], s32 offen offset:2048 lds
buffer_load_dwordx4 v227, s[8:11], s32 offen offset:3072 lds
s_add_u32 m0, s31, 0x4000
s_mov_b32 s32, 0x4000
buffer_load_dwordx4 v224, s[8:11], s32 offen offset:0 lds
buffer_load_dwordx4 v225, s[8:11], s32 offen offset:1024 lds
buffer_load_dwordx4 v226, s[8:11], s32 offen offset:2048 lds
buffer_load_dwordx4 v227, s[8:11], s32 offen offset:3072 lds
s_add_u32 m0, s31, 0x8000
s_mov_b32 s32, 0x8000
buffer_load_dwordx4 v224, s[8:11], s32 offen offset:0 lds
buffer_load_dwordx4 v225, s[8:11], s32 offen offset:1024 lds
buffer_load_dwordx4 v226, s[8:11], s32 offen offset:2048 lds
buffer_load_dwordx4 v227, s[8:11], s32 offen offset:3072 lds
v_and_b32 v234, 3, v242
v_lshlrev_b32 v234, 2, v234
v_bfe_u32 v235, v242, 2, 2
v_or_b32 v234, v234, v235
v_lshlrev_b32 v236, 9, v242
s_lshl_b32 s33, s29, 14
s_add_u32 s33, s33, 131072
s_lshl_b32 s34, s30, 8
s_add_u32 s33, s33, s34
v_add_u32 v236, s33, v236
v_add_u32 v235, 0, v241
v_xor_b32 v235, v235, v234
v_lshl_add_u32 v200, v235, 4, v236
v_add_u32 v235, 2, v241
v_xor_b32 v235, v235, v234
v_lshl_add_u32 v201, v235, 4, v236
v_add_u32 v235, 4, v241
v_xor_b32 v235, v235, v234
v_lshl_add_u32 v202, v235, 4, v236
v_add_u32 v235, 6, v241
v_xor_b32 v235, v235, v234
v_lshl_add_u32 v203, v235, 4, v236
v_add_u32 v235, 8, v241
v_xor_b32 v235, v235, v234
v_lshl_add_u32 v204, v235, 4, v236
v_add_u32 v235, 10, v241
v_xor_b32 v235, v235, v234
v_lshl_add_u32 v205, v235, 4, v236
v_add_u32 v235, 12, v241
v_xor_b32 v235, v235, v234
v_lshl_add_u32 v206, v235, 4, v236
v_add_u32 v235, 14, v241
v_xor_b32 v235, v235, v234
v_lshl_add_u32 v207, v235, 4, v236
v_bfe_u32 v234, v240, 4, 1
v_bfe_u32 v235, v240, 2, 2
v_bfe_u32 v236, v240, 1, 1
v_lshl_add_u32 v236, v234, 1, v236
v_and_b32 v237, 1, v240
v_lshlrev_b32 v237, 3, v237
v_lshl_add_u32 v238, v241, 3, v235
v_lshl_add_u32 v237, v238, 9, v237
s_lshl_b32 s33, s30, 8
v_add_u32 v237, s33, v237
v_lshl_add_u32 v238, v241, 1, 0
v_lshl_or_b32 v238, v235, 2, v238
v_add_u32 v239, 0, v236
v_xor_b32 v238, v238, v239
v_lshl_add_u32 v208, v238, 4, v237
v_add_u32 v216, 0x10000, v208
v_lshl_add_u32 v238, v241, 1, 1
v_lshl_or_b32 v238, v235, 2, v238
v_add_u32 v239, 0, v236
v_xor_b32 v238, v238, v239
v_lshl_add_u32 v209, v238, 4, v237
v_add_u32 v209, 2048, v209
v_add_u32 v217, 0x10000, v209
v_lshl_add_u32 v238, v241, 1, 0
v_lshl_or_b32 v238, v235, 2, v238
v_add_u32 v239, 4, v236
v_xor_b32 v238, v238, v239
v_lshl_add_u32 v210, v238, 4, v237
v_add_u32 v218, 0x10000, v210
v_lshl_add_u32 v238, v241, 1, 1
v_lshl_or_b32 v238, v235, 2, v238
v_add_u32 v239, 4, v236
v_xor_b32 v238, v238, v239
v_lshl_add_u32 v211, v238, 4, v237
v_add_u32 v211, 2048, v211
v_add_u32 v219, 0x10000, v211
v_lshl_add_u32 v238, v241, 1, 0
v_lshl_or_b32 v238, v235, 2, v238
v_add_u32 v239, 8, v236
v_xor_b32 v238, v238, v239
v_lshl_add_u32 v212, v238, 4, v237
v_add_u32 v220, 0x10000, v212
v_lshl_add_u32 v238, v241, 1, 1
v_lshl_or_b32 v238, v235, 2, v238
v_add_u32 v239, 8, v236
v_xor_b32 v238, v238, v239
v_lshl_add_u32 v213, v238, 4, v237
v_add_u32 v213, 2048, v213
v_add_u32 v221, 0x10000, v213
v_lshl_add_u32 v238, v241, 1, 0
v_lshl_or_b32 v238, v235, 2, v238
v_add_u32 v239, 12, v236
v_xor_b32 v238, v238, v239
v_lshl_add_u32 v214, v238, 4, v237
v_add_u32 v222, 0x10000, v214
v_lshl_add_u32 v238, v241, 1, 1
v_lshl_or_b32 v238, v235, 2, v238
v_add_u32 v239, 12, v236
v_xor_b32 v238, v238, v239
v_lshl_add_u32 v215, v238, 4, v237
v_add_u32 v215, 2048, v215
v_add_u32 v223, 0x10000, v215
s_waitcnt vmcnt(12)
s_barrier
ds_read_b128 v[64:67], v200
ds_read_b128 v[68:71], v201
ds_read_b128 v[72:75], v202
ds_read_b128 v[76:79], v203
ds_read_b128 v[80:83], v204
ds_read_b128 v[84:87], v205
ds_read_b128 v[88:91], v206
ds_read_b128 v[92:95], v207
s_mov_b32 s34, 0x3f803f80
v_mov_b32 v232, 0
v_mov_b32 v233, 0
v_mov_b32 v234, 0
v_mov_b32 v235, 0
s_waitcnt lgkmcnt(7)
v_dot2_f32_bf16 v232, v64, s34, v232
v_dot2_f32_bf16 v234, v64, v64, v234
v_dot2_f32_bf16 v233, v65, s34, v233
v_dot2_f32_bf16 v235, v65, v65, v235
v_dot2_f32_bf16 v232, v66, s34, v232
v_dot2_f32_bf16 v234, v66, v66, v234
s_add_u32 m0, s31, 0xc000
s_mov_b32 s32, 0xc000
buffer_load_dwordx4 v224, s[8:11], s32 offen offset:0 lds
v_dot2_f32_bf16 v233, v67, s34, v233
v_dot2_f32_bf16 v235, v67, v67, v235
s_waitcnt lgkmcnt(6)
v_dot2_f32_bf16 v232, v68, s34, v232
v_dot2_f32_bf16 v234, v68, v68, v234
v_dot2_f32_bf16 v233, v69, s34, v233
v_dot2_f32_bf16 v235, v69, v69, v235
v_dot2_f32_bf16 v232, v70, s34, v232
v_dot2_f32_bf16 v234, v70, v70, v234
v_dot2_f32_bf16 v233, v71, s34, v233
v_dot2_f32_bf16 v235, v71, v71, v235
s_waitcnt lgkmcnt(5)
buffer_load_dwordx4 v225, s[8:11], s32 offen offset:1024 lds
v_dot2_f32_bf16 v232, v72, s34, v232
v_dot2_f32_bf16 v234, v72, v72, v234
v_dot2_f32_bf16 v233, v73, s34, v233
v_dot2_f32_bf16 v235, v73, v73, v235
v_dot2_f32_bf16 v232, v74, s34, v232
v_dot2_f32_bf16 v234, v74, v74, v234
v_dot2_f32_bf16 v233, v75, s34, v233
v_dot2_f32_bf16 v235, v75, v75, v235
s_waitcnt lgkmcnt(4)
v_dot2_f32_bf16 v232, v76, s34, v232
v_dot2_f32_bf16 v234, v76, v76, v234
v_dot2_f32_bf16 v233, v77, s34, v233
buffer_load_dwordx4 v226, s[8:11], s32 offen offset:2048 lds
v_dot2_f32_bf16 v235, v77, v77, v235
v_dot2_f32_bf16 v232, v78, s34, v232
v_dot2_f32_bf16 v234, v78, v78, v234
v_dot2_f32_bf16 v233, v79, s34, v233
v_dot2_f32_bf16 v235, v79, v79, v235
s_waitcnt lgkmcnt(3)
v_dot2_f32_bf16 v232, v80, s34, v232
v_dot2_f32_bf16 v234, v80, v80, v234
v_dot2_f32_bf16 v233, v81, s34, v233
v_dot2_f32_bf16 v235, v81, v81, v235
v_dot2_f32_bf16 v232, v82, s34, v232
v_dot2_f32_bf16 v234, v82, v82, v234
buffer_load_dwordx4 v227, s[8:11], s32 offen offset:3072 lds
v_dot2_f32_bf16 v233, v83, s34, v233
v_dot2_f32_bf16 v235, v83, v83, v235
s_waitcnt lgkmcnt(2)
v_dot2_f32_bf16 v232, v84, s34, v232
v_dot2_f32_bf16 v234, v84, v84, v234
v_dot2_f32_bf16 v233, v85, s34, v233
v_dot2_f32_bf16 v235, v85, v85, v235
v_dot2_f32_bf16 v232, v86, s34, v232
v_dot2_f32_bf16 v234, v86, v86, v234
v_dot2_f32_bf16 v233, v87, s34, v233
v_dot2_f32_bf16 v235, v87, v87, v235
s_waitcnt lgkmcnt(1)
s_add_u32 m0, s31, 0x10000
s_mov_b32 s32, 0x10000
buffer_load_dwordx4 v224, s[8:11], s32 offen offset:0 lds
v_dot2_f32_bf16 v232, v88, s34, v232
v_dot2_f32_bf16 v234, v88, v88, v234
v_dot2_f32_bf16 v233, v89, s34, v233
v_dot2_f32_bf16 v235, v89, v89, v235
v_dot2_f32_bf16 v232, v90, s34, v232
v_dot2_f32_bf16 v234, v90, v90, v234
v_dot2_f32_bf16 v233, v91, s34, v233
v_dot2_f32_bf16 v235, v91, v91, v235
s_waitcnt lgkmcnt(0)
v_dot2_f32_bf16 v232, v92, s34, v232
v_dot2_f32_bf16 v234, v92, v92, v234
v_dot2_f32_bf16 v233, v93, s34, v233
buffer_load_dwordx4 v225, s[8:11], s32 offen offset:1024 lds
v_dot2_f32_bf16 v235, v93, v93, v235
v_dot2_f32_bf16 v232, v94, s34, v232
v_dot2_f32_bf16 v234, v94, v94, v234
v_dot2_f32_bf16 v233, v95, s34, v233
v_dot2_f32_bf16 v235, v95, v95, v235
s_nop 2
v_add_f32 v232, v232, v233
v_add_f32 v234, v234, v235
v_mov_b32 v233, v232
v_mov_b32 v235, v234
s_nop 1
v_permlane32_swap_b32 v232, v233
buffer_load_dwordx4 v226, s[8:11], s32 offen offset:2048 lds
v_permlane32_swap_b32 v234, v235
s_nop 1
v_add_f32 v232, v232, v233
v_add_f32 v233, v234, v235
ds_write_b64 v200, v[232:233]
v_xor_b32 v238, 256, v200
s_waitcnt lgkmcnt(0)
s_barrier
ds_read_b64 v[234:235], v238
s_waitcnt lgkmcnt(0)
v_add_f32 v232, v232, v234
v_add_f32 v234, v233, v235
buffer_load_dwordx4 v227, s[8:11], s32 offen offset:3072 lds
v_mul_f32 v232, 0x3b800000, v232
v_mul_f32 v234, 0x3b800000, v234
v_fma_f32 v234, -v232, v232, v234
v_max_f32 v234, 0, v234
v_add_f32 v234, 0x3727c5ac, v234
v_rsq_f32 v234, v234
s_nop 0
v_mul_f32 v236, v232, v234
v_sub_f32 v236, 0, v236
s_barrier
v_lshlrev_b32 v244, 16, v64
v_and_b32 v245, 0xffff0000, v64
s_add_u32 m0, s31, 0x14000
s_mov_b32 s32, 0x14000
buffer_load_dwordx4 v224, s[8:11], s32 offen offset:0 lds
v_pk_fma_f32 v[244:245], v[244:245], v[234:235], v[236:237] op_sel_hi:[1,0,0]
v_cvt_pk_bf16_f32 v64, v244, v245
v_lshlrev_b32 v246, 16, v65
v_and_b32 v247, 0xffff0000, v65
v_pk_fma_f32 v[246:247], v[246:247], v[234:235], v[236:237] op_sel_hi:[1,0,0]
v_cvt_pk_bf16_f32 v65, v246, v247
v_lshlrev_b32 v248, 16, v66
v_and_b32 v249, 0xffff0000, v66
v_pk_fma_f32 v[248:249], v[248:249], v[234:235], v[236:237] op_sel_hi:[1,0,0]
v_cvt_pk_bf16_f32 v66, v248, v249
v_lshlrev_b32 v250, 16, v67
v_and_b32 v251, 0xffff0000, v67
buffer_load_dwordx4 v225, s[8:11], s32 offen offset:1024 lds
v_pk_fma_f32 v[250:251], v[250:251], v[234:235], v[236:237] op_sel_hi:[1,0,0]
v_cvt_pk_bf16_f32 v67, v250, v251
ds_write_b128 v200, v[64:67]
v_lshlrev_b32 v244, 16, v68
v_and_b32 v245, 0xffff0000, v68
v_pk_fma_f32 v[244:245], v[244:245], v[234:235], v[236:237] op_sel_hi:[1,0,0]
v_cvt_pk_bf16_f32 v68, v244, v245
v_lshlrev_b32 v246, 16, v69
v_and_b32 v247, 0xffff0000, v69
v_pk_fma_f32 v[246:247], v[246:247], v[234:235], v[236:237] op_sel_hi:[1,0,0]
v_cvt_pk_bf16_f32 v69, v246, v247
v_lshlrev_b32 v248, 16, v70
buffer_load_dwordx4 v226, s[8:11], s32 offen offset:2048 lds
v_and_b32 v249, 0xffff0000, v70
v_pk_fma_f32 v[248:249], v[248:249], v[234:235], v[236:237] op_sel_hi:[1,0,0]
v_cvt_pk_bf16_f32 v70, v248, v249
v_lshlrev_b32 v250, 16, v71
v_and_b32 v251, 0xffff0000, v71
v_pk_fma_f32 v[250:251], v[250:251], v[234:235], v[236:237] op_sel_hi:[1,0,0]
v_cvt_pk_bf16_f32 v71, v250, v251
ds_write_b128 v201, v[68:71]
v_lshlrev_b32 v244, 16, v72
v_and_b32 v245, 0xffff0000, v72
v_pk_fma_f32 v[244:245], v[244:245], v[234:235], v[236:237] op_sel_hi:[1,0,0]
v_cvt_pk_bf16_f32 v72, v244, v245
buffer_load_dwordx4 v227, s[8:11], s32 offen offset:3072 lds
v_lshlrev_b32 v246, 16, v73
v_and_b32 v247, 0xffff0000, v73
v_pk_fma_f32 v[246:247], v[246:247], v[234:235], v[236:237] op_sel_hi:[1,0,0]
v_cvt_pk_bf16_f32 v73, v246, v247
v_lshlrev_b32 v248, 16, v74
v_and_b32 v249, 0xffff0000, v74
v_pk_fma_f32 v[248:249], v[248:249], v[234:235], v[236:237] op_sel_hi:[1,0,0]
v_cvt_pk_bf16_f32 v74, v248, v249
v_lshlrev_b32 v250, 16, v75
v_and_b32 v251, 0xffff0000, v75
v_pk_fma_f32 v[250:251], v[250:251], v[234:235], v[236:237] op_sel_hi:[1,0,0]
v_cvt_pk_bf16_f32 v75, v250, v251
s_add_u32 m0, s31, 0x18000
s_mov_b32 s32, 0x18000
buffer_load_dwordx4 v224, s[8:11], s32 offen offset:0 lds
ds_write_b128 v202, v[72:75]
v_lshlrev_b32 v244, 16, v76
v_and_b32 v245, 0xffff0000, v76
v_pk_fma_f32 v[244:245], v[244:245], v[234:235], v[236:237] op_sel_hi:[1,0,0]
v_cvt_pk_bf16_f32 v76, v244, v245
v_lshlrev_b32 v246, 16, v77
v_and_b32 v247, 0xffff0000, v77
v_pk_fma_f32 v[246:247], v[246:247], v[234:235], v[236:237] op_sel_hi:[1,0,0]
v_cvt_pk_bf16_f32 v77, v246, v247
v_lshlrev_b32 v248, 16, v78
v_and_b32 v249, 0xffff0000, v78
v_pk_fma_f32 v[248:249], v[248:249], v[234:235], v[236:237] op_sel_hi:[1,0,0]
buffer_load_dwordx4 v225, s[8:11], s32 offen offset:1024 lds
v_cvt_pk_bf16_f32 v78, v248, v249
v_lshlrev_b32 v250, 16, v79
v_and_b32 v251, 0xffff0000, v79
v_pk_fma_f32 v[250:251], v[250:251], v[234:235], v[236:237] op_sel_hi:[1,0,0]
v_cvt_pk_bf16_f32 v79, v250, v251
ds_write_b128 v203, v[76:79]
v_lshlrev_b32 v244, 16, v80
v_and_b32 v245, 0xffff0000, v80
v_pk_fma_f32 v[244:245], v[244:245], v[234:235], v[236:237] op_sel_hi:[1,0,0]
v_cvt_pk_bf16_f32 v80, v244, v245
v_lshlrev_b32 v246, 16, v81
v_and_b32 v247, 0xffff0000, v81
buffer_load_dwordx4 v226, s[8:11], s32 offen offset:2048 lds
v_pk_fma_f32 v[246:247], v[246:247], v[234:235], v[236:237] op_sel_hi:[1,0,0]
v_cvt_pk_bf16_f32 v81, v246, v247
v_lshlrev_b32 v248, 16, v82
v_and_b32 v249, 0xffff0000, v82
v_pk_fma_f32 v[248:249], v[248:249], v[234:235], v[236:237] op_sel_hi:[1,0,0]
v_cvt_pk_bf16_f32 v82, v248, v249
v_lshlrev_b32 v250, 16, v83
v_and_b32 v251, 0xffff0000, v83
v_pk_fma_f32 v[250:251], v[250:251], v[234:235], v[236:237] op_sel_hi:[1,0,0]
v_cvt_pk_bf16_f32 v83, v250, v251
ds_write_b128 v204, v[80:83]
v_lshlrev_b32 v244, 16, v84
buffer_load_dwordx4 v227, s[8:11], s32 offen offset:3072 lds
v_and_b32 v245, 0xffff0000, v84
v_pk_fma_f32 v[244:245], v[244:245], v[234:235], v[236:237] op_sel_hi:[1,0,0]
v_cvt_pk_bf16_f32 v84, v244, v245
v_lshlrev_b32 v246, 16, v85
v_and_b32 v247, 0xffff0000, v85
v_pk_fma_f32 v[246:247], v[246:247], v[234:235], v[236:237] op_sel_hi:[1,0,0]
v_cvt_pk_bf16_f32 v85, v246, v247
v_lshlrev_b32 v248, 16, v86
v_and_b32 v249, 0xffff0000, v86
v_pk_fma_f32 v[248:249], v[248:249], v[234:235], v[236:237] op_sel_hi:[1,0,0]
v_cvt_pk_bf16_f32 v86, v248, v249
v_lshlrev_b32 v250, 16, v87
s_add_u32 m0, s31, 0x1c000
s_mov_b32 s32, 0x1c000
buffer_load_dwordx4 v224, s[8:11], s32 offen offset:0 lds
v_and_b32 v251, 0xffff0000, v87
v_pk_fma_f32 v[250:251], v[250:251], v[234:235], v[236:237] op_sel_hi:[1,0,0]
v_cvt_pk_bf16_f32 v87, v250, v251
ds_write_b128 v205, v[84:87]
v_lshlrev_b32 v244, 16, v88
v_and_b32 v245, 0xffff0000, v88
v_pk_fma_f32 v[244:245], v[244:245], v[234:235], v[236:237] op_sel_hi:[1,0,0]
v_cvt_pk_bf16_f32 v88, v244, v245
v_lshlrev_b32 v246, 16, v89
v_and_b32 v247, 0xffff0000, v89
v_pk_fma_f32 v[246:247], v[246:247], v[234:235], v[236:237] op_sel_hi:[1,0,0]
v_cvt_pk_bf16_f32 v89, v246, v247
buffer_load_dwordx4 v225, s[8:11], s32 offen offset:1024 lds
v_lshlrev_b32 v248, 16, v90
v_and_b32 v249, 0xffff0000, v90
v_pk_fma_f32 v[248:249], v[248:249], v[234:235], v[236:237] op_sel_hi:[1,0,0]
v_cvt_pk_bf16_f32 v90, v248, v249
v_lshlrev_b32 v250, 16, v91
v_and_b32 v251, 0xffff0000, v91
v_pk_fma_f32 v[250:251], v[250:251], v[234:235], v[236:237] op_sel_hi:[1,0,0]
v_cvt_pk_bf16_f32 v91, v250, v251
ds_write_b128 v206, v[88:91]
v_lshlrev_b32 v244, 16, v92
v_and_b32 v245, 0xffff0000, v92
v_pk_fma_f32 v[244:245], v[244:245], v[234:235], v[236:237] op_sel_hi:[1,0,0]
buffer_load_dwordx4 v226, s[8:11], s32 offen offset:2048 lds
v_cvt_pk_bf16_f32 v92, v244, v245
v_lshlrev_b32 v246, 16, v93
v_and_b32 v247, 0xffff0000, v93
v_pk_fma_f32 v[246:247], v[246:247], v[234:235], v[236:237] op_sel_hi:[1,0,0]
v_cvt_pk_bf16_f32 v93, v246, v247
v_lshlrev_b32 v248, 16, v94
v_and_b32 v249, 0xffff0000, v94
v_pk_fma_f32 v[248:249], v[248:249], v[234:235], v[236:237] op_sel_hi:[1,0,0]
v_cvt_pk_bf16_f32 v94, v248, v249
v_lshlrev_b32 v250, 16, v95
v_and_b32 v251, 0xffff0000, v95
v_pk_fma_f32 v[250:251], v[250:251], v[234:235], v[236:237] op_sel_hi:[1,0,0]
buffer_load_dwordx4 v227, s[8:11], s32 offen offset:3072 lds
v_cvt_pk_bf16_f32 v95, v250, v251
ds_write_b128 v207, v[92:95]
s_waitcnt lgkmcnt(0)
s_barrier
s_lshl_b32 s33, s30, 8
v_subrev_u32 v244, s33, v200
v_subrev_u32 v245, s33, v201
v_subrev_u32 v246, s33, v202
v_subrev_u32 v247, s33, v203
v_subrev_u32 v248, s33, v204
v_subrev_u32 v249, s33, v205
v_subrev_u32 v250, s33, v206
v_subrev_u32 v251, s33, v207
ds_read_b128 v[0:3], v244 offset:0
ds_read_b128 v[4:7], v245 offset:0
ds_read_b128 v[8:11], v246 offset:0
ds_read_b128 v[12:15], v247 offset:0
ds_read_b128 v[16:19], v248 offset:0
ds_read_b128 v[20:23], v249 offset:0
ds_read_b128 v[24:27], v250 offset:0
ds_read_b128 v[28:31], v251 offset:0
ds_read_b128 v[32:35], v244 offset:256
ds_read_b128 v[36:39], v245 offset:256
ds_read_b128 v[40:43], v246 offset:256
ds_read_b128 v[44:47], v247 offset:256
ds_read_b128 v[48:51], v248 offset:256
ds_read_b128 v[52:55], v249 offset:256
ds_read_b128 v[56:59], v250 offset:256
ds_read_b128 v[60:63], v251 offset:256
s_waitcnt lgkmcnt(0)
buffer_load_dword v243, off, s[4:7], 0 sc1
v_and_b32 v234, 3, v242
v_lshlrev_b32 v234, 2, v234
v_bfe_u32 v235, v242, 2, 2
v_or_b32 v234, v234, v235
v_lshlrev_b32 v236, 9, v242
s_lshl_b32 s33, s30, 14
v_add_u32 v236, s33, v236
v_add_u32 v235, 0, v241
v_xor_b32 v235, v235, v234
v_lshl_add_u32 v192, v235, 4, v236
v_add_u32 v200, 0x10000, v192
v_add_u32 v235, 2, v241
v_xor_b32 v235, v235, v234
v_lshl_add_u32 v193, v235, 4, v236
v_add_u32 v201, 0x10000, v193
v_add_u32 v235, 4, v241
v_xor_b32 v235, v235, v234
v_lshl_add_u32 v194, v235, 4, v236
v_add_u32 v202, 0x10000, v194
v_add_u32 v235, 6, v241
v_xor_b32 v235, v235, v234
v_lshl_add_u32 v195, v235, 4, v236
v_add_u32 v203, 0x10000, v195
v_add_u32 v235, 8, v241
v_xor_b32 v235, v235, v234
v_lshl_add_u32 v196, v235, 4, v236
v_add_u32 v204, 0x10000, v196
v_add_u32 v235, 10, v241
v_xor_b32 v235, v235, v234
v_lshl_add_u32 v197, v235, 4, v236
v_add_u32 v205, 0x10000, v197
v_add_u32 v235, 12, v241
v_xor_b32 v235, v235, v234
v_lshl_add_u32 v198, v235, 4, v236
v_add_u32 v206, 0x10000, v198
v_add_u32 v235, 14, v241
v_xor_b32 v235, v235, v234
v_lshl_add_u32 v199, v235, 4, v236
v_add_u32 v207, 0x10000, v199
v_lshlrev_b32 v232, 4, v240
s_add_u32 s33, s31, 131072
v_add_u32 v232, s33, v232
ds_read_b128 v[128:131], v232 offset:0
ds_read_b128 v[132:135], v232 offset:1024
ds_read_b128 v[136:139], v232 offset:2048
ds_read_b128 v[140:143], v232 offset:3072
ds_read_b128 v[144:147], v232 offset:16384
ds_read_b128 v[148:151], v232 offset:17408
ds_read_b128 v[152:155], v232 offset:18432
ds_read_b128 v[156:159], v232 offset:19456
s_waitcnt lgkmcnt(0)
s_lshl_b32 s34, s35, 15
s_add_u32 s56, s34, 16384
s_waitcnt vmcnt(25)
s_barrier
ds_read_b64_tr_b16 a[0:1], v208 offset:0
ds_read_b64_tr_b16 a[2:3], v209 offset:0
ds_read_b64_tr_b16 a[4:5], v210 offset:0
ds_read_b64_tr_b16 a[6:7], v211 offset:0
ds_read_b64_tr_b16 a[8:9], v212 offset:0
ds_read_b64_tr_b16 a[10:11], v213 offset:0
ds_read_b64_tr_b16 a[12:13], v214 offset:0
ds_read_b64_tr_b16 a[14:15], v215 offset:0
ds_read_b64_tr_b16 a[16:17], v208 offset:8192
ds_read_b64_tr_b16 a[18:19], v209 offset:8192
ds_read_b64_tr_b16 a[20:21], v210 offset:8192
ds_read_b64_tr_b16 a[22:23], v211 offset:8192
s_waitcnt lgkmcnt(8)
v_mfma_f32_32x32x16_bf16 v[64:79], a[0:3], v[0:3], 0
ds_read_b64_tr_b16 a[24:25], v212 offset:8192
ds_read_b64_tr_b16 a[26:27], v213 offset:8192
v_mfma_f32_32x32x16_bf16 v[80:95], a[4:7], v[0:3], 0
ds_read_b64_tr_b16 a[28:29], v214 offset:8192
ds_read_b64_tr_b16 a[30:31], v215 offset:8192
buffer_store_dwordx4 v[128:131], v228, s[20:23], s34 offen offset:0 sc1
s_waitcnt lgkmcnt(8)
v_mfma_f32_32x32x16_bf16 v[96:111], a[8:11], v[0:3], 0
ds_read_b64_tr_b16 a[0:1], v208 offset:16384
ds_read_b64_tr_b16 a[2:3], v209 offset:16384
v_accvgpr_write_b32 a128, 0
v_accvgpr_write_b32 a129, 0
v_accvgpr_write_b32 a130, 0
v_mfma_f32_32x32x16_bf16 v[112:127], a[12:15], v[0:3], 0
ds_read_b64_tr_b16 a[4:5], v210 offset:16384
ds_read_b64_tr_b16 a[6:7], v211 offset:16384
buffer_store_dwordx4 v[132:135], v229, s[20:23], s34 offen offset:1024 sc1
v_accvgpr_write_b32 a131, 0
v_accvgpr_write_b32 a132, 0
s_waitcnt lgkmcnt(8)
v_mfma_f32_32x32x16_bf16 v[64:79], a[16:19], v[4:7], v[64:79]
ds_read_b64_tr_b16 a[8:9], v212 offset:16384
ds_read_b64_tr_b16 a[10:11], v213 offset:16384
v_accvgpr_write_b32 a133, 0
v_accvgpr_write_b32 a134, 0
v_mfma_f32_32x32x16_bf16 v[80:95], a[20:23], v[4:7], v[80:95]
ds_read_b64_tr_b16 a[12:13], v214 offset:16384
ds_read_b64_tr_b16 a[14:15], v215 offset:16384
buffer_store_dwordx4 v[136:139], v230, s[20:23], s34 offen offset:2048 sc1
v_accvgpr_write_b32 a135, 0
v_accvgpr_write_b32 a136, 0
s_waitcnt lgkmcnt(8)
v_mfma_f32_32x32x16_bf16 v[96:111], a[24:27], v[4:7], v[96:111]
ds_read_b64_tr_b16 a[16:17], v208 offset:24576
ds_read_b64_tr_b16 a[18:19], v209 offset:24576
v_accvgpr_write_b32 a137, 0
v_accvgpr_write_b32 a138, 0
v_mfma_f32_32x32x16_bf16 v[112:127], a[28:31], v[4:7], v[112:127]
ds_read_b64_tr_b16 a[20:21], v210 offset:24576
ds_read_b64_tr_b16 a[22:23], v211 offset:24576
buffer_store_dwordx4 v[140:143], v231, s[20:23], s34 offen offset:3072 sc1
v_accvgpr_write_b32 a139, 0
v_accvgpr_write_b32 a140, 0
s_waitcnt lgkmcnt(8)
v_mfma_f32_32x32x16_bf16 v[64:79], a[0:3], v[8:11], v[64:79]
ds_read_b64_tr_b16 a[24:25], v212 offset:24576
ds_read_b64_tr_b16 a[26:27], v213 offset:24576
v_accvgpr_write_b32 a141, 0
v_accvgpr_write_b32 a142, 0
v_mfma_f32_32x32x16_bf16 v[80:95], a[4:7], v[8:11], v[80:95]
s_waitcnt vmcnt(21)
s_barrier
ds_read_b64_tr_b16 a[28:29], v214 offset:24576
ds_read_b64_tr_b16 a[30:31], v215 offset:24576
buffer_store_dwordx4 v[144:147], v228, s[20:23], s56 offen offset:0 sc1
v_accvgpr_write_b32 a143, 0
v_accvgpr_write_b32 a144, 0
s_waitcnt lgkmcnt(8)
v_mfma_f32_32x32x16_bf16 v[96:111], a[8:11], v[8:11], v[96:111]
ds_read_b64_tr_b16 a[0:1], v208 offset:32768
ds_read_b64_tr_b16 a[2:3], v209 offset:32768
v_accvgpr_write_b32 a145, 0
v_accvgpr_write_b32 a146, 0
v_mfma_f32_32x32x16_bf16 v[112:127], a[12:15], v[8:11], v[112:127]
ds_read_b64_tr_b16 a[4:5], v210 offset:32768
ds_read_b64_tr_b16 a[6:7], v211 offset:32768
buffer_store_dwordx4 v[148:151], v229, s[20:23], s56 offen offset:1024 sc1
v_accvgpr_write_b32 a147, 0
v_accvgpr_write_b32 a148, 0
s_waitcnt lgkmcnt(8)
v_mfma_f32_32x32x16_bf16 v[64:79], a[16:19], v[12:15], v[64:79]
ds_read_b64_tr_b16 a[8:9], v212 offset:32768
ds_read_b64_tr_b16 a[10:11], v213 offset:32768
v_accvgpr_write_b32 a149, 0
v_accvgpr_write_b32 a150, 0
v_mfma_f32_32x32x16_bf16 v[80:95], a[20:23], v[12:15], v[80:95]
ds_read_b64_tr_b16 a[12:13], v214 offset:32768
ds_read_b64_tr_b16 a[14:15], v215 offset:32768
buffer_store_dwordx4 v[152:155], v230, s[20:23], s56 offen offset:2048 sc1
v_accvgpr_write_b32 a151, 0
v_accvgpr_write_b32 a152, 0
s_waitcnt lgkmcnt(8)
v_mfma_f32_32x32x16_bf16 v[96:111], a[24:27], v[12:15], v[96:111]
ds_read_b64_tr_b16 a[16:17], v208 offset:40960
ds_read_b64_tr_b16 a[18:19], v209 offset:40960
v_accvgpr_write_b32 a153, 0
v_accvgpr_write_b32 a154, 0
v_mfma_f32_32x32x16_bf16 v[112:127], a[28:31], v[12:15], v[112:127]
ds_read_b64_tr_b16 a[20:21], v210 offset:40960
ds_read_b64_tr_b16 a[22:23], v211 offset:40960
buffer_store_dwordx4 v[156:159], v231, s[20:23], s56 offen offset:3072 sc1
v_accvgpr_write_b32 a155, 0
v_accvgpr_write_b32 a156, 0
s_waitcnt lgkmcnt(8)
v_mfma_f32_32x32x16_bf16 v[64:79], a[0:3], v[16:19], v[64:79]
ds_read_b64_tr_b16 a[24:25], v212 offset:40960
ds_read_b64_tr_b16 a[26:27], v213 offset:40960
v_accvgpr_write_b32 a157, 0
v_accvgpr_write_b32 a158, 0
v_mfma_f32_32x32x16_bf16 v[80:95], a[4:7], v[16:19], v[80:95]
ds_read_b64_tr_b16 a[28:29], v214 offset:40960
ds_read_b64_tr_b16 a[30:31], v215 offset:40960
v_accvgpr_write_b32 a159, 0
v_accvgpr_write_b32 a160, 0
v_accvgpr_write_b32 a161, 0
s_waitcnt lgkmcnt(8)
v_mfma_f32_32x32x16_bf16 v[96:111], a[8:11], v[16:19], v[96:111]
ds_read_b64_tr_b16 a[0:1], v208 offset:49152
ds_read_b64_tr_b16 a[2:3], v209 offset:49152
v_accvgpr_write_b32 a162, 0
v_accvgpr_write_b32 a163, 0
v_mfma_f32_32x32x16_bf16 v[112:127], a[12:15], v[16:19], v[112:127]
ds_read_b64_tr_b16 a[4:5], v210 offset:49152
ds_read_b64_tr_b16 a[6:7], v211 offset:49152
v_accvgpr_write_b32 a164, 0
v_accvgpr_write_b32 a165, 0
s_waitcnt lgkmcnt(8)
v_mfma_f32_32x32x16_bf16 v[64:79], a[16:19], v[20:23], v[64:79]
ds_read_b64_tr_b16 a[8:9], v212 offset:49152
ds_read_b64_tr_b16 a[10:11], v213 offset:49152
v_accvgpr_write_b32 a166, 0
v_accvgpr_write_b32 a167, 0
v_mfma_f32_32x32x16_bf16 v[80:95], a[20:23], v[20:23], v[80:95]
ds_read_b64_tr_b16 a[12:13], v214 offset:49152
ds_read_b64_tr_b16 a[14:15], v215 offset:49152
v_accvgpr_write_b32 a168, 0
v_accvgpr_write_b32 a169, 0
s_waitcnt lgkmcnt(8)
v_mfma_f32_32x32x16_bf16 v[96:111], a[24:27], v[20:23], v[96:111]
ds_read_b64_tr_b16 a[16:17], v208 offset:57344
ds_read_b64_tr_b16 a[18:19], v209 offset:57344
v_accvgpr_write_b32 a170, 0
v_accvgpr_write_b32 a171, 0
v_mfma_f32_32x32x16_bf16 v[112:127], a[28:31], v[20:23], v[112:127]
ds_read_b64_tr_b16 a[20:21], v210 offset:57344
ds_read_b64_tr_b16 a[22:23], v211 offset:57344
v_accvgpr_write_b32 a172, 0
v_accvgpr_write_b32 a173, 0
s_waitcnt lgkmcnt(8)
v_mfma_f32_32x32x16_bf16 v[64:79], a[0:3], v[24:27], v[64:79]
ds_read_b64_tr_b16 a[24:25], v212 offset:57344
ds_read_b64_tr_b16 a[26:27], v213 offset:57344
v_accvgpr_write_b32 a174, 0
v_accvgpr_write_b32 a175, 0
v_mfma_f32_32x32x16_bf16 v[80:95], a[4:7], v[24:27], v[80:95]
s_waitcnt vmcnt(17)
s_barrier
ds_read_b64_tr_b16 a[28:29], v214 offset:57344
ds_read_b64_tr_b16 a[30:31], v215 offset:57344
v_accvgpr_write_b32 a176, 0
v_accvgpr_write_b32 a177, 0
s_waitcnt lgkmcnt(8)
v_mfma_f32_32x32x16_bf16 v[96:111], a[8:11], v[24:27], v[96:111]
ds_read_b64_tr_b16 a[0:1], v216 offset:0
ds_read_b64_tr_b16 a[2:3], v217 offset:0
s_add_u32 m0, s31, 0x0
s_mov_b32 s32, 0x0
buffer_load_dwordx4 v224, s[12:15], s32 offen offset:0 lds
v_accvgpr_write_b32 a178, 0
v_accvgpr_write_b32 a179, 0
v_mfma_f32_32x32x16_bf16 v[112:127], a[12:15], v[24:27], v[112:127]
ds_read_b64_tr_b16 a[4:5], v218 offset:0
ds_read_b64_tr_b16 a[6:7], v219 offset:0
v_accvgpr_write_b32 a180, 0
v_accvgpr_write_b32 a181, 0
s_waitcnt lgkmcnt(8)
v_mfma_f32_32x32x16_bf16 v[64:79], a[16:19], v[28:31], v[64:79]
ds_read_b64_tr_b16 a[8:9], v220 offset:0
ds_read_b64_tr_b16 a[10:11], v221 offset:0
buffer_load_dwordx4 v225, s[12:15], s32 offen offset:1024 lds
v_accvgpr_write_b32 a182, 0
v_accvgpr_write_b32 a183, 0
v_mfma_f32_32x32x16_bf16 v[80:95], a[20:23], v[28:31], v[80:95]
ds_read_b64_tr_b16 a[12:13], v222 offset:0
ds_read_b64_tr_b16 a[14:15], v223 offset:0
v_accvgpr_write_b32 a184, 0
v_accvgpr_write_b32 a185, 0
s_waitcnt lgkmcnt(8)
v_mfma_f32_32x32x16_bf16 v[96:111], a[24:27], v[28:31], v[96:111]
ds_read_b64_tr_b16 a[16:17], v216 offset:8192
ds_read_b64_tr_b16 a[18:19], v217 offset:8192
buffer_load_dwordx4 v226, s[12:15], s32 offen offset:2048 lds
v_accvgpr_write_b32 a186, 0
v_accvgpr_write_b32 a187, 0
v_mfma_f32_32x32x16_bf16 v[112:127], a[28:31], v[28:31], v[112:127]
ds_read_b64_tr_b16 a[20:21], v218 offset:8192
ds_read_b64_tr_b16 a[22:23], v219 offset:8192
v_accvgpr_write_b32 a188, 0
v_accvgpr_write_b32 a189, 0
s_waitcnt lgkmcnt(8)
v_mfma_f32_32x32x16_bf16 v[64:79], a[0:3], v[32:35], v[64:79]
ds_read_b64_tr_b16 a[24:25], v220 offset:8192
ds_read_b64_tr_b16 a[26:27], v221 offset:8192
buffer_load_dwordx4 v227, s[12:15], s32 offen offset:3072 lds
v_accvgpr_write_b32 a190, 0
v_accvgpr_write_b32 a191, 0
v_mfma_f32_32x32x16_bf16 v[80:95], a[4:7], v[32:35], v[80:95]
ds_read_b64_tr_b16 a[28:29], v222 offset:8192
ds_read_b64_tr_b16 a[30:31], v223 offset:8192
v_accvgpr_write_b32 a192, 0
v_accvgpr_write_b32 a193, 0
v_accvgpr_write_b32 a194, 0
s_waitcnt lgkmcnt(8)
v_mfma_f32_32x32x16_bf16 v[96:111], a[8:11], v[32:35], v[96:111]
ds_read_b64_tr_b16 a[0:1], v216 offset:16384
ds_read_b64_tr_b16 a[2:3], v217 offset:16384
s_add_u32 m0, s31, 0x4000
s_mov_b32 s32, 0x4000
buffer_load_dwordx4 v224, s[12:15], s32 offen offset:0 lds
v_accvgpr_write_b32 a195, 0
v_accvgpr_write_b32 a196, 0
v_mfma_f32_32x32x16_bf16 v[112:127], a[12:15], v[32:35], v[112:127]
ds_read_b64_tr_b16 a[4:5], v218 offset:16384
ds_read_b64_tr_b16 a[6:7], v219 offset:16384
v_accvgpr_write_b32 a197, 0
v_accvgpr_write_b32 a198, 0
s_waitcnt lgkmcnt(8)
v_mfma_f32_32x32x16_bf16 v[64:79], a[16:19], v[36:39], v[64:79]
ds_read_b64_tr_b16 a[8:9], v220 offset:16384
ds_read_b64_tr_b16 a[10:11], v221 offset:16384
buffer_load_dwordx4 v225, s[12:15], s32 offen offset:1024 lds
v_accvgpr_write_b32 a199, 0
v_accvgpr_write_b32 a200, 0
v_mfma_f32_32x32x16_bf16 v[80:95], a[20:23], v[36:39], v[80:95]
ds_read_b64_tr_b16 a[12:13], v222 offset:16384
ds_read_b64_tr_b16 a[14:15], v223 offset:16384
v_accvgpr_write_b32 a201, 0
v_accvgpr_write_b32 a202, 0
s_waitcnt lgkmcnt(8)
v_mfma_f32_32x32x16_bf16 v[96:111], a[24:27], v[36:39], v[96:111]
ds_read_b64_tr_b16 a[16:17], v216 offset:24576
ds_read_b64_tr_b16 a[18:19], v217 offset:24576
buffer_load_dwordx4 v226, s[12:15], s32 offen offset:2048 lds
v_accvgpr_write_b32 a203, 0
v_accvgpr_write_b32 a204, 0
v_mfma_f32_32x32x16_bf16 v[112:127], a[28:31], v[36:39], v[112:127]
ds_read_b64_tr_b16 a[20:21], v218 offset:24576
ds_read_b64_tr_b16 a[22:23], v219 offset:24576
v_accvgpr_write_b32 a205, 0
v_accvgpr_write_b32 a206, 0
s_waitcnt lgkmcnt(8)
v_mfma_f32_32x32x16_bf16 v[64:79], a[0:3], v[40:43], v[64:79]
ds_read_b64_tr_b16 a[24:25], v220 offset:24576
ds_read_b64_tr_b16 a[26:27], v221 offset:24576
buffer_load_dwordx4 v227, s[12:15], s32 offen offset:3072 lds
v_accvgpr_write_b32 a207, 0
v_accvgpr_write_b32 a208, 0
v_mfma_f32_32x32x16_bf16 v[80:95], a[4:7], v[40:43], v[80:95]
s_waitcnt vmcnt(17)
s_barrier
ds_read_b64_tr_b16 a[28:29], v222 offset:24576
ds_read_b64_tr_b16 a[30:31], v223 offset:24576
v_accvgpr_write_b32 a209, 0
v_accvgpr_write_b32 a210, 0
s_waitcnt lgkmcnt(8)
v_mfma_f32_32x32x16_bf16 v[96:111], a[8:11], v[40:43], v[96:111]
ds_read_b64_tr_b16 a[0:1], v216 offset:32768
ds_read_b64_tr_b16 a[2:3], v217 offset:32768
s_add_u32 m0, s31, 0x8000
s_mov_b32 s32, 0x8000
buffer_load_dwordx4 v224, s[12:15], s32 offen offset:0 lds
v_accvgpr_write_b32 a211, 0
v_accvgpr_write_b32 a212, 0
v_mfma_f32_32x32x16_bf16 v[112:127], a[12:15], v[40:43], v[112:127]
ds_read_b64_tr_b16 a[4:5], v218 offset:32768
ds_read_b64_tr_b16 a[6:7], v219 offset:32768
v_accvgpr_write_b32 a213, 0
v_accvgpr_write_b32 a214, 0
s_waitcnt lgkmcnt(8)
v_mfma_f32_32x32x16_bf16 v[64:79], a[16:19], v[44:47], v[64:79]
ds_read_b64_tr_b16 a[8:9], v220 offset:32768
ds_read_b64_tr_b16 a[10:11], v221 offset:32768
buffer_load_dwordx4 v225, s[12:15], s32 offen offset:1024 lds
v_accvgpr_write_b32 a215, 0
v_accvgpr_write_b32 a216, 0
v_mfma_f32_32x32x16_bf16 v[80:95], a[20:23], v[44:47], v[80:95]
ds_read_b64_tr_b16 a[12:13], v222 offset:32768
ds_read_b64_tr_b16 a[14:15], v223 offset:32768
v_accvgpr_write_b32 a217, 0
v_accvgpr_write_b32 a218, 0
s_waitcnt lgkmcnt(8)
v_mfma_f32_32x32x16_bf16 v[96:111], a[24:27], v[44:47], v[96:111]
ds_read_b64_tr_b16 a[16:17], v216 offset:40960
ds_read_b64_tr_b16 a[18:19], v217 offset:40960
buffer_load_dwordx4 v226, s[12:15], s32 offen offset:2048 lds
v_accvgpr_write_b32 a219, 0
v_accvgpr_write_b32 a220, 0
v_mfma_f32_32x32x16_bf16 v[112:127], a[28:31], v[44:47], v[112:127]
ds_read_b64_tr_b16 a[20:21], v218 offset:40960
ds_read_b64_tr_b16 a[22:23], v219 offset:40960
v_accvgpr_write_b32 a221, 0
v_accvgpr_write_b32 a222, 0
s_waitcnt lgkmcnt(8)
v_mfma_f32_32x32x16_bf16 v[64:79], a[0:3], v[48:51], v[64:79]
ds_read_b64_tr_b16 a[24:25], v220 offset:40960
ds_read_b64_tr_b16 a[26:27], v221 offset:40960
buffer_load_dwordx4 v227, s[12:15], s32 offen offset:3072 lds
v_accvgpr_write_b32 a223, 0
v_accvgpr_write_b32 a224, 0
v_accvgpr_write_b32 a225, 0
v_mfma_f32_32x32x16_bf16 v[80:95], a[4:7], v[48:51], v[80:95]
ds_read_b64_tr_b16 a[28:29], v222 offset:40960
ds_read_b64_tr_b16 a[30:31], v223 offset:40960
v_accvgpr_write_b32 a226, 0
v_accvgpr_write_b32 a227, 0
s_waitcnt lgkmcnt(8)
v_mfma_f32_32x32x16_bf16 v[96:111], a[8:11], v[48:51], v[96:111]
ds_read_b64_tr_b16 a[0:1], v216 offset:49152
ds_read_b64_tr_b16 a[2:3], v217 offset:49152
s_add_u32 m0, s31, 0xc000
s_mov_b32 s32, 0xc000
buffer_load_dwordx4 v224, s[12:15], s32 offen offset:0 lds
v_accvgpr_write_b32 a228, 0
v_accvgpr_write_b32 a229, 0
v_mfma_f32_32x32x16_bf16 v[112:127], a[12:15], v[48:51], v[112:127]
ds_read_b64_tr_b16 a[4:5], v218 offset:49152
ds_read_b64_tr_b16 a[6:7], v219 offset:49152
v_accvgpr_write_b32 a230, 0
v_accvgpr_write_b32 a231, 0
s_waitcnt lgkmcnt(8)
v_mfma_f32_32x32x16_bf16 v[64:79], a[16:19], v[52:55], v[64:79]
ds_read_b64_tr_b16 a[8:9], v220 offset:49152
ds_read_b64_tr_b16 a[10:11], v221 offset:49152
buffer_load_dwordx4 v225, s[12:15], s32 offen offset:1024 lds
v_accvgpr_write_b32 a232, 0
v_accvgpr_write_b32 a233, 0
v_mfma_f32_32x32x16_bf16 v[80:95], a[20:23], v[52:55], v[80:95]
ds_read_b64_tr_b16 a[12:13], v222 offset:49152
ds_read_b64_tr_b16 a[14:15], v223 offset:49152
v_accvgpr_write_b32 a234, 0
v_accvgpr_write_b32 a235, 0
s_waitcnt lgkmcnt(8)
v_mfma_f32_32x32x16_bf16 v[96:111], a[24:27], v[52:55], v[96:111]
ds_read_b64_tr_b16 a[16:17], v216 offset:57344
ds_read_b64_tr_b16 a[18:19], v217 offset:57344
buffer_load_dwordx4 v226, s[12:15], s32 offen offset:2048 lds
v_accvgpr_write_b32 a236, 0
v_accvgpr_write_b32 a237, 0
v_mfma_f32_32x32x16_bf16 v[112:127], a[28:31], v[52:55], v[112:127]
ds_read_b64_tr_b16 a[20:21], v218 offset:57344
ds_read_b64_tr_b16 a[22:23], v219 offset:57344
v_accvgpr_write_b32 a238, 0
v_accvgpr_write_b32 a239, 0
s_waitcnt lgkmcnt(8)
v_mfma_f32_32x32x16_bf16 v[64:79], a[0:3], v[56:59], v[64:79]
ds_read_b64_tr_b16 a[24:25], v220 offset:57344
ds_read_b64_tr_b16 a[26:27], v221 offset:57344
buffer_load_dwordx4 v227, s[12:15], s32 offen offset:3072 lds
v_accvgpr_write_b32 a240, 0
v_accvgpr_write_b32 a241, 0
v_mfma_f32_32x32x16_bf16 v[80:95], a[4:7], v[56:59], v[80:95]
ds_read_b64_tr_b16 a[28:29], v222 offset:57344
ds_read_b64_tr_b16 a[30:31], v223 offset:57344
v_accvgpr_write_b32 a242, 0
v_accvgpr_write_b32 a243, 0
s_waitcnt lgkmcnt(8)
v_mfma_f32_32x32x16_bf16 v[96:111], a[8:11], v[56:59], v[96:111]
v_accvgpr_write_b32 a244, 0
v_accvgpr_write_b32 a245, 0
v_mfma_f32_32x32x16_bf16 v[112:127], a[12:15], v[56:59], v[112:127]
v_accvgpr_write_b32 a246, 0
v_accvgpr_write_b32 a247, 0
s_waitcnt lgkmcnt(4)
v_mfma_f32_32x32x16_bf16 v[64:79], a[16:19], v[60:63], v[64:79]
v_accvgpr_write_b32 a248, 0
v_accvgpr_write_b32 a249, 0
v_mfma_f32_32x32x16_bf16 v[80:95], a[20:23], v[60:63], v[80:95]
v_accvgpr_write_b32 a250, 0
v_accvgpr_write_b32 a251, 0
s_waitcnt lgkmcnt(0)
v_mfma_f32_32x32x16_bf16 v[96:111], a[24:27], v[60:63], v[96:111]
v_accvgpr_write_b32 a252, 0
v_accvgpr_write_b32 a253, 0
v_mfma_f32_32x32x16_bf16 v[112:127], a[28:31], v[60:63], v[112:127]
v_accvgpr_write_b32 a254, 0
v_accvgpr_write_b32 a255, 0
s_nop 15
v_lshlrev_b32 v232, 4, v240
s_lshl_b32 s33, s29, 14
s_add_u32 s33, s33, 131072
v_add_u32 v233, s33, v232
s_lshl_b32 s34, s30, 13
v_add_u32 v232, s34, v233
v_cvt_pk_bf16_f32 v244, v64, v65
v_cvt_pk_bf16_f32 v245, v66, v67
v_cvt_pk_bf16_f32 v246, v68, v69
v_cvt_pk_bf16_f32 v247, v70, v71
v_cvt_pk_bf16_f32 v248, v72, v73
v_cvt_pk_bf16_f32 v249, v74, v75
v_cvt_pk_bf16_f32 v250, v76, v77
v_cvt_pk_bf16_f32 v251, v78, v79
s_nop 1
v_permlane32_swap_b32 v244, v246
v_permlane32_swap_b32 v245, v247
v_permlane32_swap_b32 v248, v250
v_permlane32_swap_b32 v249, v251
ds_write_b128 v232, v[244:247] offset:0
ds_write_b128 v232, v[248:251] offset:1024
v_cvt_pk_bf16_f32 v0, v80, v81
v_cvt_pk_bf16_f32 v1, v82, v83
v_cvt_pk_bf16_f32 v2, v84, v85
v_cvt_pk_bf16_f32 v3, v86, v87
v_cvt_pk_bf16_f32 v4, v88, v89
v_cvt_pk_bf16_f32 v5, v90, v91
v_cvt_pk_bf16_f32 v6, v92, v93
v_cvt_pk_bf16_f32 v7, v94, v95
s_nop 1
v_permlane32_swap_b32 v0, v2
v_permlane32_swap_b32 v1, v3
v_permlane32_swap_b32 v4, v6
v_permlane32_swap_b32 v5, v7
ds_write_b128 v232, v[0:3] offset:2048
ds_write_b128 v232, v[4:7] offset:3072
v_cvt_pk_bf16_f32 v244, v96, v97
v_cvt_pk_bf16_f32 v245, v98, v99
v_cvt_pk_bf16_f32 v246, v100, v101
v_cvt_pk_bf16_f32 v247, v102, v103
v_cvt_pk_bf16_f32 v248, v104, v105
v_cvt_pk_bf16_f32 v249, v106, v107
v_cvt_pk_bf16_f32 v250, v108, v109
v_cvt_pk_bf16_f32 v251, v110, v111
s_nop 1
v_permlane32_swap_b32 v244, v246
v_permlane32_swap_b32 v245, v247
v_permlane32_swap_b32 v248, v250
v_permlane32_swap_b32 v249, v251
ds_write_b128 v232, v[244:247] offset:4096
ds_write_b128 v232, v[248:251] offset:5120
v_cvt_pk_bf16_f32 v0, v112, v113
v_cvt_pk_bf16_f32 v1, v114, v115
v_cvt_pk_bf16_f32 v2, v116, v117
v_cvt_pk_bf16_f32 v3, v118, v119
v_cvt_pk_bf16_f32 v4, v120, v121
v_cvt_pk_bf16_f32 v5, v122, v123
v_cvt_pk_bf16_f32 v6, v124, v125
v_cvt_pk_bf16_f32 v7, v126, v127
s_nop 1
v_permlane32_swap_b32 v0, v2
v_permlane32_swap_b32 v1, v3
v_permlane32_swap_b32 v4, v6
v_permlane32_swap_b32 v5, v7
ds_write_b128 v232, v[0:3] offset:6144
ds_write_b128 v232, v[4:7] offset:7168
s_waitcnt vmcnt(16)
s_waitcnt lgkmcnt(0)
s_barrier
v_readfirstlane_b32 s3, v243
s_or_b32 s33, s28, 0
s_cmp_eq_u32 s28, 0
s_cbranch_scc0 K1_Q_NOXF
s_cmp_lg_u32 s3, 0
s_cbranch_scc0 K1_Q_NOXF
s_add_u32 s16, s54, 0x1200000
s_addc_u32 s17, s55, 0
s_mov_b32 s18, 0x13000
s_mov_b32 s19, 0x20000
s_lshl_b32 s33, s35, 7
s_add_u32 s33, s33, 8196
v_mov_b32 v238, s3
v_cmp_eq_u32 vcc, 0, v240
s_and_saveexec_b64 s[56:57], vcc
buffer_store_dword v238, off, s[16:19], s33 sc1
s_mov_b64 exec, s[56:57]
K1_Q_NOXF:
ds_read_b128 v[0:3], v233 offset:0
ds_read_b128 v[4:7], v233 offset:1024
ds_read_b128 v[8:11], v233 offset:2048
ds_read_b128 v[12:15], v233 offset:3072
ds_read_b128 v[16:19], v233 offset:4096
ds_read_b128 v[20:23], v233 offset:5120
ds_read_b128 v[24:27], v233 offset:6144
ds_read_b128 v[28:31], v233 offset:7168
ds_read_b128 v[32:35], v233 offset:8192
ds_read_b128 v[36:39], v233 offset:9216
ds_read_b128 v[40:43], v233 offset:10240
ds_read_b128 v[44:47], v233 offset:11264
ds_read_b128 v[48:51], v233 offset:12288
ds_read_b128 v[52:55], v233 offset:13312
ds_read_b128 v[56:59], v233 offset:14336
ds_read_b128 v[60:63], v233 offset:15360
s_waitcnt lgkmcnt(0)
v_mov_b32 v236, 0x3db8aa3b
s_lshl_b32 s33, s35, 2
s_lshl_b32 s34, s29, 1
s_add_u32 s33, s33, s34
s_lshl_b32 s33, s33, 13
s_lshl_b32 s34, s30, 10
s_add_u32 s33, s33, s34
v_lshrrev_b32 v232, 4, v242
v_lshlrev_b32 v232, 13, v232
v_and_b32 v233, 15, v242
v_lshl_add_u32 v233, v241, 4, v233
v_lshl_add_u32 v232, v233, 4, v232
v_add_u32 v232, s33, v232
v_add_u32 v233, 2048, v232
v_add_u32 v234, 4096, v232
v_add_u32 v235, 6144, v232
s_waitcnt vmcnt(8)
s_barrier
ds_read_b128 a[0:3], v192 offset:0
s_add_u32 m0, s31, 0x10000
s_mov_b32 s32, 0x10000
buffer_load_dwordx4 v224, s[12:15], s32 offen offset:0 lds
ds_read_b128 a[4:7], v193 offset:0
ds_read_b128 a[8:11], v194 offset:0
buffer_load_dwordx4 v225, s[12:15], s32 offen offset:1024 lds
ds_read_b128 a[12:15], v195 offset:0
ds_read_b128 a[16:19], v196 offset:0
buffer_load_dwordx4 v226, s[12:15], s32 offen offset:2048 lds
ds_read_b128 a[20:23], v197 offset:0
s_waitcnt lgkmcnt(4)
v_mfma_f32_32x32x16_bf16 v[128:143], a[0:3], v[0:3], 0
ds_read_b128 a[24:27], v198 offset:0
buffer_load_dwordx4 v227, s[12:15], s32 offen offset:3072 lds
v_mfma_f32_32x32x16_bf16 v[128:143], a[4:7], v[4:7], v[128:143]
ds_read_b128 a[28:31], v199 offset:0
s_waitcnt lgkmcnt(4)
v_mfma_f32_32x32x16_bf16 v[128:143], a[8:11], v[8:11], v[128:143]
ds_read_b128 a[0:3], v192 offset:256
s_add_u32 m0, s31, 0x14000
s_mov_b32 s32, 0x14000
buffer_load_dwordx4 v224, s[12:15], s32 offen offset:0 lds
v_mfma_f32_32x32x16_bf16 v[128:143], a[12:15], v[12:15], v[128:143]
ds_read_b128 a[4:7], v193 offset:256
s_waitcnt lgkmcnt(4)
v_mfma_f32_32x32x16_bf16 v[128:143], a[16:19], v[16:19], v[128:143]
ds_read_b128 a[8:11], v194 offset:256
buffer_load_dwordx4 v225, s[12:15], s32 offen offset:1024 lds
v_mfma_f32_32x32x16_bf16 v[128:143], a[20:23], v[20:23], v[128:143]
ds_read_b128 a[12:15], v195 offset:256
s_waitcnt lgkmcnt(4)
v_mfma_f32_32x32x16_bf16 v[128:143], a[24:27], v[24:27], v[128:143]
ds_read_b128 a[16:19], v196 offset:256
buffer_load_dwordx4 v226, s[12:15], s32 offen offset:2048 lds
v_mfma_f32_32x32x16_bf16 v[128:143], a[28:31], v[28:31], v[128:143]
ds_read_b128 a[20:23], v197 offset:256
s_waitcnt lgkmcnt(4)
v_mfma_f32_32x32x16_bf16 v[128:143], a[0:3], v[32:35], v[128:143]
ds_read_b128 a[24:27], v198 offset:256
buffer_load_dwordx4 v227, s[12:15], s32 offen offset:3072 lds
v_mfma_f32_32x32x16_bf16 v[128:143], a[4:7], v[36:39], v[128:143]
s_waitcnt vmcnt(8)
s_barrier
ds_read_b128 a[28:31], v199 offset:256
s_waitcnt lgkmcnt(4)
v_mfma_f32_32x32x16_bf16 v[128:143], a[8:11], v[40:43], v[128:143]
ds_read_b128 a[0:3], v192 offset:32768
s_add_u32 m0, s31, 0x18000
s_mov_b32 s32, 0x18000
buffer_load_dwordx4 v224, s[12:15], s32 offen offset:0 lds
v_mfma_f32_32x32x16_bf16 v[128:143], a[12:15], v[44:47], v[128:143]
ds_read_b128 a[4:7], v193 offset:32768
s_waitcnt lgkmcnt(4)
v_mfma_f32_32x32x16_bf16 v[128:143], a[16:19], v[48:51], v[128:143]
ds_read_b128 a[8:11], v194 offset:32768
buffer_load_dwordx4 v225, s[12:15], s32 offen offset:1024 lds
v_mfma_f32_32x32x16_bf16 v[128:143], a[20:23], v[52:55], v[128:143]
ds_read_b128 a[12:15], v195 offset:32768
s_waitcnt lgkmcnt(4)
v_mfma_f32_32x32x16_bf16 v[128:143], a[24:27], v[56:59], v[128:143]
ds_read_b128 a[16:19], v196 offset:32768
buffer_load_dwordx4 v226, s[12:15], s32 offen offset:2048 lds
v_mfma_f32_32x32x16_bf16 v[128:143], a[28:31], v[60:63], v[128:143]
ds_read_b128 a[20:23], v197 offset:32768
s_waitcnt lgkmcnt(4)
v_mfma_f32_32x32x16_bf16 v[144:159], a[0:3], v[0:3], 0
ds_read_b128 a[24:27], v198 offset:32768
buffer_load_dwordx4 v227, s[12:15], s32 offen offset:3072 lds
v_mfma_f32_32x32x16_bf16 v[144:159], a[4:7], v[4:7], v[144:159]
ds_read_b128 a[28:31], v199 offset:32768
s_waitcnt lgkmcnt(4)
v_mfma_f32_32x32x16_bf16 v[144:159], a[8:11], v[8:11], v[144:159]
ds_read_b128 a[0:3], v192 offset:33024
s_add_u32 m0, s31, 0x1c000
s_mov_b32 s32, 0x1c000
buffer_load_dwordx4 v224, s[12:15], s32 offen offset:0 lds
v_mfma_f32_32x32x16_bf16 v[144:159], a[12:15], v[12:15], v[144:159]
ds_read_b128 a[4:7], v193 offset:33024
s_waitcnt lgkmcnt(4)
v_mfma_f32_32x32x16_bf16 v[144:159], a[16:19], v[16:19], v[144:159]
ds_read_b128 a[8:11], v194 offset:33024
v_mul_f32 v128, v128, v236
buffer_load_dwordx4 v225, s[12:15], s32 offen offset:1024 lds
v_mul_f32 v129, v129, v236
v_mul_f32 v130, v130, v236
v_mfma_f32_32x32x16_bf16 v[144:159], a[20:23], v[20:23], v[144:159]
ds_read_b128 a[12:15], v195 offset:33024
v_mul_f32 v131, v131, v236
v_mul_f32 v132, v132, v236
s_waitcnt lgkmcnt(4)
v_mfma_f32_32x32x16_bf16 v[144:159], a[24:27], v[24:27], v[144:159]
ds_read_b128 a[16:19], v196 offset:33024
v_mul_f32 v133, v133, v236
buffer_load_dwordx4 v226, s[12:15], s32 offen offset:2048 lds
v_mul_f32 v134, v134, v236
v_mul_f32 v135, v135, v236
v_mfma_f32_32x32x16_bf16 v[144:159], a[28:31], v[28:31], v[144:159]
ds_read_b128 a[20:23], v197 offset:33024
v_mul_f32 v136, v136, v236
v_mul_f32 v137, v137, v236
s_waitcnt lgkmcnt(4)
v_mfma_f32_32x32x16_bf16 v[144:159], a[0:3], v[32:35], v[144:159]
ds_read_b128 a[24:27], v198 offset:33024
v_mul_f32 v138, v138, v236
buffer_load_dwordx4 v227, s[12:15], s32 offen offset:3072 lds
v_mul_f32 v139, v139, v236
v_mul_f32 v140, v140, v236
v_mfma_f32_32x32x16_bf16 v[144:159], a[4:7], v[36:39], v[144:159]
s_waitcnt vmcnt(8)
s_barrier
ds_read_b128 a[28:31], v199 offset:33024
v_mul_f32 v141, v141, v236
v_mul_f32 v142, v142, v236
s_waitcnt lgkmcnt(4)
v_mfma_f32_32x32x16_bf16 v[144:159], a[8:11], v[40:43], v[144:159]
ds_read_b128 a[0:3], v200 offset:0
v_mul_f32 v143, v143, v236
v_cvt_pk_bf16_f32 v64, v128, v129
v_cvt_pk_bf16_f32 v65, v130, v131
v_mfma_f32_32x32x16_bf16 v[144:159], a[12:15], v[44:47], v[144:159]
ds_read_b128 a[4:7], v201 offset:0
v_cvt_pk_bf16_f32 v66, v132, v133
v_cvt_pk_bf16_f32 v67, v134, v135
s_waitcnt lgkmcnt(4)
v_mfma_f32_32x32x16_bf16 v[144:159], a[16:19], v[48:51], v[144:159]
ds_read_b128 a[8:11], v202 offset:0
v_cvt_pk_bf16_f32 v68, v136, v137
v_cvt_pk_bf16_f32 v69, v138, v139
v_cvt_pk_bf16_f32 v70, v140, v141
v_mfma_f32_32x32x16_bf16 v[144:159], a[20:23], v[52:55], v[144:159]
ds_read_b128 a[12:15], v203 offset:0
v_cvt_pk_bf16_f32 v71, v142, v143
s_nop 1
s_waitcnt lgkmcnt(4)
v_mfma_f32_32x32x16_bf16 v[144:159], a[24:27], v[56:59], v[144:159]
ds_read_b128 a[16:19], v204 offset:0
v_permlane32_swap_b32 v64, v66
v_permlane32_swap_b32 v65, v67
v_permlane32_swap_b32 v68, v70
v_mfma_f32_32x32x16_bf16 v[144:159], a[28:31], v[60:63], v[144:159]
ds_read_b128 a[20:23], v205 offset:0
v_permlane32_swap_b32 v69, v71
s_waitcnt lgkmcnt(4)
v_mfma_f32_32x32x16_bf16 v[160:175], a[0:3], v[0:3], 0
ds_read_b128 a[24:27], v206 offset:0
buffer_store_dwordx4 v[64:67], v232, s[24:27], 0 offen offset:0 sc1
v_mfma_f32_32x32x16_bf16 v[160:175], a[4:7], v[4:7], v[160:175]
ds_read_b128 a[28:31], v207 offset:0
buffer_store_dwordx4 v[68:71], v232, s[24:27], 0 offen offset:512 sc1
s_waitcnt lgkmcnt(4)
v_mfma_f32_32x32x16_bf16 v[160:175], a[8:11], v[8:11], v[160:175]
ds_read_b128 a[0:3], v200 offset:256
v_mfma_f32_32x32x16_bf16 v[160:175], a[12:15], v[12:15], v[160:175]
ds_read_b128 a[4:7], v201 offset:256
s_waitcnt lgkmcnt(4)
v_mfma_f32_32x32x16_bf16 v[160:175], a[16:19], v[16:19], v[160:175]
ds_read_b128 a[8:11], v202 offset:256
v_mul_f32 v144, v144, v236
v_mul_f32 v145, v145, v236
v_mul_f32 v146, v146, v236
v_mfma_f32_32x32x16_bf16 v[160:175], a[20:23], v[20:23], v[160:175]
ds_read_b128 a[12:15], v203 offset:256
v_mul_f32 v147, v147, v236
v_mul_f32 v148, v148, v236
s_waitcnt lgkmcnt(4)
v_mfma_f32_32x32x16_bf16 v[160:175], a[24:27], v[24:27], v[160:175]
ds_read_b128 a[16:19], v204 offset:256
v_mul_f32 v149, v149, v236
v_mul_f32 v150, v150, v236
v_mul_f32 v151, v151, v236
v_mfma_f32_32x32x16_bf16 v[160:175], a[28:31], v[28:31], v[160:175]
ds_read_b128 a[20:23], v205 offset:256
v_mul_f32 v152, v152, v236
v_mul_f32 v153, v153, v236
s_waitcnt lgkmcnt(4)
v_mfma_f32_32x32x16_bf16 v[160:175], a[0:3], v[32:35], v[160:175]
ds_read_b128 a[24:27], v206 offset:256
v_mul_f32 v154, v154, v236
v_mul_f32 v155, v155, v236
v_mul_f32 v156, v156, v236
v_mfma_f32_32x32x16_bf16 v[160:175], a[4:7], v[36:39], v[160:175]
s_waitcnt vmcnt(2)
s_barrier
ds_read_b128 a[28:31], v207 offset:256
v_mul_f32 v157, v157, v236
v_mul_f32 v158, v158, v236
s_waitcnt lgkmcnt(4)
v_mfma_f32_32x32x16_bf16 v[160:175], a[8:11], v[40:43], v[160:175]
ds_read_b128 a[0:3], v200 offset:32768
v_mul_f32 v159, v159, v236
v_cvt_pk_bf16_f32 v72, v144, v145
v_cvt_pk_bf16_f32 v73, v146, v147
v_mfma_f32_32x32x16_bf16 v[160:175], a[12:15], v[44:47], v[160:175]
ds_read_b128 a[4:7], v201 offset:32768
v_cvt_pk_bf16_f32 v74, v148, v149
v_cvt_pk_bf16_f32 v75, v150, v151
s_waitcnt lgkmcnt(4)
v_mfma_f32_32x32x16_bf16 v[160:175], a[16:19], v[48:51], v[160:175]
ds_read_b128 a[8:11], v202 offset:32768
v_cvt_pk_bf16_f32 v76, v152, v153
v_cvt_pk_bf16_f32 v77, v154, v155
v_cvt_pk_bf16_f32 v78, v156, v157
v_mfma_f32_32x32x16_bf16 v[160:175], a[20:23], v[52:55], v[160:175]
ds_read_b128 a[12:15], v203 offset:32768
v_cvt_pk_bf16_f32 v79, v158, v159
s_nop 1
s_waitcnt lgkmcnt(4)
v_mfma_f32_32x32x16_bf16 v[160:175], a[24:27], v[56:59], v[160:175]
ds_read_b128 a[16:19], v204 offset:32768
v_permlane32_swap_b32 v72, v74
v_permlane32_swap_b32 v73, v75
v_permlane32_swap_b32 v76, v78
v_mfma_f32_32x32x16_bf16 v[160:175], a[28:31], v[60:63], v[160:175]
ds_read_b128 a[20:23], v205 offset:32768
v_permlane32_swap_b32 v77, v79
s_waitcnt lgkmcnt(4)
v_mfma_f32_32x32x16_bf16 v[176:191], a[0:3], v[0:3], 0
ds_read_b128 a[24:27], v206 offset:32768
buffer_store_dwordx4 v[72:75], v233, s[24:27], 0 offen offset:0 sc1
v_mfma_f32_32x32x16_bf16 v[176:191], a[4:7], v[4:7], v[176:191]
ds_read_b128 a[28:31], v207 offset:32768
buffer_store_dwordx4 v[76:79], v233, s[24:27], 0 offen offset:512 sc1
s_waitcnt lgkmcnt(4)
v_mfma_f32_32x32x16_bf16 v[176:191], a[8:11], v[8:11], v[176:191]
ds_read_b128 a[0:3], v200 offset:33024
v_mfma_f32_32x32x16_bf16 v[176:191], a[12:15], v[12:15], v[176:191]
ds_read_b128 a[4:7], v201 offset:33024
s_waitcnt lgkmcnt(4)
v_mfma_f32_32x32x16_bf16 v[176:191], a[16:19], v[16:19], v[176:191]
ds_read_b128 a[8:11], v202 offset:33024
v_mul_f32 v160, v160, v236
v_mul_f32 v161, v161, v236
v_mul_f32 v162, v162, v236
v_mfma_f32_32x32x16_bf16 v[176:191], a[20:23], v[20:23], v[176:191]
ds_read_b128 a[12:15], v203 offset:33024
v_mul_f32 v163, v163, v236
v_mul_f32 v164, v164, v236
s_waitcnt lgkmcnt(4)
v_mfma_f32_32x32x16_bf16 v[176:191], a[24:27], v[24:27], v[176:191]
ds_read_b128 a[16:19], v204 offset:33024
v_mul_f32 v165, v165, v236
v_mul_f32 v166, v166, v236
v_mul_f32 v167, v167, v236
v_mfma_f32_32x32x16_bf16 v[176:191], a[28:31], v[28:31], v[176:191]
ds_read_b128 a[20:23], v205 offset:33024
v_mul_f32 v168, v168, v236
v_mul_f32 v169, v169, v236
s_waitcnt lgkmcnt(4)
v_mfma_f32_32x32x16_bf16 v[176:191], a[0:3], v[32:35], v[176:191]
ds_read_b128 a[24:27], v206 offset:33024
v_mul_f32 v170, v170, v236
v_mul_f32 v171, v171, v236
v_mul_f32 v172, v172, v236
v_mfma_f32_32x32x16_bf16 v[176:191], a[4:7], v[36:39], v[176:191]
ds_read_b128 a[28:31], v207 offset:33024
v_mul_f32 v173, v173, v236
v_mul_f32 v174, v174, v236
s_waitcnt lgkmcnt(4)
v_mfma_f32_32x32x16_bf16 v[176:191], a[8:11], v[40:43], v[176:191]
v_mul_f32 v175, v175, v236
v_cvt_pk_bf16_f32 v80, v160, v161
v_cvt_pk_bf16_f32 v81, v162, v163
v_mfma_f32_32x32x16_bf16 v[176:191], a[12:15], v[44:47], v[176:191]
v_cvt_pk_bf16_f32 v82, v164, v165
v_cvt_pk_bf16_f32 v83, v166, v167
s_waitcnt lgkmcnt(2)
v_mfma_f32_32x32x16_bf16 v[176:191], a[16:19], v[48:51], v[176:191]
v_cvt_pk_bf16_f32 v84, v168, v169
v_cvt_pk_bf16_f32 v85, v170, v171
v_cvt_pk_bf16_f32 v86, v172, v173
v_mfma_f32_32x32x16_bf16 v[176:191], a[20:23], v[52:55], v[176:191]
v_cvt_pk_bf16_f32 v87, v174, v175
s_nop 1
s_waitcnt lgkmcnt(0)
v_mfma_f32_32x32x16_bf16 v[176:191], a[24:27], v[56:59], v[176:191]
v_permlane32_swap_b32 v80, v82
v_permlane32_swap_b32 v81, v83
v_permlane32_swap_b32 v84, v86
v_mfma_f32_32x32x16_bf16 v[176:191], a[28:31], v[60:63], v[176:191]
v_permlane32_swap_b32 v85, v87
buffer_store_dwordx4 v[80:83], v234, s[24:27], 0 offen offset:0 sc1
buffer_store_dwordx4 v[84:87], v234, s[24:27], 0 offen offset:512 sc1
s_nop 15
v_mul_f32 v176, v176, v236
v_mul_f32 v177, v177, v236
v_mul_f32 v178, v178, v236
v_mul_f32 v179, v179, v236
v_mul_f32 v180, v180, v236
v_mul_f32 v181, v181, v236
v_mul_f32 v182, v182, v236
v_mul_f32 v183, v183, v236
v_mul_f32 v184, v184, v236
v_mul_f32 v185, v185, v236
v_mul_f32 v186, v186, v236
v_mul_f32 v187, v187, v236
v_mul_f32 v188, v188, v236
v_mul_f32 v189, v189, v236
v_mul_f32 v190, v190, v236
v_mul_f32 v191, v191, v236
v_cvt_pk_bf16_f32 v88, v176, v177
v_cvt_pk_bf16_f32 v89, v178, v179
v_cvt_pk_bf16_f32 v90, v180, v181
v_cvt_pk_bf16_f32 v91, v182, v183
v_cvt_pk_bf16_f32 v92, v184, v185
v_cvt_pk_bf16_f32 v93, v186, v187
v_cvt_pk_bf16_f32 v94, v188, v189
v_cvt_pk_bf16_f32 v95, v190, v191
s_nop 1
v_permlane32_swap_b32 v88, v90
v_permlane32_swap_b32 v89, v91
v_permlane32_swap_b32 v92, v94
v_permlane32_swap_b32 v93, v95
buffer_store_dwordx4 v[88:91], v235, s[24:27], 0 offen offset:0 sc1
buffer_store_dwordx4 v[92:95], v235, s[24:27], 0 offen offset:512 sc1
s_branch K1_FIN
K1_UG:
s_lshl_b32 s33, s28, 1
v_add_u32 v234, 0, v241
v_and_b32 v234, 3, v234
v_lshlrev_b32 v234, 2, v234
s_add_u32 s34, s33, 0
s_and_b32 s34, s34, 3
v_or_b32 v234, s34, v234
v_xor_b32 v234, v242, v234
v_lshlrev_b32 v234, 4, v234
v_lshl_add_u32 v234, v241, 10, v234
s_lshl_b32 s34, s28, 13
s_add_u32 s34, s34, 0
v_add_u32 v224, s34, v234
v_add_u32 v234, 2, v241
v_and_b32 v234, 3, v234
v_lshlrev_b32 v234, 2, v234
s_add_u32 s34, s33, 0
s_and_b32 s34, s34, 3
v_or_b32 v234, s34, v234
v_xor_b32 v234, v242, v234
v_lshlrev_b32 v234, 4, v234
v_lshl_add_u32 v234, v241, 10, v234
s_lshl_b32 s34, s28, 13
s_add_u32 s34, s34, 1024
v_add_u32 v225, s34, v234
v_add_u32 v234, 4, v241
v_and_b32 v234, 3, v234
v_lshlrev_b32 v234, 2, v234
s_add_u32 s34, s33, 1
s_and_b32 s34, s34, 3
v_or_b32 v234, s34, v234
v_xor_b32 v234, v242, v234
v_lshlrev_b32 v234, 4, v234
v_lshl_add_u32 v234, v241, 10, v234
s_lshl_b32 s34, s28, 13
s_add_u32 s34, s34, 2048
v_add_u32 v226, s34, v234
v_add_u32 v234, 6, v241
v_and_b32 v234, 3, v234
v_lshlrev_b32 v234, 2, v234
s_add_u32 s34, s33, 1
s_and_b32 s34, s34, 3
v_or_b32 v234, s34, v234
v_xor_b32 v234, v242, v234
v_lshlrev_b32 v234, 4, v234
v_lshl_add_u32 v234, v241, 10, v234
s_lshl_b32 s34, s28, 13
s_add_u32 s34, s34, 3072
v_add_u32 v227, s34, v234
s_add_u32 s8, s46, 0x0
s_addc_u32 s9, s47, 0
s_mov_b32 s10, 0x40000
s_mov_b32 s11, 0x20000
s_add_u32 s20, s54, 0x800000
s_addc_u32 s21, s55, 0
s_mov_b32 s22, 0x3e8000
s_mov_b32 s23, 0x20000
s_add_u32 s24, s54, 0xc00000
s_addc_u32 s25, s55, 0
s_mov_b32 s26, 0x3e8000
s_mov_b32 s27, 0x20000
s_add_u32 m0, s31, 0x0
s_mov_b32 s32, 0x200
buffer_load_dwordx4 v224, s[8:11], s32 offen offset:0 lds
buffer_load_dwordx4 v225, s[8:11], s32 offen offset:1024 lds
buffer_load_dwordx4 v226, s[8:11], s32 offen offset:2048 lds
buffer_load_dwordx4 v227, s[8:11], s32 offen offset:3072 lds
s_add_u32 m0, s31, 0x4000
s_mov_b32 s32, 0x8200
buffer_load_dwordx4 v224, s[8:11], s32 offen offset:0 lds
buffer_load_dwordx4 v225, s[8:11], s32 offen offset:1024 lds
buffer_load_dwordx4 v226, s[8:11], s32 offen offset:2048 lds
buffer_load_dwordx4 v227, s[8:11], s32 offen offset:3072 lds
s_add_u32 m0, s31, 0x8000
s_mov_b32 s32, 0x10200
buffer_load_dwordx4 v224, s[8:11], s32 offen offset:0 lds
buffer_load_dwordx4 v225, s[8:11], s32 offen offset:1024 lds
buffer_load_dwordx4 v226, s[8:11], s32 offen offset:2048 lds
buffer_load_dwordx4 v227, s[8:11], s32 offen offset:3072 lds
v_and_b32 v234, 3, v242
v_lshlrev_b32 v234, 2, v234
v_bfe_u32 v235, v242, 2, 2
v_or_b32 v234, v234, v235
v_lshlrev_b32 v236, 9, v242
s_lshl_b32 s33, s29, 14
s_add_u32 s33, s33, 131072
s_lshl_b32 s34, s30, 8
s_add_u32 s33, s33, s34
v_add_u32 v236, s33, v236
v_add_u32 v235, 0, v241
v_xor_b32 v235, v235, v234
v_lshl_add_u32 v200, v235, 4, v236
v_add_u32 v235, 2, v241
v_xor_b32 v235, v235, v234
v_lshl_add_u32 v201, v235, 4, v236
v_add_u32 v235, 4, v241
v_xor_b32 v235, v235, v234
v_lshl_add_u32 v202, v235, 4, v236
v_add_u32 v235, 6, v241
v_xor_b32 v235, v235, v234
v_lshl_add_u32 v203, v235, 4, v236
v_add_u32 v235, 8, v241
v_xor_b32 v235, v235, v234
v_lshl_add_u32 v204, v235, 4, v236
v_add_u32 v235, 10, v241
v_xor_b32 v235, v235, v234
v_lshl_add_u32 v205, v235, 4, v236
v_add_u32 v235, 12, v241
v_xor_b32 v235, v235, v234
v_lshl_add_u32 v206, v235, 4, v236
v_add_u32 v235, 14, v241
v_xor_b32 v235, v235, v234
v_lshl_add_u32 v207, v235, 4, v236
v_bfe_u32 v234, v240, 4, 1
v_bfe_u32 v235, v240, 2, 2
v_bfe_u32 v236, v240, 1, 1
v_lshl_add_u32 v236, v234, 1, v236
v_and_b32 v237, 1, v240
v_lshlrev_b32 v237, 3, v237
v_lshl_add_u32 v238, v241, 3, v235
v_lshl_add_u32 v237, v238, 9, v237
s_lshl_b32 s33, s30, 8
v_add_u32 v237, s33, v237
v_lshl_add_u32 v238, v241, 1, 0
v_lshl_or_b32 v238, v235, 2, v238
v_add_u32 v239, 0, v236
v_xor_b32 v238, v238, v239
v_lshl_add_u32 v208, v238, 4, v237
v_add_u32 v216, 0x10000, v208
v_lshl_add_u32 v238, v241, 1, 1
v_lshl_or_b32 v238, v235, 2, v238
v_add_u32 v239, 0, v236
v_xor_b32 v238, v238, v239
v_lshl_add_u32 v209, v238, 4, v237
v_add_u32 v209, 2048, v209
v_add_u32 v217, 0x10000, v209
v_lshl_add_u32 v238, v241, 1, 0
v_lshl_or_b32 v238, v235, 2, v238
v_add_u32 v239, 4, v236
v_xor_b32 v238, v238, v239
v_lshl_add_u32 v210, v238, 4, v237
v_add_u32 v218, 0x10000, v210
v_lshl_add_u32 v238, v241, 1, 1
v_lshl_or_b32 v238, v235, 2, v238
v_add_u32 v239, 4, v236
v_xor_b32 v238, v238, v239
v_lshl_add_u32 v211, v238, 4, v237
v_add_u32 v211, 2048, v211
v_add_u32 v219, 0x10000, v211
v_lshl_add_u32 v238, v241, 1, 0
v_lshl_or_b32 v238, v235, 2, v238
v_add_u32 v239, 8, v236
v_xor_b32 v238, v238, v239
v_lshl_add_u32 v212, v238, 4, v237
v_add_u32 v220, 0x10000, v212
v_lshl_add_u32 v238, v241, 1, 1
v_lshl_or_b32 v238, v235, 2, v238
v_add_u32 v239, 8, v236
v_xor_b32 v238, v238, v239
v_lshl_add_u32 v213, v238, 4, v237
v_add_u32 v213, 2048, v213
v_add_u32 v221, 0x10000, v213
v_lshl_add_u32 v238, v241, 1, 0
v_lshl_or_b32 v238, v235, 2, v238
v_add_u32 v239, 12, v236
v_xor_b32 v238, v238, v239
v_lshl_add_u32 v214, v238, 4, v237
v_add_u32 v222, 0x10000, v214
v_lshl_add_u32 v238, v241, 1, 1
v_lshl_or_b32 v238, v235, 2, v238
v_add_u32 v239, 12, v236
v_xor_b32 v238, v238, v239
v_lshl_add_u32 v215, v238, 4, v237
v_add_u32 v215, 2048, v215
v_add_u32 v223, 0x10000, v215
s_waitcnt vmcnt(12)
s_barrier
ds_read_b128 v[64:67], v200
ds_read_b128 v[68:71], v201
ds_read_b128 v[72:75], v202
ds_read_b128 v[76:79], v203
ds_read_b128 v[80:83], v204
ds_read_b128 v[84:87], v205
ds_read_b128 v[88:91], v206
ds_read_b128 v[92:95], v207
s_mov_b32 s34, 0x3f803f80
v_mov_b32 v232, 0
v_mov_b32 v233, 0
v_mov_b32 v234, 0
v_mov_b32 v235, 0
s_waitcnt lgkmcnt(7)
v_dot2_f32_bf16 v232, v64, s34, v232
v_dot2_f32_bf16 v234, v64, v64, v234
v_dot2_f32_bf16 v233, v65, s34, v233
v_dot2_f32_bf16 v235, v65, v65, v235
v_dot2_f32_bf16 v232, v66, s34, v232
v_dot2_f32_bf16 v234, v66, v66, v234
s_add_u32 m0, s31, 0xc000
s_mov_b32 s32, 0x18200
buffer_load_dwordx4 v224, s[8:11], s32 offen offset:0 lds
v_dot2_f32_bf16 v233, v67, s34, v233
v_dot2_f32_bf16 v235, v67, v67, v235
s_waitcnt lgkmcnt(6)
v_dot2_f32_bf16 v232, v68, s34, v232
v_dot2_f32_bf16 v234, v68, v68, v234
v_dot2_f32_bf16 v233, v69, s34, v233
v_dot2_f32_bf16 v235, v69, v69, v235
v_dot2_f32_bf16 v232, v70, s34, v232
v_dot2_f32_bf16 v234, v70, v70, v234
v_dot2_f32_bf16 v233, v71, s34, v233
v_dot2_f32_bf16 v235, v71, v71, v235
s_waitcnt lgkmcnt(5)
buffer_load_dwordx4 v225, s[8:11], s32 offen offset:1024 lds
v_dot2_f32_bf16 v232, v72, s34, v232
v_dot2_f32_bf16 v234, v72, v72, v234
v_dot2_f32_bf16 v233, v73, s34, v233
v_dot2_f32_bf16 v235, v73, v73, v235
v_dot2_f32_bf16 v232, v74, s34, v232
v_dot2_f32_bf16 v234, v74, v74, v234
v_dot2_f32_bf16 v233, v75, s34, v233
v_dot2_f32_bf16 v235, v75, v75, v235
s_waitcnt lgkmcnt(4)
v_dot2_f32_bf16 v232, v76, s34, v232
v_dot2_f32_bf16 v234, v76, v76, v234
v_dot2_f32_bf16 v233, v77, s34, v233
buffer_load_dwordx4 v226, s[8:11], s32 offen offset:2048 lds
v_dot2_f32_bf16 v235, v77, v77, v235
v_dot2_f32_bf16 v232, v78, s34, v232
v_dot2_f32_bf16 v234, v78, v78, v234
v_dot2_f32_bf16 v233, v79, s34, v233
v_dot2_f32_bf16 v235, v79, v79, v235
s_waitcnt lgkmcnt(3)
v_dot2_f32_bf16 v232, v80, s34, v232
v_dot2_f32_bf16 v234, v80, v80, v234
v_dot2_f32_bf16 v233, v81, s34, v233
v_dot2_f32_bf16 v235, v81, v81, v235
v_dot2_f32_bf16 v232, v82, s34, v232
v_dot2_f32_bf16 v234, v82, v82, v234
buffer_load_dwordx4 v227, s[8:11], s32 offen offset:3072 lds
v_dot2_f32_bf16 v233, v83, s34, v233
v_dot2_f32_bf16 v235, v83, v83, v235
s_waitcnt lgkmcnt(2)
v_dot2_f32_bf16 v232, v84, s34, v232
v_dot2_f32_bf16 v234, v84, v84, v234
v_dot2_f32_bf16 v233, v85, s34, v233
v_dot2_f32_bf16 v235, v85, v85, v235
v_dot2_f32_bf16 v232, v86, s34, v232
v_dot2_f32_bf16 v234, v86, v86, v234
v_dot2_f32_bf16 v233, v87, s34, v233
v_dot2_f32_bf16 v235, v87, v87, v235
s_waitcnt lgkmcnt(1)
s_add_u32 m0, s31, 0x10000
s_mov_b32 s32, 0x20200
buffer_load_dwordx4 v224, s[8:11], s32 offen offset:0 lds
v_dot2_f32_bf16 v232, v88, s34, v232
v_dot2_f32_bf16 v234, v88, v88, v234
v_dot2_f32_bf16 v233, v89, s34, v233
v_dot2_f32_bf16 v235, v89, v89, v235
v_dot2_f32_bf16 v232, v90, s34, v232
v_dot2_f32_bf16 v234, v90, v90, v234
v_dot2_f32_bf16 v233, v91, s34, v233
v_dot2_f32_bf16 v235, v91, v91, v235
s_waitcnt lgkmcnt(0)
v_dot2_f32_bf16 v232, v92, s34, v232
v_dot2_f32_bf16 v234, v92, v92, v234
v_dot2_f32_bf16 v233, v93, s34, v233
buffer_load_dwordx4 v225, s[8:11], s32 offen offset:1024 lds
v_dot2_f32_bf16 v235, v93, v93, v235
v_dot2_f32_bf16 v232, v94, s34, v232
v_dot2_f32_bf16 v234, v94, v94, v234
v_dot2_f32_bf16 v233, v95, s34, v233
v_dot2_f32_bf16 v235, v95, v95, v235
s_nop 2
v_add_f32 v232, v232, v233
v_add_f32 v234, v234, v235
v_mov_b32 v233, v232
v_mov_b32 v235, v234
s_nop 1
v_permlane32_swap_b32 v232, v233
buffer_load_dwordx4 v226, s[8:11], s32 offen offset:2048 lds
v_permlane32_swap_b32 v234, v235
s_nop 1
v_add_f32 v232, v232, v233
v_add_f32 v233, v234, v235
ds_write_b64 v200, v[232:233]
v_xor_b32 v238, 256, v200
s_waitcnt lgkmcnt(0)
s_barrier
ds_read_b64 v[234:235], v238
s_waitcnt lgkmcnt(0)
v_add_f32 v232, v232, v234
v_add_f32 v234, v233, v235
buffer_load_dwordx4 v227, s[8:11], s32 offen offset:3072 lds
v_mul_f32 v232, 0x3b800000, v232
v_mul_f32 v234, 0x3b800000, v234
v_fma_f32 v234, -v232, v232, v234
v_max_f32 v234, 0, v234
v_add_f32 v234, 0x3727c5ac, v234
v_rsq_f32 v234, v234
s_nop 0
v_mul_f32 v236, v232, v234
v_sub_f32 v236, 0, v236
s_barrier
v_lshlrev_b32 v244, 16, v64
v_and_b32 v245, 0xffff0000, v64
s_add_u32 m0, s31, 0x14000
s_mov_b32 s32, 0x28200
buffer_load_dwordx4 v224, s[8:11], s32 offen offset:0 lds
v_pk_fma_f32 v[244:245], v[244:245], v[234:235], v[236:237] op_sel_hi:[1,0,0]
v_cvt_pk_bf16_f32 v64, v244, v245
v_lshlrev_b32 v246, 16, v65
v_and_b32 v247, 0xffff0000, v65
v_pk_fma_f32 v[246:247], v[246:247], v[234:235], v[236:237] op_sel_hi:[1,0,0]
v_cvt_pk_bf16_f32 v65, v246, v247
v_lshlrev_b32 v248, 16, v66
v_and_b32 v249, 0xffff0000, v66
v_pk_fma_f32 v[248:249], v[248:249], v[234:235], v[236:237] op_sel_hi:[1,0,0]
v_cvt_pk_bf16_f32 v66, v248, v249
v_lshlrev_b32 v250, 16, v67
v_and_b32 v251, 0xffff0000, v67
buffer_load_dwordx4 v225, s[8:11], s32 offen offset:1024 lds
v_pk_fma_f32 v[250:251], v[250:251], v[234:235], v[236:237] op_sel_hi:[1,0,0]
v_cvt_pk_bf16_f32 v67, v250, v251
ds_write_b128 v200, v[64:67]
v_lshlrev_b32 v244, 16, v68
v_and_b32 v245, 0xffff0000, v68
v_pk_fma_f32 v[244:245], v[244:245], v[234:235], v[236:237] op_sel_hi:[1,0,0]
v_cvt_pk_bf16_f32 v68, v244, v245
v_lshlrev_b32 v246, 16, v69
v_and_b32 v247, 0xffff0000, v69
v_pk_fma_f32 v[246:247], v[246:247], v[234:235], v[236:237] op_sel_hi:[1,0,0]
v_cvt_pk_bf16_f32 v69, v246, v247
v_lshlrev_b32 v248, 16, v70
buffer_load_dwordx4 v226, s[8:11], s32 offen offset:2048 lds
v_and_b32 v249, 0xffff0000, v70
v_pk_fma_f32 v[248:249], v[248:249], v[234:235], v[236:237] op_sel_hi:[1,0,0]
v_cvt_pk_bf16_f32 v70, v248, v249
v_lshlrev_b32 v250, 16, v71
v_and_b32 v251, 0xffff0000, v71
v_pk_fma_f32 v[250:251], v[250:251], v[234:235], v[236:237] op_sel_hi:[1,0,0]
v_cvt_pk_bf16_f32 v71, v250, v251
ds_write_b128 v201, v[68:71]
v_lshlrev_b32 v244, 16, v72
v_and_b32 v245, 0xffff0000, v72
v_pk_fma_f32 v[244:245], v[244:245], v[234:235], v[236:237] op_sel_hi:[1,0,0]
v_cvt_pk_bf16_f32 v72, v244, v245
buffer_load_dwordx4 v227, s[8:11], s32 offen offset:3072 lds
v_lshlrev_b32 v246, 16, v73
v_and_b32 v247, 0xffff0000, v73
v_pk_fma_f32 v[246:247], v[246:247], v[234:235], v[236:237] op_sel_hi:[1,0,0]
v_cvt_pk_bf16_f32 v73, v246, v247
v_lshlrev_b32 v248, 16, v74
v_and_b32 v249, 0xffff0000, v74
v_pk_fma_f32 v[248:249], v[248:249], v[234:235], v[236:237] op_sel_hi:[1,0,0]
v_cvt_pk_bf16_f32 v74, v248, v249
v_lshlrev_b32 v250, 16, v75
v_and_b32 v251, 0xffff0000, v75
v_pk_fma_f32 v[250:251], v[250:251], v[234:235], v[236:237] op_sel_hi:[1,0,0]
v_cvt_pk_bf16_f32 v75, v250, v251
s_add_u32 m0, s31, 0x18000
s_mov_b32 s32, 0x30200
buffer_load_dwordx4 v224, s[8:11], s32 offen offset:0 lds
ds_write_b128 v202, v[72:75]
v_lshlrev_b32 v244, 16, v76
v_and_b32 v245, 0xffff0000, v76
v_pk_fma_f32 v[244:245], v[244:245], v[234:235], v[236:237] op_sel_hi:[1,0,0]
v_cvt_pk_bf16_f32 v76, v244, v245
v_lshlrev_b32 v246, 16, v77
v_and_b32 v247, 0xffff0000, v77
v_pk_fma_f32 v[246:247], v[246:247], v[234:235], v[236:237] op_sel_hi:[1,0,0]
v_cvt_pk_bf16_f32 v77, v246, v247
v_lshlrev_b32 v248, 16, v78
v_and_b32 v249, 0xffff0000, v78
v_pk_fma_f32 v[248:249], v[248:249], v[234:235], v[236:237] op_sel_hi:[1,0,0]
buffer_load_dwordx4 v225, s[8:11], s32 offen offset:1024 lds
v_cvt_pk_bf16_f32 v78, v248, v249
v_lshlrev_b32 v250, 16, v79
v_and_b32 v251, 0xffff0000, v79
v_pk_fma_f32 v[250:251], v[250:251], v[234:235], v[236:237] op_sel_hi:[1,0,0]
v_cvt_pk_bf16_f32 v79, v250, v251
ds_write_b128 v203, v[76:79]
v_lshlrev_b32 v244, 16, v80
v_and_b32 v245, 0xffff0000, v80
v_pk_fma_f32 v[244:245], v[244:245], v[234:235], v[236:237] op_sel_hi:[1,0,0]
v_cvt_pk_bf16_f32 v80, v244, v245
v_lshlrev_b32 v246, 16, v81
v_and_b32 v247, 0xffff0000, v81
buffer_load_dwordx4 v226, s[8:11], s32 offen offset:2048 lds
v_pk_fma_f32 v[246:247], v[246:247], v[234:235], v[236:237] op_sel_hi:[1,0,0]
v_cvt_pk_bf16_f32 v81, v246, v247
v_lshlrev_b32 v248, 16, v82
v_and_b32 v249, 0xffff0000, v82
v_pk_fma_f32 v[248:249], v[248:249], v[234:235], v[236:237] op_sel_hi:[1,0,0]
v_cvt_pk_bf16_f32 v82, v248, v249
v_lshlrev_b32 v250, 16, v83
v_and_b32 v251, 0xffff0000, v83
v_pk_fma_f32 v[250:251], v[250:251], v[234:235], v[236:237] op_sel_hi:[1,0,0]
v_cvt_pk_bf16_f32 v83, v250, v251
ds_write_b128 v204, v[80:83]
v_lshlrev_b32 v244, 16, v84
buffer_load_dwordx4 v227, s[8:11], s32 offen offset:3072 lds
v_and_b32 v245, 0xffff0000, v84
v_pk_fma_f32 v[244:245], v[244:245], v[234:235], v[236:237] op_sel_hi:[1,0,0]
v_cvt_pk_bf16_f32 v84, v244, v245
v_lshlrev_b32 v246, 16, v85
v_and_b32 v247, 0xffff0000, v85
v_pk_fma_f32 v[246:247], v[246:247], v[234:235], v[236:237] op_sel_hi:[1,0,0]
v_cvt_pk_bf16_f32 v85, v246, v247
v_lshlrev_b32 v248, 16, v86
v_and_b32 v249, 0xffff0000, v86
v_pk_fma_f32 v[248:249], v[248:249], v[234:235], v[236:237] op_sel_hi:[1,0,0]
v_cvt_pk_bf16_f32 v86, v248, v249
v_lshlrev_b32 v250, 16, v87
s_add_u32 m0, s31, 0x1c000
s_mov_b32 s32, 0x38200
buffer_load_dwordx4 v224, s[8:11], s32 offen offset:0 lds
v_and_b32 v251, 0xffff0000, v87
v_pk_fma_f32 v[250:251], v[250:251], v[234:235], v[236:237] op_sel_hi:[1,0,0]
v_cvt_pk_bf16_f32 v87, v250, v251
ds_write_b128 v205, v[84:87]
v_lshlrev_b32 v244, 16, v88
v_and_b32 v245, 0xffff0000, v88
v_pk_fma_f32 v[244:245], v[244:245], v[234:235], v[236:237] op_sel_hi:[1,0,0]
v_cvt_pk_bf16_f32 v88, v244, v245
v_lshlrev_b32 v246, 16, v89
v_and_b32 v247, 0xffff0000, v89
v_pk_fma_f32 v[246:247], v[246:247], v[234:235], v[236:237] op_sel_hi:[1,0,0]
v_cvt_pk_bf16_f32 v89, v246, v247
buffer_load_dwordx4 v225, s[8:11], s32 offen offset:1024 lds
v_lshlrev_b32 v248, 16, v90
v_and_b32 v249, 0xffff0000, v90
v_pk_fma_f32 v[248:249], v[248:249], v[234:235], v[236:237] op_sel_hi:[1,0,0]
v_cvt_pk_bf16_f32 v90, v248, v249
v_lshlrev_b32 v250, 16, v91
v_and_b32 v251, 0xffff0000, v91
v_pk_fma_f32 v[250:251], v[250:251], v[234:235], v[236:237] op_sel_hi:[1,0,0]
v_cvt_pk_bf16_f32 v91, v250, v251
ds_write_b128 v206, v[88:91]
v_lshlrev_b32 v244, 16, v92
v_and_b32 v245, 0xffff0000, v92
v_pk_fma_f32 v[244:245], v[244:245], v[234:235], v[236:237] op_sel_hi:[1,0,0]
buffer_load_dwordx4 v226, s[8:11], s32 offen offset:2048 lds
v_cvt_pk_bf16_f32 v92, v244, v245
v_lshlrev_b32 v246, 16, v93
v_and_b32 v247, 0xffff0000, v93
v_pk_fma_f32 v[246:247], v[246:247], v[234:235], v[236:237] op_sel_hi:[1,0,0]
v_cvt_pk_bf16_f32 v93, v246, v247
v_lshlrev_b32 v248, 16, v94
v_and_b32 v249, 0xffff0000, v94
v_pk_fma_f32 v[248:249], v[248:249], v[234:235], v[236:237] op_sel_hi:[1,0,0]
v_cvt_pk_bf16_f32 v94, v248, v249
v_lshlrev_b32 v250, 16, v95
v_and_b32 v251, 0xffff0000, v95
v_pk_fma_f32 v[250:251], v[250:251], v[234:235], v[236:237] op_sel_hi:[1,0,0]
buffer_load_dwordx4 v227, s[8:11], s32 offen offset:3072 lds
v_cvt_pk_bf16_f32 v95, v250, v251
ds_write_b128 v207, v[92:95]
s_waitcnt lgkmcnt(0)
s_barrier
s_lshl_b32 s33, s30, 8
v_subrev_u32 v244, s33, v200
v_subrev_u32 v245, s33, v201
v_subrev_u32 v246, s33, v202
v_subrev_u32 v247, s33, v203
v_subrev_u32 v248, s33, v204
v_subrev_u32 v249, s33, v205
v_subrev_u32 v250, s33, v206
v_subrev_u32 v251, s33, v207
ds_read_b128 v[0:3], v244 offset:0
ds_read_b128 v[4:7], v245 offset:0
ds_read_b128 v[8:11], v246 offset:0
ds_read_b128 v[12:15], v247 offset:0
ds_read_b128 v[16:19], v248 offset:0
ds_read_b128 v[20:23], v249 offset:0
ds_read_b128 v[24:27], v250 offset:0
ds_read_b128 v[28:31], v251 offset:0
ds_read_b128 v[32:35], v244 offset:256
ds_read_b128 v[36:39], v245 offset:256
ds_read_b128 v[40:43], v246 offset:256
ds_read_b128 v[44:47], v247 offset:256
ds_read_b128 v[48:51], v248 offset:256
ds_read_b128 v[52:55], v249 offset:256
ds_read_b128 v[56:59], v250 offset:256
ds_read_b128 v[60:63], v251 offset:256
s_waitcnt lgkmcnt(0)
buffer_load_dword v243, off, s[4:7], 0 sc1
s_waitcnt vmcnt(25)
s_barrier
ds_read_b64_tr_b16 a[0:1], v208 offset:0
ds_read_b64_tr_b16 a[2:3], v209 offset:0
ds_read_b64_tr_b16 a[4:5], v210 offset:0
ds_read_b64_tr_b16 a[6:7], v211 offset:0
ds_read_b64_tr_b16 a[8:9], v212 offset:0
ds_read_b64_tr_b16 a[10:11], v213 offset:0
ds_read_b64_tr_b16 a[12:13], v214 offset:0
ds_read_b64_tr_b16 a[14:15], v215 offset:0
ds_read_b64_tr_b16 a[16:17], v208 offset:8192
ds_read_b64_tr_b16 a[18:19], v209 offset:8192
ds_read_b64_tr_b16 a[20:21], v210 offset:8192
ds_read_b64_tr_b16 a[22:23], v211 offset:8192
s_waitcnt lgkmcnt(8)
v_mfma_f32_32x32x16_bf16 v[64:79], a[0:3], v[0:3], 0
ds_read_b64_tr_b16 a[24:25], v212 offset:8192
ds_read_b64_tr_b16 a[26:27], v213 offset:8192
v_mfma_f32_32x32x16_bf16 v[80:95], a[4:7], v[0:3], 0
ds_read_b64_tr_b16 a[28:29], v214 offset:8192
ds_read_b64_tr_b16 a[30:31], v215 offset:8192
s_waitcnt lgkmcnt(8)
v_mfma_f32_32x32x16_bf16 v[96:111], a[8:11], v[0:3], 0
ds_read_b64_tr_b16 a[0:1], v208 offset:16384
ds_read_b64_tr_b16 a[2:3], v209 offset:16384
v_accvgpr_write_b32 a128, 0
v_accvgpr_write_b32 a129, 0
v_accvgpr_write_b32 a130, 0
v_mfma_f32_32x32x16_bf16 v[112:127], a[12:15], v[0:3], 0
ds_read_b64_tr_b16 a[4:5], v210 offset:16384
ds_read_b64_tr_b16 a[6:7], v211 offset:16384
v_accvgpr_write_b32 a131, 0
v_accvgpr_write_b32 a132, 0
s_waitcnt lgkmcnt(8)
v_mfma_f32_32x32x16_bf16 v[64:79], a[16:19], v[4:7], v[64:79]
ds_read_b64_tr_b16 a[8:9], v212 offset:16384
ds_read_b64_tr_b16 a[10:11], v213 offset:16384
v_accvgpr_write_b32 a133, 0
v_accvgpr_write_b32 a134, 0
v_mfma_f32_32x32x16_bf16 v[80:95], a[20:23], v[4:7], v[80:95]
ds_read_b64_tr_b16 a[12:13], v214 offset:16384
ds_read_b64_tr_b16 a[14:15], v215 offset:16384
v_accvgpr_write_b32 a135, 0
v_accvgpr_write_b32 a136, 0
s_waitcnt lgkmcnt(8)
v_mfma_f32_32x32x16_bf16 v[96:111], a[24:27], v[4:7], v[96:111]
ds_read_b64_tr_b16 a[16:17], v208 offset:24576
ds_read_b64_tr_b16 a[18:19], v209 offset:24576
v_accvgpr_write_b32 a137, 0
v_accvgpr_write_b32 a138, 0
v_mfma_f32_32x32x16_bf16 v[112:127], a[28:31], v[4:7], v[112:127]
ds_read_b64_tr_b16 a[20:21], v210 offset:24576
ds_read_b64_tr_b16 a[22:23], v211 offset:24576
v_accvgpr_write_b32 a139, 0
v_accvgpr_write_b32 a140, 0
s_waitcnt lgkmcnt(8)
v_mfma_f32_32x32x16_bf16 v[64:79], a[0:3], v[8:11], v[64:79]
ds_read_b64_tr_b16 a[24:25], v212 offset:24576
ds_read_b64_tr_b16 a[26:27], v213 offset:24576
v_accvgpr_write_b32 a141, 0
v_accvgpr_write_b32 a142, 0
v_mfma_f32_32x32x16_bf16 v[80:95], a[4:7], v[8:11], v[80:95]
s_waitcnt vmcnt(17)
s_barrier
ds_read_b64_tr_b16 a[28:29], v214 offset:24576
ds_read_b64_tr_b16 a[30:31], v215 offset:24576
v_accvgpr_write_b32 a143, 0
v_accvgpr_write_b32 a144, 0
s_waitcnt lgkmcnt(8)
v_mfma_f32_32x32x16_bf16 v[96:111], a[8:11], v[8:11], v[96:111]
ds_read_b64_tr_b16 a[0:1], v208 offset:32768
ds_read_b64_tr_b16 a[2:3], v209 offset:32768
v_accvgpr_write_b32 a145, 0
v_accvgpr_write_b32 a146, 0
v_mfma_f32_32x32x16_bf16 v[112:127], a[12:15], v[8:11], v[112:127]
ds_read_b64_tr_b16 a[4:5], v210 offset:32768
ds_read_b64_tr_b16 a[6:7], v211 offset:32768
v_accvgpr_write_b32 a147, 0
v_accvgpr_write_b32 a148, 0
s_waitcnt lgkmcnt(8)
v_mfma_f32_32x32x16_bf16 v[64:79], a[16:19], v[12:15], v[64:79]
ds_read_b64_tr_b16 a[8:9], v212 offset:32768
ds_read_b64_tr_b16 a[10:11], v213 offset:32768
v_accvgpr_write_b32 a149, 0
v_accvgpr_write_b32 a150, 0
v_mfma_f32_32x32x16_bf16 v[80:95], a[20:23], v[12:15], v[80:95]
ds_read_b64_tr_b16 a[12:13], v214 offset:32768
ds_read_b64_tr_b16 a[14:15], v215 offset:32768
v_accvgpr_write_b32 a151, 0
v_accvgpr_write_b32 a152, 0
s_waitcnt lgkmcnt(8)
v_mfma_f32_32x32x16_bf16 v[96:111], a[24:27], v[12:15], v[96:111]
ds_read_b64_tr_b16 a[16:17], v208 offset:40960
ds_read_b64_tr_b16 a[18:19], v209 offset:40960
v_accvgpr_write_b32 a153, 0
v_accvgpr_write_b32 a154, 0
v_mfma_f32_32x32x16_bf16 v[112:127], a[28:31], v[12:15], v[112:127]
ds_read_b64_tr_b16 a[20:21], v210 offset:40960
ds_read_b64_tr_b16 a[22:23], v211 offset:40960
v_accvgpr_write_b32 a155, 0
v_accvgpr_write_b32 a156, 0
s_waitcnt lgkmcnt(8)
v_mfma_f32_32x32x16_bf16 v[64:79], a[0:3], v[16:19], v[64:79]
ds_read_b64_tr_b16 a[24:25], v212 offset:40960
ds_read_b64_tr_b16 a[26:27], v213 offset:40960
v_accvgpr_write_b32 a157, 0
v_accvgpr_write_b32 a158, 0
v_mfma_f32_32x32x16_bf16 v[80:95], a[4:7], v[16:19], v[80:95]
ds_read_b64_tr_b16 a[28:29], v214 offset:40960
ds_read_b64_tr_b16 a[30:31], v215 offset:40960
v_accvgpr_write_b32 a159, 0
v_accvgpr_write_b32 a160, 0
v_accvgpr_write_b32 a161, 0
s_waitcnt lgkmcnt(8)
v_mfma_f32_32x32x16_bf16 v[96:111], a[8:11], v[16:19], v[96:111]
ds_read_b64_tr_b16 a[0:1], v208 offset:49152
ds_read_b64_tr_b16 a[2:3], v209 offset:49152
v_accvgpr_write_b32 a162, 0
v_accvgpr_write_b32 a163, 0
v_mfma_f32_32x32x16_bf16 v[112:127], a[12:15], v[16:19], v[112:127]
ds_read_b64_tr_b16 a[4:5], v210 offset:49152
ds_read_b64_tr_b16 a[6:7], v211 offset:49152
v_accvgpr_write_b32 a164, 0
v_accvgpr_write_b32 a165, 0
s_waitcnt lgkmcnt(8)
v_mfma_f32_32x32x16_bf16 v[64:79], a[16:19], v[20:23], v[64:79]
ds_read_b64_tr_b16 a[8:9], v212 offset:49152
ds_read_b64_tr_b16 a[10:11], v213 offset:49152
v_accvgpr_write_b32 a166, 0
v_accvgpr_write_b32 a167, 0
v_mfma_f32_32x32x16_bf16 v[80:95], a[20:23], v[20:23], v[80:95]
ds_read_b64_tr_b16 a[12:13], v214 offset:49152
ds_read_b64_tr_b16 a[14:15], v215 offset:49152
v_accvgpr_write_b32 a168, 0
v_accvgpr_write_b32 a169, 0
s_waitcnt lgkmcnt(8)
v_mfma_f32_32x32x16_bf16 v[96:111], a[24:27], v[20:23], v[96:111]
ds_read_b64_tr_b16 a[16:17], v208 offset:57344
ds_read_b64_tr_b16 a[18:19], v209 offset:57344
v_accvgpr_write_b32 a170, 0
v_accvgpr_write_b32 a171, 0
v_mfma_f32_32x32x16_bf16 v[112:127], a[28:31], v[20:23], v[112:127]
ds_read_b64_tr_b16 a[20:21], v210 offset:57344
ds_read_b64_tr_b16 a[22:23], v211 offset:57344
v_accvgpr_write_b32 a172, 0
v_accvgpr_write_b32 a173, 0
s_waitcnt lgkmcnt(8)
v_mfma_f32_32x32x16_bf16 v[64:79], a[0:3], v[24:27], v[64:79]
ds_read_b64_tr_b16 a[24:25], v212 offset:57344
ds_read_b64_tr_b16 a[26:27], v213 offset:57344
v_accvgpr_write_b32 a174, 0
v_accvgpr_write_b32 a175, 0
v_mfma_f32_32x32x16_bf16 v[80:95], a[4:7], v[24:27], v[80:95]
s_waitcnt vmcnt(9)
s_barrier
ds_read_b64_tr_b16 a[28:29], v214 offset:57344
ds_read_b64_tr_b16 a[30:31], v215 offset:57344
v_accvgpr_write_b32 a176, 0
v_accvgpr_write_b32 a177, 0
s_waitcnt lgkmcnt(8)
v_mfma_f32_32x32x16_bf16 v[96:111], a[8:11], v[24:27], v[96:111]
ds_read_b64_tr_b16 a[0:1], v216 offset:0
ds_read_b64_tr_b16 a[2:3], v217 offset:0
s_add_u32 m0, s31, 0x0
s_mov_b32 s32, 0x0
buffer_load_dwordx4 v224, s[8:11], s32 offen offset:0 lds
v_accvgpr_write_b32 a178, 0
v_accvgpr_write_b32 a179, 0
v_mfma_f32_32x32x16_bf16 v[112:127], a[12:15], v[24:27], v[112:127]
ds_read_b64_tr_b16 a[4:5], v218 offset:0
ds_read_b64_tr_b16 a[6:7], v219 offset:0
v_accvgpr_write_b32 a180, 0
v_accvgpr_write_b32 a181, 0
s_waitcnt lgkmcnt(8)
v_mfma_f32_32x32x16_bf16 v[64:79], a[16:19], v[28:31], v[64:79]
ds_read_b64_tr_b16 a[8:9], v220 offset:0
ds_read_b64_tr_b16 a[10:11], v221 offset:0
buffer_load_dwordx4 v225, s[8:11], s32 offen offset:1024 lds
v_accvgpr_write_b32 a182, 0
v_accvgpr_write_b32 a183, 0
v_mfma_f32_32x32x16_bf16 v[80:95], a[20:23], v[28:31], v[80:95]
ds_read_b64_tr_b16 a[12:13], v222 offset:0
ds_read_b64_tr_b16 a[14:15], v223 offset:0
v_accvgpr_write_b32 a184, 0
v_accvgpr_write_b32 a185, 0
s_waitcnt lgkmcnt(8)
v_mfma_f32_32x32x16_bf16 v[96:111], a[24:27], v[28:31], v[96:111]
ds_read_b64_tr_b16 a[16:17], v216 offset:8192
ds_read_b64_tr_b16 a[18:19], v217 offset:8192
buffer_load_dwordx4 v226, s[8:11], s32 offen offset:2048 lds
v_accvgpr_write_b32 a186, 0
v_accvgpr_write_b32 a187, 0
v_mfma_f32_32x32x16_bf16 v[112:127], a[28:31], v[28:31], v[112:127]
ds_read_b64_tr_b16 a[20:21], v218 offset:8192
ds_read_b64_tr_b16 a[22:23], v219 offset:8192
v_accvgpr_write_b32 a188, 0
v_accvgpr_write_b32 a189, 0
s_waitcnt lgkmcnt(8)
v_mfma_f32_32x32x16_bf16 v[64:79], a[0:3], v[32:35], v[64:79]
ds_read_b64_tr_b16 a[24:25], v220 offset:8192
ds_read_b64_tr_b16 a[26:27], v221 offset:8192
buffer_load_dwordx4 v227, s[8:11], s32 offen offset:3072 lds
v_accvgpr_write_b32 a190, 0
v_accvgpr_write_b32 a191, 0
v_mfma_f32_32x32x16_bf16 v[80:95], a[4:7], v[32:35], v[80:95]
ds_read_b64_tr_b16 a[28:29], v222 offset:8192
ds_read_b64_tr_b16 a[30:31], v223 offset:8192
v_accvgpr_write_b32 a192, 0
v_accvgpr_write_b32 a193, 0
v_accvgpr_write_b32 a194, 0
s_waitcnt lgkmcnt(8)
v_mfma_f32_32x32x16_bf16 v[96:111], a[8:11], v[32:35], v[96:111]
ds_read_b64_tr_b16 a[0:1], v216 offset:16384
ds_read_b64_tr_b16 a[2:3], v217 offset:16384
s_add_u32 m0, s31, 0x4000
s_mov_b32 s32, 0x8000
buffer_load_dwordx4 v224, s[8:11], s32 offen offset:0 lds
v_accvgpr_write_b32 a195, 0
v_accvgpr_write_b32 a196, 0
v_mfma_f32_32x32x16_bf16 v[112:127], a[12:15], v[32:35], v[112:127]
ds_read_b64_tr_b16 a[4:5], v218 offset:16384
ds_read_b64_tr_b16 a[6:7], v219 offset:16384
v_accvgpr_write_b32 a197, 0
v_accvgpr_write_b32 a198, 0
s_waitcnt lgkmcnt(8)
v_mfma_f32_32x32x16_bf16 v[64:79], a[16:19], v[36:39], v[64:79]
ds_read_b64_tr_b16 a[8:9], v220 offset:16384
ds_read_b64_tr_b16 a[10:11], v221 offset:16384
buffer_load_dwordx4 v225, s[8:11], s32 offen offset:1024 lds
v_accvgpr_write_b32 a199, 0
v_accvgpr_write_b32 a200, 0
v_mfma_f32_32x32x16_bf16 v[80:95], a[20:23], v[36:39], v[80:95]
ds_read_b64_tr_b16 a[12:13], v222 offset:16384
ds_read_b64_tr_b16 a[14:15], v223 offset:16384
v_accvgpr_write_b32 a201, 0
v_accvgpr_write_b32 a202, 0
s_waitcnt lgkmcnt(8)
v_mfma_f32_32x32x16_bf16 v[96:111], a[24:27], v[36:39], v[96:111]
ds_read_b64_tr_b16 a[16:17], v216 offset:24576
ds_read_b64_tr_b16 a[18:19], v217 offset:24576
buffer_load_dwordx4 v226, s[8:11], s32 offen offset:2048 lds
v_accvgpr_write_b32 a203, 0
v_accvgpr_write_b32 a204, 0
v_mfma_f32_32x32x16_bf16 v[112:127], a[28:31], v[36:39], v[112:127]
ds_read_b64_tr_b16 a[20:21], v218 offset:24576
ds_read_b64_tr_b16 a[22:23], v219 offset:24576
v_accvgpr_write_b32 a205, 0
v_accvgpr_write_b32 a206, 0
s_waitcnt lgkmcnt(8)
v_mfma_f32_32x32x16_bf16 v[64:79], a[0:3], v[40:43], v[64:79]
ds_read_b64_tr_b16 a[24:25], v220 offset:24576
ds_read_b64_tr_b16 a[26:27], v221 offset:24576
buffer_load_dwordx4 v227, s[8:11], s32 offen offset:3072 lds
v_accvgpr_write_b32 a207, 0
v_accvgpr_write_b32 a208, 0
v_mfma_f32_32x32x16_bf16 v[80:95], a[4:7], v[40:43], v[80:95]
s_waitcnt vmcnt(9)
s_barrier
ds_read_b64_tr_b16 a[28:29], v222 offset:24576
ds_read_b64_tr_b16 a[30:31], v223 offset:24576
v_accvgpr_write_b32 a209, 0
v_accvgpr_write_b32 a210, 0
s_waitcnt lgkmcnt(8)
v_mfma_f32_32x32x16_bf16 v[96:111], a[8:11], v[40:43], v[96:111]
ds_read_b64_tr_b16 a[0:1], v216 offset:32768
ds_read_b64_tr_b16 a[2:3], v217 offset:32768
s_add_u32 m0, s31, 0x8000
s_mov_b32 s32, 0x10000
buffer_load_dwordx4 v224, s[8:11], s32 offen offset:0 lds
v_accvgpr_write_b32 a211, 0
v_accvgpr_write_b32 a212, 0
v_mfma_f32_32x32x16_bf16 v[112:127], a[12:15], v[40:43], v[112:127]
ds_read_b64_tr_b16 a[4:5], v218 offset:32768
ds_read_b64_tr_b16 a[6:7], v219 offset:32768
v_accvgpr_write_b32 a213, 0
v_accvgpr_write_b32 a214, 0
s_waitcnt lgkmcnt(8)
v_mfma_f32_32x32x16_bf16 v[64:79], a[16:19], v[44:47], v[64:79]
ds_read_b64_tr_b16 a[8:9], v220 offset:32768
ds_read_b64_tr_b16 a[10:11], v221 offset:32768
buffer_load_dwordx4 v225, s[8:11], s32 offen offset:1024 lds
v_accvgpr_write_b32 a215, 0
v_accvgpr_write_b32 a216, 0
v_mfma_f32_32x32x16_bf16 v[80:95], a[20:23], v[44:47], v[80:95]
ds_read_b64_tr_b16 a[12:13], v222 offset:32768
ds_read_b64_tr_b16 a[14:15], v223 offset:32768
v_accvgpr_write_b32 a217, 0
v_accvgpr_write_b32 a218, 0
s_waitcnt lgkmcnt(8)
v_mfma_f32_32x32x16_bf16 v[96:111], a[24:27], v[44:47], v[96:111]
ds_read_b64_tr_b16 a[16:17], v216 offset:40960
ds_read_b64_tr_b16 a[18:19], v217 offset:40960
buffer_load_dwordx4 v226, s[8:11], s32 offen offset:2048 lds
v_accvgpr_write_b32 a219, 0
v_accvgpr_write_b32 a220, 0
v_mfma_f32_32x32x16_bf16 v[112:127], a[28:31], v[44:47], v[112:127]
ds_read_b64_tr_b16 a[20:21], v218 offset:40960
ds_read_b64_tr_b16 a[22:23], v219 offset:40960
v_accvgpr_write_b32 a221, 0
v_accvgpr_write_b32 a222, 0
s_waitcnt lgkmcnt(8)
v_mfma_f32_32x32x16_bf16 v[64:79], a[0:3], v[48:51], v[64:79]
ds_read_b64_tr_b16 a[24:25], v220 offset:40960
ds_read_b64_tr_b16 a[26:27], v221 offset:40960
buffer_load_dwordx4 v227, s[8:11], s32 offen offset:3072 lds
v_accvgpr_write_b32 a223, 0
v_accvgpr_write_b32 a224, 0
v_accvgpr_write_b32 a225, 0
v_mfma_f32_32x32x16_bf16 v[80:95], a[4:7], v[48:51], v[80:95]
ds_read_b64_tr_b16 a[28:29], v222 offset:40960
ds_read_b64_tr_b16 a[30:31], v223 offset:40960
v_accvgpr_write_b32 a226, 0
v_accvgpr_write_b32 a227, 0
s_waitcnt lgkmcnt(8)
v_mfma_f32_32x32x16_bf16 v[96:111], a[8:11], v[48:51], v[96:111]
ds_read_b64_tr_b16 a[0:1], v216 offset:49152
ds_read_b64_tr_b16 a[2:3], v217 offset:49152
s_add_u32 m0, s31, 0xc000
s_mov_b32 s32, 0x18000
buffer_load_dwordx4 v224, s[8:11], s32 offen offset:0 lds
v_accvgpr_write_b32 a228, 0
v_accvgpr_write_b32 a229, 0
v_mfma_f32_32x32x16_bf16 v[112:127], a[12:15], v[48:51], v[112:127]
ds_read_b64_tr_b16 a[4:5], v218 offset:49152
ds_read_b64_tr_b16 a[6:7], v219 offset:49152
v_accvgpr_write_b32 a230, 0
v_accvgpr_write_b32 a231, 0
s_waitcnt lgkmcnt(8)
v_mfma_f32_32x32x16_bf16 v[64:79], a[16:19], v[52:55], v[64:79]
ds_read_b64_tr_b16 a[8:9], v220 offset:49152
ds_read_b64_tr_b16 a[10:11], v221 offset:49152
buffer_load_dwordx4 v225, s[8:11], s32 offen offset:1024 lds
v_accvgpr_write_b32 a232, 0
v_accvgpr_write_b32 a233, 0
v_mfma_f32_32x32x16_bf16 v[80:95], a[20:23], v[52:55], v[80:95]
ds_read_b64_tr_b16 a[12:13], v222 offset:49152
ds_read_b64_tr_b16 a[14:15], v223 offset:49152
v_accvgpr_write_b32 a234, 0
v_accvgpr_write_b32 a235, 0
s_waitcnt lgkmcnt(8)
v_mfma_f32_32x32x16_bf16 v[96:111], a[24:27], v[52:55], v[96:111]
ds_read_b64_tr_b16 a[16:17], v216 offset:57344
ds_read_b64_tr_b16 a[18:19], v217 offset:57344
buffer_load_dwordx4 v226, s[8:11], s32 offen offset:2048 lds
v_accvgpr_write_b32 a236, 0
v_accvgpr_write_b32 a237, 0
v_mfma_f32_32x32x16_bf16 v[112:127], a[28:31], v[52:55], v[112:127]
ds_read_b64_tr_b16 a[20:21], v218 offset:57344
ds_read_b64_tr_b16 a[22:23], v219 offset:57344
v_accvgpr_write_b32 a238, 0
v_accvgpr_write_b32 a239, 0
s_waitcnt lgkmcnt(8)
v_mfma_f32_32x32x16_bf16 v[64:79], a[0:3], v[56:59], v[64:79]
ds_read_b64_tr_b16 a[24:25], v220 offset:57344
ds_read_b64_tr_b16 a[26:27], v221 offset:57344
buffer_load_dwordx4 v227, s[8:11], s32 offen offset:3072 lds
v_accvgpr_write_b32 a240, 0
v_accvgpr_write_b32 a241, 0
v_mfma_f32_32x32x16_bf16 v[80:95], a[4:7], v[56:59], v[80:95]
ds_read_b64_tr_b16 a[28:29], v222 offset:57344
ds_read_b64_tr_b16 a[30:31], v223 offset:57344
v_accvgpr_write_b32 a242, 0
v_accvgpr_write_b32 a243, 0
s_waitcnt lgkmcnt(8)
v_mfma_f32_32x32x16_bf16 v[96:111], a[8:11], v[56:59], v[96:111]
v_accvgpr_write_b32 a244, 0
v_accvgpr_write_b32 a245, 0
v_mfma_f32_32x32x16_bf16 v[112:127], a[12:15], v[56:59], v[112:127]
v_accvgpr_write_b32 a246, 0
v_accvgpr_write_b32 a247, 0
s_waitcnt lgkmcnt(4)
v_mfma_f32_32x32x16_bf16 v[64:79], a[16:19], v[60:63], v[64:79]
v_accvgpr_write_b32 a248, 0
v_accvgpr_write_b32 a249, 0
v_mfma_f32_32x32x16_bf16 v[80:95], a[20:23], v[60:63], v[80:95]
v_accvgpr_write_b32 a250, 0
v_accvgpr_write_b32 a251, 0
s_waitcnt lgkmcnt(0)
v_mfma_f32_32x32x16_bf16 v[96:111], a[24:27], v[60:63], v[96:111]
v_accvgpr_write_b32 a252, 0
v_accvgpr_write_b32 a253, 0
v_mfma_f32_32x32x16_bf16 v[112:127], a[28:31], v[60:63], v[112:127]
v_accvgpr_write_b32 a254, 0
v_accvgpr_write_b32 a255, 0
v_mov_b32 v232, 0xc0135761
v_mov_b32 v234, 0xbdd2d3e8
v_mov_b32 v236, 1.0
v_mov_b32 v252, 0
v_mov_b32 v253, 0
v_mov_b32 v254, 0
v_mov_b32 v255, 0
s_waitcnt vmcnt(8)
s_barrier
ds_read_b64_tr_b16 a[0:1], v208 offset:0
ds_read_b64_tr_b16 a[2:3], v209 offset:0
s_add_u32 m0, s31, 0x10000
s_mov_b32 s32, 0x20000
buffer_load_dwordx4 v224, s[8:11], s32 offen offset:0 lds
ds_read_b64_tr_b16 a[4:5], v210 offset:0
ds_read_b64_tr_b16 a[6:7], v211 offset:0
ds_read_b64_tr_b16 a[8:9], v212 offset:0
ds_read_b64_tr_b16 a[10:11], v213 offset:0
buffer_load_dwordx4 v225, s[8:11], s32 offen offset:1024 lds
ds_read_b64_tr_b16 a[12:13], v214 offset:0
ds_read_b64_tr_b16 a[14:15], v215 offset:0
ds_read_b64_tr_b16 a[16:17], v208 offset:8192
ds_read_b64_tr_b16 a[18:19], v209 offset:8192
buffer_load_dwordx4 v226, s[8:11], s32 offen offset:2048 lds
ds_read_b64_tr_b16 a[20:21], v210 offset:8192
ds_read_b64_tr_b16 a[22:23], v211 offset:8192
s_waitcnt lgkmcnt(8)
v_mfma_f32_32x32x16_bf16 v[128:143], a[0:3], v[0:3], 0
ds_read_b64_tr_b16 a[24:25], v212 offset:8192
ds_read_b64_tr_b16 a[26:27], v213 offset:8192
buffer_load_dwordx4 v227, s[8:11], s32 offen offset:3072 lds
v_mfma_f32_32x32x16_bf16 v[144:159], a[4:7], v[0:3], 0
ds_read_b64_tr_b16 a[28:29], v214 offset:8192
ds_read_b64_tr_b16 a[30:31], v215 offset:8192
s_waitcnt lgkmcnt(8)
v_mfma_f32_32x32x16_bf16 v[160:175], a[8:11], v[0:3], 0
ds_read_b64_tr_b16 a[0:1], v208 offset:16384
ds_read_b64_tr_b16 a[2:3], v209 offset:16384
s_add_u32 m0, s31, 0x14000
s_mov_b32 s32, 0x28000
buffer_load_dwordx4 v224, s[8:11], s32 offen offset:0 lds
v_mfma_f32_32x32x16_bf16 v[176:191], a[12:15], v[0:3], 0
ds_read_b64_tr_b16 a[4:5], v210 offset:16384
ds_read_b64_tr_b16 a[6:7], v211 offset:16384
s_waitcnt lgkmcnt(8)
v_mfma_f32_32x32x16_bf16 v[128:143], a[16:19], v[4:7], v[128:143]
ds_read_b64_tr_b16 a[8:9], v212 offset:16384
ds_read_b64_tr_b16 a[10:11], v213 offset:16384
v_mul_f32 v244, v64, v64
buffer_load_dwordx4 v225, s[8:11], s32 offen offset:1024 lds
v_mul_f32 v246, v66, v66
v_mul_f32 v248, v68, v68
v_mul_f32 v250, v70, v70
v_mul_f32 v245, v65, v65
v_mul_f32 v247, v67, v67
v_mul_f32 v249, v69, v69
v_mul_f32 v251, v71, v71
v_fma_f32 v244, v244, v234, v232
v_fma_f32 v246, v246, v234, v232
v_mfma_f32_32x32x16_bf16 v[144:159], a[20:23], v[4:7], v[144:159]
ds_read_b64_tr_b16 a[12:13], v214 offset:16384
ds_read_b64_tr_b16 a[14:15], v215 offset:16384
v_fma_f32 v248, v248, v234, v232
v_fma_f32 v250, v250, v234, v232
v_fma_f32 v245, v245, v234, v232
v_fma_f32 v247, v247, v234, v232
v_fma_f32 v249, v249, v234, v232
v_fma_f32 v251, v251, v234, v232
v_mul_f32 v244, v244, v64
v_mul_f32 v246, v246, v66
v_mul_f32 v248, v248, v68
v_mul_f32 v250, v250, v70
s_waitcnt lgkmcnt(8)
v_mfma_f32_32x32x16_bf16 v[160:175], a[24:27], v[4:7], v[160:175]
ds_read_b64_tr_b16 a[16:17], v208 offset:24576
ds_read_b64_tr_b16 a[18:19], v209 offset:24576
buffer_load_dwordx4 v226, s[8:11], s32 offen offset:2048 lds
v_mul_f32 v245, v245, v65
v_mul_f32 v247, v247, v67
v_mul_f32 v249, v249, v69
v_mul_f32 v251, v251, v71
v_exp_f32 v244, v244
v_exp_f32 v246, v246
v_exp_f32 v248, v248
v_exp_f32 v250, v250
v_exp_f32 v245, v245
v_mfma_f32_32x32x16_bf16 v[176:191], a[28:31], v[4:7], v[176:191]
ds_read_b64_tr_b16 a[20:21], v210 offset:24576
ds_read_b64_tr_b16 a[22:23], v211 offset:24576
v_exp_f32 v247, v247
v_exp_f32 v249, v249
v_exp_f32 v251, v251
v_add_f32 v244, 1.0, v244
v_add_f32 v246, 1.0, v246
v_add_f32 v248, 1.0, v248
v_add_f32 v250, 1.0, v250
v_add_f32 v245, 1.0, v245
v_add_f32 v247, 1.0, v247
v_add_f32 v249, 1.0, v249
s_waitcnt lgkmcnt(8)
v_mfma_f32_32x32x16_bf16 v[128:143], a[0:3], v[8:11], v[128:143]
ds_read_b64_tr_b16 a[24:25], v212 offset:24576
ds_read_b64_tr_b16 a[26:27], v213 offset:24576
buffer_load_dwordx4 v227, s[8:11], s32 offen offset:3072 lds
v_add_f32 v251, 1.0, v251
v_rcp_f32 v244, v244
v_rcp_f32 v246, v246
v_rcp_f32 v248, v248
v_rcp_f32 v250, v250
v_rcp_f32 v245, v245
v_rcp_f32 v247, v247
v_rcp_f32 v249, v249
v_rcp_f32 v251, v251
v_mfma_f32_32x32x16_bf16 v[144:159], a[4:7], v[8:11], v[144:159]
s_waitcnt vmcnt(8)
s_barrier
ds_read_b64_tr_b16 a[28:29], v214 offset:24576
ds_read_b64_tr_b16 a[30:31], v215 offset:24576
v_mul_f32 v64, v64, v244
v_mul_f32 v66, v66, v246
v_mul_f32 v68, v68, v248
v_mul_f32 v70, v70, v250
v_mul_f32 v65, v65, v245
v_mul_f32 v67, v67, v247
v_mul_f32 v69, v69, v249
v_mul_f32 v71, v71, v251
v_add_f32 v252, v252, v64
v_add_f32 v252, v252, v66
s_waitcnt lgkmcnt(8)
v_mfma_f32_32x32x16_bf16 v[160:175], a[8:11], v[8:11], v[160:175]
ds_read_b64_tr_b16 a[0:1], v208 offset:32768
ds_read_b64_tr_b16 a[2:3], v209 offset:32768
s_add_u32 m0, s31, 0x18000
s_mov_b32 s32, 0x30000
buffer_load_dwordx4 v224, s[8:11], s32 offen offset:0 lds
v_add_f32 v252, v252, v68
v_add_f32 v252, v252, v70
v_add_f32 v253, v253, v65
v_add_f32 v253, v253, v67
v_add_f32 v253, v253, v69
v_add_f32 v253, v253, v71
v_fmac_f32 v254, v64, v64
v_fmac_f32 v254, v66, v66
v_fmac_f32 v254, v68, v68
v_fmac_f32 v254, v70, v70
v_mfma_f32_32x32x16_bf16 v[176:191], a[12:15], v[8:11], v[176:191]
ds_read_b64_tr_b16 a[4:5], v210 offset:32768
ds_read_b64_tr_b16 a[6:7], v211 offset:32768
v_fmac_f32 v255, v65, v65
v_fmac_f32 v255, v67, v67
v_fmac_f32 v255, v69, v69
v_fmac_f32 v255, v71, v71
v_mul_f32 v244, v72, v72
v_mul_f32 v246, v74, v74
v_mul_f32 v248, v76, v76
v_mul_f32 v250, v78, v78
v_mul_f32 v245, v73, v73
s_waitcnt lgkmcnt(8)
v_mfma_f32_32x32x16_bf16 v[128:143], a[16:19], v[12:15], v[128:143]
ds_read_b64_tr_b16 a[8:9], v212 offset:32768
ds_read_b64_tr_b16 a[10:11], v213 offset:32768
buffer_load_dwordx4 v225, s[8:11], s32 offen offset:1024 lds
v_mul_f32 v247, v75, v75
v_mul_f32 v249, v77, v77
v_mul_f32 v251, v79, v79
v_fma_f32 v244, v244, v234, v232
v_fma_f32 v246, v246, v234, v232
v_fma_f32 v248, v248, v234, v232
v_fma_f32 v250, v250, v234, v232
v_fma_f32 v245, v245, v234, v232
v_fma_f32 v247, v247, v234, v232
v_fma_f32 v249, v249, v234, v232
v_mfma_f32_32x32x16_bf16 v[144:159], a[20:23], v[12:15], v[144:159]
ds_read_b64_tr_b16 a[12:13], v214 offset:32768
ds_read_b64_tr_b16 a[14:15], v215 offset:32768
v_fma_f32 v251, v251, v234, v232
v_mul_f32 v244, v244, v72
v_mul_f32 v246, v246, v74
v_mul_f32 v248, v248, v76
v_mul_f32 v250, v250, v78
v_mul_f32 v245, v245, v73
v_mul_f32 v247, v247, v75
v_mul_f32 v249, v249, v77
v_mul_f32 v251, v251, v79
s_waitcnt lgkmcnt(8)
v_mfma_f32_32x32x16_bf16 v[160:175], a[24:27], v[12:15], v[160:175]
ds_read_b64_tr_b16 a[16:17], v208 offset:40960
ds_read_b64_tr_b16 a[18:19], v209 offset:40960
v_exp_f32 v244, v244
buffer_load_dwordx4 v226, s[8:11], s32 offen offset:2048 lds
v_exp_f32 v246, v246
v_exp_f32 v248, v248
v_exp_f32 v250, v250
v_exp_f32 v245, v245
v_exp_f32 v247, v247
v_exp_f32 v249, v249
v_exp_f32 v251, v251
v_add_f32 v244, 1.0, v244
v_add_f32 v246, 1.0, v246
v_mfma_f32_32x32x16_bf16 v[176:191], a[28:31], v[12:15], v[176:191]
ds_read_b64_tr_b16 a[20:21], v210 offset:40960
ds_read_b64_tr_b16 a[22:23], v211 offset:40960
v_add_f32 v248, 1.0, v248
v_add_f32 v250, 1.0, v250
v_add_f32 v245, 1.0, v245
v_add_f32 v247, 1.0, v247
v_add_f32 v249, 1.0, v249
v_add_f32 v251, 1.0, v251
v_rcp_f32 v244, v244
v_rcp_f32 v246, v246
v_rcp_f32 v248, v248
v_rcp_f32 v250, v250
s_waitcnt lgkmcnt(8)
v_mfma_f32_32x32x16_bf16 v[128:143], a[0:3], v[16:19], v[128:143]
ds_read_b64_tr_b16 a[24:25], v212 offset:40960
ds_read_b64_tr_b16 a[26:27], v213 offset:40960
buffer_load_dwordx4 v227, s[8:11], s32 offen offset:3072 lds
v_rcp_f32 v245, v245
v_rcp_f32 v247, v247
v_rcp_f32 v249, v249
v_rcp_f32 v251, v251
v_mul_f32 v72, v72, v244
v_mul_f32 v74, v74, v246
v_mul_f32 v76, v76, v248
v_mul_f32 v78, v78, v250
v_mul_f32 v73, v73, v245
v_mfma_f32_32x32x16_bf16 v[144:159], a[4:7], v[16:19], v[144:159]
ds_read_b64_tr_b16 a[28:29], v214 offset:40960
ds_read_b64_tr_b16 a[30:31], v215 offset:40960
v_mul_f32 v75, v75, v247
v_mul_f32 v77, v77, v249
v_mul_f32 v79, v79, v251
v_add_f32 v252, v252, v72
v_add_f32 v252, v252, v74
v_add_f32 v252, v252, v76
v_add_f32 v252, v252, v78
v_add_f32 v253, v253, v73
v_add_f32 v253, v253, v75
v_add_f32 v253, v253, v77
s_waitcnt lgkmcnt(8)
v_mfma_f32_32x32x16_bf16 v[160:175], a[8:11], v[16:19], v[160:175]
ds_read_b64_tr_b16 a[0:1], v208 offset:49152
ds_read_b64_tr_b16 a[2:3], v209 offset:49152
s_add_u32 m0, s31, 0x1c000
s_mov_b32 s32, 0x38000
buffer_load_dwordx4 v224, s[8:11], s32 offen offset:0 lds
v_add_f32 v253, v253, v79
v_fmac_f32 v254, v72, v72
v_fmac_f32 v254, v74, v74
v_fmac_f32 v254, v76, v76
v_fmac_f32 v254, v78, v78
v_fmac_f32 v255, v73, v73
v_fmac_f32 v255, v75, v75
v_fmac_f32 v255, v77, v77
v_fmac_f32 v255, v79, v79
v_mfma_f32_32x32x16_bf16 v[176:191], a[12:15], v[16:19], v[176:191]
ds_read_b64_tr_b16 a[4:5], v210 offset:49152
ds_read_b64_tr_b16 a[6:7], v211 offset:49152
v_mul_f32 v244, v80, v80
v_mul_f32 v246, v82, v82
v_mul_f32 v248, v84, v84
v_mul_f32 v250, v86, v86
v_mul_f32 v245, v81, v81
v_mul_f32 v247, v83, v83
v_mul_f32 v249, v85, v85
v_mul_f32 v251, v87, v87
v_fma_f32 v244, v244, v234, v232
v_fma_f32 v246, v246, v234, v232
s_waitcnt lgkmcnt(8)
v_mfma_f32_32x32x16_bf16 v[128:143], a[16:19], v[20:23], v[128:143]
ds_read_b64_tr_b16 a[8:9], v212 offset:49152
ds_read_b64_tr_b16 a[10:11], v213 offset:49152
buffer_load_dwordx4 v225, s[8:11], s32 offen offset:1024 lds
v_fma_f32 v248, v248, v234, v232
v_fma_f32 v250, v250, v234, v232
v_fma_f32 v245, v245, v234, v232
v_fma_f32 v247, v247, v234, v232
v_fma_f32 v249, v249, v234, v232
v_fma_f32 v251, v251, v234, v232
v_mul_f32 v244, v244, v80
v_mul_f32 v246, v246, v82
v_mul_f32 v248, v248, v84
v_mul_f32 v250, v250, v86
v_mfma_f32_32x32x16_bf16 v[144:159], a[20:23], v[20:23], v[144:159]
ds_read_b64_tr_b16 a[12:13], v214 offset:49152
ds_read_b64_tr_b16 a[14:15], v215 offset:49152
v_mul_f32 v245, v245, v81
v_mul_f32 v247, v247, v83
v_mul_f32 v249, v249, v85
v_mul_f32 v251, v251, v87
v_exp_f32 v244, v244
v_exp_f32 v246, v246
v_exp_f32 v248, v248
v_exp_f32 v250, v250
v_exp_f32 v245, v245
s_waitcnt lgkmcnt(8)
v_mfma_f32_32x32x16_bf16 v[160:175], a[24:27], v[20:23], v[160:175]
ds_read_b64_tr_b16 a[16:17], v208 offset:57344
ds_read_b64_tr_b16 a[18:19], v209 offset:57344
buffer_load_dwordx4 v226, s[8:11], s32 offen offset:2048 lds
v_exp_f32 v247, v247
v_exp_f32 v249, v249
v_exp_f32 v251, v251
v_add_f32 v244, 1.0, v244
v_add_f32 v246, 1.0, v246
v_add_f32 v248, 1.0, v248
v_add_f32 v250, 1.0, v250
v_add_f32 v245, 1.0, v245
v_add_f32 v247, 1.0, v247
v_add_f32 v249, 1.0, v249
v_mfma_f32_32x32x16_bf16 v[176:191], a[28:31], v[20:23], v[176:191]
ds_read_b64_tr_b16 a[20:21], v210 offset:57344
ds_read_b64_tr_b16 a[22:23], v211 offset:57344
v_add_f32 v251, 1.0, v251
v_rcp_f32 v244, v244
v_rcp_f32 v246, v246
v_rcp_f32 v248, v248
v_rcp_f32 v250, v250
v_rcp_f32 v245, v245
v_rcp_f32 v247, v247
v_rcp_f32 v249, v249
v_rcp_f32 v251, v251
s_waitcnt lgkmcnt(8)
v_mfma_f32_32x32x16_bf16 v[128:143], a[0:3], v[24:27], v[128:143]
ds_read_b64_tr_b16 a[24:25], v212 offset:57344
ds_read_b64_tr_b16 a[26:27], v213 offset:57344
v_mul_f32 v80, v80, v244
buffer_load_dwordx4 v227, s[8:11], s32 offen offset:3072 lds
v_mul_f32 v82, v82, v246
v_mul_f32 v84, v84, v248
v_mul_f32 v86, v86, v250
v_mul_f32 v81, v81, v245
v_mul_f32 v83, v83, v247
v_mul_f32 v85, v85, v249
v_mul_f32 v87, v87, v251
v_add_f32 v252, v252, v80
v_add_f32 v252, v252, v82
v_mfma_f32_32x32x16_bf16 v[144:159], a[4:7], v[24:27], v[144:159]
s_waitcnt vmcnt(8)
s_barrier
ds_read_b64_tr_b16 a[28:29], v214 offset:57344
ds_read_b64_tr_b16 a[30:31], v215 offset:57344
v_add_f32 v252, v252, v84
v_add_f32 v252, v252, v86
v_add_f32 v253, v253, v81
v_add_f32 v253, v253, v83
v_add_f32 v253, v253, v85
v_add_f32 v253, v253, v87
v_fmac_f32 v254, v80, v80
v_fmac_f32 v254, v82, v82
v_fmac_f32 v254, v84, v84
v_fmac_f32 v254, v86, v86
s_waitcnt lgkmcnt(8)
v_mfma_f32_32x32x16_bf16 v[160:175], a[8:11], v[24:27], v[160:175]
ds_read_b64_tr_b16 a[0:1], v216 offset:0
ds_read_b64_tr_b16 a[2:3], v217 offset:0
v_fmac_f32 v255, v81, v81
v_fmac_f32 v255, v83, v83
v_fmac_f32 v255, v85, v85
v_fmac_f32 v255, v87, v87
v_mul_f32 v244, v88, v88
v_mul_f32 v246, v90, v90
v_mul_f32 v248, v92, v92
v_mul_f32 v250, v94, v94
v_mul_f32 v245, v89, v89
v_mfma_f32_32x32x16_bf16 v[176:191], a[12:15], v[24:27], v[176:191]
ds_read_b64_tr_b16 a[4:5], v218 offset:0
ds_read_b64_tr_b16 a[6:7], v219 offset:0
v_mul_f32 v247, v91, v91
v_mul_f32 v249, v93, v93
v_mul_f32 v251, v95, v95
v_fma_f32 v244, v244, v234, v232
v_fma_f32 v246, v246, v234, v232
v_fma_f32 v248, v248, v234, v232
v_fma_f32 v250, v250, v234, v232
v_fma_f32 v245, v245, v234, v232
v_fma_f32 v247, v247, v234, v232
v_fma_f32 v249, v249, v234, v232
s_waitcnt lgkmcnt(8)
v_mfma_f32_32x32x16_bf16 v[128:143], a[16:19], v[28:31], v[128:143]
ds_read_b64_tr_b16 a[8:9], v220 offset:0
ds_read_b64_tr_b16 a[10:11], v221 offset:0
v_fma_f32 v251, v251, v234, v232
v_mul_f32 v244, v244, v88
v_mul_f32 v246, v246, v90
v_mul_f32 v248, v248, v92
v_mul_f32 v250, v250, v94
v_mul_f32 v245, v245, v89
v_mul_f32 v247, v247, v91
v_mul_f32 v249, v249, v93
v_mul_f32 v251, v251, v95
v_mfma_f32_32x32x16_bf16 v[144:159], a[20:23], v[28:31], v[144:159]
ds_read_b64_tr_b16 a[12:13], v222 offset:0
ds_read_b64_tr_b16 a[14:15], v223 offset:0
v_exp_f32 v244, v244
v_exp_f32 v246, v246
v_exp_f32 v248, v248
v_exp_f32 v250, v250
v_exp_f32 v245, v245
v_exp_f32 v247, v247
v_exp_f32 v249, v249
v_exp_f32 v251, v251
v_add_f32 v244, 1.0, v244
v_add_f32 v246, 1.0, v246
s_waitcnt lgkmcnt(8)
v_mfma_f32_32x32x16_bf16 v[160:175], a[24:27], v[28:31], v[160:175]
ds_read_b64_tr_b16 a[16:17], v216 offset:8192
ds_read_b64_tr_b16 a[18:19], v217 offset:8192
v_add_f32 v248, 1.0, v248
v_add_f32 v250, 1.0, v250
v_add_f32 v245, 1.0, v245
v_add_f32 v247, 1.0, v247
v_add_f32 v249, 1.0, v249
v_add_f32 v251, 1.0, v251
v_rcp_f32 v244, v244
v_rcp_f32 v246, v246
v_rcp_f32 v248, v248
v_rcp_f32 v250, v250
v_mfma_f32_32x32x16_bf16 v[176:191], a[28:31], v[28:31], v[176:191]
ds_read_b64_tr_b16 a[20:21], v218 offset:8192
ds_read_b64_tr_b16 a[22:23], v219 offset:8192
v_rcp_f32 v245, v245
v_rcp_f32 v247, v247
v_rcp_f32 v249, v249
v_rcp_f32 v251, v251
v_mul_f32 v88, v88, v244
v_mul_f32 v90, v90, v246
v_mul_f32 v92, v92, v248
v_mul_f32 v94, v94, v250
v_mul_f32 v89, v89, v245
s_waitcnt lgkmcnt(8)
v_mfma_f32_32x32x16_bf16 v[128:143], a[0:3], v[32:35], v[128:143]
ds_read_b64_tr_b16 a[24:25], v220 offset:8192
ds_read_b64_tr_b16 a[26:27], v221 offset:8192
v_mul_f32 v91, v91, v247
v_mul_f32 v93, v93, v249
v_mul_f32 v95, v95, v251
v_add_f32 v252, v252, v88
v_add_f32 v252, v252, v90
v_add_f32 v252, v252, v92
v_add_f32 v252, v252, v94
v_add_f32 v253, v253, v89
v_add_f32 v253, v253, v91
v_add_f32 v253, v253, v93
v_mfma_f32_32x32x16_bf16 v[144:159], a[4:7], v[32:35], v[144:159]
ds_read_b64_tr_b16 a[28:29], v222 offset:8192
ds_read_b64_tr_b16 a[30:31], v223 offset:8192
v_add_f32 v253, v253, v95
v_fmac_f32 v254, v88, v88
v_fmac_f32 v254, v90, v90
v_fmac_f32 v254, v92, v92
v_fmac_f32 v254, v94, v94
v_fmac_f32 v255, v89, v89
v_fmac_f32 v255, v91, v91
v_fmac_f32 v255, v93, v93
v_fmac_f32 v255, v95, v95
s_waitcnt lgkmcnt(8)
v_mfma_f32_32x32x16_bf16 v[160:175], a[8:11], v[32:35], v[160:175]
ds_read_b64_tr_b16 a[0:1], v216 offset:16384
ds_read_b64_tr_b16 a[2:3], v217 offset:16384
v_mul_f32 v244, v96, v96
v_mul_f32 v246, v98, v98
v_mul_f32 v248, v100, v100
v_mul_f32 v250, v102, v102
v_mul_f32 v245, v97, v97
v_mul_f32 v247, v99, v99
v_mul_f32 v249, v101, v101
v_mul_f32 v251, v103, v103
v_fma_f32 v244, v244, v234, v232
v_fma_f32 v246, v246, v234, v232
v_mfma_f32_32x32x16_bf16 v[176:191], a[12:15], v[32:35], v[176:191]
ds_read_b64_tr_b16 a[4:5], v218 offset:16384
ds_read_b64_tr_b16 a[6:7], v219 offset:16384
v_fma_f32 v248, v248, v234, v232
v_fma_f32 v250, v250, v234, v232
v_fma_f32 v245, v245, v234, v232
v_fma_f32 v247, v247, v234, v232
v_fma_f32 v249, v249, v234, v232
v_fma_f32 v251, v251, v234, v232
v_mul_f32 v244, v244, v96
v_mul_f32 v246, v246, v98
v_mul_f32 v248, v248, v100
v_mul_f32 v250, v250, v102
s_waitcnt lgkmcnt(8)
v_mfma_f32_32x32x16_bf16 v[128:143], a[16:19], v[36:39], v[128:143]
ds_read_b64_tr_b16 a[8:9], v220 offset:16384
ds_read_b64_tr_b16 a[10:11], v221 offset:16384
v_mul_f32 v245, v245, v97
v_mul_f32 v247, v247, v99
v_mul_f32 v249, v249, v101
v_mul_f32 v251, v251, v103
v_exp_f32 v244, v244
v_exp_f32 v246, v246
v_exp_f32 v248, v248
v_exp_f32 v250, v250
v_exp_f32 v245, v245
v_mfma_f32_32x32x16_bf16 v[144:159], a[20:23], v[36:39], v[144:159]
ds_read_b64_tr_b16 a[12:13], v222 offset:16384
ds_read_b64_tr_b16 a[14:15], v223 offset:16384
v_exp_f32 v247, v247
v_exp_f32 v249, v249
v_exp_f32 v251, v251
v_add_f32 v244, 1.0, v244
v_add_f32 v246, 1.0, v246
v_add_f32 v248, 1.0, v248
v_add_f32 v250, 1.0, v250
v_add_f32 v245, 1.0, v245
v_add_f32 v247, 1.0, v247
v_add_f32 v249, 1.0, v249
s_waitcnt lgkmcnt(8)
v_mfma_f32_32x32x16_bf16 v[160:175], a[24:27], v[36:39], v[160:175]
ds_read_b64_tr_b16 a[16:17], v216 offset:24576
ds_read_b64_tr_b16 a[18:19], v217 offset:24576
v_add_f32 v251, 1.0, v251
v_rcp_f32 v244, v244
v_rcp_f32 v246, v246
v_rcp_f32 v248, v248
v_rcp_f32 v250, v250
v_rcp_f32 v245, v245
v_rcp_f32 v247, v247
v_rcp_f32 v249, v249
v_rcp_f32 v251, v251
v_mfma_f32_32x32x16_bf16 v[176:191], a[28:31], v[36:39], v[176:191]
ds_read_b64_tr_b16 a[20:21], v218 offset:24576
ds_read_b64_tr_b16 a[22:23], v219 offset:24576
v_mul_f32 v96, v96, v244
v_mul_f32 v98, v98, v246
v_mul_f32 v100, v100, v248
v_mul_f32 v102, v102, v250
v_mul_f32 v97, v97, v245
v_mul_f32 v99, v99, v247
v_mul_f32 v101, v101, v249
v_mul_f32 v103, v103, v251
v_add_f32 v252, v252, v96
v_add_f32 v252, v252, v98
s_waitcnt lgkmcnt(8)
v_mfma_f32_32x32x16_bf16 v[128:143], a[0:3], v[40:43], v[128:143]
ds_read_b64_tr_b16 a[24:25], v220 offset:24576
ds_read_b64_tr_b16 a[26:27], v221 offset:24576
v_add_f32 v252, v252, v100
v_add_f32 v252, v252, v102
v_add_f32 v253, v253, v97
v_add_f32 v253, v253, v99
v_add_f32 v253, v253, v101
v_add_f32 v253, v253, v103
v_fmac_f32 v254, v96, v96
v_fmac_f32 v254, v98, v98
v_fmac_f32 v254, v100, v100
v_fmac_f32 v254, v102, v102
v_mfma_f32_32x32x16_bf16 v[144:159], a[4:7], v[40:43], v[144:159]
s_waitcnt vmcnt(0)
s_barrier
ds_read_b64_tr_b16 a[28:29], v222 offset:24576
ds_read_b64_tr_b16 a[30:31], v223 offset:24576
v_fmac_f32 v255, v97, v97
v_fmac_f32 v255, v99, v99
v_fmac_f32 v255, v101, v101
v_fmac_f32 v255, v103, v103
v_mul_f32 v244, v104, v104
v_mul_f32 v246, v106, v106
v_mul_f32 v248, v108, v108
v_mul_f32 v250, v110, v110
v_mul_f32 v245, v105, v105
s_waitcnt lgkmcnt(8)
v_mfma_f32_32x32x16_bf16 v[160:175], a[8:11], v[40:43], v[160:175]
ds_read_b64_tr_b16 a[0:1], v216 offset:32768
ds_read_b64_tr_b16 a[2:3], v217 offset:32768
v_mul_f32 v247, v107, v107
v_mul_f32 v249, v109, v109
v_mul_f32 v251, v111, v111
v_fma_f32 v244, v244, v234, v232
v_fma_f32 v246, v246, v234, v232
v_fma_f32 v248, v248, v234, v232
v_fma_f32 v250, v250, v234, v232
v_fma_f32 v245, v245, v234, v232
v_fma_f32 v247, v247, v234, v232
v_fma_f32 v249, v249, v234, v232
v_mfma_f32_32x32x16_bf16 v[176:191], a[12:15], v[40:43], v[176:191]
ds_read_b64_tr_b16 a[4:5], v218 offset:32768
ds_read_b64_tr_b16 a[6:7], v219 offset:32768
v_fma_f32 v251, v251, v234, v232
v_mul_f32 v244, v244, v104
v_mul_f32 v246, v246, v106
v_mul_f32 v248, v248, v108
v_mul_f32 v250, v250, v110
v_mul_f32 v245, v245, v105
v_mul_f32 v247, v247, v107
v_mul_f32 v249, v249, v109
v_mul_f32 v251, v251, v111
s_waitcnt lgkmcnt(8)
v_mfma_f32_32x32x16_bf16 v[128:143], a[16:19], v[44:47], v[128:143]
ds_read_b64_tr_b16 a[8:9], v220 offset:32768
ds_read_b64_tr_b16 a[10:11], v221 offset:32768
v_exp_f32 v244, v244
v_exp_f32 v246, v246
v_exp_f32 v248, v248
v_exp_f32 v250, v250
v_exp_f32 v245, v245
v_exp_f32 v247, v247
v_exp_f32 v249, v249
v_exp_f32 v251, v251
v_add_f32 v244, 1.0, v244
v_add_f32 v246, 1.0, v246
v_mfma_f32_32x32x16_bf16 v[144:159], a[20:23], v[44:47], v[144:159]
ds_read_b64_tr_b16 a[12:13], v222 offset:32768
ds_read_b64_tr_b16 a[14:15], v223 offset:32768
v_add_f32 v248, 1.0, v248
v_add_f32 v250, 1.0, v250
v_add_f32 v245, 1.0, v245
v_add_f32 v247, 1.0, v247
v_add_f32 v249, 1.0, v249
v_add_f32 v251, 1.0, v251
v_rcp_f32 v244, v244
v_rcp_f32 v246, v246
v_rcp_f32 v248, v248
v_rcp_f32 v250, v250
s_waitcnt lgkmcnt(8)
v_mfma_f32_32x32x16_bf16 v[160:175], a[24:27], v[44:47], v[160:175]
ds_read_b64_tr_b16 a[16:17], v216 offset:40960
ds_read_b64_tr_b16 a[18:19], v217 offset:40960
v_rcp_f32 v245, v245
v_rcp_f32 v247, v247
v_rcp_f32 v249, v249
v_rcp_f32 v251, v251
v_mul_f32 v104, v104, v244
v_mul_f32 v106, v106, v246
v_mul_f32 v108, v108, v248
v_mul_f32 v110, v110, v250
v_mul_f32 v105, v105, v245
v_mfma_f32_32x32x16_bf16 v[176:191], a[28:31], v[44:47], v[176:191]
ds_read_b64_tr_b16 a[20:21], v218 offset:40960
ds_read_b64_tr_b16 a[22:23], v219 offset:40960
v_mul_f32 v107, v107, v247
v_mul_f32 v109, v109, v249
v_mul_f32 v111, v111, v251
v_add_f32 v252, v252, v104
v_add_f32 v252, v252, v106
v_add_f32 v252, v252, v108
v_add_f32 v252, v252, v110
v_add_f32 v253, v253, v105
v_add_f32 v253, v253, v107
v_add_f32 v253, v253, v109
s_waitcnt lgkmcnt(8)
v_mfma_f32_32x32x16_bf16 v[128:143], a[0:3], v[48:51], v[128:143]
ds_read_b64_tr_b16 a[24:25], v220 offset:40960
ds_read_b64_tr_b16 a[26:27], v221 offset:40960
v_add_f32 v253, v253, v111
v_fmac_f32 v254, v104, v104
v_fmac_f32 v254, v106, v106
v_fmac_f32 v254, v108, v108
v_fmac_f32 v254, v110, v110
v_fmac_f32 v255, v105, v105
v_fmac_f32 v255, v107, v107
v_fmac_f32 v255, v109, v109
v_fmac_f32 v255, v111, v111
v_mfma_f32_32x32x16_bf16 v[144:159], a[4:7], v[48:51], v[144:159]
ds_read_b64_tr_b16 a[28:29], v222 offset:40960
ds_read_b64_tr_b16 a[30:31], v223 offset:40960
v_mul_f32 v244, v112, v112
v_mul_f32 v246, v114, v114
v_mul_f32 v248, v116, v116
v_mul_f32 v250, v118, v118
v_mul_f32 v245, v113, v113
v_mul_f32 v247, v115, v115
v_mul_f32 v249, v117, v117
v_mul_f32 v251, v119, v119
v_fma_f32 v244, v244, v234, v232
v_fma_f32 v246, v246, v234, v232
s_waitcnt lgkmcnt(8)
v_mfma_f32_32x32x16_bf16 v[160:175], a[8:11], v[48:51], v[160:175]
ds_read_b64_tr_b16 a[0:1], v216 offset:49152
ds_read_b64_tr_b16 a[2:3], v217 offset:49152
v_fma_f32 v248, v248, v234, v232
v_fma_f32 v250, v250, v234, v232
v_fma_f32 v245, v245, v234, v232
v_fma_f32 v247, v247, v234, v232
v_fma_f32 v249, v249, v234, v232
v_fma_f32 v251, v251, v234, v232
v_mul_f32 v244, v244, v112
v_mul_f32 v246, v246, v114
v_mul_f32 v248, v248, v116
v_mul_f32 v250, v250, v118
v_mfma_f32_32x32x16_bf16 v[176:191], a[12:15], v[48:51], v[176:191]
ds_read_b64_tr_b16 a[4:5], v218 offset:49152
ds_read_b64_tr_b16 a[6:7], v219 offset:49152
v_mul_f32 v245, v245, v113
v_mul_f32 v247, v247, v115
v_mul_f32 v249, v249, v117
v_mul_f32 v251, v251, v119
v_exp_f32 v244, v244
v_exp_f32 v246, v246
v_exp_f32 v248, v248
v_exp_f32 v250, v250
v_exp_f32 v245, v245
s_waitcnt lgkmcnt(8)
v_mfma_f32_32x32x16_bf16 v[128:143], a[16:19], v[52:55], v[128:143]
ds_read_b64_tr_b16 a[8:9], v220 offset:49152
ds_read_b64_tr_b16 a[10:11], v221 offset:49152
v_exp_f32 v247, v247
v_exp_f32 v249, v249
v_exp_f32 v251, v251
v_add_f32 v244, 1.0, v244
v_add_f32 v246, 1.0, v246
v_add_f32 v248, 1.0, v248
v_add_f32 v250, 1.0, v250
v_add_f32 v245, 1.0, v245
v_add_f32 v247, 1.0, v247
v_add_f32 v249, 1.0, v249
v_mfma_f32_32x32x16_bf16 v[144:159], a[20:23], v[52:55], v[144:159]
ds_read_b64_tr_b16 a[12:13], v222 offset:49152
ds_read_b64_tr_b16 a[14:15], v223 offset:49152
v_add_f32 v251, 1.0, v251
v_rcp_f32 v244, v244
v_rcp_f32 v246, v246
v_rcp_f32 v248, v248
v_rcp_f32 v250, v250
v_rcp_f32 v245, v245
v_rcp_f32 v247, v247
v_rcp_f32 v249, v249
v_rcp_f32 v251, v251
s_waitcnt lgkmcnt(8)
v_mfma_f32_32x32x16_bf16 v[160:175], a[24:27], v[52:55], v[160:175]
ds_read_b64_tr_b16 a[16:17], v216 offset:57344
ds_read_b64_tr_b16 a[18:19], v217 offset:57344
v_mul_f32 v112, v112, v244
v_mul_f32 v114, v114, v246
v_mul_f32 v116, v116, v248
v_mul_f32 v118, v118, v250
v_mul_f32 v113, v113, v245
v_mul_f32 v115, v115, v247
v_mul_f32 v117, v117, v249
v_mul_f32 v119, v119, v251
v_add_f32 v252, v252, v112
v_add_f32 v252, v252, v114
v_mfma_f32_32x32x16_bf16 v[176:191], a[28:31], v[52:55], v[176:191]
ds_read_b64_tr_b16 a[20:21], v218 offset:57344
ds_read_b64_tr_b16 a[22:23], v219 offset:57344
v_add_f32 v252, v252, v116
v_add_f32 v252, v252, v118
v_add_f32 v253, v253, v113
v_add_f32 v253, v253, v115
v_add_f32 v253, v253, v117
v_add_f32 v253, v253, v119
v_fmac_f32 v254, v112, v112
v_fmac_f32 v254, v114, v114
v_fmac_f32 v254, v116, v116
v_fmac_f32 v254, v118, v118
s_waitcnt lgkmcnt(8)
v_mfma_f32_32x32x16_bf16 v[128:143], a[0:3], v[56:59], v[128:143]
ds_read_b64_tr_b16 a[24:25], v220 offset:57344
ds_read_b64_tr_b16 a[26:27], v221 offset:57344
v_fmac_f32 v255, v113, v113
v_fmac_f32 v255, v115, v115
v_fmac_f32 v255, v117, v117
v_fmac_f32 v255, v119, v119
v_mul_f32 v244, v120, v120
v_mul_f32 v246, v122, v122
v_mul_f32 v248, v124, v124
v_mul_f32 v250, v126, v126
v_mul_f32 v245, v121, v121
v_mfma_f32_32x32x16_bf16 v[144:159], a[4:7], v[56:59], v[144:159]
ds_read_b64_tr_b16 a[28:29], v222 offset:57344
ds_read_b64_tr_b16 a[30:31], v223 offset:57344
v_mul_f32 v247, v123, v123
v_mul_f32 v249, v125, v125
v_mul_f32 v251, v127, v127
v_fma_f32 v244, v244, v234, v232
v_fma_f32 v246, v246, v234, v232
v_fma_f32 v248, v248, v234, v232
v_fma_f32 v250, v250, v234, v232
v_fma_f32 v245, v245, v234, v232
v_fma_f32 v247, v247, v234, v232
v_fma_f32 v249, v249, v234, v232
s_waitcnt lgkmcnt(8)
v_mfma_f32_32x32x16_bf16 v[160:175], a[8:11], v[56:59], v[160:175]
v_fma_f32 v251, v251, v234, v232
v_mul_f32 v244, v244, v120
v_mul_f32 v246, v246, v122
v_mul_f32 v248, v248, v124
v_mul_f32 v250, v250, v126
v_mul_f32 v245, v245, v121
v_mul_f32 v247, v247, v123
v_mul_f32 v249, v249, v125
v_mul_f32 v251, v251, v127
v_mfma_f32_32x32x16_bf16 v[176:191], a[12:15], v[56:59], v[176:191]
v_exp_f32 v244, v244
v_exp_f32 v246, v246
v_exp_f32 v248, v248
v_exp_f32 v250, v250
v_exp_f32 v245, v245
v_exp_f32 v247, v247
v_exp_f32 v249, v249
v_exp_f32 v251, v251
v_add_f32 v244, 1.0, v244
v_add_f32 v246, 1.0, v246
s_waitcnt lgkmcnt(4)
v_mfma_f32_32x32x16_bf16 v[128:143], a[16:19], v[60:63], v[128:143]
v_add_f32 v248, 1.0, v248
v_add_f32 v250, 1.0, v250
v_add_f32 v245, 1.0, v245
v_add_f32 v247, 1.0, v247
v_add_f32 v249, 1.0, v249
v_add_f32 v251, 1.0, v251
v_rcp_f32 v244, v244
v_rcp_f32 v246, v246
v_rcp_f32 v248, v248
v_rcp_f32 v250, v250
v_mfma_f32_32x32x16_bf16 v[144:159], a[20:23], v[60:63], v[144:159]
v_rcp_f32 v245, v245
v_rcp_f32 v247, v247
v_rcp_f32 v249, v249
v_rcp_f32 v251, v251
v_mul_f32 v120, v120, v244
v_mul_f32 v122, v122, v246
v_mul_f32 v124, v124, v248
v_mul_f32 v126, v126, v250
v_mul_f32 v121, v121, v245
s_waitcnt lgkmcnt(0)
v_mfma_f32_32x32x16_bf16 v[160:175], a[24:27], v[60:63], v[160:175]
v_mul_f32 v123, v123, v247
v_mul_f32 v125, v125, v249
v_mul_f32 v127, v127, v251
v_add_f32 v252, v252, v120
v_add_f32 v252, v252, v122
v_add_f32 v252, v252, v124
v_add_f32 v252, v252, v126
v_add_f32 v253, v253, v121
v_add_f32 v253, v253, v123
v_add_f32 v253, v253, v125
v_mfma_f32_32x32x16_bf16 v[176:191], a[28:31], v[60:63], v[176:191]
v_add_f32 v253, v253, v127
v_fmac_f32 v254, v120, v120
v_fmac_f32 v254, v122, v122
v_fmac_f32 v254, v124, v124
v_fmac_f32 v254, v126, v126
v_fmac_f32 v255, v121, v121
v_fmac_f32 v255, v123, v123
v_fmac_f32 v255, v125, v125
v_fmac_f32 v255, v127, v127
v_add_f32 v8, v252, v253
v_add_f32 v10, v254, v255
v_mov_b32 v9, v8
v_mov_b32 v11, v10
s_nop 1
v_permlane32_swap_b32 v8, v9
v_permlane32_swap_b32 v10, v11
s_nop 1
v_add_f32 v8, v8, v9
v_add_f32 v9, v10, v11
s_lshl_b32 s33, s29, 1
s_add_u32 s33, s33, s30
s_lshl_b32 s33, s33, 9
s_add_u32 s33, s33, 32768
v_lshlrev_b32 v12, 3, v240
v_add_u32 v13, s33, v12
s_xor_b32 s33, s33, 512
v_add_u32 v14, s33, v12
ds_write_b64 v13, v[8:9]
v_cvt_pk_bf16_f32 v244, v128, v129
v_cvt_pk_bf16_f32 v245, v130, v131
v_cvt_pk_bf16_f32 v246, v132, v133
v_cvt_pk_bf16_f32 v247, v134, v135
v_cvt_pk_bf16_f32 v248, v136, v137
v_cvt_pk_bf16_f32 v249, v138, v139
v_cvt_pk_bf16_f32 v250, v140, v141
v_cvt_pk_bf16_f32 v251, v142, v143
s_nop 1
v_permlane32_swap_b32 v244, v246
v_permlane32_swap_b32 v245, v247
v_permlane32_swap_b32 v248, v250
v_permlane32_swap_b32 v249, v251
ds_write_b128 v200, v[244:247]
ds_write_b128 v201, v[248:251]
v_cvt_pk_bf16_f32 v16, v144, v145
v_cvt_pk_bf16_f32 v17, v146, v147
v_cvt_pk_bf16_f32 v18, v148, v149
v_cvt_pk_bf16_f32 v19, v150, v151
v_cvt_pk_bf16_f32 v20, v152, v153
v_cvt_pk_bf16_f32 v21, v154, v155
v_cvt_pk_bf16_f32 v22, v156, v157
v_cvt_pk_bf16_f32 v23, v158, v159
s_nop 1
v_permlane32_swap_b32 v16, v18
v_permlane32_swap_b32 v17, v19
v_permlane32_swap_b32 v20, v22
v_permlane32_swap_b32 v21, v23
ds_write_b128 v202, v[16:19]
ds_write_b128 v203, v[20:23]
v_cvt_pk_bf16_f32 v244, v160, v161
v_cvt_pk_bf16_f32 v245, v162, v163
v_cvt_pk_bf16_f32 v246, v164, v165
v_cvt_pk_bf16_f32 v247, v166, v167
v_cvt_pk_bf16_f32 v248, v168, v169
v_cvt_pk_bf16_f32 v249, v170, v171
v_cvt_pk_bf16_f32 v250, v172, v173
v_cvt_pk_bf16_f32 v251, v174, v175
s_nop 1
v_permlane32_swap_b32 v244, v246
v_permlane32_swap_b32 v245, v247
v_permlane32_swap_b32 v248, v250
v_permlane32_swap_b32 v249, v251
ds_write_b128 v204, v[244:247]
ds_write_b128 v205, v[248:251]
v_cvt_pk_bf16_f32 v16, v176, v177
v_cvt_pk_bf16_f32 v17, v178, v179
v_cvt_pk_bf16_f32 v18, v180, v181
v_cvt_pk_bf16_f32 v19, v182, v183
v_cvt_pk_bf16_f32 v20, v184, v185
v_cvt_pk_bf16_f32 v21, v186, v187
v_cvt_pk_bf16_f32 v22, v188, v189
v_cvt_pk_bf16_f32 v23, v190, v191
s_nop 1
v_permlane32_swap_b32 v16, v18
v_permlane32_swap_b32 v17, v19
v_permlane32_swap_b32 v20, v22
v_permlane32_swap_b32 v21, v23
ds_write_b128 v206, v[16:19]
ds_write_b128 v207, v[20:23]
s_waitcnt lgkmcnt(0)
s_barrier
ds_read_b64 v[10:11], v14
v_lshlrev_b32 v15, 4, v240
v_add_u32 v15, s31, v15
v_add_u32 v232, 131072, v15
ds_read_b128 v[128:131], v232 offset:0
ds_read_b128 v[132:135], v232 offset:1024
ds_read_b128 v[136:139], v232 offset:2048
ds_read_b128 v[140:143], v232 offset:3072
ds_read_b128 v[144:147], v232 offset:16384
ds_read_b128 v[148:151], v232 offset:17408
ds_read_b128 v[152:155], v232 offset:18432
ds_read_b128 v[156:159], v232 offset:19456
v_subrev_u32 v200, 131072, v200
v_subrev_u32 v201, 131072, v201
v_subrev_u32 v202, 131072, v202
v_subrev_u32 v203, 131072, v203
v_subrev_u32 v204, 131072, v204
v_subrev_u32 v205, 131072, v205
v_subrev_u32 v206, 131072, v206
v_subrev_u32 v207, 131072, v207
s_waitcnt lgkmcnt(8)
v_add_f32 v8, v8, v10
v_add_f32 v9, v9, v11
v_mul_f32 v8, 0x3b800000, v8
v_mul_f32 v9, 0x3b800000, v9
v_fma_f32 v9, -v8, v8, v9
v_max_f32 v9, 0, v9
v_add_f32 v9, 0x3727c5ac, v9
v_rsq_f32 v10, v9
s_nop 0
v_mul_f32 v12, v8, v10
v_sub_f32 v12, 0, v12
s_lshl_b32 s32, s35, 15
s_add_u32 s56, s32, 16384
s_waitcnt lgkmcnt(0)
v_pk_fma_f32 v[64:65], v[64:65], v[10:11], v[12:13] op_sel_hi:[1,0,0]
v_pk_fma_f32 v[66:67], v[66:67], v[10:11], v[12:13] op_sel_hi:[1,0,0]
v_pk_fma_f32 v[68:69], v[68:69], v[10:11], v[12:13] op_sel_hi:[1,0,0]
v_pk_fma_f32 v[70:71], v[70:71], v[10:11], v[12:13] op_sel_hi:[1,0,0]
v_pk_fma_f32 v[72:73], v[72:73], v[10:11], v[12:13] op_sel_hi:[1,0,0]
v_pk_fma_f32 v[74:75], v[74:75], v[10:11], v[12:13] op_sel_hi:[1,0,0]
v_pk_fma_f32 v[76:77], v[76:77], v[10:11], v[12:13] op_sel_hi:[1,0,0]
v_pk_fma_f32 v[78:79], v[78:79], v[10:11], v[12:13] op_sel_hi:[1,0,0]
buffer_store_dwordx4 v[128:131], v228, s[20:23], s32 offen offset:0 sc1
v_cvt_pk_bf16_f32 v16, v64, v65
v_cvt_pk_bf16_f32 v17, v66, v67
v_cvt_pk_bf16_f32 v18, v68, v69
v_cvt_pk_bf16_f32 v19, v70, v71
v_cvt_pk_bf16_f32 v20, v72, v73
v_cvt_pk_bf16_f32 v21, v74, v75
v_cvt_pk_bf16_f32 v22, v76, v77
v_cvt_pk_bf16_f32 v23, v78, v79
s_nop 1
v_permlane32_swap_b32 v16, v18
v_permlane32_swap_b32 v17, v19
v_permlane32_swap_b32 v20, v22
v_permlane32_swap_b32 v21, v23
ds_write_b128 v200, v[16:19]
ds_write_b128 v201, v[20:23]
buffer_store_dwordx4 v[132:135], v229, s[20:23], s32 offen offset:1024 sc1
v_pk_fma_f32 v[80:81], v[80:81], v[10:11], v[12:13] op_sel_hi:[1,0,0]
v_pk_fma_f32 v[82:83], v[82:83], v[10:11], v[12:13] op_sel_hi:[1,0,0]
v_pk_fma_f32 v[84:85], v[84:85], v[10:11], v[12:13] op_sel_hi:[1,0,0]
v_pk_fma_f32 v[86:87], v[86:87], v[10:11], v[12:13] op_sel_hi:[1,0,0]
v_pk_fma_f32 v[88:89], v[88:89], v[10:11], v[12:13] op_sel_hi:[1,0,0]
v_pk_fma_f32 v[90:91], v[90:91], v[10:11], v[12:13] op_sel_hi:[1,0,0]
v_pk_fma_f32 v[92:93], v[92:93], v[10:11], v[12:13] op_sel_hi:[1,0,0]
v_pk_fma_f32 v[94:95], v[94:95], v[10:11], v[12:13] op_sel_hi:[1,0,0]
buffer_store_dwordx4 v[136:139], v230, s[20:23], s32 offen offset:2048 sc1
v_cvt_pk_bf16_f32 v24, v80, v81
v_cvt_pk_bf16_f32 v25, v82, v83
v_cvt_pk_bf16_f32 v26, v84, v85
v_cvt_pk_bf16_f32 v27, v86, v87
v_cvt_pk_bf16_f32 v28, v88, v89
v_cvt_pk_bf16_f32 v29, v90, v91
v_cvt_pk_bf16_f32 v30, v92, v93
v_cvt_pk_bf16_f32 v31, v94, v95
s_nop 1
v_permlane32_swap_b32 v24, v26
v_permlane32_swap_b32 v25, v27
v_permlane32_swap_b32 v28, v30
v_permlane32_swap_b32 v29, v31
ds_write_b128 v202, v[24:27]
ds_write_b128 v203, v[28:31]
buffer_store_dwordx4 v[140:143], v231, s[20:23], s32 offen offset:3072 sc1
v_pk_fma_f32 v[96:97], v[96:97], v[10:11], v[12:13] op_sel_hi:[1,0,0]
v_pk_fma_f32 v[98:99], v[98:99], v[10:11], v[12:13] op_sel_hi:[1,0,0]
v_pk_fma_f32 v[100:101], v[100:101], v[10:11], v[12:13] op_sel_hi:[1,0,0]
v_pk_fma_f32 v[102:103], v[102:103], v[10:11], v[12:13] op_sel_hi:[1,0,0]
v_pk_fma_f32 v[104:105], v[104:105], v[10:11], v[12:13] op_sel_hi:[1,0,0]
v_pk_fma_f32 v[106:107], v[106:107], v[10:11], v[12:13] op_sel_hi:[1,0,0]
v_pk_fma_f32 v[108:109], v[108:109], v[10:11], v[12:13] op_sel_hi:[1,0,0]
v_pk_fma_f32 v[110:111], v[110:111], v[10:11], v[12:13] op_sel_hi:[1,0,0]
buffer_store_dwordx4 v[144:147], v228, s[20:23], s56 offen offset:0 sc1
v_cvt_pk_bf16_f32 v32, v96, v97
v_cvt_pk_bf16_f32 v33, v98, v99
v_cvt_pk_bf16_f32 v34, v100, v101
v_cvt_pk_bf16_f32 v35, v102, v103
v_cvt_pk_bf16_f32 v36, v104, v105
v_cvt_pk_bf16_f32 v37, v106, v107
v_cvt_pk_bf16_f32 v38, v108, v109
v_cvt_pk_bf16_f32 v39, v110, v111
s_nop 1
v_permlane32_swap_b32 v32, v34
v_permlane32_swap_b32 v33, v35
v_permlane32_swap_b32 v36, v38
v_permlane32_swap_b32 v37, v39
ds_write_b128 v204, v[32:35]
ds_write_b128 v205, v[36:39]
buffer_store_dwordx4 v[148:151], v229, s[20:23], s56 offen offset:1024 sc1
v_pk_fma_f32 v[112:113], v[112:113], v[10:11], v[12:13] op_sel_hi:[1,0,0]
v_pk_fma_f32 v[114:115], v[114:115], v[10:11], v[12:13] op_sel_hi:[1,0,0]
v_pk_fma_f32 v[116:117], v[116:117], v[10:11], v[12:13] op_sel_hi:[1,0,0]
v_pk_fma_f32 v[118:119], v[118:119], v[10:11], v[12:13] op_sel_hi:[1,0,0]
v_pk_fma_f32 v[120:121], v[120:121], v[10:11], v[12:13] op_sel_hi:[1,0,0]
v_pk_fma_f32 v[122:123], v[122:123], v[10:11], v[12:13] op_sel_hi:[1,0,0]
v_pk_fma_f32 v[124:125], v[124:125], v[10:11], v[12:13] op_sel_hi:[1,0,0]
v_pk_fma_f32 v[126:127], v[126:127], v[10:11], v[12:13] op_sel_hi:[1,0,0]
buffer_store_dwordx4 v[152:155], v230, s[20:23], s56 offen offset:2048 sc1
v_cvt_pk_bf16_f32 v40, v112, v113
v_cvt_pk_bf16_f32 v41, v114, v115
v_cvt_pk_bf16_f32 v42, v116, v117
v_cvt_pk_bf16_f32 v43, v118, v119
v_cvt_pk_bf16_f32 v44, v120, v121
v_cvt_pk_bf16_f32 v45, v122, v123
v_cvt_pk_bf16_f32 v46, v124, v125
v_cvt_pk_bf16_f32 v47, v126, v127
s_nop 1
v_permlane32_swap_b32 v40, v42
v_permlane32_swap_b32 v41, v43
v_permlane32_swap_b32 v44, v46
v_permlane32_swap_b32 v45, v47
ds_write_b128 v206, v[40:43]
ds_write_b128 v207, v[44:47]
buffer_store_dwordx4 v[156:159], v231, s[20:23], s56 offen offset:3072 sc1
s_waitcnt lgkmcnt(0)
s_barrier
ds_read_b128 v[64:67], v15 offset:0
ds_read_b128 v[68:71], v15 offset:1024
ds_read_b128 v[72:75], v15 offset:2048
ds_read_b128 v[76:79], v15 offset:3072
ds_read_b128 v[80:83], v15 offset:16384
ds_read_b128 v[84:87], v15 offset:17408
ds_read_b128 v[88:91], v15 offset:18432
ds_read_b128 v[92:95], v15 offset:19456
s_mov_b32 s88, s32
s_mov_b32 s89, s56
s_mov_b32 s98, 1
s_branch K1_FIN
K1_W1:
v_mov_b32 v224, v228
v_mov_b32 v225, v229
v_mov_b32 v226, v230
v_mov_b32 v227, v231
s_sub_u32 s35, s2, 250
s_add_u32 s16, s52, 0x0
s_addc_u32 s17, s53, 0
s_mov_b32 s18, 0x40000
s_mov_b32 s19, 0x20000
s_add_u32 s8, s44, 0x0
s_addc_u32 s9, s45, 0
s_mov_b32 s10, 0x20000
s_mov_b32 s11, 0x20000
s_add_u32 s12, s42, 0x0
s_addc_u32 s13, s43, 0
s_mov_b32 s14, 0x20000
s_mov_b32 s15, 0x20000
s_add_u32 s24, s54, 0x1000000
s_addc_u32 s25, s55, 0
s_mov_b32 s26, 0x40000
s_mov_b32 s27, 0x20000
v_lshrrev_b32 v232, 3, v240
v_lshlrev_b32 v232, 9, v232
v_and_b32 v233, 7, v240
v_lshl_add_u32 v232, v233, 4, v232
s_lshl_b32 s33, s35, 7
s_lshl_b32 s34, s28, 15
s_add_u32 s33, s33, s34
s_add_u32 s33, s33, 0
v_add_u32 v232, s33, v232
s_lshl_b32 s34, s28, 13
s_add_u32 s34, s34, 131072
s_add_u32 m0, s34, 0
s_mov_b32 s32, 0
buffer_load_dwordx4 v232, s[16:19], s32 offen lds
s_add_u32 m0, s34, 1024
s_mov_b32 s32, 4096
buffer_load_dwordx4 v232, s[16:19], s32 offen lds
s_add_u32 m0, s34, 2048
s_mov_b32 s32, 8192
buffer_load_dwordx4 v232, s[16:19], s32 offen lds
s_add_u32 m0, s34, 3072
s_mov_b32 s32, 12288
buffer_load_dwordx4 v232, s[16:19], s32 offen lds
s_add_u32 m0, s34, 4096
s_mov_b32 s32, 16384
buffer_load_dwordx4 v232, s[16:19], s32 offen lds
s_add_u32 m0, s34, 5120
s_mov_b32 s32, 20480
buffer_load_dwordx4 v232, s[16:19], s32 offen lds
s_add_u32 m0, s34, 6144
s_mov_b32 s32, 24576
buffer_load_dwordx4 v232, s[16:19], s32 offen lds
s_add_u32 m0, s34, 7168
s_mov_b32 s32, 28672
buffer_load_dwordx4 v232, s[16:19], s32 offen lds
s_add_u32 m0, s31, 0x0
s_mov_b32 s32, 0x0
buffer_load_dwordx4 v224, s[8:11], s32 offen offset:0 lds
buffer_load_dwordx4 v225, s[8:11], s32 offen offset:1024 lds
buffer_load_dwordx4 v226, s[8:11], s32 offen offset:2048 lds
buffer_load_dwordx4 v227, s[8:11], s32 offen offset:3072 lds
s_add_u32 m0, s31, 0x4000
s_mov_b32 s32, 0x4000
buffer_load_dwordx4 v224, s[8:11], s32 offen offset:0 lds
buffer_load_dwordx4 v225, s[8:11], s32 offen offset:1024 lds
buffer_load_dwordx4 v226, s[8:11], s32 offen offset:2048 lds
buffer_load_dwordx4 v227, s[8:11], s32 offen offset:3072 lds
s_add_u32 m0, s31, 0x8000
s_mov_b32 s32, 0x8000
buffer_load_dwordx4 v224, s[8:11], s32 offen offset:0 lds
buffer_load_dwordx4 v225, s[8:11], s32 offen offset:1024 lds
buffer_load_dwordx4 v226, s[8:11], s32 offen offset:2048 lds
buffer_load_dwordx4 v227, s[8:11], s32 offen offset:3072 lds
v_and_b32 v234, 3, v242
v_lshlrev_b32 v234, 2, v234
v_bfe_u32 v235, v242, 2, 2
v_or_b32 v234, v234, v235
v_lshlrev_b32 v236, 9, v242
s_lshl_b32 s33, s30, 14
v_add_u32 v236, s33, v236
v_add_u32 v235, 0, v241
v_xor_b32 v235, v235, v234
v_lshl_add_u32 v192, v235, 4, v236
v_add_u32 v200, 0x10000, v192
v_add_u32 v235, 2, v241
v_xor_b32 v235, v235, v234
v_lshl_add_u32 v193, v235, 4, v236
v_add_u32 v201, 0x10000, v193
v_add_u32 v235, 4, v241
v_xor_b32 v235, v235, v234
v_lshl_add_u32 v194, v235, 4, v236
v_add_u32 v202, 0x10000, v194
v_add_u32 v235, 6, v241
v_xor_b32 v235, v235, v234
v_lshl_add_u32 v195, v235, 4, v236
v_add_u32 v203, 0x10000, v195
v_add_u32 v235, 8, v241
v_xor_b32 v235, v235, v234
v_lshl_add_u32 v196, v235, 4, v236
v_add_u32 v204, 0x10000, v196
v_add_u32 v235, 10, v241
v_xor_b32 v235, v235, v234
v_lshl_add_u32 v197, v235, 4, v236
v_add_u32 v205, 0x10000, v197
v_add_u32 v235, 12, v241
v_xor_b32 v235, v235, v234
v_lshl_add_u32 v198, v235, 4, v236
v_add_u32 v206, 0x10000, v198
v_add_u32 v235, 14, v241
v_xor_b32 v235, v235, v234
v_lshl_add_u32 v199, v235, 4, v236
v_add_u32 v207, 0x10000, v199
v_accvgpr_write_b32 a128, 0
v_accvgpr_write_b32 a129, 0
v_accvgpr_write_b32 a130, 0
v_accvgpr_write_b32 a131, 0
v_accvgpr_write_b32 a132, 0
v_accvgpr_write_b32 a133, 0
v_accvgpr_write_b32 a134, 0
v_accvgpr_write_b32 a135, 0
v_accvgpr_write_b32 a136, 0
v_accvgpr_write_b32 a137, 0
v_accvgpr_write_b32 a138, 0
v_accvgpr_write_b32 a139, 0
v_accvgpr_write_b32 a140, 0
v_accvgpr_write_b32 a141, 0
v_accvgpr_write_b32 a142, 0
v_accvgpr_write_b32 a143, 0
v_accvgpr_write_b32 a144, 0
v_accvgpr_write_b32 a145, 0
v_accvgpr_write_b32 a146, 0
v_accvgpr_write_b32 a147, 0
v_accvgpr_write_b32 a148, 0
v_accvgpr_write_b32 a149, 0
v_accvgpr_write_b32 a150, 0
v_accvgpr_write_b32 a151, 0
v_accvgpr_write_b32 a152, 0
v_accvgpr_write_b32 a153, 0
v_accvgpr_write_b32 a154, 0
v_accvgpr_write_b32 a155, 0
v_accvgpr_write_b32 a156, 0
v_accvgpr_write_b32 a157, 0
v_accvgpr_write_b32 a158, 0
v_accvgpr_write_b32 a159, 0
v_accvgpr_write_b32 a160, 0
v_accvgpr_write_b32 a161, 0
v_accvgpr_write_b32 a162, 0
v_accvgpr_write_b32 a163, 0
v_accvgpr_write_b32 a164, 0
v_accvgpr_write_b32 a165, 0
v_accvgpr_write_b32 a166, 0
v_accvgpr_write_b32 a167, 0
v_accvgpr_write_b32 a168, 0
v_accvgpr_write_b32 a169, 0
v_accvgpr_write_b32 a170, 0
v_accvgpr_write_b32 a171, 0
v_accvgpr_write_b32 a172, 0
v_accvgpr_write_b32 a173, 0
v_accvgpr_write_b32 a174, 0
v_accvgpr_write_b32 a175, 0
v_accvgpr_write_b32 a176, 0
v_accvgpr_write_b32 a177, 0
v_accvgpr_write_b32 a178, 0
v_accvgpr_write_b32 a179, 0
v_accvgpr_write_b32 a180, 0
v_accvgpr_write_b32 a181, 0
v_accvgpr_write_b32 a182, 0
v_accvgpr_write_b32 a183, 0
v_accvgpr_write_b32 a184, 0
v_accvgpr_write_b32 a185, 0
v_accvgpr_write_b32 a186, 0
v_accvgpr_write_b32 a187, 0
v_accvgpr_write_b32 a188, 0
v_accvgpr_write_b32 a189, 0
v_accvgpr_write_b32 a190, 0
v_accvgpr_write_b32 a191, 0
v_accvgpr_write_b32 a192, 0
v_accvgpr_write_b32 a193, 0
v_accvgpr_write_b32 a194, 0
v_accvgpr_write_b32 a195, 0
v_accvgpr_write_b32 a196, 0
v_accvgpr_write_b32 a197, 0
v_accvgpr_write_b32 a198, 0
v_accvgpr_write_b32 a199, 0
v_accvgpr_write_b32 a200, 0
v_accvgpr_write_b32 a201, 0
v_accvgpr_write_b32 a202, 0
v_accvgpr_write_b32 a203, 0
v_accvgpr_write_b32 a204, 0
v_accvgpr_write_b32 a205, 0
v_accvgpr_write_b32 a206, 0
v_accvgpr_write_b32 a207, 0
v_accvgpr_write_b32 a208, 0
v_accvgpr_write_b32 a209, 0
v_accvgpr_write_b32 a210, 0
v_accvgpr_write_b32 a211, 0
v_accvgpr_write_b32 a212, 0
v_accvgpr_write_b32 a213, 0
v_accvgpr_write_b32 a214, 0
v_accvgpr_write_b32 a215, 0
v_accvgpr_write_b32 a216, 0
v_accvgpr_write_b32 a217, 0
v_accvgpr_write_b32 a218, 0
v_accvgpr_write_b32 a219, 0
v_accvgpr_write_b32 a220, 0
v_accvgpr_write_b32 a221, 0
v_accvgpr_write_b32 a222, 0
v_accvgpr_write_b32 a223, 0
v_accvgpr_write_b32 a224, 0
v_accvgpr_write_b32 a225, 0
v_accvgpr_write_b32 a226, 0
v_accvgpr_write_b32 a227, 0
v_accvgpr_write_b32 a228, 0
v_accvgpr_write_b32 a229, 0
v_accvgpr_write_b32 a230, 0
v_accvgpr_write_b32 a231, 0
v_accvgpr_write_b32 a232, 0
v_accvgpr_write_b32 a233, 0
v_accvgpr_write_b32 a234, 0
v_accvgpr_write_b32 a235, 0
v_accvgpr_write_b32 a236, 0
v_accvgpr_write_b32 a237, 0
v_accvgpr_write_b32 a238, 0
v_accvgpr_write_b32 a239, 0
v_accvgpr_write_b32 a240, 0
v_accvgpr_write_b32 a241, 0
v_accvgpr_write_b32 a242, 0
v_accvgpr_write_b32 a243, 0
v_accvgpr_write_b32 a244, 0
v_accvgpr_write_b32 a245, 0
v_accvgpr_write_b32 a246, 0
v_accvgpr_write_b32 a247, 0
v_accvgpr_write_b32 a248, 0
v_accvgpr_write_b32 a249, 0
v_accvgpr_write_b32 a250, 0
v_accvgpr_write_b32 a251, 0
v_accvgpr_write_b32 a252, 0
v_accvgpr_write_b32 a253, 0
v_accvgpr_write_b32 a254, 0
v_accvgpr_write_b32 a255, 0
s_waitcnt vmcnt(12)
s_barrier
v_bfe_u32 v232, v240, 2, 2
v_lshl_add_u32 v232, v241, 3, v232
v_lshlrev_b32 v232, 7, v232
v_bfe_u32 v233, v240, 4, 1
v_lshl_add_u32 v232, v233, 5, v232
v_and_b32 v233, 3, v240
v_lshl_add_u32 v232, v233, 3, v232
s_lshl_b32 s33, s29, 6
s_add_u32 s33, s33, 131072
v_add_u32 v232, s33, v232
ds_read_b64_tr_b16 v[0:1], v232 offset:0
ds_read_b64_tr_b16 v[2:3], v232 offset:512
ds_read_b64_tr_b16 v[4:5], v232 offset:2048
ds_read_b64_tr_b16 v[6:7], v232 offset:2560
ds_read_b64_tr_b16 v[8:9], v232 offset:4096
ds_read_b64_tr_b16 v[10:11], v232 offset:4608
ds_read_b64_tr_b16 v[12:13], v232 offset:6144
ds_read_b64_tr_b16 v[14:15], v232 offset:6656
s_waitcnt lgkmcnt(0)
ds_read_b64_tr_b16 v[16:17], v232 offset:8192
ds_read_b64_tr_b16 v[18:19], v232 offset:8704
ds_read_b64_tr_b16 v[20:21], v232 offset:10240
ds_read_b64_tr_b16 v[22:23], v232 offset:10752
ds_read_b64_tr_b16 v[24:25], v232 offset:12288
ds_read_b64_tr_b16 v[26:27], v232 offset:12800
ds_read_b64_tr_b16 v[28:29], v232 offset:14336
ds_read_b64_tr_b16 v[30:31], v232 offset:14848
s_waitcnt lgkmcnt(0)
ds_read_b64_tr_b16 v[32:33], v232 offset:16384
ds_read_b64_tr_b16 v[34:35], v232 offset:16896
ds_read_b64_tr_b16 v[36:37], v232 offset:18432
ds_read_b64_tr_b16 v[38:39], v232 offset:18944
ds_read_b64_tr_b16 v[40:41], v232 offset:20480
ds_read_b64_tr_b16 v[42:43], v232 offset:20992
ds_read_b64_tr_b16 v[44:45], v232 offset:22528
ds_read_b64_tr_b16 v[46:47], v232 offset:23040
s_waitcnt lgkmcnt(0)
ds_read_b64_tr_b16 v[48:49], v232 offset:24576
ds_read_b64_tr_b16 v[50:51], v232 offset:25088
ds_read_b64_tr_b16 v[52:53], v232 offset:26624
ds_read_b64_tr_b16 v[54:55], v232 offset:27136
ds_read_b64_tr_b16 v[56:57], v232 offset:28672
ds_read_b64_tr_b16 v[58:59], v232 offset:29184
ds_read_b64_tr_b16 v[60:61], v232 offset:30720
ds_read_b64_tr_b16 v[62:63], v232 offset:31232
s_waitcnt lgkmcnt(0)
s_add_u32 m0, s31, 0xc000
s_mov_b32 s32, 0xc000
buffer_load_dwordx4 v224, s[8:11], s32 offen offset:0 lds
buffer_load_dwordx4 v225, s[8:11], s32 offen offset:1024 lds
buffer_load_dwordx4 v226, s[8:11], s32 offen offset:2048 lds
buffer_load_dwordx4 v227, s[8:11], s32 offen offset:3072 lds
s_add_u32 m0, s31, 0x10000
s_mov_b32 s32, 0x10000
buffer_load_dwordx4 v224, s[8:11], s32 offen offset:0 lds
buffer_load_dwordx4 v225, s[8:11], s32 offen offset:1024 lds
buffer_load_dwordx4 v226, s[8:11], s32 offen offset:2048 lds
buffer_load_dwordx4 v227, s[8:11], s32 offen offset:3072 lds
s_add_u32 m0, s31, 0x14000
s_mov_b32 s32, 0x14000
buffer_load_dwordx4 v224, s[8:11], s32 offen offset:0 lds
buffer_load_dwordx4 v225, s[8:11], s32 offen offset:1024 lds
buffer_load_dwordx4 v226, s[8:11], s32 offen offset:2048 lds
buffer_load_dwordx4 v227, s[8:11], s32 offen offset:3072 lds
s_add_u32 m0, s31, 0x18000
s_mov_b32 s32, 0x18000
buffer_load_dwordx4 v224, s[8:11], s32 offen offset:0 lds
buffer_load_dwordx4 v225, s[8:11], s32 offen offset:1024 lds
buffer_load_dwordx4 v226, s[8:11], s32 offen offset:2048 lds
buffer_load_dwordx4 v227, s[8:11], s32 offen offset:3072 lds
s_add_u32 m0, s31, 0x1c000
s_mov_b32 s32, 0x1c000
buffer_load_dwordx4 v224, s[8:11], s32 offen offset:0 lds
buffer_load_dwordx4 v225, s[8:11], s32 offen offset:1024 lds
buffer_load_dwordx4 v226, s[8:11], s32 offen offset:2048 lds
buffer_load_dwordx4 v227, s[8:11], s32 offen offset:3072 lds
buffer_load_dword v243, off, s[4:7], 0 sc1
s_waitcnt vmcnt(25)
s_barrier
ds_read_b128 a[0:3], v192 offset:0
ds_read_b128 a[4:7], v193 offset:0
ds_read_b128 a[8:11], v194 offset:0
ds_read_b128 a[12:15], v195 offset:0
ds_read_b128 a[16:19], v196 offset:0
ds_read_b128 a[20:23], v197 offset:0
s_waitcnt lgkmcnt(4)
v_mfma_f32_32x32x16_bf16 v[64:79], a[0:3], v[0:3], 0
ds_read_b128 a[24:27], v198 offset:0
v_mfma_f32_32x32x16_bf16 v[64:79], a[4:7], v[4:7], v[64:79]
ds_read_b128 a[28:31], v199 offset:0
s_waitcnt lgkmcnt(4)
v_mfma_f32_32x32x16_bf16 v[64:79], a[8:11], v[8:11], v[64:79]
ds_read_b128 a[0:3], v192 offset:256
v_mfma_f32_32x32x16_bf16 v[64:79], a[12:15], v[12:15], v[64:79]
ds_read_b128 a[4:7], v193 offset:256
s_waitcnt lgkmcnt(4)
v_mfma_f32_32x32x16_bf16 v[64:79], a[16:19], v[16:19], v[64:79]
ds_read_b128 a[8:11], v194 offset:256
v_mfma_f32_32x32x16_bf16 v[64:79], a[20:23], v[20:23], v[64:79]
ds_read_b128 a[12:15], v195 offset:256
s_waitcnt lgkmcnt(4)
v_mfma_f32_32x32x16_bf16 v[64:79], a[24:27], v[24:27], v[64:79]
ds_read_b128 a[16:19], v196 offset:256
v_mfma_f32_32x32x16_bf16 v[64:79], a[28:31], v[28:31], v[64:79]
ds_read_b128 a[20:23], v197 offset:256
s_waitcnt lgkmcnt(4)
v_mfma_f32_32x32x16_bf16 v[64:79], a[0:3], v[32:35], v[64:79]
ds_read_b128 a[24:27], v198 offset:256
v_mfma_f32_32x32x16_bf16 v[64:79], a[4:7], v[36:39], v[64:79]
s_waitcnt vmcnt(17)
s_barrier
ds_read_b128 a[28:31], v199 offset:256
s_waitcnt lgkmcnt(4)
v_mfma_f32_32x32x16_bf16 v[64:79], a[8:11], v[40:43], v[64:79]
ds_read_b128 a[0:3], v192 offset:32768
v_mfma_f32_32x32x16_bf16 v[64:79], a[12:15], v[44:47], v[64:79]
ds_read_b128 a[4:7], v193 offset:32768
s_waitcnt lgkmcnt(4)
v_mfma_f32_32x32x16_bf16 v[64:79], a[16:19], v[48:51], v[64:79]
ds_read_b128 a[8:11], v194 offset:32768
v_mfma_f32_32x32x16_bf16 v[64:79], a[20:23], v[52:55], v[64:79]
ds_read_b128 a[12:15], v195 offset:32768
s_waitcnt lgkmcnt(4)
v_mfma_f32_32x32x16_bf16 v[64:79], a[24:27], v[56:59], v[64:79]
ds_read_b128 a[16:19], v196 offset:32768
v_mfma_f32_32x32x16_bf16 v[64:79], a[28:31], v[60:63], v[64:79]
ds_read_b128 a[20:23], v197 offset:32768
s_waitcnt lgkmcnt(4)
v_mfma_f32_32x32x16_bf16 v[80:95], a[0:3], v[0:3], 0
ds_read_b128 a[24:27], v198 offset:32768
v_mfma_f32_32x32x16_bf16 v[80:95], a[4:7], v[4:7], v[80:95]
ds_read_b128 a[28:31], v199 offset:32768
s_waitcnt lgkmcnt(4)
v_mfma_f32_32x32x16_bf16 v[80:95], a[8:11], v[8:11], v[80:95]
ds_read_b128 a[0:3], v192 offset:33024
v_mfma_f32_32x32x16_bf16 v[80:95], a[12:15], v[12:15], v[80:95]
ds_read_b128 a[4:7], v193 offset:33024
s_waitcnt lgkmcnt(4)
v_mfma_f32_32x32x16_bf16 v[80:95], a[16:19], v[16:19], v[80:95]
ds_read_b128 a[8:11], v194 offset:33024
v_mfma_f32_32x32x16_bf16 v[80:95], a[20:23], v[20:23], v[80:95]
ds_read_b128 a[12:15], v195 offset:33024
s_waitcnt lgkmcnt(4)
v_mfma_f32_32x32x16_bf16 v[80:95], a[24:27], v[24:27], v[80:95]
ds_read_b128 a[16:19], v196 offset:33024
v_mfma_f32_32x32x16_bf16 v[80:95], a[28:31], v[28:31], v[80:95]
ds_read_b128 a[20:23], v197 offset:33024
s_waitcnt lgkmcnt(4)
v_mfma_f32_32x32x16_bf16 v[80:95], a[0:3], v[32:35], v[80:95]
ds_read_b128 a[24:27], v198 offset:33024
v_mfma_f32_32x32x16_bf16 v[80:95], a[4:7], v[36:39], v[80:95]
s_waitcnt vmcnt(9)
s_barrier
ds_read_b128 a[28:31], v199 offset:33024
s_waitcnt lgkmcnt(4)
v_mfma_f32_32x32x16_bf16 v[80:95], a[8:11], v[40:43], v[80:95]
ds_read_b128 a[0:3], v200 offset:0
s_add_u32 m0, s31, 0x0
s_mov_b32 s32, 0x0
buffer_load_dwordx4 v224, s[12:15], s32 offen offset:0 lds
v_mfma_f32_32x32x16_bf16 v[80:95], a[12:15], v[44:47], v[80:95]
ds_read_b128 a[4:7], v201 offset:0
s_waitcnt lgkmcnt(4)
v_mfma_f32_32x32x16_bf16 v[80:95], a[16:19], v[48:51], v[80:95]
ds_read_b128 a[8:11], v202 offset:0
buffer_load_dwordx4 v225, s[12:15], s32 offen offset:1024 lds
v_mfma_f32_32x32x16_bf16 v[80:95], a[20:23], v[52:55], v[80:95]
ds_read_b128 a[12:15], v203 offset:0
s_waitcnt lgkmcnt(4)
v_mfma_f32_32x32x16_bf16 v[80:95], a[24:27], v[56:59], v[80:95]
ds_read_b128 a[16:19], v204 offset:0
buffer_load_dwordx4 v226, s[12:15], s32 offen offset:2048 lds
v_mfma_f32_32x32x16_bf16 v[80:95], a[28:31], v[60:63], v[80:95]
ds_read_b128 a[20:23], v205 offset:0
s_waitcnt lgkmcnt(4)
v_mfma_f32_32x32x16_bf16 v[96:111], a[0:3], v[0:3], 0
ds_read_b128 a[24:27], v206 offset:0
buffer_load_dwordx4 v227, s[12:15], s32 offen offset:3072 lds
v_mfma_f32_32x32x16_bf16 v[96:111], a[4:7], v[4:7], v[96:111]
ds_read_b128 a[28:31], v207 offset:0
s_waitcnt lgkmcnt(4)
v_mfma_f32_32x32x16_bf16 v[96:111], a[8:11], v[8:11], v[96:111]
ds_read_b128 a[0:3], v200 offset:256
s_add_u32 m0, s31, 0x4000
s_mov_b32 s32, 0x4000
buffer_load_dwordx4 v224, s[12:15], s32 offen offset:0 lds
v_mfma_f32_32x32x16_bf16 v[96:111], a[12:15], v[12:15], v[96:111]
ds_read_b128 a[4:7], v201 offset:256
s_waitcnt lgkmcnt(4)
v_mfma_f32_32x32x16_bf16 v[96:111], a[16:19], v[16:19], v[96:111]
ds_read_b128 a[8:11], v202 offset:256
buffer_load_dwordx4 v225, s[12:15], s32 offen offset:1024 lds
v_mfma_f32_32x32x16_bf16 v[96:111], a[20:23], v[20:23], v[96:111]
ds_read_b128 a[12:15], v203 offset:256
s_waitcnt lgkmcnt(4)
v_mfma_f32_32x32x16_bf16 v[96:111], a[24:27], v[24:27], v[96:111]
ds_read_b128 a[16:19], v204 offset:256
buffer_load_dwordx4 v226, s[12:15], s32 offen offset:2048 lds
v_mfma_f32_32x32x16_bf16 v[96:111], a[28:31], v[28:31], v[96:111]
ds_read_b128 a[20:23], v205 offset:256
s_waitcnt lgkmcnt(4)
v_mfma_f32_32x32x16_bf16 v[96:111], a[0:3], v[32:35], v[96:111]
ds_read_b128 a[24:27], v206 offset:256
buffer_load_dwordx4 v227, s[12:15], s32 offen offset:3072 lds
v_mfma_f32_32x32x16_bf16 v[96:111], a[4:7], v[36:39], v[96:111]
s_waitcnt vmcnt(9)
s_barrier
ds_read_b128 a[28:31], v207 offset:256
s_waitcnt lgkmcnt(4)
v_mfma_f32_32x32x16_bf16 v[96:111], a[8:11], v[40:43], v[96:111]
ds_read_b128 a[0:3], v200 offset:32768
s_add_u32 m0, s31, 0x8000
s_mov_b32 s32, 0x8000
buffer_load_dwordx4 v224, s[12:15], s32 offen offset:0 lds
v_mfma_f32_32x32x16_bf16 v[96:111], a[12:15], v[44:47], v[96:111]
ds_read_b128 a[4:7], v201 offset:32768
s_waitcnt lgkmcnt(4)
v_mfma_f32_32x32x16_bf16 v[96:111], a[16:19], v[48:51], v[96:111]
ds_read_b128 a[8:11], v202 offset:32768
buffer_load_dwordx4 v225, s[12:15], s32 offen offset:1024 lds
v_mfma_f32_32x32x16_bf16 v[96:111], a[20:23], v[52:55], v[96:111]
ds_read_b128 a[12:15], v203 offset:32768
s_waitcnt lgkmcnt(4)
v_mfma_f32_32x32x16_bf16 v[96:111], a[24:27], v[56:59], v[96:111]
ds_read_b128 a[16:19], v204 offset:32768
buffer_load_dwordx4 v226, s[12:15], s32 offen offset:2048 lds
v_mfma_f32_32x32x16_bf16 v[96:111], a[28:31], v[60:63], v[96:111]
ds_read_b128 a[20:23], v205 offset:32768
s_waitcnt lgkmcnt(4)
v_mfma_f32_32x32x16_bf16 v[112:127], a[0:3], v[0:3], 0
ds_read_b128 a[24:27], v206 offset:32768
buffer_load_dwordx4 v227, s[12:15], s32 offen offset:3072 lds
v_mfma_f32_32x32x16_bf16 v[112:127], a[4:7], v[4:7], v[112:127]
ds_read_b128 a[28:31], v207 offset:32768
s_waitcnt lgkmcnt(4)
v_mfma_f32_32x32x16_bf16 v[112:127], a[8:11], v[8:11], v[112:127]
ds_read_b128 a[0:3], v200 offset:33024
s_add_u32 m0, s31, 0xc000
s_mov_b32 s32, 0xc000
buffer_load_dwordx4 v224, s[12:15], s32 offen offset:0 lds
v_mfma_f32_32x32x16_bf16 v[112:127], a[12:15], v[12:15], v[112:127]
ds_read_b128 a[4:7], v201 offset:33024
s_waitcnt lgkmcnt(4)
v_mfma_f32_32x32x16_bf16 v[112:127], a[16:19], v[16:19], v[112:127]
ds_read_b128 a[8:11], v202 offset:33024
buffer_load_dwordx4 v225, s[12:15], s32 offen offset:1024 lds
v_mfma_f32_32x32x16_bf16 v[112:127], a[20:23], v[20:23], v[112:127]
ds_read_b128 a[12:15], v203 offset:33024
s_waitcnt lgkmcnt(4)
v_mfma_f32_32x32x16_bf16 v[112:127], a[24:27], v[24:27], v[112:127]
ds_read_b128 a[16:19], v204 offset:33024
buffer_load_dwordx4 v226, s[12:15], s32 offen offset:2048 lds
v_mfma_f32_32x32x16_bf16 v[112:127], a[28:31], v[28:31], v[112:127]
ds_read_b128 a[20:23], v205 offset:33024
s_waitcnt lgkmcnt(4)
v_mfma_f32_32x32x16_bf16 v[112:127], a[0:3], v[32:35], v[112:127]
ds_read_b128 a[24:27], v206 offset:33024
buffer_load_dwordx4 v227, s[12:15], s32 offen offset:3072 lds
v_mfma_f32_32x32x16_bf16 v[112:127], a[4:7], v[36:39], v[112:127]
ds_read_b128 a[28:31], v207 offset:33024
s_waitcnt lgkmcnt(4)
v_mfma_f32_32x32x16_bf16 v[112:127], a[8:11], v[40:43], v[112:127]
v_mfma_f32_32x32x16_bf16 v[112:127], a[12:15], v[44:47], v[112:127]
s_waitcnt lgkmcnt(2)
v_mfma_f32_32x32x16_bf16 v[112:127], a[16:19], v[48:51], v[112:127]
v_mfma_f32_32x32x16_bf16 v[112:127], a[20:23], v[52:55], v[112:127]
s_waitcnt lgkmcnt(0)
v_mfma_f32_32x32x16_bf16 v[112:127], a[24:27], v[56:59], v[112:127]
v_mfma_f32_32x32x16_bf16 v[112:127], a[28:31], v[60:63], v[112:127]
s_barrier
s_nop 15
v_lshlrev_b32 v232, 4, v240
s_lshl_b32 s33, s29, 14
s_add_u32 s33, s33, 131072
v_add_u32 v233, s33, v232
s_lshl_b32 s34, s30, 11
v_add_u32 v232, s34, v233
v_cvt_pk_bf16_f32 v244, v64, v65
v_cvt_pk_bf16_f32 v245, v66, v67
v_cvt_pk_bf16_f32 v246, v68, v69
v_cvt_pk_bf16_f32 v247, v70, v71
v_cvt_pk_bf16_f32 v248, v72, v73
v_cvt_pk_bf16_f32 v249, v74, v75
v_cvt_pk_bf16_f32 v250, v76, v77
v_cvt_pk_bf16_f32 v251, v78, v79
s_nop 1
v_permlane32_swap_b32 v244, v246
v_permlane32_swap_b32 v245, v247
v_permlane32_swap_b32 v248, v250
v_permlane32_swap_b32 v249, v251
ds_write_b128 v232, v[244:247] offset:0
ds_write_b128 v232, v[248:251] offset:1024
v_cvt_pk_bf16_f32 v0, v80, v81
v_cvt_pk_bf16_f32 v1, v82, v83
v_cvt_pk_bf16_f32 v2, v84, v85
v_cvt_pk_bf16_f32 v3, v86, v87
v_cvt_pk_bf16_f32 v4, v88, v89
v_cvt_pk_bf16_f32 v5, v90, v91
v_cvt_pk_bf16_f32 v6, v92, v93
v_cvt_pk_bf16_f32 v7, v94, v95
s_nop 1
v_permlane32_swap_b32 v0, v2
v_permlane32_swap_b32 v1, v3
v_permlane32_swap_b32 v4, v6
v_permlane32_swap_b32 v5, v7
ds_write_b128 v232, v[0:3] offset:4096
ds_write_b128 v232, v[4:7] offset:5120
v_cvt_pk_bf16_f32 v244, v96, v97
v_cvt_pk_bf16_f32 v245, v98, v99
v_cvt_pk_bf16_f32 v246, v100, v101
v_cvt_pk_bf16_f32 v247, v102, v103
v_cvt_pk_bf16_f32 v248, v104, v105
v_cvt_pk_bf16_f32 v249, v106, v107
v_cvt_pk_bf16_f32 v250, v108, v109
v_cvt_pk_bf16_f32 v251, v110, v111
s_nop 1
v_permlane32_swap_b32 v244, v246
v_permlane32_swap_b32 v245, v247
v_permlane32_swap_b32 v248, v250
v_permlane32_swap_b32 v249, v251
ds_write_b128 v232, v[244:247] offset:8192
ds_write_b128 v232, v[248:251] offset:9216
v_cvt_pk_bf16_f32 v0, v112, v113
v_cvt_pk_bf16_f32 v1, v114, v115
v_cvt_pk_bf16_f32 v2, v116, v117
v_cvt_pk_bf16_f32 v3, v118, v119
v_cvt_pk_bf16_f32 v4, v120, v121
v_cvt_pk_bf16_f32 v5, v122, v123
v_cvt_pk_bf16_f32 v6, v124, v125
v_cvt_pk_bf16_f32 v7, v126, v127
s_nop 1
v_permlane32_swap_b32 v0, v2
v_permlane32_swap_b32 v1, v3
v_permlane32_swap_b32 v4, v6
v_permlane32_swap_b32 v5, v7
ds_write_b128 v232, v[0:3] offset:12288
ds_write_b128 v232, v[4:7] offset:13312
s_waitcnt lgkmcnt(0)
s_barrier
ds_read_b128 v[0:3], v233 offset:0
ds_read_b128 v[4:7], v233 offset:1024
ds_read_b128 v[8:11], v233 offset:2048
ds_read_b128 v[12:15], v233 offset:3072
ds_read_b128 v[16:19], v233 offset:4096
ds_read_b128 v[20:23], v233 offset:5120
ds_read_b128 v[24:27], v233 offset:6144
ds_read_b128 v[28:31], v233 offset:7168
ds_read_b128 v[32:35], v233 offset:8192
ds_read_b128 v[36:39], v233 offset:9216
ds_read_b128 v[40:43], v233 offset:10240
ds_read_b128 v[44:47], v233 offset:11264
ds_read_b128 v[48:51], v233 offset:12288
ds_read_b128 v[52:55], v233 offset:13312
ds_read_b128 v[56:59], v233 offset:14336
ds_read_b128 v[60:63], v233 offset:15360
s_waitcnt lgkmcnt(0)
s_waitcnt vmcnt(8)
s_barrier
ds_read_b128 a[0:3], v192 offset:0
s_add_u32 m0, s31, 0x10000
s_mov_b32 s32, 0x10000
buffer_load_dwordx4 v224, s[12:15], s32 offen offset:0 lds
ds_read_b128 a[4:7], v193 offset:0
ds_read_b128 a[8:11], v194 offset:0
buffer_load_dwordx4 v225, s[12:15], s32 offen offset:1024 lds
ds_read_b128 a[12:15], v195 offset:0
ds_read_b128 a[16:19], v196 offset:0
buffer_load_dwordx4 v226, s[12:15], s32 offen offset:2048 lds
ds_read_b128 a[20:23], v197 offset:0
s_waitcnt lgkmcnt(4)
v_mfma_f32_32x32x16_bf16 v[128:143], a[0:3], v[0:3], 0
ds_read_b128 a[24:27], v198 offset:0
buffer_load_dwordx4 v227, s[12:15], s32 offen offset:3072 lds
v_mfma_f32_32x32x16_bf16 v[128:143], a[4:7], v[4:7], v[128:143]
ds_read_b128 a[28:31], v199 offset:0
s_waitcnt lgkmcnt(4)
v_mfma_f32_32x32x16_bf16 v[128:143], a[8:11], v[8:11], v[128:143]
ds_read_b128 a[0:3], v192 offset:256
s_add_u32 m0, s31, 0x14000
s_mov_b32 s32, 0x14000
buffer_load_dwordx4 v224, s[12:15], s32 offen offset:0 lds
v_mfma_f32_32x32x16_bf16 v[128:143], a[12:15], v[12:15], v[128:143]
ds_read_b128 a[4:7], v193 offset:256
s_waitcnt lgkmcnt(4)
v_mfma_f32_32x32x16_bf16 v[128:143], a[16:19], v[16:19], v[128:143]
ds_read_b128 a[8:11], v194 offset:256
buffer_load_dwordx4 v225, s[12:15], s32 offen offset:1024 lds
v_mfma_f32_32x32x16_bf16 v[128:143], a[20:23], v[20:23], v[128:143]
ds_read_b128 a[12:15], v195 offset:256
s_waitcnt lgkmcnt(4)
v_mfma_f32_32x32x16_bf16 v[128:143], a[24:27], v[24:27], v[128:143]
ds_read_b128 a[16:19], v196 offset:256
buffer_load_dwordx4 v226, s[12:15], s32 offen offset:2048 lds
v_mfma_f32_32x32x16_bf16 v[128:143], a[28:31], v[28:31], v[128:143]
ds_read_b128 a[20:23], v197 offset:256
s_waitcnt lgkmcnt(4)
v_mfma_f32_32x32x16_bf16 v[128:143], a[0:3], v[32:35], v[128:143]
ds_read_b128 a[24:27], v198 offset:256
buffer_load_dwordx4 v227, s[12:15], s32 offen offset:3072 lds
v_mfma_f32_32x32x16_bf16 v[128:143], a[4:7], v[36:39], v[128:143]
s_waitcnt vmcnt(8)
s_barrier
ds_read_b128 a[28:31], v199 offset:256
s_waitcnt lgkmcnt(4)
v_mfma_f32_32x32x16_bf16 v[128:143], a[8:11], v[40:43], v[128:143]
ds_read_b128 a[0:3], v192 offset:32768
s_add_u32 m0, s31, 0x18000
s_mov_b32 s32, 0x18000
buffer_load_dwordx4 v224, s[12:15], s32 offen offset:0 lds
v_mfma_f32_32x32x16_bf16 v[128:143], a[12:15], v[44:47], v[128:143]
ds_read_b128 a[4:7], v193 offset:32768
s_waitcnt lgkmcnt(4)
v_mfma_f32_32x32x16_bf16 v[128:143], a[16:19], v[48:51], v[128:143]
ds_read_b128 a[8:11], v194 offset:32768
buffer_load_dwordx4 v225, s[12:15], s32 offen offset:1024 lds
v_mfma_f32_32x32x16_bf16 v[128:143], a[20:23], v[52:55], v[128:143]
ds_read_b128 a[12:15], v195 offset:32768
s_waitcnt lgkmcnt(4)
v_mfma_f32_32x32x16_bf16 v[128:143], a[24:27], v[56:59], v[128:143]
ds_read_b128 a[16:19], v196 offset:32768
buffer_load_dwordx4 v226, s[12:15], s32 offen offset:2048 lds
v_mfma_f32_32x32x16_bf16 v[128:143], a[28:31], v[60:63], v[128:143]
ds_read_b128 a[20:23], v197 offset:32768
s_waitcnt lgkmcnt(4)
v_mfma_f32_32x32x16_bf16 v[144:159], a[0:3], v[0:3], 0
ds_read_b128 a[24:27], v198 offset:32768
buffer_load_dwordx4 v227, s[12:15], s32 offen offset:3072 lds
v_mfma_f32_32x32x16_bf16 v[144:159], a[4:7], v[4:7], v[144:159]
ds_read_b128 a[28:31], v199 offset:32768
s_waitcnt lgkmcnt(4)
v_mfma_f32_32x32x16_bf16 v[144:159], a[8:11], v[8:11], v[144:159]
ds_read_b128 a[0:3], v192 offset:33024
s_add_u32 m0, s31, 0x1c000
s_mov_b32 s32, 0x1c000
buffer_load_dwordx4 v224, s[12:15], s32 offen offset:0 lds
v_mfma_f32_32x32x16_bf16 v[144:159], a[12:15], v[12:15], v[144:159]
ds_read_b128 a[4:7], v193 offset:33024
s_waitcnt lgkmcnt(4)
v_mfma_f32_32x32x16_bf16 v[144:159], a[16:19], v[16:19], v[144:159]
ds_read_b128 a[8:11], v194 offset:33024
buffer_load_dwordx4 v225, s[12:15], s32 offen offset:1024 lds
v_mfma_f32_32x32x16_bf16 v[144:159], a[20:23], v[20:23], v[144:159]
ds_read_b128 a[12:15], v195 offset:33024
s_waitcnt lgkmcnt(4)
v_mfma_f32_32x32x16_bf16 v[144:159], a[24:27], v[24:27], v[144:159]
ds_read_b128 a[16:19], v196 offset:33024
buffer_load_dwordx4 v226, s[12:15], s32 offen offset:2048 lds
v_mfma_f32_32x32x16_bf16 v[144:159], a[28:31], v[28:31], v[144:159]
ds_read_b128 a[20:23], v197 offset:33024
s_waitcnt lgkmcnt(4)
v_mfma_f32_32x32x16_bf16 v[144:159], a[0:3], v[32:35], v[144:159]
ds_read_b128 a[24:27], v198 offset:33024
buffer_load_dwordx4 v227, s[12:15], s32 offen offset:3072 lds
v_mfma_f32_32x32x16_bf16 v[144:159], a[4:7], v[36:39], v[144:159]
s_waitcnt vmcnt(8)
s_barrier
ds_read_b128 a[28:31], v199 offset:33024
s_waitcnt lgkmcnt(4)
v_mfma_f32_32x32x16_bf16 v[144:159], a[8:11], v[40:43], v[144:159]
ds_read_b128 a[0:3], v200 offset:0
v_mfma_f32_32x32x16_bf16 v[144:159], a[12:15], v[44:47], v[144:159]
ds_read_b128 a[4:7], v201 offset:0
s_waitcnt lgkmcnt(4)
v_mfma_f32_32x32x16_bf16 v[144:159], a[16:19], v[48:51], v[144:159]
ds_read_b128 a[8:11], v202 offset:0
v_mfma_f32_32x32x16_bf16 v[144:159], a[20:23], v[52:55], v[144:159]
ds_read_b128 a[12:15], v203 offset:0
s_waitcnt lgkmcnt(4)
v_mfma_f32_32x32x16_bf16 v[144:159], a[24:27], v[56:59], v[144:159]
ds_read_b128 a[16:19], v204 offset:0
v_mfma_f32_32x32x16_bf16 v[144:159], a[28:31], v[60:63], v[144:159]
ds_read_b128 a[20:23], v205 offset:0
s_waitcnt lgkmcnt(4)
v_mfma_f32_32x32x16_bf16 v[160:175], a[0:3], v[0:3], 0
ds_read_b128 a[24:27], v206 offset:0
v_mfma_f32_32x32x16_bf16 v[160:175], a[4:7], v[4:7], v[160:175]
ds_read_b128 a[28:31], v207 offset:0
s_waitcnt lgkmcnt(4)
v_mfma_f32_32x32x16_bf16 v[160:175], a[8:11], v[8:11], v[160:175]
ds_read_b128 a[0:3], v200 offset:256
v_mfma_f32_32x32x16_bf16 v[160:175], a[12:15], v[12:15], v[160:175]
ds_read_b128 a[4:7], v201 offset:256
s_waitcnt lgkmcnt(4)
v_mfma_f32_32x32x16_bf16 v[160:175], a[16:19], v[16:19], v[160:175]
ds_read_b128 a[8:11], v202 offset:256
v_mfma_f32_32x32x16_bf16 v[160:175], a[20:23], v[20:23], v[160:175]
ds_read_b128 a[12:15], v203 offset:256
s_waitcnt lgkmcnt(4)
v_mfma_f32_32x32x16_bf16 v[160:175], a[24:27], v[24:27], v[160:175]
ds_read_b128 a[16:19], v204 offset:256
v_mfma_f32_32x32x16_bf16 v[160:175], a[28:31], v[28:31], v[160:175]
ds_read_b128 a[20:23], v205 offset:256
s_waitcnt lgkmcnt(4)
v_mfma_f32_32x32x16_bf16 v[160:175], a[0:3], v[32:35], v[160:175]
ds_read_b128 a[24:27], v206 offset:256
v_mfma_f32_32x32x16_bf16 v[160:175], a[4:7], v[36:39], v[160:175]
s_waitcnt vmcnt(0)
s_barrier
ds_read_b128 a[28:31], v207 offset:256
s_waitcnt lgkmcnt(4)
v_mfma_f32_32x32x16_bf16 v[160:175], a[8:11], v[40:43], v[160:175]
ds_read_b128 a[0:3], v200 offset:32768
v_mfma_f32_32x32x16_bf16 v[160:175], a[12:15], v[44:47], v[160:175]
ds_read_b128 a[4:7], v201 offset:32768
s_waitcnt lgkmcnt(4)
v_mfma_f32_32x32x16_bf16 v[160:175], a[16:19], v[48:51], v[160:175]
ds_read_b128 a[8:11], v202 offset:32768
v_mfma_f32_32x32x16_bf16 v[160:175], a[20:23], v[52:55], v[160:175]
ds_read_b128 a[12:15], v203 offset:32768
s_waitcnt lgkmcnt(4)
v_mfma_f32_32x32x16_bf16 v[160:175], a[24:27], v[56:59], v[160:175]
ds_read_b128 a[16:19], v204 offset:32768
v_mfma_f32_32x32x16_bf16 v[160:175], a[28:31], v[60:63], v[160:175]
ds_read_b128 a[20:23], v205 offset:32768
s_waitcnt lgkmcnt(4)
v_mfma_f32_32x32x16_bf16 v[176:191], a[0:3], v[0:3], 0
ds_read_b128 a[24:27], v206 offset:32768
v_mfma_f32_32x32x16_bf16 v[176:191], a[4:7], v[4:7], v[176:191]
ds_read_b128 a[28:31], v207 offset:32768
s_waitcnt lgkmcnt(4)
v_mfma_f32_32x32x16_bf16 v[176:191], a[8:11], v[8:11], v[176:191]
ds_read_b128 a[0:3], v200 offset:33024
v_mfma_f32_32x32x16_bf16 v[176:191], a[12:15], v[12:15], v[176:191]
ds_read_b128 a[4:7], v201 offset:33024
s_waitcnt lgkmcnt(4)
v_mfma_f32_32x32x16_bf16 v[176:191], a[16:19], v[16:19], v[176:191]
ds_read_b128 a[8:11], v202 offset:33024
v_mfma_f32_32x32x16_bf16 v[176:191], a[20:23], v[20:23], v[176:191]
ds_read_b128 a[12:15], v203 offset:33024
s_waitcnt lgkmcnt(4)
v_mfma_f32_32x32x16_bf16 v[176:191], a[24:27], v[24:27], v[176:191]
ds_read_b128 a[16:19], v204 offset:33024
v_mfma_f32_32x32x16_bf16 v[176:191], a[28:31], v[28:31], v[176:191]
ds_read_b128 a[20:23], v205 offset:33024
s_waitcnt lgkmcnt(4)
v_mfma_f32_32x32x16_bf16 v[176:191], a[0:3], v[32:35], v[176:191]
ds_read_b128 a[24:27], v206 offset:33024
v_mfma_f32_32x32x16_bf16 v[176:191], a[4:7], v[36:39], v[176:191]
ds_read_b128 a[28:31], v207 offset:33024
s_waitcnt lgkmcnt(4)
v_mfma_f32_32x32x16_bf16 v[176:191], a[8:11], v[40:43], v[176:191]
v_mfma_f32_32x32x16_bf16 v[176:191], a[12:15], v[44:47], v[176:191]
s_waitcnt lgkmcnt(2)
v_mfma_f32_32x32x16_bf16 v[176:191], a[16:19], v[48:51], v[176:191]
v_mfma_f32_32x32x16_bf16 v[176:191], a[20:23], v[52:55], v[176:191]
s_waitcnt lgkmcnt(0)
v_mfma_f32_32x32x16_bf16 v[176:191], a[24:27], v[56:59], v[176:191]
v_mfma_f32_32x32x16_bf16 v[176:191], a[28:31], v[60:63], v[176:191]
s_nop 15
s_lshl_b32 s33, s35, 2
s_lshl_b32 s34, s29, 1
s_add_u32 s33, s33, s34
s_lshl_b32 s33, s33, 14
s_lshl_b32 s34, s30, 10
s_add_u32 s33, s33, s34
v_lshrrev_b32 v232, 4, v242
v_lshlrev_b32 v232, 14, v232
v_and_b32 v233, 15, v242
v_lshl_add_u32 v233, v241, 4, v233
v_lshl_add_u32 v232, v233, 4, v232
v_add_u32 v232, s33, v232
v_cvt_pk_bf16_f32 v244, v128, v129
v_cvt_pk_bf16_f32 v245, v130, v131
v_cvt_pk_bf16_f32 v246, v136, v137
v_cvt_pk_bf16_f32 v247, v138, v139
v_cvt_pk_bf16_f32 v248, v132, v133
v_cvt_pk_bf16_f32 v249, v134, v135
v_cvt_pk_bf16_f32 v250, v140, v141
v_cvt_pk_bf16_f32 v251, v142, v143
s_mov_b32 s33, 0
buffer_store_dwordx4 v[244:247], v232, s[24:27], s33 offen offset:0 sc1
buffer_store_dwordx4 v[248:251], v232, s[24:27], s33 offen offset:512 sc1
s_nop 1
v_cvt_pk_bf16_f32 v244, v144, v145
v_cvt_pk_bf16_f32 v245, v146, v147
v_cvt_pk_bf16_f32 v246, v152, v153
v_cvt_pk_bf16_f32 v247, v154, v155
v_cvt_pk_bf16_f32 v248, v148, v149
v_cvt_pk_bf16_f32 v249, v150, v151
v_cvt_pk_bf16_f32 v250, v156, v157
v_cvt_pk_bf16_f32 v251, v158, v159
s_mov_b32 s33, 2048
buffer_store_dwordx4 v[244:247], v232, s[24:27], s33 offen offset:0 sc1
buffer_store_dwordx4 v[248:251], v232, s[24:27], s33 offen offset:512 sc1
s_nop 1
v_cvt_pk_bf16_f32 v244, v160, v161
v_cvt_pk_bf16_f32 v245, v162, v163
v_cvt_pk_bf16_f32 v246, v168, v169
v_cvt_pk_bf16_f32 v247, v170, v171
v_cvt_pk_bf16_f32 v248, v164, v165
v_cvt_pk_bf16_f32 v249, v166, v167
v_cvt_pk_bf16_f32 v250, v172, v173
v_cvt_pk_bf16_f32 v251, v174, v175
s_mov_b32 s33, 4096
buffer_store_dwordx4 v[244:247], v232, s[24:27], s33 offen offset:0 sc1
buffer_store_dwordx4 v[248:251], v232, s[24:27], s33 offen offset:512 sc1
s_nop 1
v_cvt_pk_bf16_f32 v244, v176, v177
v_cvt_pk_bf16_f32 v245, v178, v179
v_cvt_pk_bf16_f32 v246, v184, v185
v_cvt_pk_bf16_f32 v247, v186, v187
v_cvt_pk_bf16_f32 v248, v180, v181
v_cvt_pk_bf16_f32 v249, v182, v183
v_cvt_pk_bf16_f32 v250, v188, v189
v_cvt_pk_bf16_f32 v251, v190, v191
s_mov_b32 s33, 6144
buffer_store_dwordx4 v[244:247], v232, s[24:27], s33 offen offset:0 sc1
buffer_store_dwordx4 v[248:251], v232, s[24:27], s33 offen offset:512 sc1
s_nop 1
s_branch K1_FIN
K1_W2:
v_mov_b32 v224, v228
v_mov_b32 v225, v229
v_mov_b32 v226, v230
v_mov_b32 v227, v231
s_sub_u32 s35, s2, 254
s_lshl_b32 s35, s35, 1
s_add_u32 s16, s52, 0x0
s_addc_u32 s17, s53, 0
s_mov_b32 s18, 0x40000
s_mov_b32 s19, 0x20000
s_add_u32 s8, s50, 0x0
s_addc_u32 s9, s51, 0
s_mov_b32 s10, 0x20000
s_mov_b32 s11, 0x20000
s_add_u32 s24, s54, 0x1000000
s_addc_u32 s25, s55, 0
s_mov_b32 s26, 0x40000
s_mov_b32 s27, 0x20000
v_lshrrev_b32 v232, 3, v240
v_lshlrev_b32 v232, 9, v232
v_and_b32 v233, 7, v240
v_lshl_add_u32 v232, v233, 4, v232
s_lshl_b32 s33, s35, 7
s_lshl_b32 s34, s28, 15
s_add_u32 s33, s33, s34
s_add_u32 s33, s33, 131072
v_add_u32 v232, s33, v232
s_lshl_b32 s34, s28, 13
s_add_u32 s34, s34, 131072
s_add_u32 m0, s34, 0
s_mov_b32 s32, 0
buffer_load_dwordx4 v232, s[16:19], s32 offen lds
s_add_u32 m0, s34, 1024
s_mov_b32 s32, 4096
buffer_load_dwordx4 v232, s[16:19], s32 offen lds
s_add_u32 m0, s34, 2048
s_mov_b32 s32, 8192
buffer_load_dwordx4 v232, s[16:19], s32 offen lds
s_add_u32 m0, s34, 3072
s_mov_b32 s32, 12288
buffer_load_dwordx4 v232, s[16:19], s32 offen lds
s_add_u32 m0, s34, 4096
s_mov_b32 s32, 16384
buffer_load_dwordx4 v232, s[16:19], s32 offen lds
s_add_u32 m0, s34, 5120
s_mov_b32 s32, 20480
buffer_load_dwordx4 v232, s[16:19], s32 offen lds
s_add_u32 m0, s34, 6144
s_mov_b32 s32, 24576
buffer_load_dwordx4 v232, s[16:19], s32 offen lds
s_add_u32 m0, s34, 7168
s_mov_b32 s32, 28672
buffer_load_dwordx4 v232, s[16:19], s32 offen lds
s_add_u32 m0, s31, 0x0
s_mov_b32 s32, 0x0
buffer_load_dwordx4 v224, s[8:11], s32 offen offset:0 lds
buffer_load_dwordx4 v225, s[8:11], s32 offen offset:1024 lds
buffer_load_dwordx4 v226, s[8:11], s32 offen offset:2048 lds
buffer_load_dwordx4 v227, s[8:11], s32 offen offset:3072 lds
s_add_u32 m0, s31, 0x4000
s_mov_b32 s32, 0x4000
buffer_load_dwordx4 v224, s[8:11], s32 offen offset:0 lds
buffer_load_dwordx4 v225, s[8:11], s32 offen offset:1024 lds
buffer_load_dwordx4 v226, s[8:11], s32 offen offset:2048 lds
buffer_load_dwordx4 v227, s[8:11], s32 offen offset:3072 lds
s_add_u32 m0, s31, 0x8000
s_mov_b32 s32, 0x8000
buffer_load_dwordx4 v224, s[8:11], s32 offen offset:0 lds
buffer_load_dwordx4 v225, s[8:11], s32 offen offset:1024 lds
buffer_load_dwordx4 v226, s[8:11], s32 offen offset:2048 lds
buffer_load_dwordx4 v227, s[8:11], s32 offen offset:3072 lds
v_and_b32 v234, 3, v242
v_lshlrev_b32 v234, 2, v234
v_bfe_u32 v235, v242, 2, 2
v_or_b32 v234, v234, v235
v_lshlrev_b32 v236, 9, v242
s_lshl_b32 s33, s30, 14
v_add_u32 v236, s33, v236
v_add_u32 v235, 0, v241
v_xor_b32 v235, v235, v234
v_lshl_add_u32 v192, v235, 4, v236
v_add_u32 v200, 0x10000, v192
v_add_u32 v235, 2, v241
v_xor_b32 v235, v235, v234
v_lshl_add_u32 v193, v235, 4, v236
v_add_u32 v201, 0x10000, v193
v_add_u32 v235, 4, v241
v_xor_b32 v235, v235, v234
v_lshl_add_u32 v194, v235, 4, v236
v_add_u32 v202, 0x10000, v194
v_add_u32 v235, 6, v241
v_xor_b32 v235, v235, v234
v_lshl_add_u32 v195, v235, 4, v236
v_add_u32 v203, 0x10000, v195
v_add_u32 v235, 8, v241
v_xor_b32 v235, v235, v234
v_lshl_add_u32 v196, v235, 4, v236
v_add_u32 v204, 0x10000, v196
v_add_u32 v235, 10, v241
v_xor_b32 v235, v235, v234
v_lshl_add_u32 v197, v235, 4, v236
v_add_u32 v205, 0x10000, v197
v_add_u32 v235, 12, v241
v_xor_b32 v235, v235, v234
v_lshl_add_u32 v198, v235, 4, v236
v_add_u32 v206, 0x10000, v198
v_add_u32 v235, 14, v241
v_xor_b32 v235, v235, v234
v_lshl_add_u32 v199, v235, 4, v236
v_add_u32 v207, 0x10000, v199
v_accvgpr_write_b32 a128, 0
v_accvgpr_write_b32 a129, 0
v_accvgpr_write_b32 a130, 0
v_accvgpr_write_b32 a131, 0
v_accvgpr_write_b32 a132, 0
v_accvgpr_write_b32 a133, 0
v_accvgpr_write_b32 a134, 0
v_accvgpr_write_b32 a135, 0
v_accvgpr_write_b32 a136, 0
v_accvgpr_write_b32 a137, 0
v_accvgpr_write_b32 a138, 0
v_accvgpr_write_b32 a139, 0
v_accvgpr_write_b32 a140, 0
v_accvgpr_write_b32 a141, 0
v_accvgpr_write_b32 a142, 0
v_accvgpr_write_b32 a143, 0
v_accvgpr_write_b32 a144, 0
v_accvgpr_write_b32 a145, 0
v_accvgpr_write_b32 a146, 0
v_accvgpr_write_b32 a147, 0
v_accvgpr_write_b32 a148, 0
v_accvgpr_write_b32 a149, 0
v_accvgpr_write_b32 a150, 0
v_accvgpr_write_b32 a151, 0
v_accvgpr_write_b32 a152, 0
v_accvgpr_write_b32 a153, 0
v_accvgpr_write_b32 a154, 0
v_accvgpr_write_b32 a155, 0
v_accvgpr_write_b32 a156, 0
v_accvgpr_write_b32 a157, 0
v_accvgpr_write_b32 a158, 0
v_accvgpr_write_b32 a159, 0
v_accvgpr_write_b32 a160, 0
v_accvgpr_write_b32 a161, 0
v_accvgpr_write_b32 a162, 0
v_accvgpr_write_b32 a163, 0
v_accvgpr_write_b32 a164, 0
v_accvgpr_write_b32 a165, 0
v_accvgpr_write_b32 a166, 0
v_accvgpr_write_b32 a167, 0
v_accvgpr_write_b32 a168, 0
v_accvgpr_write_b32 a169, 0
v_accvgpr_write_b32 a170, 0
v_accvgpr_write_b32 a171, 0
v_accvgpr_write_b32 a172, 0
v_accvgpr_write_b32 a173, 0
v_accvgpr_write_b32 a174, 0
v_accvgpr_write_b32 a175, 0
v_accvgpr_write_b32 a176, 0
v_accvgpr_write_b32 a177, 0
v_accvgpr_write_b32 a178, 0
v_accvgpr_write_b32 a179, 0
v_accvgpr_write_b32 a180, 0
v_accvgpr_write_b32 a181, 0
v_accvgpr_write_b32 a182, 0
v_accvgpr_write_b32 a183, 0
v_accvgpr_write_b32 a184, 0
v_accvgpr_write_b32 a185, 0
v_accvgpr_write_b32 a186, 0
v_accvgpr_write_b32 a187, 0
v_accvgpr_write_b32 a188, 0
v_accvgpr_write_b32 a189, 0
v_accvgpr_write_b32 a190, 0
v_accvgpr_write_b32 a191, 0
v_accvgpr_write_b32 a192, 0
v_accvgpr_write_b32 a193, 0
v_accvgpr_write_b32 a194, 0
v_accvgpr_write_b32 a195, 0
v_accvgpr_write_b32 a196, 0
v_accvgpr_write_b32 a197, 0
v_accvgpr_write_b32 a198, 0
v_accvgpr_write_b32 a199, 0
v_accvgpr_write_b32 a200, 0
v_accvgpr_write_b32 a201, 0
v_accvgpr_write_b32 a202, 0
v_accvgpr_write_b32 a203, 0
v_accvgpr_write_b32 a204, 0
v_accvgpr_write_b32 a205, 0
v_accvgpr_write_b32 a206, 0
v_accvgpr_write_b32 a207, 0
v_accvgpr_write_b32 a208, 0
v_accvgpr_write_b32 a209, 0
v_accvgpr_write_b32 a210, 0
v_accvgpr_write_b32 a211, 0
v_accvgpr_write_b32 a212, 0
v_accvgpr_write_b32 a213, 0
v_accvgpr_write_b32 a214, 0
v_accvgpr_write_b32 a215, 0
v_accvgpr_write_b32 a216, 0
v_accvgpr_write_b32 a217, 0
v_accvgpr_write_b32 a218, 0
v_accvgpr_write_b32 a219, 0
v_accvgpr_write_b32 a220, 0
v_accvgpr_write_b32 a221, 0
v_accvgpr_write_b32 a222, 0
v_accvgpr_write_b32 a223, 0
v_accvgpr_write_b32 a224, 0
v_accvgpr_write_b32 a225, 0
v_accvgpr_write_b32 a226, 0
v_accvgpr_write_b32 a227, 0
v_accvgpr_write_b32 a228, 0
v_accvgpr_write_b32 a229, 0
v_accvgpr_write_b32 a230, 0
v_accvgpr_write_b32 a231, 0
v_accvgpr_write_b32 a232, 0
v_accvgpr_write_b32 a233, 0
v_accvgpr_write_b32 a234, 0
v_accvgpr_write_b32 a235, 0
v_accvgpr_write_b32 a236, 0
v_accvgpr_write_b32 a237, 0
v_accvgpr_write_b32 a238, 0
v_accvgpr_write_b32 a239, 0
v_accvgpr_write_b32 a240, 0
v_accvgpr_write_b32 a241, 0
v_accvgpr_write_b32 a242, 0
v_accvgpr_write_b32 a243, 0
v_accvgpr_write_b32 a244, 0
v_accvgpr_write_b32 a245, 0
v_accvgpr_write_b32 a246, 0
v_accvgpr_write_b32 a247, 0
v_accvgpr_write_b32 a248, 0
v_accvgpr_write_b32 a249, 0
v_accvgpr_write_b32 a250, 0
v_accvgpr_write_b32 a251, 0
v_accvgpr_write_b32 a252, 0
v_accvgpr_write_b32 a253, 0
v_accvgpr_write_b32 a254, 0
v_accvgpr_write_b32 a255, 0
s_waitcnt vmcnt(12)
s_barrier
v_bfe_u32 v232, v240, 2, 2
v_lshl_add_u32 v232, v241, 3, v232
v_lshlrev_b32 v232, 7, v232
v_bfe_u32 v233, v240, 4, 1
v_lshl_add_u32 v232, v233, 5, v232
v_and_b32 v233, 3, v240
v_lshl_add_u32 v232, v233, 3, v232
s_lshl_b32 s33, s29, 6
s_add_u32 s33, s33, 131072
v_add_u32 v232, s33, v232
ds_read_b64_tr_b16 v[0:1], v232 offset:0
ds_read_b64_tr_b16 v[2:3], v232 offset:512
ds_read_b64_tr_b16 v[4:5], v232 offset:2048
ds_read_b64_tr_b16 v[6:7], v232 offset:2560
ds_read_b64_tr_b16 v[8:9], v232 offset:4096
ds_read_b64_tr_b16 v[10:11], v232 offset:4608
ds_read_b64_tr_b16 v[12:13], v232 offset:6144
ds_read_b64_tr_b16 v[14:15], v232 offset:6656
s_waitcnt lgkmcnt(0)
ds_read_b64_tr_b16 v[16:17], v232 offset:8192
ds_read_b64_tr_b16 v[18:19], v232 offset:8704
ds_read_b64_tr_b16 v[20:21], v232 offset:10240
ds_read_b64_tr_b16 v[22:23], v232 offset:10752
ds_read_b64_tr_b16 v[24:25], v232 offset:12288
ds_read_b64_tr_b16 v[26:27], v232 offset:12800
ds_read_b64_tr_b16 v[28:29], v232 offset:14336
ds_read_b64_tr_b16 v[30:31], v232 offset:14848
s_waitcnt lgkmcnt(0)
ds_read_b64_tr_b16 v[32:33], v232 offset:16384
ds_read_b64_tr_b16 v[34:35], v232 offset:16896
ds_read_b64_tr_b16 v[36:37], v232 offset:18432
ds_read_b64_tr_b16 v[38:39], v232 offset:18944
ds_read_b64_tr_b16 v[40:41], v232 offset:20480
ds_read_b64_tr_b16 v[42:43], v232 offset:20992
ds_read_b64_tr_b16 v[44:45], v232 offset:22528
ds_read_b64_tr_b16 v[46:47], v232 offset:23040
s_waitcnt lgkmcnt(0)
ds_read_b64_tr_b16 v[48:49], v232 offset:24576
ds_read_b64_tr_b16 v[50:51], v232 offset:25088
ds_read_b64_tr_b16 v[52:53], v232 offset:26624
ds_read_b64_tr_b16 v[54:55], v232 offset:27136
ds_read_b64_tr_b16 v[56:57], v232 offset:28672
ds_read_b64_tr_b16 v[58:59], v232 offset:29184
ds_read_b64_tr_b16 v[60:61], v232 offset:30720
ds_read_b64_tr_b16 v[62:63], v232 offset:31232
s_waitcnt lgkmcnt(0)
s_add_u32 m0, s31, 0xc000
s_mov_b32 s32, 0xc000
buffer_load_dwordx4 v224, s[8:11], s32 offen offset:0 lds
buffer_load_dwordx4 v225, s[8:11], s32 offen offset:1024 lds
buffer_load_dwordx4 v226, s[8:11], s32 offen offset:2048 lds
buffer_load_dwordx4 v227, s[8:11], s32 offen offset:3072 lds
s_add_u32 m0, s31, 0x10000
s_mov_b32 s32, 0x10000
buffer_load_dwordx4 v224, s[8:11], s32 offen offset:0 lds
buffer_load_dwordx4 v225, s[8:11], s32 offen offset:1024 lds
buffer_load_dwordx4 v226, s[8:11], s32 offen offset:2048 lds
buffer_load_dwordx4 v227, s[8:11], s32 offen offset:3072 lds
s_add_u32 m0, s31, 0x14000
s_mov_b32 s32, 0x14000
buffer_load_dwordx4 v224, s[8:11], s32 offen offset:0 lds
buffer_load_dwordx4 v225, s[8:11], s32 offen offset:1024 lds
buffer_load_dwordx4 v226, s[8:11], s32 offen offset:2048 lds
buffer_load_dwordx4 v227, s[8:11], s32 offen offset:3072 lds
s_add_u32 m0, s31, 0x18000
s_mov_b32 s32, 0x18000
buffer_load_dwordx4 v224, s[8:11], s32 offen offset:0 lds
buffer_load_dwordx4 v225, s[8:11], s32 offen offset:1024 lds
buffer_load_dwordx4 v226, s[8:11], s32 offen offset:2048 lds
buffer_load_dwordx4 v227, s[8:11], s32 offen offset:3072 lds
s_add_u32 m0, s31, 0x1c000
s_mov_b32 s32, 0x1c000
buffer_load_dwordx4 v224, s[8:11], s32 offen offset:0 lds
buffer_load_dwordx4 v225, s[8:11], s32 offen offset:1024 lds
buffer_load_dwordx4 v226, s[8:11], s32 offen offset:2048 lds
buffer_load_dwordx4 v227, s[8:11], s32 offen offset:3072 lds
buffer_load_dword v243, off, s[4:7], 0 sc1
s_barrier
s_add_u32 s56, s35, 1
v_lshrrev_b32 v232, 3, v240
v_lshlrev_b32 v232, 9, v232
v_and_b32 v233, 7, v240
v_lshl_add_u32 v232, v233, 4, v232
s_lshl_b32 s33, s56, 7
s_lshl_b32 s34, s28, 15
s_add_u32 s33, s33, s34
s_add_u32 s33, s33, 131072
v_add_u32 v232, s33, v232
s_lshl_b32 s34, s28, 13
s_add_u32 s34, s34, 131072
s_add_u32 m0, s34, 0
s_mov_b32 s32, 0
buffer_load_dwordx4 v232, s[16:19], s32 offen lds
s_add_u32 m0, s34, 1024
s_mov_b32 s32, 4096
buffer_load_dwordx4 v232, s[16:19], s32 offen lds
s_add_u32 m0, s34, 2048
s_mov_b32 s32, 8192
buffer_load_dwordx4 v232, s[16:19], s32 offen lds
s_add_u32 m0, s34, 3072
s_mov_b32 s32, 12288
buffer_load_dwordx4 v232, s[16:19], s32 offen lds
s_add_u32 m0, s34, 4096
s_mov_b32 s32, 16384
buffer_load_dwordx4 v232, s[16:19], s32 offen lds
s_add_u32 m0, s34, 5120
s_mov_b32 s32, 20480
buffer_load_dwordx4 v232, s[16:19], s32 offen lds
s_add_u32 m0, s34, 6144
s_mov_b32 s32, 24576
buffer_load_dwordx4 v232, s[16:19], s32 offen lds
s_add_u32 m0, s34, 7168
s_mov_b32 s32, 28672
buffer_load_dwordx4 v232, s[16:19], s32 offen lds
s_waitcnt vmcnt(33)
s_barrier
ds_read_b128 a[0:3], v192 offset:0
ds_read_b128 a[4:7], v193 offset:0
ds_read_b128 a[8:11], v194 offset:0
ds_read_b128 a[12:15], v195 offset:0
ds_read_b128 a[16:19], v196 offset:0
ds_read_b128 a[20:23], v197 offset:0
s_waitcnt lgkmcnt(4)
v_mfma_f32_32x32x16_bf16 v[64:79], a[0:3], v[0:3], 0
ds_read_b128 a[24:27], v198 offset:0
v_mfma_f32_32x32x16_bf16 v[64:79], a[4:7], v[4:7], v[64:79]
ds_read_b128 a[28:31], v199 offset:0
s_waitcnt lgkmcnt(4)
v_mfma_f32_32x32x16_bf16 v[64:79], a[8:11], v[8:11], v[64:79]
ds_read_b128 a[0:3], v192 offset:256
v_mfma_f32_32x32x16_bf16 v[64:79], a[12:15], v[12:15], v[64:79]
ds_read_b128 a[4:7], v193 offset:256
s_waitcnt lgkmcnt(4)
v_mfma_f32_32x32x16_bf16 v[64:79], a[16:19], v[16:19], v[64:79]
ds_read_b128 a[8:11], v194 offset:256
v_mfma_f32_32x32x16_bf16 v[64:79], a[20:23], v[20:23], v[64:79]
ds_read_b128 a[12:15], v195 offset:256
s_waitcnt lgkmcnt(4)
v_mfma_f32_32x32x16_bf16 v[64:79], a[24:27], v[24:27], v[64:79]
ds_read_b128 a[16:19], v196 offset:256
v_mfma_f32_32x32x16_bf16 v[64:79], a[28:31], v[28:31], v[64:79]
ds_read_b128 a[20:23], v197 offset:256
s_waitcnt lgkmcnt(4)
v_mfma_f32_32x32x16_bf16 v[64:79], a[0:3], v[32:35], v[64:79]
ds_read_b128 a[24:27], v198 offset:256
v_mfma_f32_32x32x16_bf16 v[64:79], a[4:7], v[36:39], v[64:79]
s_waitcnt vmcnt(25)
s_barrier
ds_read_b128 a[28:31], v199 offset:256
s_waitcnt lgkmcnt(4)
v_mfma_f32_32x32x16_bf16 v[64:79], a[8:11], v[40:43], v[64:79]
ds_read_b128 a[0:3], v192 offset:32768
v_mfma_f32_32x32x16_bf16 v[64:79], a[12:15], v[44:47], v[64:79]
ds_read_b128 a[4:7], v193 offset:32768
s_waitcnt lgkmcnt(4)
v_mfma_f32_32x32x16_bf16 v[64:79], a[16:19], v[48:51], v[64:79]
ds_read_b128 a[8:11], v194 offset:32768
v_mfma_f32_32x32x16_bf16 v[64:79], a[20:23], v[52:55], v[64:79]
ds_read_b128 a[12:15], v195 offset:32768
s_waitcnt lgkmcnt(4)
v_mfma_f32_32x32x16_bf16 v[64:79], a[24:27], v[56:59], v[64:79]
ds_read_b128 a[16:19], v196 offset:32768
v_mfma_f32_32x32x16_bf16 v[64:79], a[28:31], v[60:63], v[64:79]
ds_read_b128 a[20:23], v197 offset:32768
s_waitcnt lgkmcnt(4)
v_mfma_f32_32x32x16_bf16 v[80:95], a[0:3], v[0:3], 0
ds_read_b128 a[24:27], v198 offset:32768
v_mfma_f32_32x32x16_bf16 v[80:95], a[4:7], v[4:7], v[80:95]
ds_read_b128 a[28:31], v199 offset:32768
s_waitcnt lgkmcnt(4)
v_mfma_f32_32x32x16_bf16 v[80:95], a[8:11], v[8:11], v[80:95]
ds_read_b128 a[0:3], v192 offset:33024
v_mfma_f32_32x32x16_bf16 v[80:95], a[12:15], v[12:15], v[80:95]
ds_read_b128 a[4:7], v193 offset:33024
s_waitcnt lgkmcnt(4)
v_mfma_f32_32x32x16_bf16 v[80:95], a[16:19], v[16:19], v[80:95]
ds_read_b128 a[8:11], v194 offset:33024
v_mfma_f32_32x32x16_bf16 v[80:95], a[20:23], v[20:23], v[80:95]
ds_read_b128 a[12:15], v195 offset:33024
s_waitcnt lgkmcnt(4)
v_mfma_f32_32x32x16_bf16 v[80:95], a[24:27], v[24:27], v[80:95]
ds_read_b128 a[16:19], v196 offset:33024
v_mfma_f32_32x32x16_bf16 v[80:95], a[28:31], v[28:31], v[80:95]
ds_read_b128 a[20:23], v197 offset:33024
s_waitcnt lgkmcnt(4)
v_mfma_f32_32x32x16_bf16 v[80:95], a[0:3], v[32:35], v[80:95]
ds_read_b128 a[24:27], v198 offset:33024
v_mfma_f32_32x32x16_bf16 v[80:95], a[4:7], v[36:39], v[80:95]
s_waitcnt vmcnt(17)
s_barrier
ds_read_b128 a[28:31], v199 offset:33024
s_waitcnt lgkmcnt(4)
v_mfma_f32_32x32x16_bf16 v[80:95], a[8:11], v[40:43], v[80:95]
ds_read_b128 a[0:3], v200 offset:0
s_add_u32 m0, s31, 0x0
s_mov_b32 s32, 0x0
buffer_load_dwordx4 v224, s[8:11], s32 offen offset:0 lds
v_mfma_f32_32x32x16_bf16 v[80:95], a[12:15], v[44:47], v[80:95]
ds_read_b128 a[4:7], v201 offset:0
s_waitcnt lgkmcnt(4)
v_mfma_f32_32x32x16_bf16 v[80:95], a[16:19], v[48:51], v[80:95]
ds_read_b128 a[8:11], v202 offset:0
buffer_load_dwordx4 v225, s[8:11], s32 offen offset:1024 lds
v_mfma_f32_32x32x16_bf16 v[80:95], a[20:23], v[52:55], v[80:95]
ds_read_b128 a[12:15], v203 offset:0
s_waitcnt lgkmcnt(4)
v_mfma_f32_32x32x16_bf16 v[80:95], a[24:27], v[56:59], v[80:95]
ds_read_b128 a[16:19], v204 offset:0
buffer_load_dwordx4 v226, s[8:11], s32 offen offset:2048 lds
v_mfma_f32_32x32x16_bf16 v[80:95], a[28:31], v[60:63], v[80:95]
ds_read_b128 a[20:23], v205 offset:0
s_waitcnt lgkmcnt(4)
v_mfma_f32_32x32x16_bf16 v[96:111], a[0:3], v[0:3], 0
ds_read_b128 a[24:27], v206 offset:0
buffer_load_dwordx4 v227, s[8:11], s32 offen offset:3072 lds
v_mfma_f32_32x32x16_bf16 v[96:111], a[4:7], v[4:7], v[96:111]
ds_read_b128 a[28:31], v207 offset:0
s_waitcnt lgkmcnt(4)
v_mfma_f32_32x32x16_bf16 v[96:111], a[8:11], v[8:11], v[96:111]
ds_read_b128 a[0:3], v200 offset:256
s_add_u32 m0, s31, 0x4000
s_mov_b32 s32, 0x4000
buffer_load_dwordx4 v224, s[8:11], s32 offen offset:0 lds
v_mfma_f32_32x32x16_bf16 v[96:111], a[12:15], v[12:15], v[96:111]
ds_read_b128 a[4:7], v201 offset:256
s_waitcnt lgkmcnt(4)
v_mfma_f32_32x32x16_bf16 v[96:111], a[16:19], v[16:19], v[96:111]
ds_read_b128 a[8:11], v202 offset:256
buffer_load_dwordx4 v225, s[8:11], s32 offen offset:1024 lds
v_mfma_f32_32x32x16_bf16 v[96:111], a[20:23], v[20:23], v[96:111]
ds_read_b128 a[12:15], v203 offset:256
s_waitcnt lgkmcnt(4)
v_mfma_f32_32x32x16_bf16 v[96:111], a[24:27], v[24:27], v[96:111]
ds_read_b128 a[16:19], v204 offset:256
buffer_load_dwordx4 v226, s[8:11], s32 offen offset:2048 lds
v_mfma_f32_32x32x16_bf16 v[96:111], a[28:31], v[28:31], v[96:111]
ds_read_b128 a[20:23], v205 offset:256
s_waitcnt lgkmcnt(4)
v_mfma_f32_32x32x16_bf16 v[96:111], a[0:3], v[32:35], v[96:111]
ds_read_b128 a[24:27], v206 offset:256
buffer_load_dwordx4 v227, s[8:11], s32 offen offset:3072 lds
v_mfma_f32_32x32x16_bf16 v[96:111], a[4:7], v[36:39], v[96:111]
s_waitcnt vmcnt(17)
s_barrier
ds_read_b128 a[28:31], v207 offset:256
s_waitcnt lgkmcnt(4)
v_mfma_f32_32x32x16_bf16 v[96:111], a[8:11], v[40:43], v[96:111]
ds_read_b128 a[0:3], v200 offset:32768
s_add_u32 m0, s31, 0x8000
s_mov_b32 s32, 0x8000
buffer_load_dwordx4 v224, s[8:11], s32 offen offset:0 lds
v_mfma_f32_32x32x16_bf16 v[96:111], a[12:15], v[44:47], v[96:111]
ds_read_b128 a[4:7], v201 offset:32768
s_waitcnt lgkmcnt(4)
v_mfma_f32_32x32x16_bf16 v[96:111], a[16:19], v[48:51], v[96:111]
ds_read_b128 a[8:11], v202 offset:32768
buffer_load_dwordx4 v225, s[8:11], s32 offen offset:1024 lds
v_mfma_f32_32x32x16_bf16 v[96:111], a[20:23], v[52:55], v[96:111]
ds_read_b128 a[12:15], v203 offset:32768
s_waitcnt lgkmcnt(4)
v_mfma_f32_32x32x16_bf16 v[96:111], a[24:27], v[56:59], v[96:111]
ds_read_b128 a[16:19], v204 offset:32768
buffer_load_dwordx4 v226, s[8:11], s32 offen offset:2048 lds
v_mfma_f32_32x32x16_bf16 v[96:111], a[28:31], v[60:63], v[96:111]
ds_read_b128 a[20:23], v205 offset:32768
s_waitcnt lgkmcnt(4)
v_mfma_f32_32x32x16_bf16 v[112:127], a[0:3], v[0:3], 0
ds_read_b128 a[24:27], v206 offset:32768
buffer_load_dwordx4 v227, s[8:11], s32 offen offset:3072 lds
v_mfma_f32_32x32x16_bf16 v[112:127], a[4:7], v[4:7], v[112:127]
ds_read_b128 a[28:31], v207 offset:32768
s_waitcnt lgkmcnt(4)
v_mfma_f32_32x32x16_bf16 v[112:127], a[8:11], v[8:11], v[112:127]
ds_read_b128 a[0:3], v200 offset:33024
s_add_u32 m0, s31, 0xc000
s_mov_b32 s32, 0xc000
buffer_load_dwordx4 v224, s[8:11], s32 offen offset:0 lds
v_mfma_f32_32x32x16_bf16 v[112:127], a[12:15], v[12:15], v[112:127]
ds_read_b128 a[4:7], v201 offset:33024
s_waitcnt lgkmcnt(4)
v_mfma_f32_32x32x16_bf16 v[112:127], a[16:19], v[16:19], v[112:127]
ds_read_b128 a[8:11], v202 offset:33024
buffer_load_dwordx4 v225, s[8:11], s32 offen offset:1024 lds
v_mfma_f32_32x32x16_bf16 v[112:127], a[20:23], v[20:23], v[112:127]
ds_read_b128 a[12:15], v203 offset:33024
s_waitcnt lgkmcnt(4)
v_mfma_f32_32x32x16_bf16 v[112:127], a[24:27], v[24:27], v[112:127]
ds_read_b128 a[16:19], v204 offset:33024
buffer_load_dwordx4 v226, s[8:11], s32 offen offset:2048 lds
v_mfma_f32_32x32x16_bf16 v[112:127], a[28:31], v[28:31], v[112:127]
ds_read_b128 a[20:23], v205 offset:33024
s_waitcnt lgkmcnt(4)
v_mfma_f32_32x32x16_bf16 v[112:127], a[0:3], v[32:35], v[112:127]
ds_read_b128 a[24:27], v206 offset:33024
buffer_load_dwordx4 v227, s[8:11], s32 offen offset:3072 lds
v_mfma_f32_32x32x16_bf16 v[112:127], a[4:7], v[36:39], v[112:127]
ds_read_b128 a[28:31], v207 offset:33024
s_waitcnt lgkmcnt(4)
v_mfma_f32_32x32x16_bf16 v[112:127], a[8:11], v[40:43], v[112:127]
v_mfma_f32_32x32x16_bf16 v[112:127], a[12:15], v[44:47], v[112:127]
s_waitcnt lgkmcnt(2)
v_mfma_f32_32x32x16_bf16 v[112:127], a[16:19], v[48:51], v[112:127]
v_mfma_f32_32x32x16_bf16 v[112:127], a[20:23], v[52:55], v[112:127]
s_waitcnt lgkmcnt(0)
v_mfma_f32_32x32x16_bf16 v[112:127], a[24:27], v[56:59], v[112:127]
v_mfma_f32_32x32x16_bf16 v[112:127], a[28:31], v[60:63], v[112:127]
s_nop 15
s_lshl_b32 s33, s35, 2
s_lshl_b32 s34, s29, 1
s_add_u32 s33, s33, s34
s_lshl_b32 s33, s33, 14
s_lshl_b32 s34, s30, 10
s_add_u32 s33, s33, s34
s_add_u32 s33, s33, 8192
v_lshrrev_b32 v232, 4, v242
v_lshlrev_b32 v232, 14, v232
v_and_b32 v233, 15, v242
v_lshl_add_u32 v233, v241, 4, v233
v_lshl_add_u32 v232, v233, 4, v232
v_add_u32 v232, s33, v232
v_cvt_pk_bf16_f32 v244, v64, v65
v_cvt_pk_bf16_f32 v245, v66, v67
v_cvt_pk_bf16_f32 v246, v68, v69
v_cvt_pk_bf16_f32 v247, v70, v71
v_cvt_pk_bf16_f32 v248, v72, v73
v_cvt_pk_bf16_f32 v249, v74, v75
v_cvt_pk_bf16_f32 v250, v76, v77
v_cvt_pk_bf16_f32 v251, v78, v79
s_nop 1
v_permlane32_swap_b32 v244, v246
v_permlane32_swap_b32 v245, v247
v_permlane32_swap_b32 v248, v250
v_permlane32_swap_b32 v249, v251
s_mov_b32 s33, 0
buffer_store_dwordx4 v[244:247], v232, s[24:27], s33 offen offset:0 sc1
buffer_store_dwordx4 v[248:251], v232, s[24:27], s33 offen offset:512 sc1
s_nop 1
v_cvt_pk_bf16_f32 v244, v80, v81
v_cvt_pk_bf16_f32 v245, v82, v83
v_cvt_pk_bf16_f32 v246, v84, v85
v_cvt_pk_bf16_f32 v247, v86, v87
v_cvt_pk_bf16_f32 v248, v88, v89
v_cvt_pk_bf16_f32 v249, v90, v91
v_cvt_pk_bf16_f32 v250, v92, v93
v_cvt_pk_bf16_f32 v251, v94, v95
s_nop 1
v_permlane32_swap_b32 v244, v246
v_permlane32_swap_b32 v245, v247
v_permlane32_swap_b32 v248, v250
v_permlane32_swap_b32 v249, v251
s_mov_b32 s33, 2048
buffer_store_dwordx4 v[244:247], v232, s[24:27], s33 offen offset:0 sc1
buffer_store_dwordx4 v[248:251], v232, s[24:27], s33 offen offset:512 sc1
s_nop 1
v_cvt_pk_bf16_f32 v244, v96, v97
v_cvt_pk_bf16_f32 v245, v98, v99
v_cvt_pk_bf16_f32 v246, v100, v101
v_cvt_pk_bf16_f32 v247, v102, v103
v_cvt_pk_bf16_f32 v248, v104, v105
v_cvt_pk_bf16_f32 v249, v106, v107
v_cvt_pk_bf16_f32 v250, v108, v109
v_cvt_pk_bf16_f32 v251, v110, v111
s_nop 1
v_permlane32_swap_b32 v244, v246
v_permlane32_swap_b32 v245, v247
v_permlane32_swap_b32 v248, v250
v_permlane32_swap_b32 v249, v251
s_mov_b32 s33, 4096
buffer_store_dwordx4 v[244:247], v232, s[24:27], s33 offen offset:0 sc1
buffer_store_dwordx4 v[248:251], v232, s[24:27], s33 offen offset:512 sc1
s_nop 1
v_cvt_pk_bf16_f32 v244, v112, v113
v_cvt_pk_bf16_f32 v245, v114, v115
v_cvt_pk_bf16_f32 v246, v116, v117
v_cvt_pk_bf16_f32 v247, v118, v119
v_cvt_pk_bf16_f32 v248, v120, v121
v_cvt_pk_bf16_f32 v249, v122, v123
v_cvt_pk_bf16_f32 v250, v124, v125
v_cvt_pk_bf16_f32 v251, v126, v127
s_nop 1
v_permlane32_swap_b32 v244, v246
v_permlane32_swap_b32 v245, v247
v_permlane32_swap_b32 v248, v250
v_permlane32_swap_b32 v249, v251
s_mov_b32 s33, 6144
buffer_store_dwordx4 v[244:247], v232, s[24:27], s33 offen offset:0 sc1
buffer_store_dwordx4 v[248:251], v232, s[24:27], s33 offen offset:512 sc1
s_nop 1
s_waitcnt vmcnt(24)
s_barrier
v_bfe_u32 v232, v240, 2, 2
v_lshl_add_u32 v232, v241, 3, v232
v_lshlrev_b32 v232, 7, v232
v_bfe_u32 v233, v240, 4, 1
v_lshl_add_u32 v232, v233, 5, v232
v_and_b32 v233, 3, v240
v_lshl_add_u32 v232, v233, 3, v232
s_lshl_b32 s33, s29, 6
s_add_u32 s33, s33, 131072
v_add_u32 v232, s33, v232
ds_read_b64_tr_b16 v[0:1], v232 offset:0
ds_read_b64_tr_b16 v[2:3], v232 offset:512
ds_read_b64_tr_b16 v[4:5], v232 offset:2048
ds_read_b64_tr_b16 v[6:7], v232 offset:2560
ds_read_b64_tr_b16 v[8:9], v232 offset:4096
ds_read_b64_tr_b16 v[10:11], v232 offset:4608
ds_read_b64_tr_b16 v[12:13], v232 offset:6144
ds_read_b64_tr_b16 v[14:15], v232 offset:6656
s_waitcnt lgkmcnt(0)
ds_read_b64_tr_b16 v[16:17], v232 offset:8192
ds_read_b64_tr_b16 v[18:19], v232 offset:8704
ds_read_b64_tr_b16 v[20:21], v232 offset:10240
ds_read_b64_tr_b16 v[22:23], v232 offset:10752
ds_read_b64_tr_b16 v[24:25], v232 offset:12288
ds_read_b64_tr_b16 v[26:27], v232 offset:12800
ds_read_b64_tr_b16 v[28:29], v232 offset:14336
ds_read_b64_tr_b16 v[30:31], v232 offset:14848
s_waitcnt lgkmcnt(0)
ds_read_b64_tr_b16 v[32:33], v232 offset:16384
ds_read_b64_tr_b16 v[34:35], v232 offset:16896
ds_read_b64_tr_b16 v[36:37], v232 offset:18432
ds_read_b64_tr_b16 v[38:39], v232 offset:18944
ds_read_b64_tr_b16 v[40:41], v232 offset:20480
ds_read_b64_tr_b16 v[42:43], v232 offset:20992
ds_read_b64_tr_b16 v[44:45], v232 offset:22528
ds_read_b64_tr_b16 v[46:47], v232 offset:23040
s_waitcnt lgkmcnt(0)
ds_read_b64_tr_b16 v[48:49], v232 offset:24576
ds_read_b64_tr_b16 v[50:51], v232 offset:25088
ds_read_b64_tr_b16 v[52:53], v232 offset:26624
ds_read_b64_tr_b16 v[54:55], v232 offset:27136
ds_read_b64_tr_b16 v[56:57], v232 offset:28672
ds_read_b64_tr_b16 v[58:59], v232 offset:29184
ds_read_b64_tr_b16 v[60:61], v232 offset:30720
ds_read_b64_tr_b16 v[62:63], v232 offset:31232
s_waitcnt lgkmcnt(0)
s_waitcnt vmcnt(16)
s_barrier
ds_read_b128 a[0:3], v192 offset:0
s_add_u32 m0, s31, 0x10000
s_mov_b32 s32, 0x10000
buffer_load_dwordx4 v224, s[8:11], s32 offen offset:0 lds
ds_read_b128 a[4:7], v193 offset:0
ds_read_b128 a[8:11], v194 offset:0
buffer_load_dwordx4 v225, s[8:11], s32 offen offset:1024 lds
ds_read_b128 a[12:15], v195 offset:0
ds_read_b128 a[16:19], v196 offset:0
buffer_load_dwordx4 v226, s[8:11], s32 offen offset:2048 lds
ds_read_b128 a[20:23], v197 offset:0
s_waitcnt lgkmcnt(4)
v_mfma_f32_32x32x16_bf16 v[128:143], a[0:3], v[0:3], 0
ds_read_b128 a[24:27], v198 offset:0
buffer_load_dwordx4 v227, s[8:11], s32 offen offset:3072 lds
v_mfma_f32_32x32x16_bf16 v[128:143], a[4:7], v[4:7], v[128:143]
ds_read_b128 a[28:31], v199 offset:0
s_waitcnt lgkmcnt(4)
v_mfma_f32_32x32x16_bf16 v[128:143], a[8:11], v[8:11], v[128:143]
ds_read_b128 a[0:3], v192 offset:256
s_add_u32 m0, s31, 0x14000
s_mov_b32 s32, 0x14000
buffer_load_dwordx4 v224, s[8:11], s32 offen offset:0 lds
v_mfma_f32_32x32x16_bf16 v[128:143], a[12:15], v[12:15], v[128:143]
ds_read_b128 a[4:7], v193 offset:256
s_waitcnt lgkmcnt(4)
v_mfma_f32_32x32x16_bf16 v[128:143], a[16:19], v[16:19], v[128:143]
ds_read_b128 a[8:11], v194 offset:256
buffer_load_dwordx4 v225, s[8:11], s32 offen offset:1024 lds
v_mfma_f32_32x32x16_bf16 v[128:143], a[20:23], v[20:23], v[128:143]
ds_read_b128 a[12:15], v195 offset:256
s_waitcnt lgkmcnt(4)
v_mfma_f32_32x32x16_bf16 v[128:143], a[24:27], v[24:27], v[128:143]
ds_read_b128 a[16:19], v196 offset:256
buffer_load_dwordx4 v226, s[8:11], s32 offen offset:2048 lds
v_mfma_f32_32x32x16_bf16 v[128:143], a[28:31], v[28:31], v[128:143]
ds_read_b128 a[20:23], v197 offset:256
s_waitcnt lgkmcnt(4)
v_mfma_f32_32x32x16_bf16 v[128:143], a[0:3], v[32:35], v[128:143]
ds_read_b128 a[24:27], v198 offset:256
buffer_load_dwordx4 v227, s[8:11], s32 offen offset:3072 lds
v_mfma_f32_32x32x16_bf16 v[128:143], a[4:7], v[36:39], v[128:143]
s_waitcnt vmcnt(16)
s_barrier
ds_read_b128 a[28:31], v199 offset:256
s_waitcnt lgkmcnt(4)
v_mfma_f32_32x32x16_bf16 v[128:143], a[8:11], v[40:43], v[128:143]
ds_read_b128 a[0:3], v192 offset:32768
s_add_u32 m0, s31, 0x18000
s_mov_b32 s32, 0x18000
buffer_load_dwordx4 v224, s[8:11], s32 offen offset:0 lds
v_mfma_f32_32x32x16_bf16 v[128:143], a[12:15], v[44:47], v[128:143]
ds_read_b128 a[4:7], v193 offset:32768
s_waitcnt lgkmcnt(4)
v_mfma_f32_32x32x16_bf16 v[128:143], a[16:19], v[48:51], v[128:143]
ds_read_b128 a[8:11], v194 offset:32768
buffer_load_dwordx4 v225, s[8:11], s32 offen offset:1024 lds
v_mfma_f32_32x32x16_bf16 v[128:143], a[20:23], v[52:55], v[128:143]
ds_read_b128 a[12:15], v195 offset:32768
s_waitcnt lgkmcnt(4)
v_mfma_f32_32x32x16_bf16 v[128:143], a[24:27], v[56:59], v[128:143]
ds_read_b128 a[16:19], v196 offset:32768
buffer_load_dwordx4 v226, s[8:11], s32 offen offset:2048 lds
v_mfma_f32_32x32x16_bf16 v[128:143], a[28:31], v[60:63], v[128:143]
ds_read_b128 a[20:23], v197 offset:32768
s_waitcnt lgkmcnt(4)
v_mfma_f32_32x32x16_bf16 v[144:159], a[0:3], v[0:3], 0
ds_read_b128 a[24:27], v198 offset:32768
buffer_load_dwordx4 v227, s[8:11], s32 offen offset:3072 lds
v_mfma_f32_32x32x16_bf16 v[144:159], a[4:7], v[4:7], v[144:159]
ds_read_b128 a[28:31], v199 offset:32768
s_waitcnt lgkmcnt(4)
v_mfma_f32_32x32x16_bf16 v[144:159], a[8:11], v[8:11], v[144:159]
ds_read_b128 a[0:3], v192 offset:33024
s_add_u32 m0, s31, 0x1c000
s_mov_b32 s32, 0x1c000
buffer_load_dwordx4 v224, s[8:11], s32 offen offset:0 lds
v_mfma_f32_32x32x16_bf16 v[144:159], a[12:15], v[12:15], v[144:159]
ds_read_b128 a[4:7], v193 offset:33024
s_waitcnt lgkmcnt(4)
v_mfma_f32_32x32x16_bf16 v[144:159], a[16:19], v[16:19], v[144:159]
ds_read_b128 a[8:11], v194 offset:33024
buffer_load_dwordx4 v225, s[8:11], s32 offen offset:1024 lds
v_mfma_f32_32x32x16_bf16 v[144:159], a[20:23], v[20:23], v[144:159]
ds_read_b128 a[12:15], v195 offset:33024
s_waitcnt lgkmcnt(4)
v_mfma_f32_32x32x16_bf16 v[144:159], a[24:27], v[24:27], v[144:159]
ds_read_b128 a[16:19], v196 offset:33024
buffer_load_dwordx4 v226, s[8:11], s32 offen offset:2048 lds
v_mfma_f32_32x32x16_bf16 v[144:159], a[28:31], v[28:31], v[144:159]
ds_read_b128 a[20:23], v197 offset:33024
s_waitcnt lgkmcnt(4)
v_mfma_f32_32x32x16_bf16 v[144:159], a[0:3], v[32:35], v[144:159]
ds_read_b128 a[24:27], v198 offset:33024
buffer_load_dwordx4 v227, s[8:11], s32 offen offset:3072 lds
v_mfma_f32_32x32x16_bf16 v[144:159], a[4:7], v[36:39], v[144:159]
s_waitcnt vmcnt(8)
s_barrier
ds_read_b128 a[28:31], v199 offset:33024
s_waitcnt lgkmcnt(4)
v_mfma_f32_32x32x16_bf16 v[144:159], a[8:11], v[40:43], v[144:159]
ds_read_b128 a[0:3], v200 offset:0
v_mfma_f32_32x32x16_bf16 v[144:159], a[12:15], v[44:47], v[144:159]
ds_read_b128 a[4:7], v201 offset:0
s_waitcnt lgkmcnt(4)
v_mfma_f32_32x32x16_bf16 v[144:159], a[16:19], v[48:51], v[144:159]
ds_read_b128 a[8:11], v202 offset:0
v_mfma_f32_32x32x16_bf16 v[144:159], a[20:23], v[52:55], v[144:159]
ds_read_b128 a[12:15], v203 offset:0
s_waitcnt lgkmcnt(4)
v_mfma_f32_32x32x16_bf16 v[144:159], a[24:27], v[56:59], v[144:159]
ds_read_b128 a[16:19], v204 offset:0
v_mfma_f32_32x32x16_bf16 v[144:159], a[28:31], v[60:63], v[144:159]
ds_read_b128 a[20:23], v205 offset:0
s_waitcnt lgkmcnt(4)
v_mfma_f32_32x32x16_bf16 v[160:175], a[0:3], v[0:3], 0
ds_read_b128 a[24:27], v206 offset:0
v_mfma_f32_32x32x16_bf16 v[160:175], a[4:7], v[4:7], v[160:175]
ds_read_b128 a[28:31], v207 offset:0
s_waitcnt lgkmcnt(4)
v_mfma_f32_32x32x16_bf16 v[160:175], a[8:11], v[8:11], v[160:175]
ds_read_b128 a[0:3], v200 offset:256
v_mfma_f32_32x32x16_bf16 v[160:175], a[12:15], v[12:15], v[160:175]
ds_read_b128 a[4:7], v201 offset:256
s_waitcnt lgkmcnt(4)
v_mfma_f32_32x32x16_bf16 v[160:175], a[16:19], v[16:19], v[160:175]
ds_read_b128 a[8:11], v202 offset:256
v_mfma_f32_32x32x16_bf16 v[160:175], a[20:23], v[20:23], v[160:175]
ds_read_b128 a[12:15], v203 offset:256
s_waitcnt lgkmcnt(4)
v_mfma_f32_32x32x16_bf16 v[160:175], a[24:27], v[24:27], v[160:175]
ds_read_b128 a[16:19], v204 offset:256
v_mfma_f32_32x32x16_bf16 v[160:175], a[28:31], v[28:31], v[160:175]
ds_read_b128 a[20:23], v205 offset:256
s_waitcnt lgkmcnt(4)
v_mfma_f32_32x32x16_bf16 v[160:175], a[0:3], v[32:35], v[160:175]
ds_read_b128 a[24:27], v206 offset:256
v_mfma_f32_32x32x16_bf16 v[160:175], a[4:7], v[36:39], v[160:175]
s_waitcnt vmcnt(0)
s_barrier
ds_read_b128 a[28:31], v207 offset:256
s_waitcnt lgkmcnt(4)
v_mfma_f32_32x32x16_bf16 v[160:175], a[8:11], v[40:43], v[160:175]
ds_read_b128 a[0:3], v200 offset:32768
v_mfma_f32_32x32x16_bf16 v[160:175], a[12:15], v[44:47], v[160:175]
ds_read_b128 a[4:7], v201 offset:32768
s_waitcnt lgkmcnt(4)
v_mfma_f32_32x32x16_bf16 v[160:175], a[16:19], v[48:51], v[160:175]
ds_read_b128 a[8:11], v202 offset:32768
v_mfma_f32_32x32x16_bf16 v[160:175], a[20:23], v[52:55], v[160:175]
ds_read_b128 a[12:15], v203 offset:32768
s_waitcnt lgkmcnt(4)
v_mfma_f32_32x32x16_bf16 v[160:175], a[24:27], v[56:59], v[160:175]
ds_read_b128 a[16:19], v204 offset:32768
v_mfma_f32_32x32x16_bf16 v[160:175], a[28:31], v[60:63], v[160:175]
ds_read_b128 a[20:23], v205 offset:32768
s_waitcnt lgkmcnt(4)
v_mfma_f32_32x32x16_bf16 v[176:191], a[0:3], v[0:3], 0
ds_read_b128 a[24:27], v206 offset:32768
v_mfma_f32_32x32x16_bf16 v[176:191], a[4:7], v[4:7], v[176:191]
ds_read_b128 a[28:31], v207 offset:32768
s_waitcnt lgkmcnt(4)
v_mfma_f32_32x32x16_bf16 v[176:191], a[8:11], v[8:11], v[176:191]
ds_read_b128 a[0:3], v200 offset:33024
v_mfma_f32_32x32x16_bf16 v[176:191], a[12:15], v[12:15], v[176:191]
ds_read_b128 a[4:7], v201 offset:33024
s_waitcnt lgkmcnt(4)
v_mfma_f32_32x32x16_bf16 v[176:191], a[16:19], v[16:19], v[176:191]
ds_read_b128 a[8:11], v202 offset:33024
v_mfma_f32_32x32x16_bf16 v[176:191], a[20:23], v[20:23], v[176:191]
ds_read_b128 a[12:15], v203 offset:33024
s_waitcnt lgkmcnt(4)
v_mfma_f32_32x32x16_bf16 v[176:191], a[24:27], v[24:27], v[176:191]
ds_read_b128 a[16:19], v204 offset:33024
v_mfma_f32_32x32x16_bf16 v[176:191], a[28:31], v[28:31], v[176:191]
ds_read_b128 a[20:23], v205 offset:33024
s_waitcnt lgkmcnt(4)
v_mfma_f32_32x32x16_bf16 v[176:191], a[0:3], v[32:35], v[176:191]
ds_read_b128 a[24:27], v206 offset:33024
v_mfma_f32_32x32x16_bf16 v[176:191], a[4:7], v[36:39], v[176:191]
ds_read_b128 a[28:31], v207 offset:33024
s_waitcnt lgkmcnt(4)
v_mfma_f32_32x32x16_bf16 v[176:191], a[8:11], v[40:43], v[176:191]
v_mfma_f32_32x32x16_bf16 v[176:191], a[12:15], v[44:47], v[176:191]
s_waitcnt lgkmcnt(2)
v_mfma_f32_32x32x16_bf16 v[176:191], a[16:19], v[48:51], v[176:191]
v_mfma_f32_32x32x16_bf16 v[176:191], a[20:23], v[52:55], v[176:191]
s_waitcnt lgkmcnt(0)
v_mfma_f32_32x32x16_bf16 v[176:191], a[24:27], v[56:59], v[176:191]
v_mfma_f32_32x32x16_bf16 v[176:191], a[28:31], v[60:63], v[176:191]
s_nop 15
s_lshl_b32 s33, s56, 2
s_lshl_b32 s34, s29, 1
s_add_u32 s33, s33, s34
s_lshl_b32 s33, s33, 14
s_lshl_b32 s34, s30, 10
s_add_u32 s33, s33, s34
s_add_u32 s33, s33, 8192
v_lshrrev_b32 v232, 4, v242
v_lshlrev_b32 v232, 14, v232
v_and_b32 v233, 15, v242
v_lshl_add_u32 v233, v241, 4, v233
v_lshl_add_u32 v232, v233, 4, v232
v_add_u32 v232, s33, v232
v_cvt_pk_bf16_f32 v244, v128, v129
v_cvt_pk_bf16_f32 v245, v130, v131
v_cvt_pk_bf16_f32 v246, v132, v133
v_cvt_pk_bf16_f32 v247, v134, v135
v_cvt_pk_bf16_f32 v248, v136, v137
v_cvt_pk_bf16_f32 v249, v138, v139
v_cvt_pk_bf16_f32 v250, v140, v141
v_cvt_pk_bf16_f32 v251, v142, v143
s_nop 1
v_permlane32_swap_b32 v244, v246
v_permlane32_swap_b32 v245, v247
v_permlane32_swap_b32 v248, v250
v_permlane32_swap_b32 v249, v251
s_mov_b32 s33, 0
buffer_store_dwordx4 v[244:247], v232, s[24:27], s33 offen offset:0 sc1
buffer_store_dwordx4 v[248:251], v232, s[24:27], s33 offen offset:512 sc1
s_nop 1
v_cvt_pk_bf16_f32 v244, v144, v145
v_cvt_pk_bf16_f32 v245, v146, v147
v_cvt_pk_bf16_f32 v246, v148, v149
v_cvt_pk_bf16_f32 v247, v150, v151
v_cvt_pk_bf16_f32 v248, v152, v153
v_cvt_pk_bf16_f32 v249, v154, v155
v_cvt_pk_bf16_f32 v250, v156, v157
v_cvt_pk_bf16_f32 v251, v158, v159
s_nop 1
v_permlane32_swap_b32 v244, v246
v_permlane32_swap_b32 v245, v247
v_permlane32_swap_b32 v248, v250
v_permlane32_swap_b32 v249, v251
s_mov_b32 s33, 2048
buffer_store_dwordx4 v[244:247], v232, s[24:27], s33 offen offset:0 sc1
buffer_store_dwordx4 v[248:251], v232, s[24:27], s33 offen offset:512 sc1
s_nop 1
v_cvt_pk_bf16_f32 v244, v160, v161
v_cvt_pk_bf16_f32 v245, v162, v163
v_cvt_pk_bf16_f32 v246, v164, v165
v_cvt_pk_bf16_f32 v247, v166, v167
v_cvt_pk_bf16_f32 v248, v168, v169
v_cvt_pk_bf16_f32 v249, v170, v171
v_cvt_pk_bf16_f32 v250, v172, v173
v_cvt_pk_bf16_f32 v251, v174, v175
s_nop 1
v_permlane32_swap_b32 v244, v246
v_permlane32_swap_b32 v245, v247
v_permlane32_swap_b32 v248, v250
v_permlane32_swap_b32 v249, v251
s_mov_b32 s33, 4096
buffer_store_dwordx4 v[244:247], v232, s[24:27], s33 offen offset:0 sc1
buffer_store_dwordx4 v[248:251], v232, s[24:27], s33 offen offset:512 sc1
s_nop 1
v_cvt_pk_bf16_f32 v244, v176, v177
v_cvt_pk_bf16_f32 v245, v178, v179
v_cvt_pk_bf16_f32 v246, v180, v181
v_cvt_pk_bf16_f32 v247, v182, v183
v_cvt_pk_bf16_f32 v248, v184, v185
v_cvt_pk_bf16_f32 v249, v186, v187
v_cvt_pk_bf16_f32 v250, v188, v189
v_cvt_pk_bf16_f32 v251, v190, v191
s_nop 1
v_permlane32_swap_b32 v244, v246
v_permlane32_swap_b32 v245, v247
v_permlane32_swap_b32 v248, v250
v_permlane32_swap_b32 v249, v251
s_mov_b32 s33, 6144
buffer_store_dwordx4 v[244:247], v232, s[24:27], s33 offen offset:0 sc1
buffer_store_dwordx4 v[248:251], v232, s[24:27], s33 offen offset:512 sc1
s_nop 1
s_branch K1_FIN
K1_FIN:
s_lshl_b32 s33, s2, 7
s_add_u32 s67, s33, 40960
s_add_u32 s56, s33, -7808
s_cmp_ge_u32 s2, 125
s_cselect_b32 s67, s56, s67
s_add_u32 s56, s33, 41728
s_cmp_ge_u32 s2, 250
s_cselect_b32 s67, s56, s67
s_mov_b32 s92, s4
s_mov_b32 s93, s5
s_mov_b32 s94, s6
s_mov_b32 s95, s7
s_mov_b32 s4, s54
s_mov_b32 s5, s55
s_mov_b32 s32, s48
s_mov_b32 s33, s49
s_mov_b32 s40, s100
s_mov_b32 s41, s101
s_mov_b32 s48, s28
s_mov_b32 s101, 0
v_mbcnt_lo_u32_b32 v131, -1, 0
v_mbcnt_hi_u32_b32 v131, -1, v131
s_and_b32 s60, s2, 7
s_lshr_b32 s61, s2, 3
s_lshr_b32 s51, s60, 2
s_and_b32 s53, s61, 3
s_lshr_b32 s61, s61, 2
s_and_b32 s52, s60, 3
s_lshl_b32 s52, s52, 3
s_add_u32 s52, s52, s61
s_and_b32 s49, s48, 1
s_lshr_b32 s50, s48, 1
s_lshl_b32 s54, s53, 5
s_lshl_b32 s60, s50, 4
s_add_u32 s54, s54, s60
s_max_u32 s60, s53, 1
s_sub_u32 s60, s60, 1
s_sub_u32 s54, s54, s60
s_min_u32 s60, s53, 1
s_and_b32 s60, s60, s50
s_sub_u32 s55, 16, s60
s_lshl_b32 s55, s55, 14
s_cmp_eq_u32 s60, 1
s_cselect_b32 s59, 3, 0xffff
s_lshl_b32 s54, s54, 14
s_mul_i32 s60, s51, 2048000
s_add_u32 s54, s54, s60
v_and_b32 v132, 15, v131
v_lshrrev_b32 v133, 4, v131
v_lshrrev_b32 v134, 5, v131
v_and_b32 v135, 31, v131
s_lshl_b32 s60, s49, 13
v_add_u32 v136, 0, v134
v_lshlrev_b32 v136, 1, v136
v_xor_b32 v136, v135, v136
v_lshlrev_b32 v136, 4, v136
v_lshl_add_u32 v136, v134, 9, v136
v_add_u32 v244, s60, v136
v_add_u32 v136, 2, v134
v_lshlrev_b32 v136, 1, v136
v_xor_b32 v136, v135, v136
v_lshlrev_b32 v136, 4, v136
v_lshl_add_u32 v136, v134, 9, v136
v_add_u32 v245, s60, v136
v_add_u32 v136, 4, v134
v_lshlrev_b32 v136, 1, v136
v_xor_b32 v136, v135, v136
v_lshlrev_b32 v136, 4, v136
v_lshl_add_u32 v136, v134, 9, v136
v_add_u32 v246, s60, v136
v_add_u32 v136, 6, v134
v_lshlrev_b32 v136, 1, v136
v_xor_b32 v136, v135, v136
v_lshlrev_b32 v136, 4, v136
v_lshl_add_u32 v136, v134, 9, v136
v_add_u32 v247, s60, v136
s_waitcnt lgkmcnt(0)
s_add_u32 s8, s4, s54
s_addc_u32 s9, s5, 0
s_mov_b32 s10, s55
s_mov_b32 s11, 0x20000
s_mul_i32 s60, s51, 2048000
s_add_u32 s60, s60, 0x400000
s_add_u32 s12, s4, s60
s_addc_u32 s13, s5, 0
s_mov_b32 s14, 0x1f4000
s_mov_b32 s15, 0x20000
s_getreg_b32 s63, hwreg(HW_REG_XCC_ID, 0, 3)
s_or_b32 s63, s63, 8
s_add_u32 s44, s4, 0x1200000
s_addc_u32 s45, s5, 0
s_mov_b32 s46, 0x13000
s_mov_b32 s47, 0x20000
s_lshl_b32 s65, s51, 5
s_add_u32 s65, s65, s52
s_lshl_b32 s56, s50, 16
s_lshl_b32 s60, s49, 13
s_add_u32 s56, s56, s60
s_mov_b32 s57, 0
s_mov_b32 s54, 0
s_lshl_b32 s60, s53, 5
s_max_u32 s61, s53, 1
s_sub_u32 s61, s61, 1
s_sub_u32 s60, s60, s61
s_lshl_b32 s60, s60, 5
s_mul_i32 s61, s51, 4000
s_add_u32 s60, s60, s61
s_lshr_b32 s60, s60, 6
s_lshl_b32 s62, s52, 7
s_add_u32 s62, s62, s61
s_lshr_b32 s62, s62, 6
v_add_u32 v150, s60, v131
v_add_u32 v151, s62, v131
v_subrev_u32 v151, 18, v151
v_cmp_gt_u32 vcc, 18, v131
s_nop 1
v_cndmask_b32 v150, v151, v150, vcc
v_mov_b32 v151, s62
v_cmp_gt_u32 vcc, 21, v131
s_nop 1
v_cndmask_b32 v150, v151, v150, vcc
v_min_u32 v150, 124, v150
v_lshlrev_b32 v150, 7, v150
v_add_u32 v150, 8192, v150
v_add_u32 v152, 4, v150
v_cmp_gt_u32 vcc, 18, v131
s_nop 1
v_cndmask_b32 v150, v150, v152, vcc
buffer_load_dword v151, v150, s[44:47], 0 offen sc1
s_cmp_eq_u32 s98, 1
s_cbranch_scc0 K1_NODEF
s_waitcnt lgkmcnt(0)
buffer_store_dwordx4 v[64:67], v228, s[24:27], s88 offen offset:0 sc1
buffer_store_dwordx4 v[68:71], v229, s[24:27], s88 offen offset:1024 sc1
buffer_store_dwordx4 v[72:75], v230, s[24:27], s88 offen offset:2048 sc1
buffer_store_dwordx4 v[76:79], v231, s[24:27], s88 offen offset:3072 sc1
buffer_store_dwordx4 v[80:83], v228, s[24:27], s89 offen offset:0 sc1
buffer_store_dwordx4 v[84:87], v229, s[24:27], s89 offen offset:1024 sc1
buffer_store_dwordx4 v[88:91], v230, s[24:27], s89 offen offset:2048 sc1
buffer_store_dwordx4 v[92:95], v231, s[24:27], s89 offen offset:3072 sc1
s_waitcnt vmcnt(8)
v_readfirstlane_b32 s3, v243
s_nop 3
s_cmp_lg_u32 s3, 0
s_cbranch_scc0 K1_TAGP
s_barrier
s_branch K1_NOFL
K1_NODEF:
s_waitcnt vmcnt(0) lgkmcnt(0)
v_readfirstlane_b32 s3, v243
s_nop 3
s_cmp_lg_u32 s3, 0
s_cbranch_scc1 K1_TAGD
K1_TAGP:
buffer_load_dword v154, off, s[92:95], 0 sc1
s_waitcnt vmcnt(0)
v_readfirstlane_b32 s3, v154
s_nop 3
s_cmp_lg_u32 s3, 0
s_cbranch_scc1 K1_TAGD
s_sleep 1
s_add_u32 s101, s101, 1
s_cmp_lt_u32 s101, 0x400000
s_cbranch_scc1 K1_TAGP
K1_TAGD:
s_barrier
s_cmp_eq_u32 s98, 1
s_cbranch_scc1 K1_NOFL
s_cmp_eq_u32 s48, 0
s_cbranch_scc0 K1_NOFL
v_mov_b32 v152, s3
v_mov_b32 v153, s3
v_cmp_eq_u32 vcc, 0, v131
s_and_saveexec_b64 s[70:71], vcc
buffer_store_dwordx2 v[152:153], off, s[44:47], s67 sc1
s_mov_b64 exec, s[70:71]
K1_NOFL:
v_cmp_ne_u32 vcc, s3, v151
s_nop 1
s_cmp_eq_u64 vcc, 0
s_cbranch_scc1 K2_QD
s_mov_b32 s66, 0
K2_QA:
s_and_b32 s60, vcc_lo, 0x3ffff
s_cmp_eq_u32 s60, 0
s_cbranch_scc1 K2_QAD
s_sleep 1
buffer_load_dword v151, v150, s[44:47], 0 offen sc1
s_waitcnt vmcnt(0)
v_cmp_ne_u32 vcc, s3, v151
s_nop 1
s_add_u32 s101, s101, 1
s_cmp_lt_u32 s101, 0x400000
s_cbranch_scc1 K2_QA
K2_QAD:
s_add_u32 m0, s56, 0x0
s_nop 0
buffer_load_dwordx4 v244, s[8:11], s57 offen offset:0 sc1 lds
buffer_load_dwordx4 v245, s[8:11], s57 offen offset:1024 sc1 lds
buffer_load_dwordx4 v246, s[8:11], s57 offen offset:2048 sc1 lds
buffer_load_dwordx4 v247, s[8:11], s57 offen offset:3072 sc1 lds
s_add_u32 m0, s56, 0x1000
s_add_u32 s57, s57, 4096
buffer_load_dwordx4 v244, s[8:11], s57 offen offset:0 sc1 lds
buffer_load_dwordx4 v245, s[8:11], s57 offen offset:1024 sc1 lds
buffer_load_dwordx4 v246, s[8:11], s57 offen offset:2048 sc1 lds
buffer_load_dwordx4 v247, s[8:11], s57 offen offset:3072 sc1 lds
s_add_u32 s57, s57, 12288
K2_QP:
buffer_load_dword v151, v150, s[44:47], 0 offen sc1
s_waitcnt vmcnt(0)
v_cmp_ne_u32 vcc, s3, v151
s_nop 1
s_cmp_eq_u64 vcc, 0
s_cbranch_scc1 K2_QB
s_sleep 1
s_add_u32 s101, s101, 1
s_cmp_lt_u32 s101, 0x400000
s_cbranch_scc1 K2_QP
K2_QB:
v_lshlrev_b32 v137, 4, v131
s_lshl_b32 s60, s52, 3
s_lshl_b32 s61, s48, 1
s_add_u32 s60, s60, s61
s_lshl_b32 s60, s60, 13
s_lshl_b32 s61, s48, 14
s_add_u32 s61, s61, 98304
s_cmp_eq_u32 s48, 0
s_cselect_b32 s61, 49152, s61
s_add_u32 m0, s61, 0
s_nop 0
buffer_load_dwordx4 v137, s[12:15], s60 offen offset:0 sc1 lds
buffer_load_dwordx4 v137, s[12:15], s60 offen offset:1024 sc1 lds
buffer_load_dwordx4 v137, s[12:15], s60 offen offset:2048 sc1 lds
buffer_load_dwordx4 v137, s[12:15], s60 offen offset:3072 sc1 lds
s_add_u32 m0, s61, 4096
s_add_u32 s60, s60, 4096
buffer_load_dwordx4 v137, s[12:15], s60 offen offset:0 sc1 lds
buffer_load_dwordx4 v137, s[12:15], s60 offen offset:1024 sc1 lds
buffer_load_dwordx4 v137, s[12:15], s60 offen offset:2048 sc1 lds
buffer_load_dwordx4 v137, s[12:15], s60 offen offset:3072 sc1 lds
s_add_u32 m0, s61, 8192
s_add_u32 s60, s60, 4096
buffer_load_dwordx4 v137, s[12:15], s60 offen offset:0 sc1 lds
buffer_load_dwordx4 v137, s[12:15], s60 offen offset:1024 sc1 lds
buffer_load_dwordx4 v137, s[12:15], s60 offen offset:2048 sc1 lds
buffer_load_dwordx4 v137, s[12:15], s60 offen offset:3072 sc1 lds
s_add_u32 m0, s61, 12288
s_add_u32 s60, s60, 4096
buffer_load_dwordx4 v137, s[12:15], s60 offen offset:0 sc1 lds
buffer_load_dwordx4 v137, s[12:15], s60 offen offset:1024 sc1 lds
buffer_load_dwordx4 v137, s[12:15], s60 offen offset:2048 sc1 lds
buffer_load_dwordx4 v137, s[12:15], s60 offen offset:3072 sc1 lds
s_branch K2_QE
K2_QD:
s_mov_b32 s66, 1
s_add_u32 m0, s56, 0x0
s_nop 0
buffer_load_dwordx4 v244, s[8:11], s57 offen offset:0 sc1 lds
buffer_load_dwordx4 v245, s[8:11], s57 offen offset:1024 sc1 lds
buffer_load_dwordx4 v246, s[8:11], s57 offen offset:2048 sc1 lds
buffer_load_dwordx4 v247, s[8:11], s57 offen offset:3072 sc1 lds
s_add_u32 m0, s56, 0x1000
s_add_u32 s57, s57, 4096
buffer_load_dwordx4 v244, s[8:11], s57 offen offset:0 sc1 lds
buffer_load_dwordx4 v245, s[8:11], s57 offen offset:1024 sc1 lds
buffer_load_dwordx4 v246, s[8:11], s57 offen offset:2048 sc1 lds
buffer_load_dwordx4 v247, s[8:11], s57 offen offset:3072 sc1 lds
s_add_u32 s57, s57, 12288
v_lshlrev_b32 v137, 4, v131
s_lshl_b32 s60, s52, 3
s_lshl_b32 s61, s48, 1
s_add_u32 s60, s60, s61
s_lshl_b32 s60, s60, 13
s_lshl_b32 s61, s48, 14
s_add_u32 s61, s61, 98304
s_cmp_eq_u32 s48, 0
s_cselect_b32 s61, 49152, s61
s_add_u32 m0, s61, 0
s_nop 0
buffer_load_dwordx4 v137, s[12:15], s60 offen offset:0 sc1 lds
buffer_load_dwordx4 v137, s[12:15], s60 offen offset:1024 sc1 lds
buffer_load_dwordx4 v137, s[12:15], s60 offen offset:2048 sc1 lds
buffer_load_dwordx4 v137, s[12:15], s60 offen offset:3072 sc1 lds
s_add_u32 m0, s61, 4096
s_add_u32 s60, s60, 4096
buffer_load_dwordx4 v137, s[12:15], s60 offen offset:0 sc1 lds
buffer_load_dwordx4 v137, s[12:15], s60 offen offset:1024 sc1 lds
buffer_load_dwordx4 v137, s[12:15], s60 offen offset:2048 sc1 lds
buffer_load_dwordx4 v137, s[12:15], s60 offen offset:3072 sc1 lds
s_add_u32 m0, s61, 8192
s_add_u32 s60, s60, 4096
buffer_load_dwordx4 v137, s[12:15], s60 offen offset:0 sc1 lds
buffer_load_dwordx4 v137, s[12:15], s60 offen offset:1024 sc1 lds
buffer_load_dwordx4 v137, s[12:15], s60 offen offset:2048 sc1 lds
buffer_load_dwordx4 v137, s[12:15], s60 offen offset:3072 sc1 lds
s_add_u32 m0, s61, 12288
s_add_u32 s60, s60, 4096
buffer_load_dwordx4 v137, s[12:15], s60 offen offset:0 sc1 lds
buffer_load_dwordx4 v137, s[12:15], s60 offen offset:1024 sc1 lds
buffer_load_dwordx4 v137, s[12:15], s60 offen offset:2048 sc1 lds
buffer_load_dwordx4 v137, s[12:15], s60 offen offset:3072 sc1 lds
K2_QE:
v_and_b32 v136, 7, v132
v_lshlrev_b32 v136, 1, v136
v_lshlrev_b32 v138, 9, v132
s_lshl_b32 s60, s50, 16
v_add_u32 v138, s60, v138
v_add_u32 v139, 0, v133
v_xor_b32 v139, v139, v136
v_lshl_add_u32 v232, v139, 4, v138
v_add_u32 v139, 4, v133
v_xor_b32 v139, v139, v136
v_lshl_add_u32 v233, v139, 4, v138
v_add_u32 v139, 8, v133
v_xor_b32 v139, v139, v136
v_lshl_add_u32 v234, v139, 4, v138
v_add_u32 v139, 12, v133
v_xor_b32 v139, v139, v136
v_lshl_add_u32 v235, v139, 4, v138
v_lshrrev_b32 v136, 2, v132
v_lshl_add_u32 v136, v133, 2, v136
v_lshlrev_b32 v138, 9, v136
v_add_u32 v138, s60, v138
v_and_b32 v139, 1, v132
v_lshl_add_u32 v138, v139, 3, v138
v_and_b32 v136, 7, v136
v_lshlrev_b32 v136, 1, v136
v_bfe_u32 v139, v132, 1, 1
v_add_u32 v140, 0, v139
v_xor_b32 v140, v140, v136
v_lshl_add_u32 v236, v140, 4, v138
v_add_u32 v140, 2, v139
v_xor_b32 v140, v140, v136
v_lshl_add_u32 v237, v140, 4, v138
v_add_u32 v140, 4, v139
v_xor_b32 v140, v140, v136
v_lshl_add_u32 v238, v140, 4, v138
v_add_u32 v140, 6, v139
v_xor_b32 v140, v140, v136
v_lshl_add_u32 v239, v140, 4, v138
v_add_u32 v140, 8, v139
v_xor_b32 v140, v140, v136
v_lshl_add_u32 v240, v140, 4, v138
v_add_u32 v140, 10, v139
v_xor_b32 v140, v140, v136
v_lshl_add_u32 v241, v140, 4, v138
v_add_u32 v140, 12, v139
v_xor_b32 v140, v140, v136
v_lshl_add_u32 v242, v140, 4, v138
v_add_u32 v140, 14, v139
v_xor_b32 v140, v140, v136
v_lshl_add_u32 v243, v140, 4, v138
v_mov_b32 v248, 0
v_mov_b32 v249, 0
v_mov_b32 v250, 0
v_mov_b32 v251, 0
s_mov_b32 s58, 0
v_lshlrev_b32 v137, 4, v131
s_lshl_b32 s60, s50, 1
s_add_u32 s60, s60, 0
s_and_b32 s60, s60, 3
s_lshl_b32 s61, s49, 2
s_add_u32 s60, s60, s61
s_lshr_b32 s61, s60, 1
s_lshl_b32 s62, s61, 14
s_add_u32 s62, s62, 98304
s_cmp_eq_u32 s61, 0
s_cselect_b32 s62, 49152, s62
s_and_b32 s60, s60, 1
s_lshl_b32 s60, s60, 13
s_add_u32 s62, s62, s60
v_add_u32 v140, s62, v137
s_lshl_b32 s60, s50, 1
s_add_u32 s60, s60, 1
s_and_b32 s60, s60, 3
s_lshl_b32 s61, s49, 2
s_add_u32 s60, s60, s61
s_lshr_b32 s61, s60, 1
s_lshl_b32 s62, s61, 14
s_add_u32 s62, s62, 98304
s_cmp_eq_u32 s61, 0
s_cselect_b32 s62, 49152, s62
s_and_b32 s60, s60, 1
s_lshl_b32 s60, s60, 13
s_add_u32 s62, s62, s60
v_add_u32 v141, s62, v137
s_lshl_b32 s60, s50, 1
s_add_u32 s60, s60, 2
s_and_b32 s60, s60, 3
s_lshl_b32 s61, s49, 2
s_add_u32 s60, s60, s61
s_lshr_b32 s61, s60, 1
s_lshl_b32 s62, s61, 14
s_add_u32 s62, s62, 98304
s_cmp_eq_u32 s61, 0
s_cselect_b32 s62, 49152, s62
s_and_b32 s60, s60, 1
s_lshl_b32 s60, s60, 13
s_add_u32 s62, s62, s60
v_add_u32 v142, s62, v137
s_lshl_b32 s60, s50, 1
s_add_u32 s60, s60, 3
s_and_b32 s60, s60, 3
s_lshl_b32 s61, s49, 2
s_add_u32 s60, s60, s61
s_lshr_b32 s61, s60, 1
s_lshl_b32 s62, s61, 14
s_add_u32 s62, s62, 98304
s_cmp_eq_u32 s61, 0
s_cselect_b32 s62, 49152, s62
s_and_b32 s60, s60, 1
s_lshl_b32 s60, s60, 13
s_add_u32 s62, s62, s60
v_add_u32 v143, s62, v137
s_waitcnt vmcnt(0)
s_barrier
s_cmp_eq_u32 s48, 0
s_cbranch_scc0 K2_NOXCC
s_lshl_b32 s60, s65, 7
s_lshl_b32 s61, s53, 2
s_add_u32 s60, s60, s61
s_add_u32 s60, s60, 16
s_xor_b32 s61, s63, s3
v_mov_b32 v137, s61
v_cmp_eq_u32 vcc, 0, v131
s_and_saveexec_b64 s[70:71], vcc
buffer_store_dword v137, off, s[44:47], s60 sc1
s_mov_b64 exec, s[70:71]
K2_NOXCC:
s_cmp_eq_u32 s98, 1
s_cbranch_scc0 K2_NODF
s_cmp_eq_u32 s48, 0
s_cbranch_scc0 K2_NODF
v_mov_b32 v152, s3
v_mov_b32 v153, s3
v_mbcnt_lo_u32_b32 v154, -1, 0
v_mbcnt_hi_u32_b32 v154, -1, v154
v_cmp_eq_u32 vcc, 0, v154
s_and_saveexec_b64 s[70:71], vcc
buffer_store_dwordx2 v[152:153], off, s[44:47], s67 sc1
s_mov_b64 exec, s[70:71]
K2_NODF:
ds_read_b128 a[0:3], v140 offset:0
ds_read_b128 a[32:35], v141 offset:0
ds_read_b128 a[64:67], v142 offset:0
ds_read_b128 a[96:99], v143 offset:0
ds_read_b128 a[4:7], v140 offset:1024
ds_read_b128 a[36:39], v141 offset:1024
ds_read_b128 a[68:71], v142 offset:1024
ds_read_b128 a[100:103], v143 offset:1024
ds_read_b128 a[8:11], v140 offset:2048
ds_read_b128 a[40:43], v141 offset:2048
ds_read_b128 a[72:75], v142 offset:2048
ds_read_b128 a[104:107], v143 offset:2048
ds_read_b128 a[12:15], v140 offset:3072
ds_read_b128 a[44:47], v141 offset:3072
ds_read_b128 a[76:79], v142 offset:3072
ds_read_b128 a[108:111], v143 offset:3072
ds_read_b128 a[16:19], v140 offset:4096
ds_read_b128 a[48:51], v141 offset:4096
ds_read_b128 a[80:83], v142 offset:4096
ds_read_b128 a[112:115], v143 offset:4096
ds_read_b128 a[20:23], v140 offset:5120
ds_read_b128 a[52:55], v141 offset:5120
ds_read_b128 a[84:87], v142 offset:5120
ds_read_b128 a[116:119], v143 offset:5120
ds_read_b128 a[24:27], v140 offset:6144
ds_read_b128 a[56:59], v141 offset:6144
ds_read_b128 a[88:91], v142 offset:6144
ds_read_b128 a[120:123], v143 offset:6144
ds_read_b128 a[28:31], v140 offset:7168
ds_read_b128 a[60:63], v141 offset:7168
ds_read_b128 a[92:95], v142 offset:7168
ds_read_b128 a[124:127], v143 offset:7168
ds_read_b128 v[208:211], v232 offset:0
ds_read_b128 v[212:215], v233 offset:0
ds_read_b128 v[216:219], v234 offset:0
s_waitcnt lgkmcnt(2)
v_mfma_f32_16x16x32_bf16 v[128:131], v[208:211], a[0:3], 0
ds_read_b128 v[220:223], v235 offset:0
v_mov_b32 v0, 0
v_mov_b32 v1, 0
v_mfma_f32_16x16x32_bf16 v[132:135], v[208:211], a[32:35], 0
v_mov_b32 v2, 0
v_mov_b32 v3, 0
s_add_u32 m0, s56, 0x4000
s_nop 0
buffer_load_dwordx4 v244, s[8:11], s57 offen offset:0 sc1 lds
v_mfma_f32_16x16x32_bf16 v[136:139], v[208:211], a[64:67], 0
v_mov_b32 v4, 0
v_mov_b32 v5, 0
v_mfma_f32_16x16x32_bf16 v[140:143], v[208:211], a[96:99], 0
v_mov_b32 v6, 0
v_mov_b32 v7, 0
s_waitcnt lgkmcnt(2)
v_mfma_f32_16x16x32_bf16 v[128:131], v[212:215], a[4:7], v[128:131]
ds_read_b128 v[208:211], v232 offset:256
v_mov_b32 v8, 0
v_mov_b32 v9, 0
v_mfma_f32_16x16x32_bf16 v[132:135], v[212:215], a[36:39], v[132:135]
v_mov_b32 v10, 0
v_mov_b32 v11, 0
buffer_load_dwordx4 v245, s[8:11], s57 offen offset:1024 sc1 lds
v_mfma_f32_16x16x32_bf16 v[136:139], v[212:215], a[68:71], v[136:139]
v_mov_b32 v12, 0
v_mov_b32 v13, 0
v_mfma_f32_16x16x32_bf16 v[140:143], v[212:215], a[100:103], v[140:143]
v_mov_b32 v14, 0
v_mov_b32 v15, 0
s_waitcnt lgkmcnt(2)
v_mfma_f32_16x16x32_bf16 v[128:131], v[216:219], a[8:11], v[128:131]
ds_read_b128 v[212:215], v233 offset:256
v_mov_b32 v16, 0
v_mov_b32 v17, 0
v_mfma_f32_16x16x32_bf16 v[132:135], v[216:219], a[40:43], v[132:135]
v_mov_b32 v18, 0
v_mov_b32 v19, 0
buffer_load_dwordx4 v246, s[8:11], s57 offen offset:2048 sc1 lds
v_mfma_f32_16x16x32_bf16 v[136:139], v[216:219], a[72:75], v[136:139]
v_mov_b32 v20, 0
v_mov_b32 v21, 0
v_mfma_f32_16x16x32_bf16 v[140:143], v[216:219], a[104:107], v[140:143]
v_mov_b32 v22, 0
v_mov_b32 v23, 0
s_waitcnt lgkmcnt(2)
v_mfma_f32_16x16x32_bf16 v[128:131], v[220:223], a[12:15], v[128:131]
ds_read_b128 v[216:219], v234 offset:256
v_mov_b32 v24, 0
v_mov_b32 v25, 0
v_mfma_f32_16x16x32_bf16 v[132:135], v[220:223], a[44:47], v[132:135]
v_mov_b32 v26, 0
v_mov_b32 v27, 0
buffer_load_dwordx4 v247, s[8:11], s57 offen offset:3072 sc1 lds
v_mfma_f32_16x16x32_bf16 v[136:139], v[220:223], a[76:79], v[136:139]
v_mov_b32 v28, 0
v_mov_b32 v29, 0
v_mfma_f32_16x16x32_bf16 v[140:143], v[220:223], a[108:111], v[140:143]
v_mov_b32 v30, 0
v_mov_b32 v31, 0
s_waitcnt lgkmcnt(2)
v_mfma_f32_16x16x32_bf16 v[128:131], v[208:211], a[16:19], v[128:131]
ds_read_b128 v[220:223], v235 offset:256
v_mov_b32 v32, 0
v_mov_b32 v33, 0
v_mfma_f32_16x16x32_bf16 v[132:135], v[208:211], a[48:51], v[132:135]
v_mov_b32 v34, 0
v_mov_b32 v35, 0
s_add_u32 m0, s56, 0x5000
s_add_u32 s57, s57, 4096
buffer_load_dwordx4 v244, s[8:11], s57 offen offset:0 sc1 lds
v_mfma_f32_16x16x32_bf16 v[136:139], v[208:211], a[80:83], v[136:139]
v_mov_b32 v36, 0
v_mov_b32 v37, 0
v_mfma_f32_16x16x32_bf16 v[140:143], v[208:211], a[112:115], v[140:143]
v_mov_b32 v38, 0
v_mov_b32 v39, 0
s_waitcnt lgkmcnt(2)
v_mfma_f32_16x16x32_bf16 v[128:131], v[212:215], a[20:23], v[128:131]
ds_read_b128 v[208:211], v232 offset:8192
v_mov_b32 v40, 0
v_mov_b32 v41, 0
v_mfma_f32_16x16x32_bf16 v[132:135], v[212:215], a[52:55], v[132:135]
v_mov_b32 v42, 0
v_mov_b32 v43, 0
buffer_load_dwordx4 v245, s[8:11], s57 offen offset:1024 sc1 lds
v_mfma_f32_16x16x32_bf16 v[136:139], v[212:215], a[84:87], v[136:139]
v_mov_b32 v44, 0
v_mov_b32 v45, 0
v_mfma_f32_16x16x32_bf16 v[140:143], v[212:215], a[116:119], v[140:143]
v_mov_b32 v46, 0
v_mov_b32 v47, 0
s_waitcnt lgkmcnt(2)
v_mfma_f32_16x16x32_bf16 v[128:131], v[216:219], a[24:27], v[128:131]
ds_read_b128 v[212:215], v233 offset:8192
v_mov_b32 v48, 0
v_mov_b32 v49, 0
v_mfma_f32_16x16x32_bf16 v[132:135], v[216:219], a[56:59], v[132:135]
v_mov_b32 v50, 0
v_mov_b32 v51, 0
buffer_load_dwordx4 v246, s[8:11], s57 offen offset:2048 sc1 lds
v_mfma_f32_16x16x32_bf16 v[136:139], v[216:219], a[88:91], v[136:139]
v_mov_b32 v52, 0
v_mov_b32 v53, 0
v_mfma_f32_16x16x32_bf16 v[140:143], v[216:219], a[120:123], v[140:143]
v_mov_b32 v54, 0
v_mov_b32 v55, 0
s_waitcnt lgkmcnt(2)
v_mfma_f32_16x16x32_bf16 v[128:131], v[220:223], a[28:31], v[128:131]
ds_read_b128 v[216:219], v234 offset:8192
v_mov_b32 v56, 0
v_mov_b32 v57, 0
v_mfma_f32_16x16x32_bf16 v[132:135], v[220:223], a[60:63], v[132:135]
v_mov_b32 v58, 0
v_mov_b32 v59, 0
buffer_load_dwordx4 v247, s[8:11], s57 offen offset:3072 sc1 lds
s_add_u32 s57, s57, 12288
v_mfma_f32_16x16x32_bf16 v[136:139], v[220:223], a[92:95], v[136:139]
v_mov_b32 v60, 0
v_mov_b32 v61, 0
v_mfma_f32_16x16x32_bf16 v[140:143], v[220:223], a[124:127], v[140:143]
v_mov_b32 v62, 0
v_mov_b32 v63, 0
s_waitcnt lgkmcnt(2)
v_mfma_f32_16x16x32_bf16 v[144:147], v[208:211], a[0:3], 0
ds_read_b128 v[220:223], v235 offset:8192
v_mov_b32 v64, 0
v_mov_b32 v65, 0
v_mfma_f32_16x16x32_bf16 v[148:151], v[208:211], a[32:35], 0
v_mov_b32 v66, 0
v_mov_b32 v67, 0
s_add_u32 m0, s56, 0x8000
s_nop 0
buffer_load_dwordx4 v244, s[8:11], s57 offen offset:0 sc1 lds
v_mfma_f32_16x16x32_bf16 v[152:155], v[208:211], a[64:67], 0
v_mov_b32 v68, 0
v_mov_b32 v69, 0
v_mfma_f32_16x16x32_bf16 v[156:159], v[208:211], a[96:99], 0
v_mov_b32 v70, 0
v_mov_b32 v71, 0
s_waitcnt lgkmcnt(2)
v_mfma_f32_16x16x32_bf16 v[144:147], v[212:215], a[4:7], v[144:147]
ds_read_b128 v[208:211], v232 offset:8448
v_mov_b32 v72, 0
v_mov_b32 v73, 0
v_mfma_f32_16x16x32_bf16 v[148:151], v[212:215], a[36:39], v[148:151]
v_mov_b32 v74, 0
v_mov_b32 v75, 0
buffer_load_dwordx4 v245, s[8:11], s57 offen offset:1024 sc1 lds
v_mfma_f32_16x16x32_bf16 v[152:155], v[212:215], a[68:71], v[152:155]
v_mov_b32 v76, 0
v_mov_b32 v77, 0
v_mfma_f32_16x16x32_bf16 v[156:159], v[212:215], a[100:103], v[156:159]
v_mov_b32 v78, 0
v_mov_b32 v79, 0
s_waitcnt lgkmcnt(2)
v_mfma_f32_16x16x32_bf16 v[144:147], v[216:219], a[8:11], v[144:147]
ds_read_b128 v[212:215], v233 offset:8448
v_mov_b32 v80, 0
v_mov_b32 v81, 0
v_mfma_f32_16x16x32_bf16 v[148:151], v[216:219], a[40:43], v[148:151]
v_mov_b32 v82, 0
v_mov_b32 v83, 0
buffer_load_dwordx4 v246, s[8:11], s57 offen offset:2048 sc1 lds
v_mfma_f32_16x16x32_bf16 v[152:155], v[216:219], a[72:75], v[152:155]
v_mov_b32 v84, 0
v_mov_b32 v85, 0
v_mfma_f32_16x16x32_bf16 v[156:159], v[216:219], a[104:107], v[156:159]
v_mov_b32 v86, 0
v_mov_b32 v87, 0
s_waitcnt lgkmcnt(2)
v_mfma_f32_16x16x32_bf16 v[144:147], v[220:223], a[12:15], v[144:147]
ds_read_b128 v[216:219], v234 offset:8448
v_mov_b32 v88, 0
v_mov_b32 v89, 0
v_mfma_f32_16x16x32_bf16 v[148:151], v[220:223], a[44:47], v[148:151]
v_mov_b32 v90, 0
v_mov_b32 v91, 0
buffer_load_dwordx4 v247, s[8:11], s57 offen offset:3072 sc1 lds
v_mfma_f32_16x16x32_bf16 v[152:155], v[220:223], a[76:79], v[152:155]
v_mov_b32 v92, 0
v_mov_b32 v93, 0
v_mfma_f32_16x16x32_bf16 v[156:159], v[220:223], a[108:111], v[156:159]
v_mov_b32 v94, 0
v_mov_b32 v95, 0
s_waitcnt lgkmcnt(2)
v_mfma_f32_16x16x32_bf16 v[144:147], v[208:211], a[16:19], v[144:147]
ds_read_b128 v[220:223], v235 offset:8448
v_mov_b32 v96, 0
v_mov_b32 v97, 0
v_mfma_f32_16x16x32_bf16 v[148:151], v[208:211], a[48:51], v[148:151]
v_mov_b32 v98, 0
v_mov_b32 v99, 0
s_add_u32 m0, s56, 0x9000
s_add_u32 s57, s57, 4096
buffer_load_dwordx4 v244, s[8:11], s57 offen offset:0 sc1 lds
v_mfma_f32_16x16x32_bf16 v[152:155], v[208:211], a[80:83], v[152:155]
v_mov_b32 v100, 0
v_mov_b32 v101, 0
v_mfma_f32_16x16x32_bf16 v[156:159], v[208:211], a[112:115], v[156:159]
v_mov_b32 v102, 0
v_mov_b32 v103, 0
s_waitcnt lgkmcnt(2)
v_mfma_f32_16x16x32_bf16 v[144:147], v[212:215], a[20:23], v[144:147]
v_mov_b32 v104, 0
v_mov_b32 v105, 0
v_mfma_f32_16x16x32_bf16 v[148:151], v[212:215], a[52:55], v[148:151]
v_mov_b32 v106, 0
v_mov_b32 v107, 0
buffer_load_dwordx4 v245, s[8:11], s57 offen offset:1024 sc1 lds
v_mfma_f32_16x16x32_bf16 v[152:155], v[212:215], a[84:87], v[152:155]
v_mov_b32 v108, 0
v_mov_b32 v109, 0
v_mfma_f32_16x16x32_bf16 v[156:159], v[212:215], a[116:119], v[156:159]
v_mov_b32 v110, 0
v_mov_b32 v111, 0
s_waitcnt lgkmcnt(1)
v_mfma_f32_16x16x32_bf16 v[144:147], v[216:219], a[24:27], v[144:147]
v_mov_b32 v112, 0
v_mov_b32 v113, 0
v_mfma_f32_16x16x32_bf16 v[148:151], v[216:219], a[56:59], v[148:151]
v_mov_b32 v114, 0
v_mov_b32 v115, 0
buffer_load_dwordx4 v246, s[8:11], s57 offen offset:2048 sc1 lds
v_mfma_f32_16x16x32_bf16 v[152:155], v[216:219], a[88:91], v[152:155]
v_mov_b32 v116, 0
v_mov_b32 v117, 0
v_mfma_f32_16x16x32_bf16 v[156:159], v[216:219], a[120:123], v[156:159]
v_mov_b32 v118, 0
v_mov_b32 v119, 0
s_waitcnt lgkmcnt(0)
v_mfma_f32_16x16x32_bf16 v[144:147], v[220:223], a[28:31], v[144:147]
v_mov_b32 v120, 0
v_mov_b32 v121, 0
v_mfma_f32_16x16x32_bf16 v[148:151], v[220:223], a[60:63], v[148:151]
v_mov_b32 v122, 0
v_mov_b32 v123, 0
buffer_load_dwordx4 v247, s[8:11], s57 offen offset:3072 sc1 lds
s_add_u32 s57, s57, 12288
v_mfma_f32_16x16x32_bf16 v[152:155], v[220:223], a[92:95], v[152:155]
v_mov_b32 v124, 0
v_mov_b32 v125, 0
v_mfma_f32_16x16x32_bf16 v[156:159], v[220:223], a[124:127], v[156:159]
s_nop 7
v_max3_f32 v192, v128, v129, v130
v_max3_f32 v192, v192, v131, v144
v_max3_f32 v192, v192, v145, v146
v_max_f32 v192, v192, v147
v_max3_f32 v193, v132, v133, v134
v_max3_f32 v193, v193, v135, v148
v_max3_f32 v193, v193, v149, v150
v_max_f32 v193, v193, v151
v_max3_f32 v194, v136, v137, v138
v_max3_f32 v194, v194, v139, v152
v_max3_f32 v194, v194, v153, v154
v_max_f32 v194, v194, v155
v_max3_f32 v195, v140, v141, v142
v_max3_f32 v195, v195, v143, v156
v_max3_f32 v195, v195, v157, v158
v_max_f32 v195, v195, v159
v_mov_b32 v196, v192
v_mov_b32 v197, v193
v_mov_b32 v198, v194
v_mov_b32 v199, v195
s_nop 1
v_permlane16_swap_b32 v192, v196
v_permlane16_swap_b32 v193, v197
v_permlane16_swap_b32 v194, v198
v_permlane16_swap_b32 v195, v199
s_nop 1
v_max_f32 v192, v192, v196
v_max_f32 v193, v193, v197
v_max_f32 v194, v194, v198
v_max_f32 v195, v195, v199
v_mov_b32 v196, v192
v_mov_b32 v197, v193
v_mov_b32 v198, v194
v_mov_b32 v199, v195
s_nop 1
v_permlane32_swap_b32 v192, v196
v_permlane32_swap_b32 v193, v197
v_permlane32_swap_b32 v194, v198
v_permlane32_swap_b32 v195, v199
s_nop 1
v_max_f32 v192, v192, v196
v_max_f32 v193, v193, v197
v_max_f32 v194, v194, v198
v_max_f32 v195, v195, v199
v_mbcnt_lo_u32_b32 v254, -1, 0
v_mbcnt_hi_u32_b32 v254, -1, v254
v_lshlrev_b32 v254, 4, v254
s_lshl_b32 s60, s48, 10
s_add_u32 s60, s60, 131072
v_add_u32 v255, s60, v254
ds_write_b128 v255, v[192:195]
s_xor_b32 s60, s60, 2048
v_add_u32 v255, s60, v254
s_waitcnt lgkmcnt(0)
s_barrier
ds_read_b128 v[196:199], v255
s_waitcnt lgkmcnt(0)
v_max_f32 v200, v192, v198
v_max_f32 v201, v193, v199
v_max_f32 v202, v194, v196
v_max_f32 v203, v195, v197
v_mov_b32 v252, v200
v_mov_b32 v253, v201
v_sub_f32 v128, v128, v200
v_sub_f32 v129, v129, v200
v_sub_f32 v130, v130, v200
v_sub_f32 v131, v131, v200
v_sub_f32 v132, v132, v201
v_sub_f32 v133, v133, v201
v_sub_f32 v134, v134, v201
v_sub_f32 v135, v135, v201
v_sub_f32 v136, v136, v202
v_sub_f32 v137, v137, v202
v_sub_f32 v138, v138, v202
v_sub_f32 v139, v139, v202
v_sub_f32 v140, v140, v203
v_sub_f32 v141, v141, v203
v_sub_f32 v142, v142, v203
v_sub_f32 v143, v143, v203
v_sub_f32 v144, v144, v200
v_sub_f32 v145, v145, v200
v_sub_f32 v146, v146, v200
v_sub_f32 v147, v147, v200
v_sub_f32 v148, v148, v201
v_sub_f32 v149, v149, v201
v_sub_f32 v150, v150, v201
v_sub_f32 v151, v151, v201
v_sub_f32 v152, v152, v202
v_sub_f32 v153, v153, v202
v_sub_f32 v154, v154, v202
v_sub_f32 v155, v155, v202
v_sub_f32 v156, v156, v203
v_sub_f32 v157, v157, v203
v_sub_f32 v158, v158, v203
v_sub_f32 v159, v159, v203
v_sub_f32 v204, 0, v203
v_sub_f32 v205, 0, v203
v_sub_f32 v206, 0, v203
v_sub_f32 v207, 0, v203
v_sub_f32 v196, 0, v201
v_sub_f32 v197, 0, v201
v_sub_f32 v198, 0, v201
v_sub_f32 v199, 0, v201
v_sub_f32 v192, 0, v200
v_sub_f32 v193, 0, v200
v_sub_f32 v194, 0, v200
v_sub_f32 v195, 0, v200
v_sub_f32 v254, 0, v202
v_mov_b32 v200, v254
v_mov_b32 v201, v254
v_mov_b32 v202, v254
v_mov_b32 v203, v254
v_exp_f32 v128, v128
s_nop 0
v_add_f32 v248, v248, v128
v_exp_f32 v129, v129
s_nop 0
v_add_f32 v248, v248, v129
v_cvt_pk_bf16_f32 v160, v128, v129
v_exp_f32 v130, v130
s_nop 0
v_add_f32 v248, v248, v130
v_exp_f32 v131, v131
s_nop 0
v_add_f32 v248, v248, v131
v_cvt_pk_bf16_f32 v161, v130, v131
v_exp_f32 v132, v132
s_nop 0
v_add_f32 v249, v249, v132
v_exp_f32 v133, v133
s_nop 0
v_add_f32 v249, v249, v133
v_cvt_pk_bf16_f32 v164, v132, v133
v_exp_f32 v134, v134
s_nop 0
v_add_f32 v249, v249, v134
v_mov_b32 v126, 0
v_mov_b32 v127, 0
v_exp_f32 v135, v135
s_nop 0
v_add_f32 v249, v249, v135
v_cvt_pk_bf16_f32 v165, v134, v135
v_exp_f32 v136, v136
s_nop 0
v_add_f32 v250, v250, v136
v_exp_f32 v137, v137
s_nop 0
v_add_f32 v250, v250, v137
v_cvt_pk_bf16_f32 v168, v136, v137
v_exp_f32 v138, v138
s_nop 0
v_add_f32 v250, v250, v138
v_exp_f32 v139, v139
s_nop 0
v_add_f32 v250, v250, v139
v_cvt_pk_bf16_f32 v169, v138, v139
v_exp_f32 v140, v140
s_nop 0
v_add_f32 v251, v251, v140
v_exp_f32 v141, v141
s_nop 0
v_add_f32 v251, v251, v141
v_cvt_pk_bf16_f32 v172, v140, v141
v_exp_f32 v142, v142
v_exp_f32 v144, v144
v_add_f32 v251, v251, v142
v_add_f32 v248, v248, v144
v_exp_f32 v143, v143
v_exp_f32 v145, v145
v_add_f32 v251, v251, v143
v_add_f32 v248, v248, v145
v_cvt_pk_bf16_f32 v173, v142, v143
v_cvt_pk_bf16_f32 v162, v144, v145
s_waitcnt vmcnt(8)
s_barrier
v_exp_f32 v146, v146
s_nop 0
v_add_f32 v248, v248, v146
v_exp_f32 v147, v147
s_nop 0
v_add_f32 v248, v248, v147
v_cvt_pk_bf16_f32 v163, v146, v147
v_exp_f32 v148, v148
s_nop 0
v_add_f32 v249, v249, v148
v_exp_f32 v149, v149
s_nop 0
v_add_f32 v249, v249, v149
v_cvt_pk_bf16_f32 v166, v148, v149
ds_read_b128 v[208:211], v232 offset:16384
v_exp_f32 v150, v150
s_nop 0
v_add_f32 v249, v249, v150
ds_read_b128 v[212:215], v233 offset:16384
v_exp_f32 v151, v151
s_nop 0
v_add_f32 v249, v249, v151
v_cvt_pk_bf16_f32 v167, v150, v151
ds_read_b128 v[216:219], v234 offset:16384
v_exp_f32 v152, v152
s_nop 0
v_add_f32 v250, v250, v152
K2_LOOP:
s_waitcnt lgkmcnt(2)
v_mfma_f32_16x16x32_bf16 v[128:131], v[208:211], a[0:3], v[192:195]
ds_read_b128 v[220:223], v235 offset:16384
v_mfma_f32_16x16x32_bf16 v[132:135], v[208:211], a[32:35], v[196:199]
v_exp_f32 v153, v153
v_mfma_f32_16x16x32_bf16 v[136:139], v[208:211], a[64:67], v[200:203]
v_add_f32 v250, v250, v153
v_cvt_pk_bf16_f32 v170, v152, v153
v_mfma_f32_16x16x32_bf16 v[140:143], v[208:211], a[96:99], v[204:207]
s_waitcnt lgkmcnt(2)
v_mfma_f32_16x16x32_bf16 v[128:131], v[212:215], a[4:7], v[128:131]
ds_read_b128 v[208:211], v232 offset:16640
v_mfma_f32_16x16x32_bf16 v[132:135], v[212:215], a[36:39], v[132:135]
v_exp_f32 v154, v154
v_mfma_f32_16x16x32_bf16 v[136:139], v[212:215], a[68:71], v[136:139]
v_add_f32 v250, v250, v154
v_mfma_f32_16x16x32_bf16 v[140:143], v[212:215], a[100:103], v[140:143]
s_waitcnt lgkmcnt(2)
v_mfma_f32_16x16x32_bf16 v[128:131], v[216:219], a[8:11], v[128:131]
ds_read_b128 v[212:215], v233 offset:16640
s_waitcnt vmcnt(0)
s_barrier
v_mfma_f32_16x16x32_bf16 v[132:135], v[216:219], a[40:43], v[132:135]
v_exp_f32 v155, v155
v_mfma_f32_16x16x32_bf16 v[136:139], v[216:219], a[72:75], v[136:139]
v_add_f32 v250, v250, v155
v_cvt_pk_bf16_f32 v171, v154, v155
v_mfma_f32_16x16x32_bf16 v[140:143], v[216:219], a[104:107], v[140:143]
s_add_u32 m0, s56, 0xc000
s_nop 0
buffer_load_dwordx4 v244, s[8:11], s57 offen offset:0 sc1 lds
s_waitcnt lgkmcnt(2)
v_mfma_f32_16x16x32_bf16 v[128:131], v[220:223], a[12:15], v[128:131]
ds_read_b128 v[216:219], v234 offset:16640
v_mfma_f32_16x16x32_bf16 v[132:135], v[220:223], a[44:47], v[132:135]
v_exp_f32 v156, v156
v_mfma_f32_16x16x32_bf16 v[136:139], v[220:223], a[76:79], v[136:139]
v_add_f32 v251, v251, v156
v_mfma_f32_16x16x32_bf16 v[140:143], v[220:223], a[108:111], v[140:143]
buffer_load_dwordx4 v245, s[8:11], s57 offen offset:1024 sc1 lds
s_waitcnt lgkmcnt(2)
v_mfma_f32_16x16x32_bf16 v[128:131], v[208:211], a[16:19], v[128:131]
ds_read_b128 v[220:223], v235 offset:16640
v_mfma_f32_16x16x32_bf16 v[132:135], v[208:211], a[48:51], v[132:135]
v_exp_f32 v157, v157
v_mfma_f32_16x16x32_bf16 v[136:139], v[208:211], a[80:83], v[136:139]
v_add_f32 v251, v251, v157
v_cvt_pk_bf16_f32 v174, v156, v157
v_mfma_f32_16x16x32_bf16 v[140:143], v[208:211], a[112:115], v[140:143]
buffer_load_dwordx4 v246, s[8:11], s57 offen offset:2048 sc1 lds
s_waitcnt lgkmcnt(2)
v_mfma_f32_16x16x32_bf16 v[128:131], v[212:215], a[20:23], v[128:131]
ds_read_b128 v[208:211], v232 offset:24576
v_mfma_f32_16x16x32_bf16 v[132:135], v[212:215], a[52:55], v[132:135]
v_exp_f32 v158, v158
v_mfma_f32_16x16x32_bf16 v[136:139], v[212:215], a[84:87], v[136:139]
v_add_f32 v251, v251, v158
v_mfma_f32_16x16x32_bf16 v[140:143], v[212:215], a[116:119], v[140:143]
buffer_load_dwordx4 v247, s[8:11], s57 offen offset:3072 sc1 lds
s_waitcnt lgkmcnt(2)
v_mfma_f32_16x16x32_bf16 v[128:131], v[216:219], a[24:27], v[128:131]
ds_read_b128 v[212:215], v233 offset:24576
v_mfma_f32_16x16x32_bf16 v[132:135], v[216:219], a[56:59], v[132:135]
v_exp_f32 v159, v159
v_mfma_f32_16x16x32_bf16 v[136:139], v[216:219], a[88:91], v[136:139]
v_add_f32 v251, v251, v159
v_cvt_pk_bf16_f32 v175, v158, v159
v_mfma_f32_16x16x32_bf16 v[140:143], v[216:219], a[120:123], v[140:143]
s_add_u32 m0, s56, 0xd000
s_add_u32 s57, s57, 4096
buffer_load_dwordx4 v244, s[8:11], s57 offen offset:0 sc1 lds
s_waitcnt lgkmcnt(2)
v_mfma_f32_16x16x32_bf16 v[128:131], v[220:223], a[28:31], v[128:131]
ds_read_b128 v[216:219], v234 offset:24576
v_mfma_f32_16x16x32_bf16 v[132:135], v[220:223], a[60:63], v[132:135]
v_mfma_f32_16x16x32_bf16 v[136:139], v[220:223], a[92:95], v[136:139]
v_mfma_f32_16x16x32_bf16 v[140:143], v[220:223], a[124:127], v[140:143]
buffer_load_dwordx4 v245, s[8:11], s57 offen offset:1024 sc1 lds
s_waitcnt lgkmcnt(2)
v_mfma_f32_16x16x32_bf16 v[144:147], v[208:211], a[0:3], v[192:195]
ds_read_b128 v[220:223], v235 offset:24576
v_mfma_f32_16x16x32_bf16 v[148:151], v[208:211], a[32:35], v[196:199]
v_mfma_f32_16x16x32_bf16 v[152:155], v[208:211], a[64:67], v[200:203]
v_mfma_f32_16x16x32_bf16 v[156:159], v[208:211], a[96:99], v[204:207]
buffer_load_dwordx4 v246, s[8:11], s57 offen offset:2048 sc1 lds
s_waitcnt lgkmcnt(2)
v_mfma_f32_16x16x32_bf16 v[144:147], v[212:215], a[4:7], v[144:147]
ds_read_b128 v[208:211], v232 offset:24832
v_mfma_f32_16x16x32_bf16 v[148:151], v[212:215], a[36:39], v[148:151]
v_exp_f32 v128, v128
v_mfma_f32_16x16x32_bf16 v[152:155], v[212:215], a[68:71], v[152:155]
v_add_f32 v248, v248, v128
v_mfma_f32_16x16x32_bf16 v[156:159], v[212:215], a[100:103], v[156:159]
buffer_load_dwordx4 v247, s[8:11], s57 offen offset:3072 sc1 lds
s_add_u32 s57, s57, 12288
s_waitcnt lgkmcnt(2)
v_mfma_f32_16x16x32_bf16 v[144:147], v[216:219], a[8:11], v[144:147]
ds_read_b128 v[212:215], v233 offset:24832
v_mfma_f32_16x16x32_bf16 v[148:151], v[216:219], a[40:43], v[148:151]
v_exp_f32 v129, v129
v_mfma_f32_16x16x32_bf16 v[152:155], v[216:219], a[72:75], v[152:155]
v_add_f32 v248, v248, v129
v_cvt_pk_bf16_f32 v176, v128, v129
v_mfma_f32_16x16x32_bf16 v[156:159], v[216:219], a[104:107], v[156:159]
s_waitcnt lgkmcnt(2)
v_mfma_f32_16x16x32_bf16 v[144:147], v[220:223], a[12:15], v[144:147]
ds_read_b128 v[216:219], v234 offset:24832
v_mfma_f32_16x16x32_bf16 v[148:151], v[220:223], a[44:47], v[148:151]
v_exp_f32 v130, v130
v_mfma_f32_16x16x32_bf16 v[152:155], v[220:223], a[76:79], v[152:155]
v_add_f32 v248, v248, v130
v_mfma_f32_16x16x32_bf16 v[156:159], v[220:223], a[108:111], v[156:159]
s_waitcnt lgkmcnt(2)
v_mfma_f32_16x16x32_bf16 v[144:147], v[208:211], a[16:19], v[144:147]
ds_read_b128 v[220:223], v235 offset:24832
v_mfma_f32_16x16x32_bf16 v[148:151], v[208:211], a[48:51], v[148:151]
v_exp_f32 v131, v131
v_mfma_f32_16x16x32_bf16 v[152:155], v[208:211], a[80:83], v[152:155]
v_add_f32 v248, v248, v131
v_cvt_pk_bf16_f32 v177, v130, v131
v_mfma_f32_16x16x32_bf16 v[156:159], v[208:211], a[112:115], v[156:159]
s_waitcnt lgkmcnt(2)
v_mfma_f32_16x16x32_bf16 v[144:147], v[212:215], a[20:23], v[144:147]
ds_read_b64_tr_b16 v[208:209], v236 offset:0
ds_read_b64_tr_b16 v[210:211], v236 offset:8192
v_mfma_f32_16x16x32_bf16 v[148:151], v[212:215], a[52:55], v[148:151]
v_exp_f32 v132, v132
v_mfma_f32_16x16x32_bf16 v[152:155], v[212:215], a[84:87], v[152:155]
v_add_f32 v249, v249, v132
v_mfma_f32_16x16x32_bf16 v[156:159], v[212:215], a[116:119], v[156:159]
s_waitcnt lgkmcnt(3)
v_mfma_f32_16x16x32_bf16 v[144:147], v[216:219], a[24:27], v[144:147]
ds_read_b64_tr_b16 v[212:213], v237 offset:0
ds_read_b64_tr_b16 v[214:215], v237 offset:8192
v_mfma_f32_16x16x32_bf16 v[148:151], v[216:219], a[56:59], v[148:151]
v_exp_f32 v133, v133
v_mfma_f32_16x16x32_bf16 v[152:155], v[216:219], a[88:91], v[152:155]
v_add_f32 v249, v249, v133
v_cvt_pk_bf16_f32 v180, v132, v133
v_mfma_f32_16x16x32_bf16 v[156:159], v[216:219], a[120:123], v[156:159]
s_waitcnt lgkmcnt(4)
v_mfma_f32_16x16x32_bf16 v[144:147], v[220:223], a[28:31], v[144:147]
ds_read_b64_tr_b16 v[216:217], v238 offset:0
ds_read_b64_tr_b16 v[218:219], v238 offset:8192
v_mfma_f32_16x16x32_bf16 v[148:151], v[220:223], a[60:63], v[148:151]
v_exp_f32 v134, v134
v_mfma_f32_16x16x32_bf16 v[152:155], v[220:223], a[92:95], v[152:155]
v_add_f32 v249, v249, v134
v_mfma_f32_16x16x32_bf16 v[156:159], v[220:223], a[124:127], v[156:159]
s_waitcnt lgkmcnt(4)
v_mfma_f32_16x16x32_bf16 v[0:3], v[208:211], v[160:163], v[0:3]
ds_read_b64_tr_b16 v[220:221], v239 offset:0
ds_read_b64_tr_b16 v[222:223], v239 offset:8192
v_mfma_f32_16x16x32_bf16 v[4:7], v[208:211], v[164:167], v[4:7]
v_exp_f32 v135, v135
v_mfma_f32_16x16x32_bf16 a[128:131], v[208:211], v[168:171], a[128:131]
v_add_f32 v249, v249, v135
v_cvt_pk_bf16_f32 v181, v134, v135
v_mfma_f32_16x16x32_bf16 a[132:135], v[208:211], v[172:175], a[132:135]
s_waitcnt lgkmcnt(4)
v_mfma_f32_16x16x32_bf16 v[8:11], v[212:215], v[160:163], v[8:11]
ds_read_b64_tr_b16 v[208:209], v240 offset:0
ds_read_b64_tr_b16 v[210:211], v240 offset:8192
v_mfma_f32_16x16x32_bf16 v[12:15], v[212:215], v[164:167], v[12:15]
v_exp_f32 v136, v136
v_mfma_f32_16x16x32_bf16 a[136:139], v[212:215], v[168:171], a[136:139]
v_add_f32 v250, v250, v136
v_mfma_f32_16x16x32_bf16 a[140:143], v[212:215], v[172:175], a[140:143]
s_waitcnt lgkmcnt(4)
v_mfma_f32_16x16x32_bf16 v[16:19], v[216:219], v[160:163], v[16:19]
ds_read_b64_tr_b16 v[212:213], v241 offset:0
ds_read_b64_tr_b16 v[214:215], v241 offset:8192
v_mfma_f32_16x16x32_bf16 v[20:23], v[216:219], v[164:167], v[20:23]
v_exp_f32 v137, v137
v_mfma_f32_16x16x32_bf16 a[144:147], v[216:219], v[168:171], a[144:147]
v_add_f32 v250, v250, v137
v_cvt_pk_bf16_f32 v184, v136, v137
v_mfma_f32_16x16x32_bf16 a[148:151], v[216:219], v[172:175], a[148:151]
s_waitcnt lgkmcnt(4)
v_mfma_f32_16x16x32_bf16 v[24:27], v[220:223], v[160:163], v[24:27]
ds_read_b64_tr_b16 v[216:217], v242 offset:0
ds_read_b64_tr_b16 v[218:219], v242 offset:8192
v_mfma_f32_16x16x32_bf16 v[28:31], v[220:223], v[164:167], v[28:31]
v_exp_f32 v138, v138
v_mfma_f32_16x16x32_bf16 a[152:155], v[220:223], v[168:171], a[152:155]
v_add_f32 v250, v250, v138
v_mfma_f32_16x16x32_bf16 a[156:159], v[220:223], v[172:175], a[156:159]
s_waitcnt lgkmcnt(4)
v_mfma_f32_16x16x32_bf16 v[32:35], v[208:211], v[160:163], v[32:35]
ds_read_b64_tr_b16 v[220:221], v243 offset:0
ds_read_b64_tr_b16 v[222:223], v243 offset:8192
v_mfma_f32_16x16x32_bf16 v[36:39], v[208:211], v[164:167], v[36:39]
v_exp_f32 v139, v139
v_mfma_f32_16x16x32_bf16 a[160:163], v[208:211], v[168:171], a[160:163]
v_add_f32 v250, v250, v139
v_cvt_pk_bf16_f32 v185, v138, v139
v_mfma_f32_16x16x32_bf16 a[164:167], v[208:211], v[172:175], a[164:167]
s_waitcnt lgkmcnt(4)
v_mfma_f32_16x16x32_bf16 v[40:43], v[212:215], v[160:163], v[40:43]
ds_read_b64_tr_b16 v[208:209], v236 offset:256
ds_read_b64_tr_b16 v[210:211], v236 offset:8448
v_mfma_f32_16x16x32_bf16 v[44:47], v[212:215], v[164:167], v[44:47]
v_exp_f32 v140, v140
v_mfma_f32_16x16x32_bf16 a[168:171], v[212:215], v[168:171], a[168:171]
v_add_f32 v251, v251, v140
v_mfma_f32_16x16x32_bf16 a[172:175], v[212:215], v[172:175], a[172:175]
s_waitcnt lgkmcnt(4)
v_mfma_f32_16x16x32_bf16 v[48:51], v[216:219], v[160:163], v[48:51]
ds_read_b64_tr_b16 v[212:213], v237 offset:256
ds_read_b64_tr_b16 v[214:215], v237 offset:8448
v_mfma_f32_16x16x32_bf16 v[52:55], v[216:219], v[164:167], v[52:55]
v_exp_f32 v141, v141
v_mfma_f32_16x16x32_bf16 a[176:179], v[216:219], v[168:171], a[176:179]
v_add_f32 v251, v251, v141
v_cvt_pk_bf16_f32 v188, v140, v141
v_mfma_f32_16x16x32_bf16 a[180:183], v[216:219], v[172:175], a[180:183]
s_waitcnt lgkmcnt(4)
v_mfma_f32_16x16x32_bf16 v[56:59], v[220:223], v[160:163], v[56:59]
ds_read_b64_tr_b16 v[216:217], v238 offset:256
ds_read_b64_tr_b16 v[218:219], v238 offset:8448
v_mfma_f32_16x16x32_bf16 v[60:63], v[220:223], v[164:167], v[60:63]
v_exp_f32 v142, v142
v_exp_f32 v144, v144
v_mfma_f32_16x16x32_bf16 a[184:187], v[220:223], v[168:171], a[184:187]
v_add_f32 v251, v251, v142
v_add_f32 v248, v248, v144
v_mfma_f32_16x16x32_bf16 a[188:191], v[220:223], v[172:175], a[188:191]
s_waitcnt lgkmcnt(4)
v_mfma_f32_16x16x32_bf16 v[64:67], v[208:211], v[160:163], v[64:67]
ds_read_b64_tr_b16 v[220:221], v239 offset:256
ds_read_b64_tr_b16 v[222:223], v239 offset:8448
v_mfma_f32_16x16x32_bf16 v[68:71], v[208:211], v[164:167], v[68:71]
v_exp_f32 v143, v143
v_exp_f32 v145, v145
v_mfma_f32_16x16x32_bf16 a[192:195], v[208:211], v[168:171], a[192:195]
v_add_f32 v251, v251, v143
v_add_f32 v248, v248, v145
v_cvt_pk_bf16_f32 v189, v142, v143
v_cvt_pk_bf16_f32 v178, v144, v145
v_mfma_f32_16x16x32_bf16 a[196:199], v[208:211], v[172:175], a[196:199]
s_waitcnt lgkmcnt(4)
v_mfma_f32_16x16x32_bf16 v[72:75], v[212:215], v[160:163], v[72:75]
ds_read_b64_tr_b16 v[208:209], v240 offset:256
ds_read_b64_tr_b16 v[210:211], v240 offset:8448
v_mfma_f32_16x16x32_bf16 v[76:79], v[212:215], v[164:167], v[76:79]
v_exp_f32 v146, v146
v_mfma_f32_16x16x32_bf16 a[200:203], v[212:215], v[168:171], a[200:203]
v_add_f32 v248, v248, v146
v_mfma_f32_16x16x32_bf16 a[204:207], v[212:215], v[172:175], a[204:207]
s_waitcnt lgkmcnt(4)
v_mfma_f32_16x16x32_bf16 v[80:83], v[216:219], v[160:163], v[80:83]
ds_read_b64_tr_b16 v[212:213], v241 offset:256
ds_read_b64_tr_b16 v[214:215], v241 offset:8448
v_mfma_f32_16x16x32_bf16 v[84:87], v[216:219], v[164:167], v[84:87]
v_exp_f32 v147, v147
v_mfma_f32_16x16x32_bf16 a[208:211], v[216:219], v[168:171], a[208:211]
v_add_f32 v248, v248, v147
v_cvt_pk_bf16_f32 v179, v146, v147
v_mfma_f32_16x16x32_bf16 a[212:215], v[216:219], v[172:175], a[212:215]
s_waitcnt lgkmcnt(4)
v_mfma_f32_16x16x32_bf16 v[88:91], v[220:223], v[160:163], v[88:91]
ds_read_b64_tr_b16 v[216:217], v242 offset:256
ds_read_b64_tr_b16 v[218:219], v242 offset:8448
v_mfma_f32_16x16x32_bf16 v[92:95], v[220:223], v[164:167], v[92:95]
v_exp_f32 v148, v148
v_mfma_f32_16x16x32_bf16 a[216:219], v[220:223], v[168:171], a[216:219]
v_add_f32 v249, v249, v148
v_mfma_f32_16x16x32_bf16 a[220:223], v[220:223], v[172:175], a[220:223]
s_waitcnt lgkmcnt(4)
v_mfma_f32_16x16x32_bf16 v[96:99], v[208:211], v[160:163], v[96:99]
ds_read_b64_tr_b16 v[220:221], v243 offset:256
ds_read_b64_tr_b16 v[222:223], v243 offset:8448
v_mfma_f32_16x16x32_bf16 v[100:103], v[208:211], v[164:167], v[100:103]
v_exp_f32 v149, v149
v_mfma_f32_16x16x32_bf16 a[224:227], v[208:211], v[168:171], a[224:227]
v_add_f32 v249, v249, v149
v_cvt_pk_bf16_f32 v182, v148, v149
v_mfma_f32_16x16x32_bf16 a[228:231], v[208:211], v[172:175], a[228:231]
s_waitcnt lgkmcnt(4)
v_mfma_f32_16x16x32_bf16 v[104:107], v[212:215], v[160:163], v[104:107]
ds_read_b128 v[208:211], v232 offset:32768
v_mfma_f32_16x16x32_bf16 v[108:111], v[212:215], v[164:167], v[108:111]
v_exp_f32 v150, v150
v_mfma_f32_16x16x32_bf16 a[232:235], v[212:215], v[168:171], a[232:235]
v_add_f32 v249, v249, v150
v_mfma_f32_16x16x32_bf16 a[236:239], v[212:215], v[172:175], a[236:239]
s_waitcnt lgkmcnt(3)
v_mfma_f32_16x16x32_bf16 v[112:115], v[216:219], v[160:163], v[112:115]
ds_read_b128 v[212:215], v233 offset:32768
v_mfma_f32_16x16x32_bf16 v[116:119], v[216:219], v[164:167], v[116:119]
v_exp_f32 v151, v151
v_mfma_f32_16x16x32_bf16 a[240:243], v[216:219], v[168:171], a[240:243]
v_add_f32 v249, v249, v151
v_cvt_pk_bf16_f32 v183, v150, v151
v_mfma_f32_16x16x32_bf16 a[244:247], v[216:219], v[172:175], a[244:247]
s_waitcnt lgkmcnt(2)
v_mfma_f32_16x16x32_bf16 v[120:123], v[220:223], v[160:163], v[120:123]
ds_read_b128 v[216:219], v234 offset:32768
v_mfma_f32_16x16x32_bf16 v[124:127], v[220:223], v[164:167], v[124:127]
v_exp_f32 v152, v152
v_mfma_f32_16x16x32_bf16 a[248:251], v[220:223], v[168:171], a[248:251]
v_add_f32 v250, v250, v152
v_mfma_f32_16x16x32_bf16 a[252:255], v[220:223], v[172:175], a[252:255]
s_cmp_eq_u32 s58, 3
s_cbranch_scc1 K2_EPI
s_waitcnt lgkmcnt(2)
v_mfma_f32_16x16x32_bf16 v[128:131], v[208:211], a[0:3], v[192:195]
ds_read_b128 v[220:223], v235 offset:32768
v_mfma_f32_16x16x32_bf16 v[132:135], v[208:211], a[32:35], v[196:199]
v_exp_f32 v153, v153
v_mfma_f32_16x16x32_bf16 v[136:139], v[208:211], a[64:67], v[200:203]
v_add_f32 v250, v250, v153
v_cvt_pk_bf16_f32 v186, v152, v153
v_mfma_f32_16x16x32_bf16 v[140:143], v[208:211], a[96:99], v[204:207]
s_waitcnt lgkmcnt(2)
v_mfma_f32_16x16x32_bf16 v[128:131], v[212:215], a[4:7], v[128:131]
ds_read_b128 v[208:211], v232 offset:33024
v_mfma_f32_16x16x32_bf16 v[132:135], v[212:215], a[36:39], v[132:135]
v_exp_f32 v154, v154
v_mfma_f32_16x16x32_bf16 v[136:139], v[212:215], a[68:71], v[136:139]
v_add_f32 v250, v250, v154
v_mfma_f32_16x16x32_bf16 v[140:143], v[212:215], a[100:103], v[140:143]
s_waitcnt lgkmcnt(2)
v_mfma_f32_16x16x32_bf16 v[128:131], v[216:219], a[8:11], v[128:131]
ds_read_b128 v[212:215], v233 offset:33024
s_waitcnt vmcnt(0)
s_barrier
v_mfma_f32_16x16x32_bf16 v[132:135], v[216:219], a[40:43], v[132:135]
v_exp_f32 v155, v155
v_mfma_f32_16x16x32_bf16 v[136:139], v[216:219], a[72:75], v[136:139]
v_add_f32 v250, v250, v155
v_cvt_pk_bf16_f32 v187, v154, v155
v_mfma_f32_16x16x32_bf16 v[140:143], v[216:219], a[104:107], v[140:143]
s_add_u32 m0, s56, 0x0
s_nop 0
buffer_load_dwordx4 v244, s[8:11], s57 offen offset:0 sc1 lds
s_waitcnt lgkmcnt(2)
v_mfma_f32_16x16x32_bf16 v[128:131], v[220:223], a[12:15], v[128:131]
ds_read_b128 v[216:219], v234 offset:33024
v_mfma_f32_16x16x32_bf16 v[132:135], v[220:223], a[44:47], v[132:135]
v_exp_f32 v156, v156
v_mfma_f32_16x16x32_bf16 v[136:139], v[220:223], a[76:79], v[136:139]
v_add_f32 v251, v251, v156
v_mfma_f32_16x16x32_bf16 v[140:143], v[220:223], a[108:111], v[140:143]
buffer_load_dwordx4 v245, s[8:11], s57 offen offset:1024 sc1 lds
s_waitcnt lgkmcnt(2)
v_mfma_f32_16x16x32_bf16 v[128:131], v[208:211], a[16:19], v[128:131]
ds_read_b128 v[220:223], v235 offset:33024
v_mfma_f32_16x16x32_bf16 v[132:135], v[208:211], a[48:51], v[132:135]
v_exp_f32 v157, v157
v_mfma_f32_16x16x32_bf16 v[136:139], v[208:211], a[80:83], v[136:139]
v_add_f32 v251, v251, v157
v_cvt_pk_bf16_f32 v190, v156, v157
v_mfma_f32_16x16x32_bf16 v[140:143], v[208:211], a[112:115], v[140:143]
buffer_load_dwordx4 v246, s[8:11], s57 offen offset:2048 sc1 lds
s_waitcnt lgkmcnt(2)
v_mfma_f32_16x16x32_bf16 v[128:131], v[212:215], a[20:23], v[128:131]
ds_read_b128 v[208:211], v232 offset:40960
v_mfma_f32_16x16x32_bf16 v[132:135], v[212:215], a[52:55], v[132:135]
v_exp_f32 v158, v158
v_mfma_f32_16x16x32_bf16 v[136:139], v[212:215], a[84:87], v[136:139]
v_add_f32 v251, v251, v158
v_mfma_f32_16x16x32_bf16 v[140:143], v[212:215], a[116:119], v[140:143]
buffer_load_dwordx4 v247, s[8:11], s57 offen offset:3072 sc1 lds
s_waitcnt lgkmcnt(2)
v_mfma_f32_16x16x32_bf16 v[128:131], v[216:219], a[24:27], v[128:131]
ds_read_b128 v[212:215], v233 offset:40960
v_mfma_f32_16x16x32_bf16 v[132:135], v[216:219], a[56:59], v[132:135]
v_exp_f32 v159, v159
v_mfma_f32_16x16x32_bf16 v[136:139], v[216:219], a[88:91], v[136:139]
v_add_f32 v251, v251, v159
v_cvt_pk_bf16_f32 v191, v158, v159
v_mfma_f32_16x16x32_bf16 v[140:143], v[216:219], a[120:123], v[140:143]
s_add_u32 m0, s56, 0x1000
s_add_u32 s57, s57, 4096
buffer_load_dwordx4 v244, s[8:11], s57 offen offset:0 sc1 lds
s_waitcnt lgkmcnt(2)
v_mfma_f32_16x16x32_bf16 v[128:131], v[220:223], a[28:31], v[128:131]
ds_read_b128 v[216:219], v234 offset:40960
v_mfma_f32_16x16x32_bf16 v[132:135], v[220:223], a[60:63], v[132:135]
v_mfma_f32_16x16x32_bf16 v[136:139], v[220:223], a[92:95], v[136:139]
v_mfma_f32_16x16x32_bf16 v[140:143], v[220:223], a[124:127], v[140:143]
buffer_load_dwordx4 v245, s[8:11], s57 offen offset:1024 sc1 lds
s_waitcnt lgkmcnt(2)
v_mfma_f32_16x16x32_bf16 v[144:147], v[208:211], a[0:3], v[192:195]
ds_read_b128 v[220:223], v235 offset:40960
v_mfma_f32_16x16x32_bf16 v[148:151], v[208:211], a[32:35], v[196:199]
v_mfma_f32_16x16x32_bf16 v[152:155], v[208:211], a[64:67], v[200:203]
v_mfma_f32_16x16x32_bf16 v[156:159], v[208:211], a[96:99], v[204:207]
buffer_load_dwordx4 v246, s[8:11], s57 offen offset:2048 sc1 lds
s_waitcnt lgkmcnt(2)
v_mfma_f32_16x16x32_bf16 v[144:147], v[212:215], a[4:7], v[144:147]
ds_read_b128 v[208:211], v232 offset:41216
v_mfma_f32_16x16x32_bf16 v[148:151], v[212:215], a[36:39], v[148:151]
v_exp_f32 v128, v128
v_mfma_f32_16x16x32_bf16 v[152:155], v[212:215], a[68:71], v[152:155]
v_add_f32 v248, v248, v128
v_mfma_f32_16x16x32_bf16 v[156:159], v[212:215], a[100:103], v[156:159]
buffer_load_dwordx4 v247, s[8:11], s57 offen offset:3072 sc1 lds
s_add_u32 s57, s57, 12288
s_waitcnt lgkmcnt(2)
v_mfma_f32_16x16x32_bf16 v[144:147], v[216:219], a[8:11], v[144:147]
ds_read_b128 v[212:215], v233 offset:41216
v_mfma_f32_16x16x32_bf16 v[148:151], v[216:219], a[40:43], v[148:151]
v_exp_f32 v129, v129
v_mfma_f32_16x16x32_bf16 v[152:155], v[216:219], a[72:75], v[152:155]
v_add_f32 v248, v248, v129
v_cvt_pk_bf16_f32 v160, v128, v129
v_mfma_f32_16x16x32_bf16 v[156:159], v[216:219], a[104:107], v[156:159]
s_waitcnt lgkmcnt(2)
v_mfma_f32_16x16x32_bf16 v[144:147], v[220:223], a[12:15], v[144:147]
ds_read_b128 v[216:219], v234 offset:41216
v_mfma_f32_16x16x32_bf16 v[148:151], v[220:223], a[44:47], v[148:151]
v_exp_f32 v130, v130
v_mfma_f32_16x16x32_bf16 v[152:155], v[220:223], a[76:79], v[152:155]
v_add_f32 v248, v248, v130
v_mfma_f32_16x16x32_bf16 v[156:159], v[220:223], a[108:111], v[156:159]
s_waitcnt lgkmcnt(2)
v_mfma_f32_16x16x32_bf16 v[144:147], v[208:211], a[16:19], v[144:147]
ds_read_b128 v[220:223], v235 offset:41216
v_mfma_f32_16x16x32_bf16 v[148:151], v[208:211], a[48:51], v[148:151]
v_exp_f32 v131, v131
v_mfma_f32_16x16x32_bf16 v[152:155], v[208:211], a[80:83], v[152:155]
v_add_f32 v248, v248, v131
v_cvt_pk_bf16_f32 v161, v130, v131
v_mfma_f32_16x16x32_bf16 v[156:159], v[208:211], a[112:115], v[156:159]
s_waitcnt lgkmcnt(2)
v_mfma_f32_16x16x32_bf16 v[144:147], v[212:215], a[20:23], v[144:147]
ds_read_b64_tr_b16 v[208:209], v236 offset:16384
ds_read_b64_tr_b16 v[210:211], v236 offset:24576
v_mfma_f32_16x16x32_bf16 v[148:151], v[212:215], a[52:55], v[148:151]
v_exp_f32 v132, v132
v_mfma_f32_16x16x32_bf16 v[152:155], v[212:215], a[84:87], v[152:155]
v_add_f32 v249, v249, v132
v_mfma_f32_16x16x32_bf16 v[156:159], v[212:215], a[116:119], v[156:159]
s_waitcnt lgkmcnt(3)
v_mfma_f32_16x16x32_bf16 v[144:147], v[216:219], a[24:27], v[144:147]
ds_read_b64_tr_b16 v[212:213], v237 offset:16384
ds_read_b64_tr_b16 v[214:215], v237 offset:24576
v_mfma_f32_16x16x32_bf16 v[148:151], v[216:219], a[56:59], v[148:151]
v_exp_f32 v133, v133
v_mfma_f32_16x16x32_bf16 v[152:155], v[216:219], a[88:91], v[152:155]
v_add_f32 v249, v249, v133
v_cvt_pk_bf16_f32 v164, v132, v133
v_mfma_f32_16x16x32_bf16 v[156:159], v[216:219], a[120:123], v[156:159]
s_waitcnt lgkmcnt(4)
v_mfma_f32_16x16x32_bf16 v[144:147], v[220:223], a[28:31], v[144:147]
ds_read_b64_tr_b16 v[216:217], v238 offset:16384
ds_read_b64_tr_b16 v[218:219], v238 offset:24576
v_mfma_f32_16x16x32_bf16 v[148:151], v[220:223], a[60:63], v[148:151]
v_exp_f32 v134, v134
v_mfma_f32_16x16x32_bf16 v[152:155], v[220:223], a[92:95], v[152:155]
v_add_f32 v249, v249, v134
v_mfma_f32_16x16x32_bf16 v[156:159], v[220:223], a[124:127], v[156:159]
s_waitcnt lgkmcnt(4)
v_mfma_f32_16x16x32_bf16 v[0:3], v[208:211], v[176:179], v[0:3]
ds_read_b64_tr_b16 v[220:221], v239 offset:16384
ds_read_b64_tr_b16 v[222:223], v239 offset:24576
v_mfma_f32_16x16x32_bf16 v[4:7], v[208:211], v[180:183], v[4:7]
v_exp_f32 v135, v135
v_mfma_f32_16x16x32_bf16 a[128:131], v[208:211], v[184:187], a[128:131]
v_add_f32 v249, v249, v135
v_cvt_pk_bf16_f32 v165, v134, v135
v_mfma_f32_16x16x32_bf16 a[132:135], v[208:211], v[188:191], a[132:135]
s_waitcnt lgkmcnt(4)
v_mfma_f32_16x16x32_bf16 v[8:11], v[212:215], v[176:179], v[8:11]
ds_read_b64_tr_b16 v[208:209], v240 offset:16384
ds_read_b64_tr_b16 v[210:211], v240 offset:24576
v_mfma_f32_16x16x32_bf16 v[12:15], v[212:215], v[180:183], v[12:15]
v_exp_f32 v136, v136
v_mfma_f32_16x16x32_bf16 a[136:139], v[212:215], v[184:187], a[136:139]
v_add_f32 v250, v250, v136
v_mfma_f32_16x16x32_bf16 a[140:143], v[212:215], v[188:191], a[140:143]
s_waitcnt lgkmcnt(4)
v_mfma_f32_16x16x32_bf16 v[16:19], v[216:219], v[176:179], v[16:19]
ds_read_b64_tr_b16 v[212:213], v241 offset:16384
ds_read_b64_tr_b16 v[214:215], v241 offset:24576
v_mfma_f32_16x16x32_bf16 v[20:23], v[216:219], v[180:183], v[20:23]
v_exp_f32 v137, v137
v_mfma_f32_16x16x32_bf16 a[144:147], v[216:219], v[184:187], a[144:147]
v_add_f32 v250, v250, v137
v_cvt_pk_bf16_f32 v168, v136, v137
v_mfma_f32_16x16x32_bf16 a[148:151], v[216:219], v[188:191], a[148:151]
s_waitcnt lgkmcnt(4)
v_mfma_f32_16x16x32_bf16 v[24:27], v[220:223], v[176:179], v[24:27]
ds_read_b64_tr_b16 v[216:217], v242 offset:16384
ds_read_b64_tr_b16 v[218:219], v242 offset:24576
v_mfma_f32_16x16x32_bf16 v[28:31], v[220:223], v[180:183], v[28:31]
v_exp_f32 v138, v138
v_mfma_f32_16x16x32_bf16 a[152:155], v[220:223], v[184:187], a[152:155]
v_add_f32 v250, v250, v138
v_mfma_f32_16x16x32_bf16 a[156:159], v[220:223], v[188:191], a[156:159]
s_waitcnt lgkmcnt(4)
v_mfma_f32_16x16x32_bf16 v[32:35], v[208:211], v[176:179], v[32:35]
ds_read_b64_tr_b16 v[220:221], v243 offset:16384
ds_read_b64_tr_b16 v[222:223], v243 offset:24576
v_mfma_f32_16x16x32_bf16 v[36:39], v[208:211], v[180:183], v[36:39]
v_exp_f32 v139, v139
v_mfma_f32_16x16x32_bf16 a[160:163], v[208:211], v[184:187], a[160:163]
v_add_f32 v250, v250, v139
v_cvt_pk_bf16_f32 v169, v138, v139
v_mfma_f32_16x16x32_bf16 a[164:167], v[208:211], v[188:191], a[164:167]
s_waitcnt lgkmcnt(4)
v_mfma_f32_16x16x32_bf16 v[40:43], v[212:215], v[176:179], v[40:43]
ds_read_b64_tr_b16 v[208:209], v236 offset:16640
ds_read_b64_tr_b16 v[210:211], v236 offset:24832
v_mfma_f32_16x16x32_bf16 v[44:47], v[212:215], v[180:183], v[44:47]
v_exp_f32 v140, v140
v_mfma_f32_16x16x32_bf16 a[168:171], v[212:215], v[184:187], a[168:171]
v_add_f32 v251, v251, v140
v_mfma_f32_16x16x32_bf16 a[172:175], v[212:215], v[188:191], a[172:175]
s_waitcnt lgkmcnt(4)
v_mfma_f32_16x16x32_bf16 v[48:51], v[216:219], v[176:179], v[48:51]
ds_read_b64_tr_b16 v[212:213], v237 offset:16640
ds_read_b64_tr_b16 v[214:215], v237 offset:24832
v_mfma_f32_16x16x32_bf16 v[52:55], v[216:219], v[180:183], v[52:55]
v_exp_f32 v141, v141
v_mfma_f32_16x16x32_bf16 a[176:179], v[216:219], v[184:187], a[176:179]
v_add_f32 v251, v251, v141
v_cvt_pk_bf16_f32 v172, v140, v141
v_mfma_f32_16x16x32_bf16 a[180:183], v[216:219], v[188:191], a[180:183]
s_waitcnt lgkmcnt(4)
v_mfma_f32_16x16x32_bf16 v[56:59], v[220:223], v[176:179], v[56:59]
ds_read_b64_tr_b16 v[216:217], v238 offset:16640
ds_read_b64_tr_b16 v[218:219], v238 offset:24832
v_mfma_f32_16x16x32_bf16 v[60:63], v[220:223], v[180:183], v[60:63]
v_exp_f32 v142, v142
v_exp_f32 v144, v144
v_mfma_f32_16x16x32_bf16 a[184:187], v[220:223], v[184:187], a[184:187]
v_add_f32 v251, v251, v142
v_add_f32 v248, v248, v144
v_mfma_f32_16x16x32_bf16 a[188:191], v[220:223], v[188:191], a[188:191]
s_waitcnt lgkmcnt(4)
v_mfma_f32_16x16x32_bf16 v[64:67], v[208:211], v[176:179], v[64:67]
ds_read_b64_tr_b16 v[220:221], v239 offset:16640
ds_read_b64_tr_b16 v[222:223], v239 offset:24832
v_mfma_f32_16x16x32_bf16 v[68:71], v[208:211], v[180:183], v[68:71]
v_exp_f32 v143, v143
v_exp_f32 v145, v145
v_mfma_f32_16x16x32_bf16 a[192:195], v[208:211], v[184:187], a[192:195]
v_add_f32 v251, v251, v143
v_add_f32 v248, v248, v145
v_cvt_pk_bf16_f32 v173, v142, v143
v_cvt_pk_bf16_f32 v162, v144, v145
v_mfma_f32_16x16x32_bf16 a[196:199], v[208:211], v[188:191], a[196:199]
s_waitcnt lgkmcnt(4)
v_mfma_f32_16x16x32_bf16 v[72:75], v[212:215], v[176:179], v[72:75]
ds_read_b64_tr_b16 v[208:209], v240 offset:16640
ds_read_b64_tr_b16 v[210:211], v240 offset:24832
v_mfma_f32_16x16x32_bf16 v[76:79], v[212:215], v[180:183], v[76:79]
v_exp_f32 v146, v146
v_mfma_f32_16x16x32_bf16 a[200:203], v[212:215], v[184:187], a[200:203]
v_add_f32 v248, v248, v146
v_mfma_f32_16x16x32_bf16 a[204:207], v[212:215], v[188:191], a[204:207]
s_waitcnt lgkmcnt(4)
v_mfma_f32_16x16x32_bf16 v[80:83], v[216:219], v[176:179], v[80:83]
ds_read_b64_tr_b16 v[212:213], v241 offset:16640
ds_read_b64_tr_b16 v[214:215], v241 offset:24832
v_mfma_f32_16x16x32_bf16 v[84:87], v[216:219], v[180:183], v[84:87]
v_exp_f32 v147, v147
v_mfma_f32_16x16x32_bf16 a[208:211], v[216:219], v[184:187], a[208:211]
v_add_f32 v248, v248, v147
v_cvt_pk_bf16_f32 v163, v146, v147
v_mfma_f32_16x16x32_bf16 a[212:215], v[216:219], v[188:191], a[212:215]
s_waitcnt lgkmcnt(4)
v_mfma_f32_16x16x32_bf16 v[88:91], v[220:223], v[176:179], v[88:91]
ds_read_b64_tr_b16 v[216:217], v242 offset:16640
ds_read_b64_tr_b16 v[218:219], v242 offset:24832
v_mfma_f32_16x16x32_bf16 v[92:95], v[220:223], v[180:183], v[92:95]
v_exp_f32 v148, v148
v_mfma_f32_16x16x32_bf16 a[216:219], v[220:223], v[184:187], a[216:219]
v_add_f32 v249, v249, v148
v_mfma_f32_16x16x32_bf16 a[220:223], v[220:223], v[188:191], a[220:223]
s_waitcnt lgkmcnt(4)
v_mfma_f32_16x16x32_bf16 v[96:99], v[208:211], v[176:179], v[96:99]
ds_read_b64_tr_b16 v[220:221], v243 offset:16640
ds_read_b64_tr_b16 v[222:223], v243 offset:24832
v_mfma_f32_16x16x32_bf16 v[100:103], v[208:211], v[180:183], v[100:103]
v_exp_f32 v149, v149
v_mfma_f32_16x16x32_bf16 a[224:227], v[208:211], v[184:187], a[224:227]
v_add_f32 v249, v249, v149
v_cvt_pk_bf16_f32 v166, v148, v149
v_mfma_f32_16x16x32_bf16 a[228:231], v[208:211], v[188:191], a[228:231]
s_waitcnt lgkmcnt(4)
v_mfma_f32_16x16x32_bf16 v[104:107], v[212:215], v[176:179], v[104:107]
ds_read_b128 v[208:211], v232 offset:49152
v_mfma_f32_16x16x32_bf16 v[108:111], v[212:215], v[180:183], v[108:111]
v_exp_f32 v150, v150
v_mfma_f32_16x16x32_bf16 a[232:235], v[212:215], v[184:187], a[232:235]
v_add_f32 v249, v249, v150
v_mfma_f32_16x16x32_bf16 a[236:239], v[212:215], v[188:191], a[236:239]
s_waitcnt lgkmcnt(3)
v_mfma_f32_16x16x32_bf16 v[112:115], v[216:219], v[176:179], v[112:115]
ds_read_b128 v[212:215], v233 offset:49152
v_mfma_f32_16x16x32_bf16 v[116:119], v[216:219], v[180:183], v[116:119]
v_exp_f32 v151, v151
v_mfma_f32_16x16x32_bf16 a[240:243], v[216:219], v[184:187], a[240:243]
v_add_f32 v249, v249, v151
v_cvt_pk_bf16_f32 v167, v150, v151
v_mfma_f32_16x16x32_bf16 a[244:247], v[216:219], v[188:191], a[244:247]
s_waitcnt lgkmcnt(2)
v_mfma_f32_16x16x32_bf16 v[120:123], v[220:223], v[176:179], v[120:123]
ds_read_b128 v[216:219], v234 offset:49152
v_mfma_f32_16x16x32_bf16 v[124:127], v[220:223], v[180:183], v[124:127]
v_exp_f32 v152, v152
v_mfma_f32_16x16x32_bf16 a[248:251], v[220:223], v[184:187], a[248:251]
v_add_f32 v250, v250, v152
v_mfma_f32_16x16x32_bf16 a[252:255], v[220:223], v[188:191], a[252:255]
s_waitcnt lgkmcnt(2)
v_mfma_f32_16x16x32_bf16 v[128:131], v[208:211], a[0:3], v[192:195]
ds_read_b128 v[220:223], v235 offset:49152
v_mfma_f32_16x16x32_bf16 v[132:135], v[208:211], a[32:35], v[196:199]
v_exp_f32 v153, v153
v_mfma_f32_16x16x32_bf16 v[136:139], v[208:211], a[64:67], v[200:203]
v_add_f32 v250, v250, v153
v_cvt_pk_bf16_f32 v170, v152, v153
v_mfma_f32_16x16x32_bf16 v[140:143], v[208:211], a[96:99], v[204:207]
s_waitcnt lgkmcnt(2)
v_mfma_f32_16x16x32_bf16 v[128:131], v[212:215], a[4:7], v[128:131]
ds_read_b128 v[208:211], v232 offset:49408
v_mfma_f32_16x16x32_bf16 v[132:135], v[212:215], a[36:39], v[132:135]
v_exp_f32 v154, v154
v_mfma_f32_16x16x32_bf16 v[136:139], v[212:215], a[68:71], v[136:139]
v_add_f32 v250, v250, v154
v_mfma_f32_16x16x32_bf16 v[140:143], v[212:215], a[100:103], v[140:143]
s_waitcnt lgkmcnt(2)
v_mfma_f32_16x16x32_bf16 v[128:131], v[216:219], a[8:11], v[128:131]
ds_read_b128 v[212:215], v233 offset:49408
s_waitcnt vmcnt(0)
s_barrier
v_mfma_f32_16x16x32_bf16 v[132:135], v[216:219], a[40:43], v[132:135]
v_exp_f32 v155, v155
v_mfma_f32_16x16x32_bf16 v[136:139], v[216:219], a[72:75], v[136:139]
v_add_f32 v250, v250, v155
v_cvt_pk_bf16_f32 v171, v154, v155
v_mfma_f32_16x16x32_bf16 v[140:143], v[216:219], a[104:107], v[140:143]
s_add_u32 m0, s56, 0x4000
s_nop 0
buffer_load_dwordx4 v244, s[8:11], s57 offen offset:0 sc1 lds
s_waitcnt lgkmcnt(2)
v_mfma_f32_16x16x32_bf16 v[128:131], v[220:223], a[12:15], v[128:131]
ds_read_b128 v[216:219], v234 offset:49408
v_mfma_f32_16x16x32_bf16 v[132:135], v[220:223], a[44:47], v[132:135]
v_exp_f32 v156, v156
v_mfma_f32_16x16x32_bf16 v[136:139], v[220:223], a[76:79], v[136:139]
v_add_f32 v251, v251, v156
v_mfma_f32_16x16x32_bf16 v[140:143], v[220:223], a[108:111], v[140:143]
buffer_load_dwordx4 v245, s[8:11], s57 offen offset:1024 sc1 lds
s_waitcnt lgkmcnt(2)
v_mfma_f32_16x16x32_bf16 v[128:131], v[208:211], a[16:19], v[128:131]
ds_read_b128 v[220:223], v235 offset:49408
v_mfma_f32_16x16x32_bf16 v[132:135], v[208:211], a[48:51], v[132:135]
v_exp_f32 v157, v157
v_mfma_f32_16x16x32_bf16 v[136:139], v[208:211], a[80:83], v[136:139]
v_add_f32 v251, v251, v157
v_cvt_pk_bf16_f32 v174, v156, v157
v_mfma_f32_16x16x32_bf16 v[140:143], v[208:211], a[112:115], v[140:143]
buffer_load_dwordx4 v246, s[8:11], s57 offen offset:2048 sc1 lds
s_waitcnt lgkmcnt(2)
v_mfma_f32_16x16x32_bf16 v[128:131], v[212:215], a[20:23], v[128:131]
ds_read_b128 v[208:211], v232 offset:57344
v_mfma_f32_16x16x32_bf16 v[132:135], v[212:215], a[52:55], v[132:135]
v_exp_f32 v158, v158
v_mfma_f32_16x16x32_bf16 v[136:139], v[212:215], a[84:87], v[136:139]
v_add_f32 v251, v251, v158
v_mfma_f32_16x16x32_bf16 v[140:143], v[212:215], a[116:119], v[140:143]
buffer_load_dwordx4 v247, s[8:11], s57 offen offset:3072 sc1 lds
s_waitcnt lgkmcnt(2)
v_mfma_f32_16x16x32_bf16 v[128:131], v[216:219], a[24:27], v[128:131]
ds_read_b128 v[212:215], v233 offset:57344
v_mfma_f32_16x16x32_bf16 v[132:135], v[216:219], a[56:59], v[132:135]
v_exp_f32 v159, v159
v_mfma_f32_16x16x32_bf16 v[136:139], v[216:219], a[88:91], v[136:139]
v_add_f32 v251, v251, v159
v_cvt_pk_bf16_f32 v175, v158, v159
v_mfma_f32_16x16x32_bf16 v[140:143], v[216:219], a[120:123], v[140:143]
s_add_u32 m0, s56, 0x5000
s_add_u32 s57, s57, 4096
buffer_load_dwordx4 v244, s[8:11], s57 offen offset:0 sc1 lds
s_waitcnt lgkmcnt(2)
v_mfma_f32_16x16x32_bf16 v[128:131], v[220:223], a[28:31], v[128:131]
ds_read_b128 v[216:219], v234 offset:57344
v_mfma_f32_16x16x32_bf16 v[132:135], v[220:223], a[60:63], v[132:135]
v_mfma_f32_16x16x32_bf16 v[136:139], v[220:223], a[92:95], v[136:139]
v_mfma_f32_16x16x32_bf16 v[140:143], v[220:223], a[124:127], v[140:143]
buffer_load_dwordx4 v245, s[8:11], s57 offen offset:1024 sc1 lds
s_waitcnt lgkmcnt(2)
v_mfma_f32_16x16x32_bf16 v[144:147], v[208:211], a[0:3], v[192:195]
ds_read_b128 v[220:223], v235 offset:57344
v_mfma_f32_16x16x32_bf16 v[148:151], v[208:211], a[32:35], v[196:199]
v_mfma_f32_16x16x32_bf16 v[152:155], v[208:211], a[64:67], v[200:203]
v_mfma_f32_16x16x32_bf16 v[156:159], v[208:211], a[96:99], v[204:207]
buffer_load_dwordx4 v246, s[8:11], s57 offen offset:2048 sc1 lds
s_waitcnt lgkmcnt(2)
v_mfma_f32_16x16x32_bf16 v[144:147], v[212:215], a[4:7], v[144:147]
ds_read_b128 v[208:211], v232 offset:57600
v_mfma_f32_16x16x32_bf16 v[148:151], v[212:215], a[36:39], v[148:151]
v_exp_f32 v128, v128
v_mfma_f32_16x16x32_bf16 v[152:155], v[212:215], a[68:71], v[152:155]
v_add_f32 v248, v248, v128
v_mfma_f32_16x16x32_bf16 v[156:159], v[212:215], a[100:103], v[156:159]
buffer_load_dwordx4 v247, s[8:11], s57 offen offset:3072 sc1 lds
s_add_u32 s57, s57, 12288
s_waitcnt lgkmcnt(2)
v_mfma_f32_16x16x32_bf16 v[144:147], v[216:219], a[8:11], v[144:147]
ds_read_b128 v[212:215], v233 offset:57600
v_mfma_f32_16x16x32_bf16 v[148:151], v[216:219], a[40:43], v[148:151]
v_exp_f32 v129, v129
v_mfma_f32_16x16x32_bf16 v[152:155], v[216:219], a[72:75], v[152:155]
v_add_f32 v248, v248, v129
v_cvt_pk_bf16_f32 v176, v128, v129
v_mfma_f32_16x16x32_bf16 v[156:159], v[216:219], a[104:107], v[156:159]
s_waitcnt lgkmcnt(2)
v_mfma_f32_16x16x32_bf16 v[144:147], v[220:223], a[12:15], v[144:147]
ds_read_b128 v[216:219], v234 offset:57600
v_mfma_f32_16x16x32_bf16 v[148:151], v[220:223], a[44:47], v[148:151]
v_exp_f32 v130, v130
v_mfma_f32_16x16x32_bf16 v[152:155], v[220:223], a[76:79], v[152:155]
v_add_f32 v248, v248, v130
v_mfma_f32_16x16x32_bf16 v[156:159], v[220:223], a[108:111], v[156:159]
s_waitcnt lgkmcnt(2)
v_mfma_f32_16x16x32_bf16 v[144:147], v[208:211], a[16:19], v[144:147]
ds_read_b128 v[220:223], v235 offset:57600
v_mfma_f32_16x16x32_bf16 v[148:151], v[208:211], a[48:51], v[148:151]
v_exp_f32 v131, v131
v_mfma_f32_16x16x32_bf16 v[152:155], v[208:211], a[80:83], v[152:155]
v_add_f32 v248, v248, v131
v_cvt_pk_bf16_f32 v177, v130, v131
v_mfma_f32_16x16x32_bf16 v[156:159], v[208:211], a[112:115], v[156:159]
s_waitcnt lgkmcnt(2)
v_mfma_f32_16x16x32_bf16 v[144:147], v[212:215], a[20:23], v[144:147]
ds_read_b64_tr_b16 v[208:209], v236 offset:32768
ds_read_b64_tr_b16 v[210:211], v236 offset:40960
v_mfma_f32_16x16x32_bf16 v[148:151], v[212:215], a[52:55], v[148:151]
v_exp_f32 v132, v132
v_mfma_f32_16x16x32_bf16 v[152:155], v[212:215], a[84:87], v[152:155]
v_add_f32 v249, v249, v132
v_mfma_f32_16x16x32_bf16 v[156:159], v[212:215], a[116:119], v[156:159]
s_waitcnt lgkmcnt(3)
v_mfma_f32_16x16x32_bf16 v[144:147], v[216:219], a[24:27], v[144:147]
ds_read_b64_tr_b16 v[212:213], v237 offset:32768
ds_read_b64_tr_b16 v[214:215], v237 offset:40960
v_mfma_f32_16x16x32_bf16 v[148:151], v[216:219], a[56:59], v[148:151]
v_exp_f32 v133, v133
v_mfma_f32_16x16x32_bf16 v[152:155], v[216:219], a[88:91], v[152:155]
v_add_f32 v249, v249, v133
v_cvt_pk_bf16_f32 v180, v132, v133
v_mfma_f32_16x16x32_bf16 v[156:159], v[216:219], a[120:123], v[156:159]
s_waitcnt lgkmcnt(4)
v_mfma_f32_16x16x32_bf16 v[144:147], v[220:223], a[28:31], v[144:147]
ds_read_b64_tr_b16 v[216:217], v238 offset:32768
ds_read_b64_tr_b16 v[218:219], v238 offset:40960
v_mfma_f32_16x16x32_bf16 v[148:151], v[220:223], a[60:63], v[148:151]
v_exp_f32 v134, v134
v_mfma_f32_16x16x32_bf16 v[152:155], v[220:223], a[92:95], v[152:155]
v_add_f32 v249, v249, v134
v_mfma_f32_16x16x32_bf16 v[156:159], v[220:223], a[124:127], v[156:159]
s_waitcnt lgkmcnt(4)
v_mfma_f32_16x16x32_bf16 v[0:3], v[208:211], v[160:163], v[0:3]
ds_read_b64_tr_b16 v[220:221], v239 offset:32768
ds_read_b64_tr_b16 v[222:223], v239 offset:40960
v_mfma_f32_16x16x32_bf16 v[4:7], v[208:211], v[164:167], v[4:7]
v_exp_f32 v135, v135
v_mfma_f32_16x16x32_bf16 a[128:131], v[208:211], v[168:171], a[128:131]
v_add_f32 v249, v249, v135
v_cvt_pk_bf16_f32 v181, v134, v135
v_mfma_f32_16x16x32_bf16 a[132:135], v[208:211], v[172:175], a[132:135]
s_waitcnt lgkmcnt(4)
v_mfma_f32_16x16x32_bf16 v[8:11], v[212:215], v[160:163], v[8:11]
ds_read_b64_tr_b16 v[208:209], v240 offset:32768
ds_read_b64_tr_b16 v[210:211], v240 offset:40960
v_mfma_f32_16x16x32_bf16 v[12:15], v[212:215], v[164:167], v[12:15]
v_exp_f32 v136, v136
v_mfma_f32_16x16x32_bf16 a[136:139], v[212:215], v[168:171], a[136:139]
v_add_f32 v250, v250, v136
v_mfma_f32_16x16x32_bf16 a[140:143], v[212:215], v[172:175], a[140:143]
s_waitcnt lgkmcnt(4)
v_mfma_f32_16x16x32_bf16 v[16:19], v[216:219], v[160:163], v[16:19]
ds_read_b64_tr_b16 v[212:213], v241 offset:32768
ds_read_b64_tr_b16 v[214:215], v241 offset:40960
v_mfma_f32_16x16x32_bf16 v[20:23], v[216:219], v[164:167], v[20:23]
v_exp_f32 v137, v137
v_mfma_f32_16x16x32_bf16 a[144:147], v[216:219], v[168:171], a[144:147]
v_add_f32 v250, v250, v137
v_cvt_pk_bf16_f32 v184, v136, v137
v_mfma_f32_16x16x32_bf16 a[148:151], v[216:219], v[172:175], a[148:151]
s_waitcnt lgkmcnt(4)
v_mfma_f32_16x16x32_bf16 v[24:27], v[220:223], v[160:163], v[24:27]
ds_read_b64_tr_b16 v[216:217], v242 offset:32768
ds_read_b64_tr_b16 v[218:219], v242 offset:40960
v_mfma_f32_16x16x32_bf16 v[28:31], v[220:223], v[164:167], v[28:31]
v_exp_f32 v138, v138
v_mfma_f32_16x16x32_bf16 a[152:155], v[220:223], v[168:171], a[152:155]
v_add_f32 v250, v250, v138
v_mfma_f32_16x16x32_bf16 a[156:159], v[220:223], v[172:175], a[156:159]
s_waitcnt lgkmcnt(4)
v_mfma_f32_16x16x32_bf16 v[32:35], v[208:211], v[160:163], v[32:35]
ds_read_b64_tr_b16 v[220:221], v243 offset:32768
ds_read_b64_tr_b16 v[222:223], v243 offset:40960
v_mfma_f32_16x16x32_bf16 v[36:39], v[208:211], v[164:167], v[36:39]
v_exp_f32 v139, v139
v_mfma_f32_16x16x32_bf16 a[160:163], v[208:211], v[168:171], a[160:163]
v_add_f32 v250, v250, v139
v_cvt_pk_bf16_f32 v185, v138, v139
v_mfma_f32_16x16x32_bf16 a[164:167], v[208:211], v[172:175], a[164:167]
s_waitcnt lgkmcnt(4)
v_mfma_f32_16x16x32_bf16 v[40:43], v[212:215], v[160:163], v[40:43]
ds_read_b64_tr_b16 v[208:209], v236 offset:33024
ds_read_b64_tr_b16 v[210:211], v236 offset:41216
v_mfma_f32_16x16x32_bf16 v[44:47], v[212:215], v[164:167], v[44:47]
v_exp_f32 v140, v140
v_mfma_f32_16x16x32_bf16 a[168:171], v[212:215], v[168:171], a[168:171]
v_add_f32 v251, v251, v140
v_mfma_f32_16x16x32_bf16 a[172:175], v[212:215], v[172:175], a[172:175]
s_waitcnt lgkmcnt(4)
v_mfma_f32_16x16x32_bf16 v[48:51], v[216:219], v[160:163], v[48:51]
ds_read_b64_tr_b16 v[212:213], v237 offset:33024
ds_read_b64_tr_b16 v[214:215], v237 offset:41216
v_mfma_f32_16x16x32_bf16 v[52:55], v[216:219], v[164:167], v[52:55]
v_exp_f32 v141, v141
v_mfma_f32_16x16x32_bf16 a[176:179], v[216:219], v[168:171], a[176:179]
v_add_f32 v251, v251, v141
v_cvt_pk_bf16_f32 v188, v140, v141
v_mfma_f32_16x16x32_bf16 a[180:183], v[216:219], v[172:175], a[180:183]
s_waitcnt lgkmcnt(4)
v_mfma_f32_16x16x32_bf16 v[56:59], v[220:223], v[160:163], v[56:59]
ds_read_b64_tr_b16 v[216:217], v238 offset:33024
ds_read_b64_tr_b16 v[218:219], v238 offset:41216
v_mfma_f32_16x16x32_bf16 v[60:63], v[220:223], v[164:167], v[60:63]
v_exp_f32 v142, v142
v_exp_f32 v144, v144
v_mfma_f32_16x16x32_bf16 a[184:187], v[220:223], v[168:171], a[184:187]
v_add_f32 v251, v251, v142
v_add_f32 v248, v248, v144
v_mfma_f32_16x16x32_bf16 a[188:191], v[220:223], v[172:175], a[188:191]
s_waitcnt lgkmcnt(4)
v_mfma_f32_16x16x32_bf16 v[64:67], v[208:211], v[160:163], v[64:67]
ds_read_b64_tr_b16 v[220:221], v239 offset:33024
ds_read_b64_tr_b16 v[222:223], v239 offset:41216
v_mfma_f32_16x16x32_bf16 v[68:71], v[208:211], v[164:167], v[68:71]
v_exp_f32 v143, v143
v_exp_f32 v145, v145
v_mfma_f32_16x16x32_bf16 a[192:195], v[208:211], v[168:171], a[192:195]
v_add_f32 v251, v251, v143
v_add_f32 v248, v248, v145
v_cvt_pk_bf16_f32 v189, v142, v143
v_cvt_pk_bf16_f32 v178, v144, v145
v_mfma_f32_16x16x32_bf16 a[196:199], v[208:211], v[172:175], a[196:199]
s_waitcnt lgkmcnt(4)
v_mfma_f32_16x16x32_bf16 v[72:75], v[212:215], v[160:163], v[72:75]
ds_read_b64_tr_b16 v[208:209], v240 offset:33024
ds_read_b64_tr_b16 v[210:211], v240 offset:41216
v_mfma_f32_16x16x32_bf16 v[76:79], v[212:215], v[164:167], v[76:79]
v_exp_f32 v146, v146
v_mfma_f32_16x16x32_bf16 a[200:203], v[212:215], v[168:171], a[200:203]
v_add_f32 v248, v248, v146
v_mfma_f32_16x16x32_bf16 a[204:207], v[212:215], v[172:175], a[204:207]
s_waitcnt lgkmcnt(4)
v_mfma_f32_16x16x32_bf16 v[80:83], v[216:219], v[160:163], v[80:83]
ds_read_b64_tr_b16 v[212:213], v241 offset:33024
ds_read_b64_tr_b16 v[214:215], v241 offset:41216
v_mfma_f32_16x16x32_bf16 v[84:87], v[216:219], v[164:167], v[84:87]
v_exp_f32 v147, v147
v_mfma_f32_16x16x32_bf16 a[208:211], v[216:219], v[168:171], a[208:211]
v_add_f32 v248, v248, v147
v_cvt_pk_bf16_f32 v179, v146, v147
v_mfma_f32_16x16x32_bf16 a[212:215], v[216:219], v[172:175], a[212:215]
s_waitcnt lgkmcnt(4)
v_mfma_f32_16x16x32_bf16 v[88:91], v[220:223], v[160:163], v[88:91]
ds_read_b64_tr_b16 v[216:217], v242 offset:33024
ds_read_b64_tr_b16 v[218:219], v242 offset:41216
v_mfma_f32_16x16x32_bf16 v[92:95], v[220:223], v[164:167], v[92:95]
v_exp_f32 v148, v148
v_mfma_f32_16x16x32_bf16 a[216:219], v[220:223], v[168:171], a[216:219]
v_add_f32 v249, v249, v148
v_mfma_f32_16x16x32_bf16 a[220:223], v[220:223], v[172:175], a[220:223]
s_waitcnt lgkmcnt(4)
v_mfma_f32_16x16x32_bf16 v[96:99], v[208:211], v[160:163], v[96:99]
ds_read_b64_tr_b16 v[220:221], v243 offset:33024
ds_read_b64_tr_b16 v[222:223], v243 offset:41216
v_mfma_f32_16x16x32_bf16 v[100:103], v[208:211], v[164:167], v[100:103]
v_exp_f32 v149, v149
v_mfma_f32_16x16x32_bf16 a[224:227], v[208:211], v[168:171], a[224:227]
v_add_f32 v249, v249, v149
v_cvt_pk_bf16_f32 v182, v148, v149
v_mfma_f32_16x16x32_bf16 a[228:231], v[208:211], v[172:175], a[228:231]
s_waitcnt lgkmcnt(4)
v_mfma_f32_16x16x32_bf16 v[104:107], v[212:215], v[160:163], v[104:107]
ds_read_b128 v[208:211], v232 offset:0
v_mfma_f32_16x16x32_bf16 v[108:111], v[212:215], v[164:167], v[108:111]
v_exp_f32 v150, v150
v_mfma_f32_16x16x32_bf16 a[232:235], v[212:215], v[168:171], a[232:235]
v_add_f32 v249, v249, v150
v_mfma_f32_16x16x32_bf16 a[236:239], v[212:215], v[172:175], a[236:239]
s_waitcnt lgkmcnt(3)
v_mfma_f32_16x16x32_bf16 v[112:115], v[216:219], v[160:163], v[112:115]
ds_read_b128 v[212:215], v233 offset:0
v_mfma_f32_16x16x32_bf16 v[116:119], v[216:219], v[164:167], v[116:119]
v_exp_f32 v151, v151
v_mfma_f32_16x16x32_bf16 a[240:243], v[216:219], v[168:171], a[240:243]
v_add_f32 v249, v249, v151
v_cvt_pk_bf16_f32 v183, v150, v151
v_mfma_f32_16x16x32_bf16 a[244:247], v[216:219], v[172:175], a[244:247]
s_waitcnt lgkmcnt(2)
v_mfma_f32_16x16x32_bf16 v[120:123], v[220:223], v[160:163], v[120:123]
ds_read_b128 v[216:219], v234 offset:0
v_mfma_f32_16x16x32_bf16 v[124:127], v[220:223], v[164:167], v[124:127]
v_exp_f32 v152, v152
v_mfma_f32_16x16x32_bf16 a[248:251], v[220:223], v[168:171], a[248:251]
v_add_f32 v250, v250, v152
v_mfma_f32_16x16x32_bf16 a[252:255], v[220:223], v[172:175], a[252:255]
s_waitcnt lgkmcnt(2)
v_mfma_f32_16x16x32_bf16 v[128:131], v[208:211], a[0:3], v[192:195]
ds_read_b128 v[220:223], v235 offset:0
v_mfma_f32_16x16x32_bf16 v[132:135], v[208:211], a[32:35], v[196:199]
v_exp_f32 v153, v153
v_mfma_f32_16x16x32_bf16 v[136:139], v[208:211], a[64:67], v[200:203]
v_add_f32 v250, v250, v153
v_cvt_pk_bf16_f32 v186, v152, v153
v_mfma_f32_16x16x32_bf16 v[140:143], v[208:211], a[96:99], v[204:207]
s_waitcnt lgkmcnt(2)
v_mfma_f32_16x16x32_bf16 v[128:131], v[212:215], a[4:7], v[128:131]
ds_read_b128 v[208:211], v232 offset:256
v_mfma_f32_16x16x32_bf16 v[132:135], v[212:215], a[36:39], v[132:135]
v_exp_f32 v154, v154
v_mfma_f32_16x16x32_bf16 v[136:139], v[212:215], a[68:71], v[136:139]
v_add_f32 v250, v250, v154
v_mfma_f32_16x16x32_bf16 v[140:143], v[212:215], a[100:103], v[140:143]
s_waitcnt lgkmcnt(2)
v_mfma_f32_16x16x32_bf16 v[128:131], v[216:219], a[8:11], v[128:131]
ds_read_b128 v[212:215], v233 offset:256
s_waitcnt vmcnt(0)
s_barrier
v_mfma_f32_16x16x32_bf16 v[132:135], v[216:219], a[40:43], v[132:135]
v_exp_f32 v155, v155
v_mfma_f32_16x16x32_bf16 v[136:139], v[216:219], a[72:75], v[136:139]
v_add_f32 v250, v250, v155
v_cvt_pk_bf16_f32 v187, v154, v155
v_mfma_f32_16x16x32_bf16 v[140:143], v[216:219], a[104:107], v[140:143]
s_add_u32 m0, s56, 0x8000
s_nop 0
buffer_load_dwordx4 v244, s[8:11], s57 offen offset:0 sc1 lds
s_waitcnt lgkmcnt(2)
v_mfma_f32_16x16x32_bf16 v[128:131], v[220:223], a[12:15], v[128:131]
ds_read_b128 v[216:219], v234 offset:256
v_mfma_f32_16x16x32_bf16 v[132:135], v[220:223], a[44:47], v[132:135]
v_exp_f32 v156, v156
v_mfma_f32_16x16x32_bf16 v[136:139], v[220:223], a[76:79], v[136:139]
v_add_f32 v251, v251, v156
v_mfma_f32_16x16x32_bf16 v[140:143], v[220:223], a[108:111], v[140:143]
buffer_load_dwordx4 v245, s[8:11], s57 offen offset:1024 sc1 lds
s_waitcnt lgkmcnt(2)
v_mfma_f32_16x16x32_bf16 v[128:131], v[208:211], a[16:19], v[128:131]
ds_read_b128 v[220:223], v235 offset:256
v_mfma_f32_16x16x32_bf16 v[132:135], v[208:211], a[48:51], v[132:135]
v_exp_f32 v157, v157
v_mfma_f32_16x16x32_bf16 v[136:139], v[208:211], a[80:83], v[136:139]
v_add_f32 v251, v251, v157
v_cvt_pk_bf16_f32 v190, v156, v157
v_mfma_f32_16x16x32_bf16 v[140:143], v[208:211], a[112:115], v[140:143]
buffer_load_dwordx4 v246, s[8:11], s57 offen offset:2048 sc1 lds
s_waitcnt lgkmcnt(2)
v_mfma_f32_16x16x32_bf16 v[128:131], v[212:215], a[20:23], v[128:131]
ds_read_b128 v[208:211], v232 offset:8192
v_mfma_f32_16x16x32_bf16 v[132:135], v[212:215], a[52:55], v[132:135]
v_exp_f32 v158, v158
v_mfma_f32_16x16x32_bf16 v[136:139], v[212:215], a[84:87], v[136:139]
v_add_f32 v251, v251, v158
v_mfma_f32_16x16x32_bf16 v[140:143], v[212:215], a[116:119], v[140:143]
buffer_load_dwordx4 v247, s[8:11], s57 offen offset:3072 sc1 lds
s_waitcnt lgkmcnt(2)
v_mfma_f32_16x16x32_bf16 v[128:131], v[216:219], a[24:27], v[128:131]
ds_read_b128 v[212:215], v233 offset:8192
v_mfma_f32_16x16x32_bf16 v[132:135], v[216:219], a[56:59], v[132:135]
v_exp_f32 v159, v159
v_mfma_f32_16x16x32_bf16 v[136:139], v[216:219], a[88:91], v[136:139]
v_add_f32 v251, v251, v159
v_cvt_pk_bf16_f32 v191, v158, v159
v_mfma_f32_16x16x32_bf16 v[140:143], v[216:219], a[120:123], v[140:143]
s_add_u32 m0, s56, 0x9000
s_add_u32 s57, s57, 4096
buffer_load_dwordx4 v244, s[8:11], s57 offen offset:0 sc1 lds
s_waitcnt lgkmcnt(2)
v_mfma_f32_16x16x32_bf16 v[128:131], v[220:223], a[28:31], v[128:131]
ds_read_b128 v[216:219], v234 offset:8192
v_mfma_f32_16x16x32_bf16 v[132:135], v[220:223], a[60:63], v[132:135]
v_mfma_f32_16x16x32_bf16 v[136:139], v[220:223], a[92:95], v[136:139]
v_mfma_f32_16x16x32_bf16 v[140:143], v[220:223], a[124:127], v[140:143]
buffer_load_dwordx4 v245, s[8:11], s57 offen offset:1024 sc1 lds
s_waitcnt lgkmcnt(2)
v_mfma_f32_16x16x32_bf16 v[144:147], v[208:211], a[0:3], v[192:195]
ds_read_b128 v[220:223], v235 offset:8192
v_mfma_f32_16x16x32_bf16 v[148:151], v[208:211], a[32:35], v[196:199]
v_mfma_f32_16x16x32_bf16 v[152:155], v[208:211], a[64:67], v[200:203]
v_mfma_f32_16x16x32_bf16 v[156:159], v[208:211], a[96:99], v[204:207]
buffer_load_dwordx4 v246, s[8:11], s57 offen offset:2048 sc1 lds
s_waitcnt lgkmcnt(2)
v_mfma_f32_16x16x32_bf16 v[144:147], v[212:215], a[4:7], v[144:147]
ds_read_b128 v[208:211], v232 offset:8448
v_mfma_f32_16x16x32_bf16 v[148:151], v[212:215], a[36:39], v[148:151]
v_exp_f32 v128, v128
v_mfma_f32_16x16x32_bf16 v[152:155], v[212:215], a[68:71], v[152:155]
v_add_f32 v248, v248, v128
v_mfma_f32_16x16x32_bf16 v[156:159], v[212:215], a[100:103], v[156:159]
buffer_load_dwordx4 v247, s[8:11], s57 offen offset:3072 sc1 lds
s_add_u32 s57, s57, 12288
s_waitcnt lgkmcnt(2)
v_mfma_f32_16x16x32_bf16 v[144:147], v[216:219], a[8:11], v[144:147]
ds_read_b128 v[212:215], v233 offset:8448
v_mfma_f32_16x16x32_bf16 v[148:151], v[216:219], a[40:43], v[148:151]
v_exp_f32 v129, v129
v_mfma_f32_16x16x32_bf16 v[152:155], v[216:219], a[72:75], v[152:155]
v_add_f32 v248, v248, v129
v_cvt_pk_bf16_f32 v160, v128, v129
v_mfma_f32_16x16x32_bf16 v[156:159], v[216:219], a[104:107], v[156:159]
s_waitcnt lgkmcnt(2)
v_mfma_f32_16x16x32_bf16 v[144:147], v[220:223], a[12:15], v[144:147]
ds_read_b128 v[216:219], v234 offset:8448
v_mfma_f32_16x16x32_bf16 v[148:151], v[220:223], a[44:47], v[148:151]
v_exp_f32 v130, v130
v_mfma_f32_16x16x32_bf16 v[152:155], v[220:223], a[76:79], v[152:155]
v_add_f32 v248, v248, v130
v_mfma_f32_16x16x32_bf16 v[156:159], v[220:223], a[108:111], v[156:159]
s_waitcnt lgkmcnt(2)
v_mfma_f32_16x16x32_bf16 v[144:147], v[208:211], a[16:19], v[144:147]
ds_read_b128 v[220:223], v235 offset:8448
v_mfma_f32_16x16x32_bf16 v[148:151], v[208:211], a[48:51], v[148:151]
v_exp_f32 v131, v131
v_mfma_f32_16x16x32_bf16 v[152:155], v[208:211], a[80:83], v[152:155]
v_add_f32 v248, v248, v131
v_cvt_pk_bf16_f32 v161, v130, v131
v_mfma_f32_16x16x32_bf16 v[156:159], v[208:211], a[112:115], v[156:159]
s_waitcnt lgkmcnt(2)
v_mfma_f32_16x16x32_bf16 v[144:147], v[212:215], a[20:23], v[144:147]
ds_read_b64_tr_b16 v[208:209], v236 offset:49152
ds_read_b64_tr_b16 v[210:211], v236 offset:57344
v_mfma_f32_16x16x32_bf16 v[148:151], v[212:215], a[52:55], v[148:151]
v_exp_f32 v132, v132
v_mfma_f32_16x16x32_bf16 v[152:155], v[212:215], a[84:87], v[152:155]
v_add_f32 v249, v249, v132
v_mfma_f32_16x16x32_bf16 v[156:159], v[212:215], a[116:119], v[156:159]
s_waitcnt lgkmcnt(3)
v_mfma_f32_16x16x32_bf16 v[144:147], v[216:219], a[24:27], v[144:147]
ds_read_b64_tr_b16 v[212:213], v237 offset:49152
ds_read_b64_tr_b16 v[214:215], v237 offset:57344
v_mfma_f32_16x16x32_bf16 v[148:151], v[216:219], a[56:59], v[148:151]
v_exp_f32 v133, v133
v_mfma_f32_16x16x32_bf16 v[152:155], v[216:219], a[88:91], v[152:155]
v_add_f32 v249, v249, v133
v_cvt_pk_bf16_f32 v164, v132, v133
v_mfma_f32_16x16x32_bf16 v[156:159], v[216:219], a[120:123], v[156:159]
s_waitcnt lgkmcnt(4)
v_mfma_f32_16x16x32_bf16 v[144:147], v[220:223], a[28:31], v[144:147]
ds_read_b64_tr_b16 v[216:217], v238 offset:49152
ds_read_b64_tr_b16 v[218:219], v238 offset:57344
v_mfma_f32_16x16x32_bf16 v[148:151], v[220:223], a[60:63], v[148:151]
v_exp_f32 v134, v134
v_mfma_f32_16x16x32_bf16 v[152:155], v[220:223], a[92:95], v[152:155]
v_add_f32 v249, v249, v134
v_mfma_f32_16x16x32_bf16 v[156:159], v[220:223], a[124:127], v[156:159]
s_waitcnt lgkmcnt(4)
v_mfma_f32_16x16x32_bf16 v[0:3], v[208:211], v[176:179], v[0:3]
ds_read_b64_tr_b16 v[220:221], v239 offset:49152
ds_read_b64_tr_b16 v[222:223], v239 offset:57344
v_mfma_f32_16x16x32_bf16 v[4:7], v[208:211], v[180:183], v[4:7]
v_exp_f32 v135, v135
v_mfma_f32_16x16x32_bf16 a[128:131], v[208:211], v[184:187], a[128:131]
v_add_f32 v249, v249, v135
v_cvt_pk_bf16_f32 v165, v134, v135
v_mfma_f32_16x16x32_bf16 a[132:135], v[208:211], v[188:191], a[132:135]
s_waitcnt lgkmcnt(4)
v_mfma_f32_16x16x32_bf16 v[8:11], v[212:215], v[176:179], v[8:11]
ds_read_b64_tr_b16 v[208:209], v240 offset:49152
ds_read_b64_tr_b16 v[210:211], v240 offset:57344
v_mfma_f32_16x16x32_bf16 v[12:15], v[212:215], v[180:183], v[12:15]
v_exp_f32 v136, v136
v_mfma_f32_16x16x32_bf16 a[136:139], v[212:215], v[184:187], a[136:139]
v_add_f32 v250, v250, v136
v_mfma_f32_16x16x32_bf16 a[140:143], v[212:215], v[188:191], a[140:143]
s_waitcnt lgkmcnt(4)
v_mfma_f32_16x16x32_bf16 v[16:19], v[216:219], v[176:179], v[16:19]
ds_read_b64_tr_b16 v[212:213], v241 offset:49152
ds_read_b64_tr_b16 v[214:215], v241 offset:57344
v_mfma_f32_16x16x32_bf16 v[20:23], v[216:219], v[180:183], v[20:23]
v_exp_f32 v137, v137
v_mfma_f32_16x16x32_bf16 a[144:147], v[216:219], v[184:187], a[144:147]
v_add_f32 v250, v250, v137
v_cvt_pk_bf16_f32 v168, v136, v137
v_mfma_f32_16x16x32_bf16 a[148:151], v[216:219], v[188:191], a[148:151]
s_waitcnt lgkmcnt(4)
v_mfma_f32_16x16x32_bf16 v[24:27], v[220:223], v[176:179], v[24:27]
ds_read_b64_tr_b16 v[216:217], v242 offset:49152
ds_read_b64_tr_b16 v[218:219], v242 offset:57344
v_mfma_f32_16x16x32_bf16 v[28:31], v[220:223], v[180:183], v[28:31]
v_exp_f32 v138, v138
v_mfma_f32_16x16x32_bf16 a[152:155], v[220:223], v[184:187], a[152:155]
v_add_f32 v250, v250, v138
v_mfma_f32_16x16x32_bf16 a[156:159], v[220:223], v[188:191], a[156:159]
s_waitcnt lgkmcnt(4)
v_mfma_f32_16x16x32_bf16 v[32:35], v[208:211], v[176:179], v[32:35]
ds_read_b64_tr_b16 v[220:221], v243 offset:49152
ds_read_b64_tr_b16 v[222:223], v243 offset:57344
v_mfma_f32_16x16x32_bf16 v[36:39], v[208:211], v[180:183], v[36:39]
v_exp_f32 v139, v139
v_mfma_f32_16x16x32_bf16 a[160:163], v[208:211], v[184:187], a[160:163]
v_add_f32 v250, v250, v139
v_cvt_pk_bf16_f32 v169, v138, v139
v_mfma_f32_16x16x32_bf16 a[164:167], v[208:211], v[188:191], a[164:167]
s_waitcnt lgkmcnt(4)
v_mfma_f32_16x16x32_bf16 v[40:43], v[212:215], v[176:179], v[40:43]
ds_read_b64_tr_b16 v[208:209], v236 offset:49408
ds_read_b64_tr_b16 v[210:211], v236 offset:57600
v_mfma_f32_16x16x32_bf16 v[44:47], v[212:215], v[180:183], v[44:47]
v_exp_f32 v140, v140
v_mfma_f32_16x16x32_bf16 a[168:171], v[212:215], v[184:187], a[168:171]
v_add_f32 v251, v251, v140
v_mfma_f32_16x16x32_bf16 a[172:175], v[212:215], v[188:191], a[172:175]
s_waitcnt lgkmcnt(4)
v_mfma_f32_16x16x32_bf16 v[48:51], v[216:219], v[176:179], v[48:51]
ds_read_b64_tr_b16 v[212:213], v237 offset:49408
ds_read_b64_tr_b16 v[214:215], v237 offset:57600
v_mfma_f32_16x16x32_bf16 v[52:55], v[216:219], v[180:183], v[52:55]
v_exp_f32 v141, v141
v_mfma_f32_16x16x32_bf16 a[176:179], v[216:219], v[184:187], a[176:179]
v_add_f32 v251, v251, v141
v_cvt_pk_bf16_f32 v172, v140, v141
v_mfma_f32_16x16x32_bf16 a[180:183], v[216:219], v[188:191], a[180:183]
s_waitcnt lgkmcnt(4)
v_mfma_f32_16x16x32_bf16 v[56:59], v[220:223], v[176:179], v[56:59]
ds_read_b64_tr_b16 v[216:217], v238 offset:49408
ds_read_b64_tr_b16 v[218:219], v238 offset:57600
v_mfma_f32_16x16x32_bf16 v[60:63], v[220:223], v[180:183], v[60:63]
v_exp_f32 v142, v142
v_exp_f32 v144, v144
v_mfma_f32_16x16x32_bf16 a[184:187], v[220:223], v[184:187], a[184:187]
v_add_f32 v251, v251, v142
v_add_f32 v248, v248, v144
v_mfma_f32_16x16x32_bf16 a[188:191], v[220:223], v[188:191], a[188:191]
s_waitcnt lgkmcnt(4)
v_mfma_f32_16x16x32_bf16 v[64:67], v[208:211], v[176:179], v[64:67]
ds_read_b64_tr_b16 v[220:221], v239 offset:49408
ds_read_b64_tr_b16 v[222:223], v239 offset:57600
v_mfma_f32_16x16x32_bf16 v[68:71], v[208:211], v[180:183], v[68:71]
v_exp_f32 v143, v143
v_exp_f32 v145, v145
v_mfma_f32_16x16x32_bf16 a[192:195], v[208:211], v[184:187], a[192:195]
v_add_f32 v251, v251, v143
v_add_f32 v248, v248, v145
v_cvt_pk_bf16_f32 v173, v142, v143
v_cvt_pk_bf16_f32 v162, v144, v145
v_mfma_f32_16x16x32_bf16 a[196:199], v[208:211], v[188:191], a[196:199]
s_waitcnt lgkmcnt(4)
v_mfma_f32_16x16x32_bf16 v[72:75], v[212:215], v[176:179], v[72:75]
ds_read_b64_tr_b16 v[208:209], v240 offset:49408
ds_read_b64_tr_b16 v[210:211], v240 offset:57600
v_mfma_f32_16x16x32_bf16 v[76:79], v[212:215], v[180:183], v[76:79]
v_exp_f32 v146, v146
v_mfma_f32_16x16x32_bf16 a[200:203], v[212:215], v[184:187], a[200:203]
v_add_f32 v248, v248, v146
v_mfma_f32_16x16x32_bf16 a[204:207], v[212:215], v[188:191], a[204:207]
s_waitcnt lgkmcnt(4)
v_mfma_f32_16x16x32_bf16 v[80:83], v[216:219], v[176:179], v[80:83]
ds_read_b64_tr_b16 v[212:213], v241 offset:49408
ds_read_b64_tr_b16 v[214:215], v241 offset:57600
v_mfma_f32_16x16x32_bf16 v[84:87], v[216:219], v[180:183], v[84:87]
v_exp_f32 v147, v147
v_mfma_f32_16x16x32_bf16 a[208:211], v[216:219], v[184:187], a[208:211]
v_add_f32 v248, v248, v147
v_cvt_pk_bf16_f32 v163, v146, v147
v_mfma_f32_16x16x32_bf16 a[212:215], v[216:219], v[188:191], a[212:215]
s_waitcnt lgkmcnt(4)
v_mfma_f32_16x16x32_bf16 v[88:91], v[220:223], v[176:179], v[88:91]
ds_read_b64_tr_b16 v[216:217], v242 offset:49408
ds_read_b64_tr_b16 v[218:219], v242 offset:57600
v_mfma_f32_16x16x32_bf16 v[92:95], v[220:223], v[180:183], v[92:95]
v_exp_f32 v148, v148
v_mfma_f32_16x16x32_bf16 a[216:219], v[220:223], v[184:187], a[216:219]
v_add_f32 v249, v249, v148
v_mfma_f32_16x16x32_bf16 a[220:223], v[220:223], v[188:191], a[220:223]
s_waitcnt lgkmcnt(4)
v_mfma_f32_16x16x32_bf16 v[96:99], v[208:211], v[176:179], v[96:99]
ds_read_b64_tr_b16 v[220:221], v243 offset:49408
ds_read_b64_tr_b16 v[222:223], v243 offset:57600
v_mfma_f32_16x16x32_bf16 v[100:103], v[208:211], v[180:183], v[100:103]
v_exp_f32 v149, v149
v_mfma_f32_16x16x32_bf16 a[224:227], v[208:211], v[184:187], a[224:227]
v_add_f32 v249, v249, v149
v_cvt_pk_bf16_f32 v166, v148, v149
v_mfma_f32_16x16x32_bf16 a[228:231], v[208:211], v[188:191], a[228:231]
s_waitcnt lgkmcnt(4)
v_mfma_f32_16x16x32_bf16 v[104:107], v[212:215], v[176:179], v[104:107]
ds_read_b128 v[208:211], v232 offset:16384
v_mfma_f32_16x16x32_bf16 v[108:111], v[212:215], v[180:183], v[108:111]
v_exp_f32 v150, v150
v_mfma_f32_16x16x32_bf16 a[232:235], v[212:215], v[184:187], a[232:235]
v_add_f32 v249, v249, v150
v_mfma_f32_16x16x32_bf16 a[236:239], v[212:215], v[188:191], a[236:239]
s_waitcnt lgkmcnt(3)
v_mfma_f32_16x16x32_bf16 v[112:115], v[216:219], v[176:179], v[112:115]
ds_read_b128 v[212:215], v233 offset:16384
v_mfma_f32_16x16x32_bf16 v[116:119], v[216:219], v[180:183], v[116:119]
v_exp_f32 v151, v151
v_mfma_f32_16x16x32_bf16 a[240:243], v[216:219], v[184:187], a[240:243]
v_add_f32 v249, v249, v151
v_cvt_pk_bf16_f32 v167, v150, v151
v_mfma_f32_16x16x32_bf16 a[244:247], v[216:219], v[188:191], a[244:247]
s_waitcnt lgkmcnt(2)
v_mfma_f32_16x16x32_bf16 v[120:123], v[220:223], v[176:179], v[120:123]
ds_read_b128 v[216:219], v234 offset:16384
v_mfma_f32_16x16x32_bf16 v[124:127], v[220:223], v[180:183], v[124:127]
v_exp_f32 v152, v152
v_mfma_f32_16x16x32_bf16 a[248:251], v[220:223], v[184:187], a[248:251]
v_add_f32 v250, v250, v152
v_mfma_f32_16x16x32_bf16 a[252:255], v[220:223], v[188:191], a[252:255]
s_add_u32 s58, s58, 1
s_branch K2_LOOP
K2_EPI:
s_lshl_b32 s60, s52, 7
s_lshl_b32 s61, s53, 5
s_add_u32 s60, s60, s61
s_min_u32 s60, s60, 3968
s_mul_i32 s61, s51, 4000
s_add_u32 s60, s60, s61
s_max_u32 s61, s60, 2
s_sub_u32 s61, s61, 2
s_lshr_b32 s61, s61, 6
s_add_u32 s60, s60, 33
s_min_u32 s60, s60, 7999
s_lshr_b32 s60, s60, 6
v_mbcnt_lo_u32_b32 v224, -1, 0
v_mbcnt_hi_u32_b32 v224, -1, v224
v_min_u32 v225, 7, v224
v_lshlrev_b32 v225, 7, v225
v_add_u32 v225, 73472, v225
s_lshl_b32 s61, s61, 7
s_add_u32 s61, s61, 40960
v_mov_b32 v226, s61
v_cmp_eq_u32 vcc, 0, v224
s_nop 1
v_cndmask_b32 v225, v225, v226, vcc
s_lshl_b32 s60, s60, 7
s_add_u32 s60, s60, 40960
v_mov_b32 v226, s60
v_cmp_eq_u32 vcc, 1, v224
s_nop 1
v_cndmask_b32 v225, v225, v226, vcc
buffer_load_dword v226, v225, s[44:47], 0 offen sc1
s_waitcnt lgkmcnt(2)
v_mfma_f32_16x16x32_bf16 v[128:131], v[208:211], a[0:3], v[192:195]
ds_read_b128 v[220:223], v235 offset:32768
v_mfma_f32_16x16x32_bf16 v[132:135], v[208:211], a[32:35], v[196:199]
v_exp_f32 v153, v153
v_mfma_f32_16x16x32_bf16 v[136:139], v[208:211], a[64:67], v[200:203]
v_add_f32 v250, v250, v153
v_cvt_pk_bf16_f32 v186, v152, v153
v_mfma_f32_16x16x32_bf16 v[140:143], v[208:211], a[96:99], v[204:207]
s_waitcnt lgkmcnt(2)
v_mfma_f32_16x16x32_bf16 v[128:131], v[212:215], a[4:7], v[128:131]
ds_read_b128 v[208:211], v232 offset:33024
v_mfma_f32_16x16x32_bf16 v[132:135], v[212:215], a[36:39], v[132:135]
v_exp_f32 v154, v154
v_mfma_f32_16x16x32_bf16 v[136:139], v[212:215], a[68:71], v[136:139]
v_add_f32 v250, v250, v154
v_mfma_f32_16x16x32_bf16 v[140:143], v[212:215], a[100:103], v[140:143]
s_waitcnt lgkmcnt(2)
v_mfma_f32_16x16x32_bf16 v[128:131], v[216:219], a[8:11], v[128:131]
ds_read_b128 v[212:215], v233 offset:33024
s_waitcnt vmcnt(1)
s_barrier
v_mfma_f32_16x16x32_bf16 v[132:135], v[216:219], a[40:43], v[132:135]
v_exp_f32 v155, v155
v_mfma_f32_16x16x32_bf16 v[136:139], v[216:219], a[72:75], v[136:139]
v_add_f32 v250, v250, v155
v_cvt_pk_bf16_f32 v187, v154, v155
v_mfma_f32_16x16x32_bf16 v[140:143], v[216:219], a[104:107], v[140:143]
s_waitcnt lgkmcnt(2)
v_mfma_f32_16x16x32_bf16 v[128:131], v[220:223], a[12:15], v[128:131]
ds_read_b128 v[216:219], v234 offset:33024
v_mfma_f32_16x16x32_bf16 v[132:135], v[220:223], a[44:47], v[132:135]
v_exp_f32 v156, v156
v_mfma_f32_16x16x32_bf16 v[136:139], v[220:223], a[76:79], v[136:139]
v_add_f32 v251, v251, v156
v_mfma_f32_16x16x32_bf16 v[140:143], v[220:223], a[108:111], v[140:143]
s_waitcnt lgkmcnt(2)
v_mfma_f32_16x16x32_bf16 v[128:131], v[208:211], a[16:19], v[128:131]
ds_read_b128 v[220:223], v235 offset:33024
v_mfma_f32_16x16x32_bf16 v[132:135], v[208:211], a[48:51], v[132:135]
v_exp_f32 v157, v157
v_mfma_f32_16x16x32_bf16 v[136:139], v[208:211], a[80:83], v[136:139]
v_add_f32 v251, v251, v157
v_cvt_pk_bf16_f32 v190, v156, v157
v_mfma_f32_16x16x32_bf16 v[140:143], v[208:211], a[112:115], v[140:143]
s_waitcnt lgkmcnt(2)
v_mfma_f32_16x16x32_bf16 v[128:131], v[212:215], a[20:23], v[128:131]
ds_read_b128 v[208:211], v232 offset:40960
v_mfma_f32_16x16x32_bf16 v[132:135], v[212:215], a[52:55], v[132:135]
v_exp_f32 v158, v158
v_mfma_f32_16x16x32_bf16 v[136:139], v[212:215], a[84:87], v[136:139]
v_add_f32 v251, v251, v158
v_mfma_f32_16x16x32_bf16 v[140:143], v[212:215], a[116:119], v[140:143]
s_waitcnt lgkmcnt(2)
v_mfma_f32_16x16x32_bf16 v[128:131], v[216:219], a[24:27], v[128:131]
ds_read_b128 v[212:215], v233 offset:40960
v_mfma_f32_16x16x32_bf16 v[132:135], v[216:219], a[56:59], v[132:135]
v_exp_f32 v159, v159
v_mfma_f32_16x16x32_bf16 v[136:139], v[216:219], a[88:91], v[136:139]
v_add_f32 v251, v251, v159
v_cvt_pk_bf16_f32 v191, v158, v159
v_mfma_f32_16x16x32_bf16 v[140:143], v[216:219], a[120:123], v[140:143]
s_waitcnt lgkmcnt(2)
v_mfma_f32_16x16x32_bf16 v[128:131], v[220:223], a[28:31], v[128:131]
ds_read_b128 v[216:219], v234 offset:40960
v_mfma_f32_16x16x32_bf16 v[132:135], v[220:223], a[60:63], v[132:135]
v_mfma_f32_16x16x32_bf16 v[136:139], v[220:223], a[92:95], v[136:139]
v_mfma_f32_16x16x32_bf16 v[140:143], v[220:223], a[124:127], v[140:143]
s_waitcnt lgkmcnt(2)
v_mfma_f32_16x16x32_bf16 v[144:147], v[208:211], a[0:3], v[192:195]
ds_read_b128 v[220:223], v235 offset:40960
v_mfma_f32_16x16x32_bf16 v[148:151], v[208:211], a[32:35], v[196:199]
v_mfma_f32_16x16x32_bf16 v[152:155], v[208:211], a[64:67], v[200:203]
v_mfma_f32_16x16x32_bf16 v[156:159], v[208:211], a[96:99], v[204:207]
s_waitcnt lgkmcnt(2)
v_mfma_f32_16x16x32_bf16 v[144:147], v[212:215], a[4:7], v[144:147]
ds_read_b128 v[208:211], v232 offset:41216
v_mfma_f32_16x16x32_bf16 v[148:151], v[212:215], a[36:39], v[148:151]
v_exp_f32 v128, v128
v_mfma_f32_16x16x32_bf16 v[152:155], v[212:215], a[68:71], v[152:155]
v_add_f32 v248, v248, v128
v_mfma_f32_16x16x32_bf16 v[156:159], v[212:215], a[100:103], v[156:159]
s_waitcnt lgkmcnt(2)
v_mfma_f32_16x16x32_bf16 v[144:147], v[216:219], a[8:11], v[144:147]
ds_read_b128 v[212:215], v233 offset:41216
v_mfma_f32_16x16x32_bf16 v[148:151], v[216:219], a[40:43], v[148:151]
v_exp_f32 v129, v129
v_mfma_f32_16x16x32_bf16 v[152:155], v[216:219], a[72:75], v[152:155]
v_add_f32 v248, v248, v129
v_cvt_pk_bf16_f32 v160, v128, v129
v_mfma_f32_16x16x32_bf16 v[156:159], v[216:219], a[104:107], v[156:159]
s_waitcnt lgkmcnt(2)
v_mfma_f32_16x16x32_bf16 v[144:147], v[220:223], a[12:15], v[144:147]
ds_read_b128 v[216:219], v234 offset:41216
v_mfma_f32_16x16x32_bf16 v[148:151], v[220:223], a[44:47], v[148:151]
v_exp_f32 v130, v130
v_mfma_f32_16x16x32_bf16 v[152:155], v[220:223], a[76:79], v[152:155]
v_add_f32 v248, v248, v130
v_mfma_f32_16x16x32_bf16 v[156:159], v[220:223], a[108:111], v[156:159]
s_waitcnt lgkmcnt(2)
v_mfma_f32_16x16x32_bf16 v[144:147], v[208:211], a[16:19], v[144:147]
ds_read_b128 v[220:223], v235 offset:41216
v_mfma_f32_16x16x32_bf16 v[148:151], v[208:211], a[48:51], v[148:151]
v_exp_f32 v131, v131
v_mfma_f32_16x16x32_bf16 v[152:155], v[208:211], a[80:83], v[152:155]
v_add_f32 v248, v248, v131
v_cvt_pk_bf16_f32 v161, v130, v131
v_mfma_f32_16x16x32_bf16 v[156:159], v[208:211], a[112:115], v[156:159]
s_waitcnt lgkmcnt(2)
v_mfma_f32_16x16x32_bf16 v[144:147], v[212:215], a[20:23], v[144:147]
ds_read_b64_tr_b16 v[208:209], v236 offset:16384
ds_read_b64_tr_b16 v[210:211], v236 offset:24576
v_mfma_f32_16x16x32_bf16 v[148:151], v[212:215], a[52:55], v[148:151]
v_exp_f32 v132, v132
v_mfma_f32_16x16x32_bf16 v[152:155], v[212:215], a[84:87], v[152:155]
v_add_f32 v249, v249, v132
v_mfma_f32_16x16x32_bf16 v[156:159], v[212:215], a[116:119], v[156:159]
s_waitcnt lgkmcnt(3)
v_mfma_f32_16x16x32_bf16 v[144:147], v[216:219], a[24:27], v[144:147]
ds_read_b64_tr_b16 v[212:213], v237 offset:16384
ds_read_b64_tr_b16 v[214:215], v237 offset:24576
v_mfma_f32_16x16x32_bf16 v[148:151], v[216:219], a[56:59], v[148:151]
v_exp_f32 v133, v133
v_mfma_f32_16x16x32_bf16 v[152:155], v[216:219], a[88:91], v[152:155]
v_add_f32 v249, v249, v133
v_cvt_pk_bf16_f32 v164, v132, v133
v_mfma_f32_16x16x32_bf16 v[156:159], v[216:219], a[120:123], v[156:159]
s_waitcnt lgkmcnt(4)
v_mfma_f32_16x16x32_bf16 v[144:147], v[220:223], a[28:31], v[144:147]
ds_read_b64_tr_b16 v[216:217], v238 offset:16384
ds_read_b64_tr_b16 v[218:219], v238 offset:24576
v_mfma_f32_16x16x32_bf16 v[148:151], v[220:223], a[60:63], v[148:151]
v_exp_f32 v134, v134
v_mfma_f32_16x16x32_bf16 v[152:155], v[220:223], a[92:95], v[152:155]
v_add_f32 v249, v249, v134
v_mfma_f32_16x16x32_bf16 v[156:159], v[220:223], a[124:127], v[156:159]
s_waitcnt lgkmcnt(4)
v_mfma_f32_16x16x32_bf16 v[0:3], v[208:211], v[176:179], v[0:3]
ds_read_b64_tr_b16 v[220:221], v239 offset:16384
ds_read_b64_tr_b16 v[222:223], v239 offset:24576
v_mfma_f32_16x16x32_bf16 v[4:7], v[208:211], v[180:183], v[4:7]
v_exp_f32 v135, v135
v_mfma_f32_16x16x32_bf16 a[128:131], v[208:211], v[184:187], a[128:131]
v_add_f32 v249, v249, v135
v_cvt_pk_bf16_f32 v165, v134, v135
v_mfma_f32_16x16x32_bf16 a[132:135], v[208:211], v[188:191], a[132:135]
s_waitcnt lgkmcnt(4)
v_mfma_f32_16x16x32_bf16 v[8:11], v[212:215], v[176:179], v[8:11]
ds_read_b64_tr_b16 v[208:209], v240 offset:16384
ds_read_b64_tr_b16 v[210:211], v240 offset:24576
v_mfma_f32_16x16x32_bf16 v[12:15], v[212:215], v[180:183], v[12:15]
v_exp_f32 v136, v136
v_mfma_f32_16x16x32_bf16 a[136:139], v[212:215], v[184:187], a[136:139]
v_add_f32 v250, v250, v136
v_mfma_f32_16x16x32_bf16 a[140:143], v[212:215], v[188:191], a[140:143]
s_waitcnt lgkmcnt(4)
v_mfma_f32_16x16x32_bf16 v[16:19], v[216:219], v[176:179], v[16:19]
ds_read_b64_tr_b16 v[212:213], v241 offset:16384
ds_read_b64_tr_b16 v[214:215], v241 offset:24576
v_mfma_f32_16x16x32_bf16 v[20:23], v[216:219], v[180:183], v[20:23]
v_exp_f32 v137, v137
v_mfma_f32_16x16x32_bf16 a[144:147], v[216:219], v[184:187], a[144:147]
v_add_f32 v250, v250, v137
v_cvt_pk_bf16_f32 v168, v136, v137
v_mfma_f32_16x16x32_bf16 a[148:151], v[216:219], v[188:191], a[148:151]
s_waitcnt lgkmcnt(4)
v_mfma_f32_16x16x32_bf16 v[24:27], v[220:223], v[176:179], v[24:27]
ds_read_b64_tr_b16 v[216:217], v242 offset:16384
ds_read_b64_tr_b16 v[218:219], v242 offset:24576
v_mfma_f32_16x16x32_bf16 v[28:31], v[220:223], v[180:183], v[28:31]
v_exp_f32 v138, v138
v_mfma_f32_16x16x32_bf16 a[152:155], v[220:223], v[184:187], a[152:155]
v_add_f32 v250, v250, v138
v_mfma_f32_16x16x32_bf16 a[156:159], v[220:223], v[188:191], a[156:159]
s_waitcnt lgkmcnt(4)
v_mfma_f32_16x16x32_bf16 v[32:35], v[208:211], v[176:179], v[32:35]
ds_read_b64_tr_b16 v[220:221], v243 offset:16384
ds_read_b64_tr_b16 v[222:223], v243 offset:24576
v_mfma_f32_16x16x32_bf16 v[36:39], v[208:211], v[180:183], v[36:39]
v_exp_f32 v139, v139
v_mfma_f32_16x16x32_bf16 a[160:163], v[208:211], v[184:187], a[160:163]
v_add_f32 v250, v250, v139
v_cvt_pk_bf16_f32 v169, v138, v139
v_mfma_f32_16x16x32_bf16 a[164:167], v[208:211], v[188:191], a[164:167]
s_waitcnt lgkmcnt(4)
v_mfma_f32_16x16x32_bf16 v[40:43], v[212:215], v[176:179], v[40:43]
ds_read_b64_tr_b16 v[208:209], v236 offset:16640
ds_read_b64_tr_b16 v[210:211], v236 offset:24832
v_mfma_f32_16x16x32_bf16 v[44:47], v[212:215], v[180:183], v[44:47]
v_exp_f32 v140, v140
v_mfma_f32_16x16x32_bf16 a[168:171], v[212:215], v[184:187], a[168:171]
v_add_f32 v251, v251, v140
v_mfma_f32_16x16x32_bf16 a[172:175], v[212:215], v[188:191], a[172:175]
s_waitcnt lgkmcnt(4)
v_mfma_f32_16x16x32_bf16 v[48:51], v[216:219], v[176:179], v[48:51]
ds_read_b64_tr_b16 v[212:213], v237 offset:16640
ds_read_b64_tr_b16 v[214:215], v237 offset:24832
v_mfma_f32_16x16x32_bf16 v[52:55], v[216:219], v[180:183], v[52:55]
v_exp_f32 v141, v141
v_mfma_f32_16x16x32_bf16 a[176:179], v[216:219], v[184:187], a[176:179]
v_add_f32 v251, v251, v141
v_cvt_pk_bf16_f32 v172, v140, v141
v_mfma_f32_16x16x32_bf16 a[180:183], v[216:219], v[188:191], a[180:183]
s_waitcnt lgkmcnt(4)
v_mfma_f32_16x16x32_bf16 v[56:59], v[220:223], v[176:179], v[56:59]
ds_read_b64_tr_b16 v[216:217], v238 offset:16640
ds_read_b64_tr_b16 v[218:219], v238 offset:24832
v_mfma_f32_16x16x32_bf16 v[60:63], v[220:223], v[180:183], v[60:63]
v_exp_f32 v142, v142
v_exp_f32 v144, v144
v_mfma_f32_16x16x32_bf16 a[184:187], v[220:223], v[184:187], a[184:187]
v_add_f32 v251, v251, v142
v_add_f32 v248, v248, v144
v_mfma_f32_16x16x32_bf16 a[188:191], v[220:223], v[188:191], a[188:191]
s_waitcnt lgkmcnt(4)
v_mfma_f32_16x16x32_bf16 v[64:67], v[208:211], v[176:179], v[64:67]
ds_read_b64_tr_b16 v[220:221], v239 offset:16640
ds_read_b64_tr_b16 v[222:223], v239 offset:24832
v_mfma_f32_16x16x32_bf16 v[68:71], v[208:211], v[180:183], v[68:71]
v_exp_f32 v143, v143
v_exp_f32 v145, v145
v_mfma_f32_16x16x32_bf16 a[192:195], v[208:211], v[184:187], a[192:195]
v_add_f32 v251, v251, v143
v_add_f32 v248, v248, v145
v_cvt_pk_bf16_f32 v173, v142, v143
v_cvt_pk_bf16_f32 v162, v144, v145
v_mfma_f32_16x16x32_bf16 a[196:199], v[208:211], v[188:191], a[196:199]
s_waitcnt lgkmcnt(4)
v_mfma_f32_16x16x32_bf16 v[72:75], v[212:215], v[176:179], v[72:75]
ds_read_b64_tr_b16 v[208:209], v240 offset:16640
ds_read_b64_tr_b16 v[210:211], v240 offset:24832
v_mfma_f32_16x16x32_bf16 v[76:79], v[212:215], v[180:183], v[76:79]
v_exp_f32 v146, v146
v_mfma_f32_16x16x32_bf16 a[200:203], v[212:215], v[184:187], a[200:203]
v_add_f32 v248, v248, v146
v_mfma_f32_16x16x32_bf16 a[204:207], v[212:215], v[188:191], a[204:207]
s_waitcnt lgkmcnt(4)
v_mfma_f32_16x16x32_bf16 v[80:83], v[216:219], v[176:179], v[80:83]
ds_read_b64_tr_b16 v[212:213], v241 offset:16640
ds_read_b64_tr_b16 v[214:215], v241 offset:24832
v_mfma_f32_16x16x32_bf16 v[84:87], v[216:219], v[180:183], v[84:87]
v_exp_f32 v147, v147
v_mfma_f32_16x16x32_bf16 a[208:211], v[216:219], v[184:187], a[208:211]
v_add_f32 v248, v248, v147
v_cvt_pk_bf16_f32 v163, v146, v147
v_mfma_f32_16x16x32_bf16 a[212:215], v[216:219], v[188:191], a[212:215]
s_waitcnt lgkmcnt(4)
v_mfma_f32_16x16x32_bf16 v[88:91], v[220:223], v[176:179], v[88:91]
ds_read_b64_tr_b16 v[216:217], v242 offset:16640
ds_read_b64_tr_b16 v[218:219], v242 offset:24832
v_mfma_f32_16x16x32_bf16 v[92:95], v[220:223], v[180:183], v[92:95]
v_exp_f32 v148, v148
v_mfma_f32_16x16x32_bf16 a[216:219], v[220:223], v[184:187], a[216:219]
v_add_f32 v249, v249, v148
v_mfma_f32_16x16x32_bf16 a[220:223], v[220:223], v[188:191], a[220:223]
s_waitcnt lgkmcnt(4)
v_mfma_f32_16x16x32_bf16 v[96:99], v[208:211], v[176:179], v[96:99]
ds_read_b64_tr_b16 v[220:221], v243 offset:16640
ds_read_b64_tr_b16 v[222:223], v243 offset:24832
v_mfma_f32_16x16x32_bf16 v[100:103], v[208:211], v[180:183], v[100:103]
v_exp_f32 v149, v149
v_mfma_f32_16x16x32_bf16 a[224:227], v[208:211], v[184:187], a[224:227]
v_add_f32 v249, v249, v149
v_cvt_pk_bf16_f32 v166, v148, v149
v_mfma_f32_16x16x32_bf16 a[228:231], v[208:211], v[188:191], a[228:231]
s_waitcnt lgkmcnt(4)
v_mfma_f32_16x16x32_bf16 v[104:107], v[212:215], v[176:179], v[104:107]
ds_read_b128 v[208:211], v232 offset:49152
v_mfma_f32_16x16x32_bf16 v[108:111], v[212:215], v[180:183], v[108:111]
v_exp_f32 v150, v150
v_mfma_f32_16x16x32_bf16 a[232:235], v[212:215], v[184:187], a[232:235]
v_add_f32 v249, v249, v150
v_mfma_f32_16x16x32_bf16 a[236:239], v[212:215], v[188:191], a[236:239]
s_waitcnt lgkmcnt(3)
v_mfma_f32_16x16x32_bf16 v[112:115], v[216:219], v[176:179], v[112:115]
ds_read_b128 v[212:215], v233 offset:49152
v_mfma_f32_16x16x32_bf16 v[116:119], v[216:219], v[180:183], v[116:119]
v_exp_f32 v151, v151
v_mfma_f32_16x16x32_bf16 a[240:243], v[216:219], v[184:187], a[240:243]
v_add_f32 v249, v249, v151
v_cvt_pk_bf16_f32 v167, v150, v151
v_mfma_f32_16x16x32_bf16 a[244:247], v[216:219], v[188:191], a[244:247]
s_waitcnt lgkmcnt(2)
v_mfma_f32_16x16x32_bf16 v[120:123], v[220:223], v[176:179], v[120:123]
ds_read_b128 v[216:219], v234 offset:49152
v_mfma_f32_16x16x32_bf16 v[124:127], v[220:223], v[180:183], v[124:127]
v_exp_f32 v152, v152
v_mfma_f32_16x16x32_bf16 a[248:251], v[220:223], v[184:187], a[248:251]
v_add_f32 v250, v250, v152
v_mfma_f32_16x16x32_bf16 a[252:255], v[220:223], v[188:191], a[252:255]
s_waitcnt vmcnt(0)
K2_TP:
v_cmp_ne_u32 vcc, s3, v226
s_nop 1
s_cmp_eq_u64 vcc, 0
s_cbranch_scc1 K2_TD
s_sleep 1
buffer_load_dword v226, v225, s[44:47], 0 offen sc1
s_waitcnt vmcnt(0)
s_add_u32 s101, s101, 1
s_cmp_lt_u32 s101, 0x400000
s_cbranch_scc1 K2_TP
K2_TD:
s_cmp_eq_u32 s59, 3
s_cbranch_scc0 K2_NOMASK
v_mov_b32 v192, 0xf149f2ca
v_mov_b32 v193, 0xf149f2ca
v_mov_b32 v194, 0xf149f2ca
v_mov_b32 v195, 0xf149f2ca
v_mov_b32 v196, 0xf149f2ca
v_mov_b32 v197, 0xf149f2ca
v_mov_b32 v198, 0xf149f2ca
v_mov_b32 v199, 0xf149f2ca
v_mov_b32 v200, 0xf149f2ca
v_mov_b32 v201, 0xf149f2ca
v_mov_b32 v202, 0xf149f2ca
v_mov_b32 v203, 0xf149f2ca
v_mov_b32 v204, 0xf149f2ca
v_mov_b32 v205, 0xf149f2ca
v_mov_b32 v206, 0xf149f2ca
v_mov_b32 v207, 0xf149f2ca
s_nop 1
K2_NOMASK:
s_add_u32 s12, s4, 0x1000000
s_addc_u32 s13, s5, 0
s_mov_b32 s14, 0x40000
s_mov_b32 s15, 0x20000
s_mul_i32 s60, s51, 2048000
s_add_u32 s61, s60, 0xc00000
s_add_u32 s24, s4, s61
s_addc_u32 s25, s5, 0
s_mov_b32 s26, 0x1f4000
s_mov_b32 s27, 0x20000
s_add_u32 s61, s60, 0x800000
s_add_u32 s28, s4, s61
s_addc_u32 s29, s5, 0
s_mov_b32 s30, 0x1f4000
s_mov_b32 s31, 0x20000
s_mov_b32 s34, 2560
s_mov_b32 s35, 0x20000
s_mov_b32 s38, 4096000
s_mov_b32 s39, 0x20000
s_mov_b32 s42, 4096000
s_mov_b32 s43, 0x20000
s_add_u32 s16, s4, 0x1400000
s_addc_u32 s17, s5, 0
s_mov_b32 s18, 0x1000000
s_mov_b32 s19, 0x20000
s_add_u32 s20, s4, 0x1100000
s_addc_u32 s21, s5, 0
s_mov_b32 s22, 0x40000
s_mov_b32 s23, 0x20000
s_lshl_b32 s62, s52, 7
s_lshl_b32 s60, s53, 5
s_add_u32 s62, s62, s60
s_lshl_b32 s64, s49, 1
s_add_u32 s64, s64, s50
v_mbcnt_lo_u32_b32 v254, -1, 0
v_mbcnt_hi_u32_b32 v254, -1, v254
v_lshlrev_b32 v247, 4, v254
v_and_b32 v246, 31, v254
v_lshlrev_b32 v246, 4, v246
v_lshrrev_b32 v255, 5, v254
s_lshl_b32 s60, s48, 1
v_add_u32 v255, s60, v255
v_lshlrev_b32 v255, 2, v255
v_add_u32 v255, s62, v255
v_lshl_add_u32 v244, v255, 9, v246
v_subrev_u32 v245, 1024, v244
s_lshl_b32 s60, s48, 15
v_add_u32 v254, s60, v247
s_add_u32 s61, s60, 16384
s_lshl_b32 s66, s50, 14
s_add_u32 s66, s66, 131072
s_cmp_eq_u32 s49, 1
s_cselect_b32 s61, s66, s61
v_add_u32 v255, s61, v247
s_waitcnt lgkmcnt(2)
v_mfma_f32_16x16x32_bf16 v[128:131], v[208:211], a[0:3], v[192:195]
ds_read_b128 v[220:223], v235 offset:49152
v_mfma_f32_16x16x32_bf16 v[132:135], v[208:211], a[32:35], v[196:199]
v_exp_f32 v153, v153
v_mfma_f32_16x16x32_bf16 v[136:139], v[208:211], a[64:67], v[200:203]
v_add_f32 v250, v250, v153
v_cvt_pk_bf16_f32 v170, v152, v153
v_mfma_f32_16x16x32_bf16 v[140:143], v[208:211], a[96:99], v[204:207]
s_waitcnt lgkmcnt(2)
v_mfma_f32_16x16x32_bf16 v[128:131], v[212:215], a[4:7], v[128:131]
ds_read_b128 v[208:211], v232 offset:49408
v_mfma_f32_16x16x32_bf16 v[132:135], v[212:215], a[36:39], v[132:135]
v_exp_f32 v154, v154
v_mfma_f32_16x16x32_bf16 v[136:139], v[212:215], a[68:71], v[136:139]
v_add_f32 v250, v250, v154
v_mfma_f32_16x16x32_bf16 v[140:143], v[212:215], a[100:103], v[140:143]
s_waitcnt lgkmcnt(2)
v_mfma_f32_16x16x32_bf16 v[128:131], v[216:219], a[8:11], v[128:131]
ds_read_b128 v[212:215], v233 offset:49408
v_mfma_f32_16x16x32_bf16 v[132:135], v[216:219], a[40:43], v[132:135]
v_exp_f32 v155, v155
v_mfma_f32_16x16x32_bf16 v[136:139], v[216:219], a[72:75], v[136:139]
v_add_f32 v250, v250, v155
v_cvt_pk_bf16_f32 v171, v154, v155
v_mfma_f32_16x16x32_bf16 v[140:143], v[216:219], a[104:107], v[140:143]
s_waitcnt lgkmcnt(2)
v_mfma_f32_16x16x32_bf16 v[128:131], v[220:223], a[12:15], v[128:131]
ds_read_b128 v[216:219], v234 offset:49408
v_mfma_f32_16x16x32_bf16 v[132:135], v[220:223], a[44:47], v[132:135]
v_exp_f32 v156, v156
v_mfma_f32_16x16x32_bf16 v[136:139], v[220:223], a[76:79], v[136:139]
v_add_f32 v251, v251, v156
v_mfma_f32_16x16x32_bf16 v[140:143], v[220:223], a[108:111], v[140:143]
s_waitcnt lgkmcnt(2)
v_mfma_f32_16x16x32_bf16 v[128:131], v[208:211], a[16:19], v[128:131]
ds_read_b128 v[220:223], v235 offset:49408
v_mfma_f32_16x16x32_bf16 v[132:135], v[208:211], a[48:51], v[132:135]
v_exp_f32 v157, v157
v_mfma_f32_16x16x32_bf16 v[136:139], v[208:211], a[80:83], v[136:139]
v_add_f32 v251, v251, v157
v_cvt_pk_bf16_f32 v174, v156, v157
v_mfma_f32_16x16x32_bf16 v[140:143], v[208:211], a[112:115], v[140:143]
s_waitcnt lgkmcnt(2)
v_mfma_f32_16x16x32_bf16 v[128:131], v[212:215], a[20:23], v[128:131]
ds_read_b128 v[208:211], v232 offset:57344
v_mfma_f32_16x16x32_bf16 v[132:135], v[212:215], a[52:55], v[132:135]
v_exp_f32 v158, v158
v_mfma_f32_16x16x32_bf16 v[136:139], v[212:215], a[84:87], v[136:139]
v_add_f32 v251, v251, v158
v_mfma_f32_16x16x32_bf16 v[140:143], v[212:215], a[116:119], v[140:143]
s_waitcnt lgkmcnt(2)
v_mfma_f32_16x16x32_bf16 v[128:131], v[216:219], a[24:27], v[128:131]
ds_read_b128 v[212:215], v233 offset:57344
v_mfma_f32_16x16x32_bf16 v[132:135], v[216:219], a[56:59], v[132:135]
v_exp_f32 v159, v159
v_mfma_f32_16x16x32_bf16 v[136:139], v[216:219], a[88:91], v[136:139]
v_add_f32 v251, v251, v159
v_cvt_pk_bf16_f32 v175, v158, v159
v_mfma_f32_16x16x32_bf16 v[140:143], v[216:219], a[120:123], v[140:143]
s_waitcnt lgkmcnt(2)
v_mfma_f32_16x16x32_bf16 v[128:131], v[220:223], a[28:31], v[128:131]
ds_read_b128 v[216:219], v234 offset:57344
v_mfma_f32_16x16x32_bf16 v[132:135], v[220:223], a[60:63], v[132:135]
v_mfma_f32_16x16x32_bf16 v[136:139], v[220:223], a[92:95], v[136:139]
v_mfma_f32_16x16x32_bf16 v[140:143], v[220:223], a[124:127], v[140:143]
s_waitcnt lgkmcnt(2)
v_mfma_f32_16x16x32_bf16 v[144:147], v[208:211], a[0:3], v[192:195]
ds_read_b128 v[220:223], v235 offset:57344
v_mfma_f32_16x16x32_bf16 v[148:151], v[208:211], a[32:35], v[196:199]
v_mfma_f32_16x16x32_bf16 v[152:155], v[208:211], a[64:67], v[200:203]
v_mfma_f32_16x16x32_bf16 v[156:159], v[208:211], a[96:99], v[204:207]
s_waitcnt lgkmcnt(2)
v_mfma_f32_16x16x32_bf16 v[144:147], v[212:215], a[4:7], v[144:147]
ds_read_b128 v[208:211], v232 offset:57600
v_mfma_f32_16x16x32_bf16 v[148:151], v[212:215], a[36:39], v[148:151]
v_exp_f32 v128, v128
v_mfma_f32_16x16x32_bf16 v[152:155], v[212:215], a[68:71], v[152:155]
v_add_f32 v248, v248, v128
v_mfma_f32_16x16x32_bf16 v[156:159], v[212:215], a[100:103], v[156:159]
s_waitcnt lgkmcnt(2)
v_mfma_f32_16x16x32_bf16 v[144:147], v[216:219], a[8:11], v[144:147]
ds_read_b128 v[212:215], v233 offset:57600
v_mfma_f32_16x16x32_bf16 v[148:151], v[216:219], a[40:43], v[148:151]
v_exp_f32 v129, v129
v_mfma_f32_16x16x32_bf16 v[152:155], v[216:219], a[72:75], v[152:155]
v_add_f32 v248, v248, v129
v_cvt_pk_bf16_f32 v176, v128, v129
v_mfma_f32_16x16x32_bf16 v[156:159], v[216:219], a[104:107], v[156:159]
s_waitcnt lgkmcnt(2)
v_mfma_f32_16x16x32_bf16 v[144:147], v[220:223], a[12:15], v[144:147]
ds_read_b128 v[216:219], v234 offset:57600
v_mfma_f32_16x16x32_bf16 v[148:151], v[220:223], a[44:47], v[148:151]
v_exp_f32 v130, v130
v_mfma_f32_16x16x32_bf16 v[152:155], v[220:223], a[76:79], v[152:155]
v_add_f32 v248, v248, v130
v_mfma_f32_16x16x32_bf16 v[156:159], v[220:223], a[108:111], v[156:159]
s_waitcnt lgkmcnt(2)
v_mfma_f32_16x16x32_bf16 v[144:147], v[208:211], a[16:19], v[144:147]
ds_read_b128 v[220:223], v235 offset:57600
v_mfma_f32_16x16x32_bf16 v[148:151], v[208:211], a[48:51], v[148:151]
buffer_load_dwordx4 v[192:195], v246, s[32:35], 0 offen offset:0
v_exp_f32 v131, v131
v_mfma_f32_16x16x32_bf16 v[152:155], v[208:211], a[80:83], v[152:155]
v_add_f32 v248, v248, v131
v_cvt_pk_bf16_f32 v177, v130, v131
v_mfma_f32_16x16x32_bf16 v[156:159], v[208:211], a[112:115], v[156:159]
s_waitcnt lgkmcnt(2)
v_mfma_f32_16x16x32_bf16 v[144:147], v[212:215], a[20:23], v[144:147]
ds_read_b64_tr_b16 v[208:209], v236 offset:32768
ds_read_b64_tr_b16 v[210:211], v236 offset:40960
v_mfma_f32_16x16x32_bf16 v[148:151], v[212:215], a[52:55], v[148:151]
buffer_load_dwordx4 v[196:199], v246, s[32:35], 0 offen offset:512
v_exp_f32 v132, v132
v_mfma_f32_16x16x32_bf16 v[152:155], v[212:215], a[84:87], v[152:155]
v_add_f32 v249, v249, v132
v_mfma_f32_16x16x32_bf16 v[156:159], v[212:215], a[116:119], v[156:159]
s_waitcnt lgkmcnt(3)
v_mfma_f32_16x16x32_bf16 v[144:147], v[216:219], a[24:27], v[144:147]
ds_read_b64_tr_b16 v[212:213], v237 offset:32768
ds_read_b64_tr_b16 v[214:215], v237 offset:40960
v_mfma_f32_16x16x32_bf16 v[148:151], v[216:219], a[56:59], v[148:151]
buffer_load_dwordx4 v[200:203], v246, s[32:35], 0 offen offset:1024
v_exp_f32 v133, v133
v_mfma_f32_16x16x32_bf16 v[152:155], v[216:219], a[88:91], v[152:155]
v_add_f32 v249, v249, v133
v_cvt_pk_bf16_f32 v180, v132, v133
v_mfma_f32_16x16x32_bf16 v[156:159], v[216:219], a[120:123], v[156:159]
s_waitcnt lgkmcnt(4)
v_mfma_f32_16x16x32_bf16 v[144:147], v[220:223], a[28:31], v[144:147]
ds_read_b64_tr_b16 v[216:217], v238 offset:32768
ds_read_b64_tr_b16 v[218:219], v238 offset:40960
v_mfma_f32_16x16x32_bf16 v[148:151], v[220:223], a[60:63], v[148:151]
buffer_load_dwordx4 v[204:207], v246, s[32:35], 0 offen offset:1536
v_exp_f32 v134, v134
v_mfma_f32_16x16x32_bf16 v[152:155], v[220:223], a[92:95], v[152:155]
v_add_f32 v249, v249, v134
v_mfma_f32_16x16x32_bf16 v[156:159], v[220:223], a[124:127], v[156:159]
s_waitcnt lgkmcnt(4)
v_mfma_f32_16x16x32_bf16 v[0:3], v[208:211], v[160:163], v[0:3]
ds_read_b64_tr_b16 v[220:221], v239 offset:32768
ds_read_b64_tr_b16 v[222:223], v239 offset:40960
v_mfma_f32_16x16x32_bf16 v[4:7], v[208:211], v[164:167], v[4:7]
buffer_load_dwordx4 v[232:235], v246, s[32:35], 0 offen offset:2048
v_exp_f32 v135, v135
v_mfma_f32_16x16x32_bf16 a[128:131], v[208:211], v[168:171], a[128:131]
v_add_f32 v249, v249, v135
v_cvt_pk_bf16_f32 v181, v134, v135
v_mfma_f32_16x16x32_bf16 a[132:135], v[208:211], v[172:175], a[132:135]
s_lshl_b32 s66, s48, 16
s_add_u32 s66, s66, 8192
buffer_load_dwordx4 a[0:3], v247, s[12:15], s66 offen offset:0 sc1
s_waitcnt lgkmcnt(4)
v_mfma_f32_16x16x32_bf16 v[8:11], v[212:215], v[160:163], v[8:11]
ds_read_b64_tr_b16 v[208:209], v240 offset:32768
ds_read_b64_tr_b16 v[210:211], v240 offset:40960
v_mfma_f32_16x16x32_bf16 v[12:15], v[212:215], v[164:167], v[12:15]
v_exp_f32 v136, v136
v_mfma_f32_16x16x32_bf16 a[136:139], v[212:215], v[168:171], a[136:139]
s_lshl_b32 s67, s48, 16
s_add_u32 s67, s67, 24576
buffer_load_dwordx4 a[32:35], v247, s[12:15], s67 offen offset:0 sc1
v_add_f32 v250, v250, v136
v_mfma_f32_16x16x32_bf16 a[140:143], v[212:215], v[172:175], a[140:143]
s_waitcnt lgkmcnt(4)
v_mfma_f32_16x16x32_bf16 v[16:19], v[216:219], v[160:163], v[16:19]
ds_read_b64_tr_b16 v[212:213], v241 offset:32768
ds_read_b64_tr_b16 v[214:215], v241 offset:40960
v_mfma_f32_16x16x32_bf16 v[20:23], v[216:219], v[164:167], v[20:23]
s_lshl_b32 s68, s48, 16
s_add_u32 s68, s68, 40960
buffer_load_dwordx4 a[64:67], v247, s[12:15], s68 offen offset:0 sc1
v_exp_f32 v137, v137
v_mfma_f32_16x16x32_bf16 a[144:147], v[216:219], v[168:171], a[144:147]
v_add_f32 v250, v250, v137
v_cvt_pk_bf16_f32 v184, v136, v137
v_mfma_f32_16x16x32_bf16 a[148:151], v[216:219], v[172:175], a[148:151]
s_waitcnt lgkmcnt(4)
v_mfma_f32_16x16x32_bf16 v[24:27], v[220:223], v[160:163], v[24:27]
s_lshl_b32 s69, s48, 16
s_add_u32 s69, s69, 57344
buffer_load_dwordx4 a[96:99], v247, s[12:15], s69 offen offset:0 sc1
ds_read_b64_tr_b16 v[216:217], v242 offset:32768
ds_read_b64_tr_b16 v[218:219], v242 offset:40960
v_mfma_f32_16x16x32_bf16 v[28:31], v[220:223], v[164:167], v[28:31]
v_exp_f32 v138, v138
v_mfma_f32_16x16x32_bf16 a[152:155], v[220:223], v[168:171], a[152:155]
v_add_f32 v250, v250, v138
v_mfma_f32_16x16x32_bf16 a[156:159], v[220:223], v[172:175], a[156:159]
buffer_load_dwordx4 a[4:7], v247, s[12:15], s66 offen offset:1024 sc1
s_waitcnt lgkmcnt(4)
v_mfma_f32_16x16x32_bf16 v[32:35], v[208:211], v[160:163], v[32:35]
ds_read_b64_tr_b16 v[220:221], v243 offset:32768
ds_read_b64_tr_b16 v[222:223], v243 offset:40960
v_mfma_f32_16x16x32_bf16 v[36:39], v[208:211], v[164:167], v[36:39]
v_exp_f32 v139, v139
v_mfma_f32_16x16x32_bf16 a[160:163], v[208:211], v[168:171], a[160:163]
buffer_load_dwordx4 a[36:39], v247, s[12:15], s67 offen offset:1024 sc1
v_add_f32 v250, v250, v139
v_cvt_pk_bf16_f32 v185, v138, v139
v_mfma_f32_16x16x32_bf16 a[164:167], v[208:211], v[172:175], a[164:167]
s_waitcnt lgkmcnt(4)
v_mfma_f32_16x16x32_bf16 v[40:43], v[212:215], v[160:163], v[40:43]
ds_read_b64_tr_b16 v[208:209], v236 offset:33024
ds_read_b64_tr_b16 v[210:211], v236 offset:41216
v_mfma_f32_16x16x32_bf16 v[44:47], v[212:215], v[164:167], v[44:47]
buffer_load_dwordx4 a[68:71], v247, s[12:15], s68 offen offset:1024 sc1
v_exp_f32 v140, v140
v_mfma_f32_16x16x32_bf16 a[168:171], v[212:215], v[168:171], a[168:171]
v_add_f32 v251, v251, v140
v_mfma_f32_16x16x32_bf16 a[172:175], v[212:215], v[172:175], a[172:175]
s_waitcnt lgkmcnt(4)
v_mfma_f32_16x16x32_bf16 v[48:51], v[216:219], v[160:163], v[48:51]
buffer_load_dwordx4 a[100:103], v247, s[12:15], s69 offen offset:1024 sc1
ds_read_b64_tr_b16 v[212:213], v237 offset:33024
ds_read_b64_tr_b16 v[214:215], v237 offset:41216
v_mfma_f32_16x16x32_bf16 v[52:55], v[216:219], v[164:167], v[52:55]
v_exp_f32 v141, v141
v_mfma_f32_16x16x32_bf16 a[176:179], v[216:219], v[168:171], a[176:179]
v_add_f32 v251, v251, v141
v_cvt_pk_bf16_f32 v188, v140, v141
v_mfma_f32_16x16x32_bf16 a[180:183], v[216:219], v[172:175], a[180:183]
buffer_load_dwordx4 a[8:11], v247, s[12:15], s66 offen offset:2048 sc1
s_waitcnt lgkmcnt(4)
v_mfma_f32_16x16x32_bf16 v[56:59], v[220:223], v[160:163], v[56:59]
ds_read_b64_tr_b16 v[216:217], v238 offset:33024
ds_read_b64_tr_b16 v[218:219], v238 offset:41216
v_mfma_f32_16x16x32_bf16 v[60:63], v[220:223], v[164:167], v[60:63]
v_exp_f32 v142, v142
v_exp_f32 v144, v144
v_mfma_f32_16x16x32_bf16 a[184:187], v[220:223], v[168:171], a[184:187]
buffer_load_dwordx4 a[40:43], v247, s[12:15], s67 offen offset:2048 sc1
v_add_f32 v251, v251, v142
v_add_f32 v248, v248, v144
v_mfma_f32_16x16x32_bf16 a[188:191], v[220:223], v[172:175], a[188:191]
s_waitcnt lgkmcnt(4)
v_mfma_f32_16x16x32_bf16 v[64:67], v[208:211], v[160:163], v[64:67]
ds_read_b64_tr_b16 v[220:221], v239 offset:33024
ds_read_b64_tr_b16 v[222:223], v239 offset:41216
v_mfma_f32_16x16x32_bf16 v[68:71], v[208:211], v[164:167], v[68:71]
buffer_load_dwordx4 a[72:75], v247, s[12:15], s68 offen offset:2048 sc1
v_exp_f32 v143, v143
v_exp_f32 v145, v145
v_mfma_f32_16x16x32_bf16 a[192:195], v[208:211], v[168:171], a[192:195]
v_add_f32 v251, v251, v143
v_add_f32 v248, v248, v145
v_cvt_pk_bf16_f32 v189, v142, v143
v_cvt_pk_bf16_f32 v178, v144, v145
v_mfma_f32_16x16x32_bf16 a[196:199], v[208:211], v[172:175], a[196:199]
s_waitcnt lgkmcnt(4)
v_mfma_f32_16x16x32_bf16 v[72:75], v[212:215], v[160:163], v[72:75]
buffer_load_dwordx4 a[104:107], v247, s[12:15], s69 offen offset:2048 sc1
ds_read_b64_tr_b16 v[208:209], v240 offset:33024
ds_read_b64_tr_b16 v[210:211], v240 offset:41216
v_mfma_f32_16x16x32_bf16 v[76:79], v[212:215], v[164:167], v[76:79]
v_exp_f32 v146, v146
v_mfma_f32_16x16x32_bf16 a[200:203], v[212:215], v[168:171], a[200:203]
v_add_f32 v248, v248, v146
v_mfma_f32_16x16x32_bf16 a[204:207], v[212:215], v[172:175], a[204:207]
buffer_load_dwordx4 a[12:15], v247, s[12:15], s66 offen offset:3072 sc1
s_waitcnt lgkmcnt(4)
v_mfma_f32_16x16x32_bf16 v[80:83], v[216:219], v[160:163], v[80:83]
ds_read_b64_tr_b16 v[212:213], v241 offset:33024
ds_read_b64_tr_b16 v[214:215], v241 offset:41216
v_mfma_f32_16x16x32_bf16 v[84:87], v[216:219], v[164:167], v[84:87]
v_exp_f32 v147, v147
v_mfma_f32_16x16x32_bf16 a[208:211], v[216:219], v[168:171], a[208:211]
buffer_load_dwordx4 a[44:47], v247, s[12:15], s67 offen offset:3072 sc1
v_add_f32 v248, v248, v147
v_cvt_pk_bf16_f32 v179, v146, v147
v_mfma_f32_16x16x32_bf16 a[212:215], v[216:219], v[172:175], a[212:215]
s_waitcnt lgkmcnt(4)
v_mfma_f32_16x16x32_bf16 v[88:91], v[220:223], v[160:163], v[88:91]
ds_read_b64_tr_b16 v[216:217], v242 offset:33024
ds_read_b64_tr_b16 v[218:219], v242 offset:41216
v_mfma_f32_16x16x32_bf16 v[92:95], v[220:223], v[164:167], v[92:95]
buffer_load_dwordx4 a[76:79], v247, s[12:15], s68 offen offset:3072 sc1
v_exp_f32 v148, v148
v_mfma_f32_16x16x32_bf16 a[216:219], v[220:223], v[168:171], a[216:219]
v_add_f32 v249, v249, v148
v_mfma_f32_16x16x32_bf16 a[220:223], v[220:223], v[172:175], a[220:223]
s_waitcnt lgkmcnt(4)
v_mfma_f32_16x16x32_bf16 v[96:99], v[208:211], v[160:163], v[96:99]
buffer_load_dwordx4 a[108:111], v247, s[12:15], s69 offen offset:3072 sc1
ds_read_b64_tr_b16 v[220:221], v243 offset:33024
ds_read_b64_tr_b16 v[222:223], v243 offset:41216
v_mfma_f32_16x16x32_bf16 v[100:103], v[208:211], v[164:167], v[100:103]
v_exp_f32 v149, v149
v_mfma_f32_16x16x32_bf16 a[224:227], v[208:211], v[168:171], a[224:227]
v_add_f32 v249, v249, v149
v_cvt_pk_bf16_f32 v182, v148, v149
v_mfma_f32_16x16x32_bf16 a[228:231], v[208:211], v[172:175], a[228:231]
s_lshl_b32 s66, s48, 16
s_add_u32 s66, s66, 12288
buffer_load_dwordx4 a[16:19], v247, s[12:15], s66 offen offset:0 sc1
s_waitcnt lgkmcnt(4)
v_mfma_f32_16x16x32_bf16 v[104:107], v[212:215], v[160:163], v[104:107]
v_mfma_f32_16x16x32_bf16 v[108:111], v[212:215], v[164:167], v[108:111]
v_exp_f32 v150, v150
v_mfma_f32_16x16x32_bf16 a[232:235], v[212:215], v[168:171], a[232:235]
s_lshl_b32 s67, s48, 16
s_add_u32 s67, s67, 28672
buffer_load_dwordx4 a[48:51], v247, s[12:15], s67 offen offset:0 sc1
v_add_f32 v249, v249, v150
v_mfma_f32_16x16x32_bf16 a[236:239], v[212:215], v[172:175], a[236:239]
s_waitcnt lgkmcnt(2)
v_mfma_f32_16x16x32_bf16 v[112:115], v[216:219], v[160:163], v[112:115]
v_mfma_f32_16x16x32_bf16 v[116:119], v[216:219], v[164:167], v[116:119]
s_lshl_b32 s68, s48, 16
s_add_u32 s68, s68, 45056
buffer_load_dwordx4 a[80:83], v247, s[12:15], s68 offen offset:0 sc1
v_exp_f32 v151, v151
v_mfma_f32_16x16x32_bf16 a[240:243], v[216:219], v[168:171], a[240:243]
v_add_f32 v249, v249, v151
v_cvt_pk_bf16_f32 v183, v150, v151
v_mfma_f32_16x16x32_bf16 a[244:247], v[216:219], v[172:175], a[244:247]
s_waitcnt lgkmcnt(0)
v_mfma_f32_16x16x32_bf16 v[120:123], v[220:223], v[160:163], v[120:123]
s_lshl_b32 s69, s48, 16
s_add_u32 s69, s69, 61440
buffer_load_dwordx4 a[112:115], v247, s[12:15], s69 offen offset:0 sc1
v_mfma_f32_16x16x32_bf16 v[124:127], v[220:223], v[164:167], v[124:127]
v_exp_f32 v152, v152
v_mfma_f32_16x16x32_bf16 a[248:251], v[220:223], v[168:171], a[248:251]
v_add_f32 v250, v250, v152
v_mfma_f32_16x16x32_bf16 a[252:255], v[220:223], v[172:175], a[252:255]
buffer_load_dwordx4 a[20:23], v247, s[12:15], s66 offen offset:1024 sc1
v_exp_f32 v153, v153
s_nop 0
v_add_f32 v250, v250, v153
buffer_load_dwordx4 a[52:55], v247, s[12:15], s67 offen offset:1024 sc1
v_cvt_pk_bf16_f32 v186, v152, v153
v_exp_f32 v154, v154
s_nop 0
v_add_f32 v250, v250, v154
v_exp_f32 v155, v155
s_nop 0
v_add_f32 v250, v250, v155
s_barrier
v_cvt_pk_bf16_f32 v187, v154, v155
v_exp_f32 v156, v156
s_nop 0
v_add_f32 v251, v251, v156
buffer_load_dwordx4 a[84:87], v247, s[12:15], s68 offen offset:1024 sc1
v_exp_f32 v157, v157
s_nop 0
v_add_f32 v251, v251, v157
v_cvt_pk_bf16_f32 v190, v156, v157
v_exp_f32 v158, v158
s_nop 0
v_add_f32 v251, v251, v158
v_exp_f32 v159, v159
s_nop 0
v_add_f32 v251, v251, v159
v_cvt_pk_bf16_f32 v191, v158, v159
buffer_load_dwordx4 a[116:119], v247, s[12:15], s69 offen offset:1024 sc1
ds_read_b64_tr_b16 v[208:209], v236 offset:49152
ds_read_b64_tr_b16 v[210:211], v236 offset:57344
ds_read_b64_tr_b16 v[212:213], v237 offset:49152
ds_read_b64_tr_b16 v[214:215], v237 offset:57344
ds_read_b64_tr_b16 v[216:217], v238 offset:49152
ds_read_b64_tr_b16 v[218:219], v238 offset:57344
s_waitcnt lgkmcnt(4)
v_mfma_f32_16x16x32_bf16 v[0:3], v[208:211], v[176:179], v[0:3]
ds_read_b64_tr_b16 v[220:221], v239 offset:49152
ds_read_b64_tr_b16 v[222:223], v239 offset:57344
v_mfma_f32_16x16x32_bf16 v[4:7], v[208:211], v[180:183], v[4:7]
buffer_load_dwordx4 a[24:27], v247, s[12:15], s66 offen offset:2048 sc1
v_mfma_f32_16x16x32_bf16 a[128:131], v[208:211], v[184:187], a[128:131]
v_mfma_f32_16x16x32_bf16 a[132:135], v[208:211], v[188:191], a[132:135]
s_waitcnt lgkmcnt(4)
v_mfma_f32_16x16x32_bf16 v[8:11], v[212:215], v[176:179], v[8:11]
ds_read_b64_tr_b16 v[208:209], v240 offset:49152
ds_read_b64_tr_b16 v[210:211], v240 offset:57344
v_mfma_f32_16x16x32_bf16 v[12:15], v[212:215], v[180:183], v[12:15]
buffer_load_dwordx4 a[56:59], v247, s[12:15], s67 offen offset:2048 sc1
v_mfma_f32_16x16x32_bf16 a[136:139], v[212:215], v[184:187], a[136:139]
v_mfma_f32_16x16x32_bf16 a[140:143], v[212:215], v[188:191], a[140:143]
s_waitcnt lgkmcnt(4)
v_mfma_f32_16x16x32_bf16 v[16:19], v[216:219], v[176:179], v[16:19]
ds_read_b64_tr_b16 v[212:213], v241 offset:49152
ds_read_b64_tr_b16 v[214:215], v241 offset:57344
v_mfma_f32_16x16x32_bf16 v[20:23], v[216:219], v[180:183], v[20:23]
buffer_load_dwordx4 a[88:91], v247, s[12:15], s68 offen offset:2048 sc1
v_mfma_f32_16x16x32_bf16 a[144:147], v[216:219], v[184:187], a[144:147]
v_mfma_f32_16x16x32_bf16 a[148:151], v[216:219], v[188:191], a[148:151]
s_waitcnt lgkmcnt(4)
v_mfma_f32_16x16x32_bf16 v[24:27], v[220:223], v[176:179], v[24:27]
ds_read_b64_tr_b16 v[216:217], v242 offset:49152
ds_read_b64_tr_b16 v[218:219], v242 offset:57344
v_mfma_f32_16x16x32_bf16 v[28:31], v[220:223], v[180:183], v[28:31]
buffer_load_dwordx4 a[120:123], v247, s[12:15], s69 offen offset:2048 sc1
ds_write_b128 v254, a[128:131] offset:0
v_mfma_f32_16x16x32_bf16 a[152:155], v[220:223], v[184:187], a[152:155]
v_mfma_f32_16x16x32_bf16 a[156:159], v[220:223], v[188:191], a[156:159]
ds_write_b128 v254, a[132:135] offset:1024
s_waitcnt lgkmcnt(4)
v_mfma_f32_16x16x32_bf16 v[32:35], v[208:211], v[176:179], v[32:35]
ds_read_b64_tr_b16 v[220:221], v243 offset:49152
ds_read_b64_tr_b16 v[222:223], v243 offset:57344
v_mfma_f32_16x16x32_bf16 v[36:39], v[208:211], v[180:183], v[36:39]
buffer_load_dwordx4 a[28:31], v247, s[12:15], s66 offen offset:3072 sc1
ds_write_b128 v254, a[136:139] offset:2048
v_mfma_f32_16x16x32_bf16 a[160:163], v[208:211], v[184:187], a[160:163]
v_mfma_f32_16x16x32_bf16 a[164:167], v[208:211], v[188:191], a[164:167]
ds_write_b128 v254, a[140:143] offset:3072
s_waitcnt lgkmcnt(4)
v_mfma_f32_16x16x32_bf16 v[40:43], v[212:215], v[176:179], v[40:43]
ds_read_b64_tr_b16 v[208:209], v236 offset:49408
ds_read_b64_tr_b16 v[210:211], v236 offset:57600
v_mfma_f32_16x16x32_bf16 v[44:47], v[212:215], v[180:183], v[44:47]
buffer_load_dwordx4 a[60:63], v247, s[12:15], s67 offen offset:3072 sc1
ds_write_b128 v254, a[144:147] offset:4096
v_mfma_f32_16x16x32_bf16 a[168:171], v[212:215], v[184:187], a[168:171]
v_mfma_f32_16x16x32_bf16 a[172:175], v[212:215], v[188:191], a[172:175]
ds_write_b128 v254, a[148:151] offset:5120
s_waitcnt lgkmcnt(4)
v_mfma_f32_16x16x32_bf16 v[48:51], v[216:219], v[176:179], v[48:51]
ds_read_b64_tr_b16 v[212:213], v237 offset:49408
ds_read_b64_tr_b16 v[214:215], v237 offset:57600
v_mfma_f32_16x16x32_bf16 v[52:55], v[216:219], v[180:183], v[52:55]
buffer_load_dwordx4 a[92:95], v247, s[12:15], s68 offen offset:3072 sc1
ds_write_b128 v254, a[152:155] offset:6144
v_mfma_f32_16x16x32_bf16 a[176:179], v[216:219], v[184:187], a[176:179]
v_mfma_f32_16x16x32_bf16 a[180:183], v[216:219], v[188:191], a[180:183]
ds_write_b128 v254, a[156:159] offset:7168
s_waitcnt lgkmcnt(4)
v_mfma_f32_16x16x32_bf16 v[56:59], v[220:223], v[176:179], v[56:59]
ds_read_b64_tr_b16 v[216:217], v238 offset:49408
ds_read_b64_tr_b16 v[218:219], v238 offset:57600
v_mfma_f32_16x16x32_bf16 v[60:63], v[220:223], v[180:183], v[60:63]
buffer_load_dwordx4 a[124:127], v247, s[12:15], s69 offen offset:3072 sc1
ds_write_b128 v254, a[160:163] offset:8192
v_mfma_f32_16x16x32_bf16 a[184:187], v[220:223], v[184:187], a[184:187]
v_mfma_f32_16x16x32_bf16 a[188:191], v[220:223], v[188:191], a[188:191]
ds_write_b128 v254, a[164:167] offset:9216
s_waitcnt lgkmcnt(4)
v_mfma_f32_16x16x32_bf16 v[64:67], v[208:211], v[176:179], v[64:67]
ds_read_b64_tr_b16 v[220:221], v239 offset:49408
ds_read_b64_tr_b16 v[222:223], v239 offset:57600
v_mfma_f32_16x16x32_bf16 v[68:71], v[208:211], v[180:183], v[68:71]
buffer_load_dwordx4 v[128:131], v245, s[24:27], 0 offen offset:0 sc1
ds_write_b128 v254, a[168:171] offset:10240
v_mfma_f32_16x16x32_bf16 a[192:195], v[208:211], v[184:187], a[192:195]
v_mfma_f32_16x16x32_bf16 a[196:199], v[208:211], v[188:191], a[196:199]
ds_write_b128 v254, a[172:175] offset:11264
s_waitcnt lgkmcnt(4)
v_mfma_f32_16x16x32_bf16 v[72:75], v[212:215], v[176:179], v[72:75]
ds_read_b64_tr_b16 v[208:209], v240 offset:49408
ds_read_b64_tr_b16 v[210:211], v240 offset:57600
v_mfma_f32_16x16x32_bf16 v[76:79], v[212:215], v[180:183], v[76:79]
buffer_load_dwordx4 v[132:135], v245, s[24:27], 0 offen offset:512 sc1
ds_write_b128 v254, a[176:179] offset:12288
v_mfma_f32_16x16x32_bf16 a[200:203], v[212:215], v[184:187], a[200:203]
v_mfma_f32_16x16x32_bf16 a[204:207], v[212:215], v[188:191], a[204:207]
ds_write_b128 v254, a[180:183] offset:13312
s_waitcnt lgkmcnt(4)
v_mfma_f32_16x16x32_bf16 v[80:83], v[216:219], v[176:179], v[80:83]
ds_read_b64_tr_b16 v[212:213], v241 offset:49408
ds_read_b64_tr_b16 v[214:215], v241 offset:57600
v_mfma_f32_16x16x32_bf16 v[84:87], v[216:219], v[180:183], v[84:87]
buffer_load_dwordx4 v[136:139], v244, s[24:27], 0 offen offset:0 sc1
ds_write_b128 v254, a[184:187] offset:14336
v_mfma_f32_16x16x32_bf16 a[208:211], v[216:219], v[184:187], a[208:211]
v_mfma_f32_16x16x32_bf16 a[212:215], v[216:219], v[188:191], a[212:215]
ds_write_b128 v254, a[188:191] offset:15360
s_waitcnt lgkmcnt(4)
v_mfma_f32_16x16x32_bf16 v[88:91], v[220:223], v[176:179], v[88:91]
ds_read_b64_tr_b16 v[216:217], v242 offset:49408
ds_read_b64_tr_b16 v[218:219], v242 offset:57600
v_mfma_f32_16x16x32_bf16 v[92:95], v[220:223], v[180:183], v[92:95]
buffer_load_dwordx4 v[140:143], v244, s[24:27], 0 offen offset:512 sc1
ds_write_b128 v255, a[192:195] offset:0
v_mfma_f32_16x16x32_bf16 a[216:219], v[220:223], v[184:187], a[216:219]
v_mfma_f32_16x16x32_bf16 a[220:223], v[220:223], v[188:191], a[220:223]
ds_write_b128 v255, a[196:199] offset:1024
s_waitcnt lgkmcnt(4)
v_mfma_f32_16x16x32_bf16 v[96:99], v[208:211], v[176:179], v[96:99]
ds_read_b64_tr_b16 v[220:221], v243 offset:49408
ds_read_b64_tr_b16 v[222:223], v243 offset:57600
v_mfma_f32_16x16x32_bf16 v[100:103], v[208:211], v[180:183], v[100:103]
buffer_load_dwordx4 v[144:147], v244, s[24:27], 0 offen offset:1024 sc1
ds_write_b128 v255, a[200:203] offset:2048
v_mfma_f32_16x16x32_bf16 a[224:227], v[208:211], v[184:187], a[224:227]
v_mfma_f32_16x16x32_bf16 a[228:231], v[208:211], v[188:191], a[228:231]
ds_write_b128 v255, a[204:207] offset:3072
s_waitcnt lgkmcnt(4)
v_mfma_f32_16x16x32_bf16 v[104:107], v[212:215], v[176:179], v[104:107]
v_mfma_f32_16x16x32_bf16 v[108:111], v[212:215], v[180:183], v[108:111]
buffer_load_dwordx4 v[148:151], v244, s[24:27], 0 offen offset:1536 sc1
ds_write_b128 v255, a[208:211] offset:4096
v_mfma_f32_16x16x32_bf16 a[232:235], v[212:215], v[184:187], a[232:235]
v_mfma_f32_16x16x32_bf16 a[236:239], v[212:215], v[188:191], a[236:239]
ds_write_b128 v255, a[212:215] offset:5120
s_waitcnt lgkmcnt(2)
v_mfma_f32_16x16x32_bf16 v[112:115], v[216:219], v[176:179], v[112:115]
v_mfma_f32_16x16x32_bf16 v[116:119], v[216:219], v[180:183], v[116:119]
buffer_load_dwordx4 v[152:155], v244, s[24:27], 0 offen offset:2048 sc1
ds_write_b128 v255, a[216:219] offset:6144
v_mfma_f32_16x16x32_bf16 a[240:243], v[216:219], v[184:187], a[240:243]
v_mfma_f32_16x16x32_bf16 a[244:247], v[216:219], v[188:191], a[244:247]
ds_write_b128 v255, a[220:223] offset:7168
s_waitcnt lgkmcnt(0)
v_mfma_f32_16x16x32_bf16 v[120:123], v[220:223], v[176:179], v[120:123]
v_mfma_f32_16x16x32_bf16 v[124:127], v[220:223], v[180:183], v[124:127]
buffer_load_dwordx4 v[156:159], v244, s[24:27], 0 offen offset:2560 sc1
ds_write_b128 v255, a[224:227] offset:8192
v_mfma_f32_16x16x32_bf16 a[248:251], v[220:223], v[184:187], a[248:251]
v_mfma_f32_16x16x32_bf16 a[252:255], v[220:223], v[188:191], a[252:255]
ds_write_b128 v255, a[228:231] offset:9216
buffer_load_dwordx4 v[160:163], v244, s[28:31], 0 offen offset:0 sc1
buffer_load_dwordx4 v[164:167], v244, s[28:31], 0 offen offset:512 sc1
buffer_load_dwordx4 v[168:171], v244, s[28:31], 0 offen offset:1024 sc1
buffer_load_dwordx4 v[172:175], v244, s[28:31], 0 offen offset:1536 sc1
v_mov_b32 v236, v248
v_mov_b32 v237, v249
v_mov_b32 v238, v250
v_mov_b32 v239, v251
s_nop 1
v_permlane16_swap_b32 v248, v236
v_permlane16_swap_b32 v249, v237
v_permlane16_swap_b32 v250, v238
v_permlane16_swap_b32 v251, v239
s_nop 1
v_add_f32 v248, v248, v236
v_add_f32 v249, v249, v237
v_add_f32 v250, v250, v238
v_add_f32 v251, v251, v239
v_mov_b32 v236, v248
v_mov_b32 v237, v249
v_mov_b32 v238, v250
v_mov_b32 v239, v251
s_nop 1
v_permlane32_swap_b32 v248, v236
v_permlane32_swap_b32 v249, v237
v_permlane32_swap_b32 v250, v238
v_permlane32_swap_b32 v251, v239
s_nop 1
v_add_f32 v248, v248, v236
v_add_f32 v249, v249, v237
v_add_f32 v250, v250, v238
v_add_f32 v251, v251, v239
s_nop 7
ds_write_b128 v255, a[232:235] offset:10240
ds_write_b128 v255, a[236:239] offset:11264
ds_write_b128 v255, a[240:243] offset:12288
ds_write_b128 v255, a[244:247] offset:13312
ds_write_b128 v255, a[248:251] offset:14336
ds_write_b128 v255, a[252:255] offset:15360
K2_POSTB:
s_waitcnt lgkmcnt(0)
s_barrier
s_lshl_b32 s60, s65, 7
s_lshl_b32 s61, s64, 2
s_add_u32 s60, s60, s61
s_add_u32 s60, s60, 16
buffer_load_dword v241, off, s[44:47], s60 sc1
v_lshrrev_b32 v240, 1, v247
s_lshl_b32 s60, s48, 10
s_add_u32 s60, s60, 114688
v_add_u32 v240, s60, v240
ds_write_b64 v240, v[250:251]
v_max_f32 v238, v248, v249
v_max3_f32 v238, v238, v250, v251
v_add_f32 v239, v248, v249
v_add_f32 v239, v239, v250
v_add_f32 v239, v239, v251
v_max_f32 v238, v238, v239
s_mov_b32 s57, 0x71800000
v_cmp_ngt_f32 vcc, s57, v239
s_nop 1
s_cmp_lg_u64 vcc, 0
s_cselect_b32 s57, 1, 0
v_mov_b32 v238, s57
s_lshl_b32 s57, s48, 2
s_add_u32 s57, s57, 122880
v_mov_b32 v239, s57
ds_write_b32 v239, v238
v_xor_b32 v254, 0x10000, v254
s_mov_b32 s57, 0x4000
s_cmp_eq_u32 s49, 1
s_cselect_b32 s60, s57, 0x10000
v_xor_b32 v255, s60, v255
ds_read_b128 v[176:179], v254 offset:0
ds_read_b128 v[180:183], v254 offset:1024
ds_read_b128 v[184:187], v254 offset:2048
ds_read_b128 v[188:191], v254 offset:3072
ds_read_b128 v[208:211], v254 offset:4096
ds_read_b128 v[212:215], v254 offset:5120
ds_read_b128 v[216:219], v254 offset:6144
ds_read_b128 v[220:223], v254 offset:7168
s_waitcnt lgkmcnt(4)
v_pk_add_f32 v[0:1], v[0:1], v[176:177]
v_pk_add_f32 v[2:3], v[2:3], v[178:179]
v_pk_add_f32 v[4:5], v[4:5], v[180:181]
v_pk_add_f32 v[6:7], v[6:7], v[182:183]
v_pk_add_f32 v[8:9], v[8:9], v[184:185]
v_pk_add_f32 v[10:11], v[10:11], v[186:187]
v_pk_add_f32 v[12:13], v[12:13], v[188:189]
v_pk_add_f32 v[14:15], v[14:15], v[190:191]
ds_read_b128 v[176:179], v254 offset:8192
ds_read_b128 v[180:183], v254 offset:9216
ds_read_b128 v[184:187], v254 offset:10240
ds_read_b128 v[188:191], v254 offset:11264
s_lshl_b32 s66, s48, 16
s_add_u32 s66, s66, 0
buffer_load_dwordx4 a[128:131], v247, s[12:15], s66 offen offset:0 sc1
s_waitcnt lgkmcnt(4)
v_pk_add_f32 v[16:17], v[16:17], v[208:209]
v_pk_add_f32 v[18:19], v[18:19], v[210:211]
v_pk_add_f32 v[20:21], v[20:21], v[212:213]
v_pk_add_f32 v[22:23], v[22:23], v[214:215]
v_pk_add_f32 v[24:25], v[24:25], v[216:217]
v_pk_add_f32 v[26:27], v[26:27], v[218:219]
v_pk_add_f32 v[28:29], v[28:29], v[220:221]
v_pk_add_f32 v[30:31], v[30:31], v[222:223]
ds_read_b128 v[208:211], v254 offset:12288
ds_read_b128 v[212:215], v254 offset:13312
ds_read_b128 v[216:219], v254 offset:14336
ds_read_b128 v[220:223], v254 offset:15360
s_lshl_b32 s67, s48, 16
s_add_u32 s67, s67, 16384
buffer_load_dwordx4 a[160:163], v247, s[12:15], s67 offen offset:0 sc1
s_waitcnt lgkmcnt(4)
v_pk_add_f32 v[32:33], v[32:33], v[176:177]
v_pk_add_f32 v[34:35], v[34:35], v[178:179]
v_pk_add_f32 v[36:37], v[36:37], v[180:181]
v_pk_add_f32 v[38:39], v[38:39], v[182:183]
v_pk_add_f32 v[40:41], v[40:41], v[184:185]
v_pk_add_f32 v[42:43], v[42:43], v[186:187]
v_pk_add_f32 v[44:45], v[44:45], v[188:189]
v_pk_add_f32 v[46:47], v[46:47], v[190:191]
ds_read_b128 v[176:179], v255 offset:0
ds_read_b128 v[180:183], v255 offset:1024
ds_read_b128 v[184:187], v255 offset:2048
ds_read_b128 v[188:191], v255 offset:3072
s_lshl_b32 s68, s48, 16
s_add_u32 s68, s68, 32768
buffer_load_dwordx4 a[192:195], v247, s[12:15], s68 offen offset:0 sc1
s_waitcnt lgkmcnt(4)
v_pk_add_f32 v[48:49], v[48:49], v[208:209]
v_pk_add_f32 v[50:51], v[50:51], v[210:211]
v_pk_add_f32 v[52:53], v[52:53], v[212:213]
v_pk_add_f32 v[54:55], v[54:55], v[214:215]
v_pk_add_f32 v[56:57], v[56:57], v[216:217]
v_pk_add_f32 v[58:59], v[58:59], v[218:219]
v_pk_add_f32 v[60:61], v[60:61], v[220:221]
v_pk_add_f32 v[62:63], v[62:63], v[222:223]
ds_read_b128 v[208:211], v255 offset:4096
ds_read_b128 v[212:215], v255 offset:5120
ds_read_b128 v[216:219], v255 offset:6144
ds_read_b128 v[220:223], v255 offset:7168
s_lshl_b32 s69, s48, 16
s_add_u32 s69, s69, 49152
buffer_load_dwordx4 a[224:227], v247, s[12:15], s69 offen offset:0 sc1
s_waitcnt lgkmcnt(4)
v_pk_add_f32 v[64:65], v[64:65], v[176:177]
v_pk_add_f32 v[66:67], v[66:67], v[178:179]
v_pk_add_f32 v[68:69], v[68:69], v[180:181]
v_pk_add_f32 v[70:71], v[70:71], v[182:183]
v_pk_add_f32 v[72:73], v[72:73], v[184:185]
v_pk_add_f32 v[74:75], v[74:75], v[186:187]
v_pk_add_f32 v[76:77], v[76:77], v[188:189]
v_pk_add_f32 v[78:79], v[78:79], v[190:191]
ds_read_b128 v[176:179], v255 offset:8192
ds_read_b128 v[180:183], v255 offset:9216
ds_read_b128 v[184:187], v255 offset:10240
ds_read_b128 v[188:191], v255 offset:11264
buffer_load_dwordx4 a[132:135], v247, s[12:15], s66 offen offset:1024 sc1
s_waitcnt lgkmcnt(4)
v_pk_add_f32 v[80:81], v[80:81], v[208:209]
v_pk_add_f32 v[82:83], v[82:83], v[210:211]
v_pk_add_f32 v[84:85], v[84:85], v[212:213]
v_pk_add_f32 v[86:87], v[86:87], v[214:215]
v_pk_add_f32 v[88:89], v[88:89], v[216:217]
v_pk_add_f32 v[90:91], v[90:91], v[218:219]
v_pk_add_f32 v[92:93], v[92:93], v[220:221]
v_pk_add_f32 v[94:95], v[94:95], v[222:223]
ds_read_b128 v[208:211], v255 offset:12288
ds_read_b128 v[212:215], v255 offset:13312
ds_read_b128 v[216:219], v255 offset:14336
ds_read_b128 v[220:223], v255 offset:15360
buffer_load_dwordx4 a[164:167], v247, s[12:15], s67 offen offset:1024 sc1
s_waitcnt lgkmcnt(4)
v_pk_add_f32 v[96:97], v[96:97], v[176:177]
v_pk_add_f32 v[98:99], v[98:99], v[178:179]
v_pk_add_f32 v[100:101], v[100:101], v[180:181]
v_pk_add_f32 v[102:103], v[102:103], v[182:183]
v_pk_add_f32 v[104:105], v[104:105], v[184:185]
v_pk_add_f32 v[106:107], v[106:107], v[186:187]
v_pk_add_f32 v[108:109], v[108:109], v[188:189]
v_pk_add_f32 v[110:111], v[110:111], v[190:191]
buffer_load_dwordx4 a[196:199], v247, s[12:15], s68 offen offset:1024 sc1
s_waitcnt lgkmcnt(0)
v_pk_add_f32 v[112:113], v[112:113], v[208:209]
v_pk_add_f32 v[114:115], v[114:115], v[210:211]
v_pk_add_f32 v[116:117], v[116:117], v[212:213]
v_pk_add_f32 v[118:119], v[118:119], v[214:215]
v_pk_add_f32 v[120:121], v[120:121], v[216:217]
v_pk_add_f32 v[122:123], v[122:123], v[218:219]
v_pk_add_f32 v[124:125], v[124:125], v[220:221]
v_pk_add_f32 v[126:127], v[126:127], v[222:223]
buffer_load_dwordx4 a[228:231], v247, s[12:15], s69 offen offset:1024 sc1
s_barrier
v_xor_b32 v240, 0x800, v240
ds_read_b64 v[236:237], v240
v_mov_b32 v239, 122880
ds_read_b128 v[212:215], v239
v_cvt_pk_bf16_f32 v0, v0, v1
v_cvt_pk_bf16_f32 v1, v2, v3
v_cvt_pk_bf16_f32 v2, v8, v9
v_cvt_pk_bf16_f32 v3, v10, v11
v_cvt_pk_bf16_f32 v4, v4, v5
v_cvt_pk_bf16_f32 v5, v6, v7
v_cvt_pk_bf16_f32 v6, v12, v13
v_cvt_pk_bf16_f32 v7, v14, v15
v_cvt_pk_bf16_f32 v16, v16, v17
v_cvt_pk_bf16_f32 v17, v18, v19
v_cvt_pk_bf16_f32 v18, v24, v25
v_cvt_pk_bf16_f32 v19, v26, v27
v_cvt_pk_bf16_f32 v20, v20, v21
v_cvt_pk_bf16_f32 v21, v22, v23
v_cvt_pk_bf16_f32 v22, v28, v29
v_cvt_pk_bf16_f32 v23, v30, v31
v_cvt_pk_bf16_f32 v32, v32, v33
v_cvt_pk_bf16_f32 v33, v34, v35
v_cvt_pk_bf16_f32 v34, v40, v41
v_cvt_pk_bf16_f32 v35, v42, v43
v_cvt_pk_bf16_f32 v36, v36, v37
v_cvt_pk_bf16_f32 v37, v38, v39
v_cvt_pk_bf16_f32 v38, v44, v45
v_cvt_pk_bf16_f32 v39, v46, v47
v_cvt_pk_bf16_f32 v48, v48, v49
v_cvt_pk_bf16_f32 v49, v50, v51
v_cvt_pk_bf16_f32 v50, v56, v57
v_cvt_pk_bf16_f32 v51, v58, v59
v_cvt_pk_bf16_f32 v52, v52, v53
v_cvt_pk_bf16_f32 v53, v54, v55
v_cvt_pk_bf16_f32 v54, v60, v61
v_cvt_pk_bf16_f32 v55, v62, v63
v_cvt_pk_bf16_f32 v64, v64, v65
v_cvt_pk_bf16_f32 v65, v66, v67
v_cvt_pk_bf16_f32 v66, v72, v73
v_cvt_pk_bf16_f32 v67, v74, v75
v_cvt_pk_bf16_f32 v68, v68, v69
v_cvt_pk_bf16_f32 v69, v70, v71
v_cvt_pk_bf16_f32 v70, v76, v77
v_cvt_pk_bf16_f32 v71, v78, v79
v_cvt_pk_bf16_f32 v80, v80, v81
v_cvt_pk_bf16_f32 v81, v82, v83
v_cvt_pk_bf16_f32 v82, v88, v89
v_cvt_pk_bf16_f32 v83, v90, v91
v_cvt_pk_bf16_f32 v84, v84, v85
v_cvt_pk_bf16_f32 v85, v86, v87
v_cvt_pk_bf16_f32 v86, v92, v93
v_cvt_pk_bf16_f32 v87, v94, v95
v_cvt_pk_bf16_f32 v96, v96, v97
v_cvt_pk_bf16_f32 v97, v98, v99
v_cvt_pk_bf16_f32 v98, v104, v105
v_cvt_pk_bf16_f32 v99, v106, v107
v_cvt_pk_bf16_f32 v100, v100, v101
v_cvt_pk_bf16_f32 v101, v102, v103
v_cvt_pk_bf16_f32 v102, v108, v109
v_cvt_pk_bf16_f32 v103, v110, v111
v_cvt_pk_bf16_f32 v112, v112, v113
v_cvt_pk_bf16_f32 v113, v114, v115
v_cvt_pk_bf16_f32 v114, v120, v121
v_cvt_pk_bf16_f32 v115, v122, v123
v_cvt_pk_bf16_f32 v116, v116, v117
v_cvt_pk_bf16_f32 v117, v118, v119
v_cvt_pk_bf16_f32 v118, v124, v125
v_cvt_pk_bf16_f32 v119, v126, v127
v_mbcnt_lo_u32_b32 v208, -1, 0
v_mbcnt_hi_u32_b32 v208, -1, v208
v_and_b32 v209, 15, v208
v_lshrrev_b32 v210, 4, v208
s_mul_i32 s60, s51, 4000
s_add_u32 s60, s60, s62
v_add_u32 v211, s60, v209
v_lshlrev_b32 v211, 9, v211
v_lshl_add_u32 v211, v210, 3, v211
s_lshl_b32 s60, s48, 7
v_add_u32 v242, s60, v211
v_add_u32 v243, 8192, v242
s_waitcnt vmcnt(8) lgkmcnt(0)
v_or_b32 v212, v212, v213
v_or_b32 v214, v214, v215
v_or_b32 v212, v212, v214
s_nop 0
v_readfirstlane_b32 s57, v212
s_nop 3
s_andn2_b32 s57, s57, s54
s_cmp_lg_u32 s57, 0
s_cbranch_scc1 K2_SLOW
v_add_f32 v248, v248, v236
v_add_f32 v249, v249, v237
s_cmp_eq_u32 s64, s53
s_cbranch_scc0 K2_PUBG
v_add_u32 v254, 49152, v247
ds_write_b128 v254, v[0:3] offset:0
ds_write_b128 v254, v[4:7] offset:1024
ds_write_b128 v254, v[16:19] offset:2048
ds_write_b128 v254, v[20:23] offset:3072
ds_write_b128 v254, v[32:35] offset:4096
ds_write_b128 v254, v[36:39] offset:5120
ds_write_b128 v254, v[48:51] offset:6144
ds_write_b128 v254, v[52:55] offset:7168
ds_write_b128 v254, v[64:67] offset:8192
ds_write_b128 v254, v[68:71] offset:9216
ds_write_b128 v254, v[80:83] offset:10240
ds_write_b128 v254, v[84:87] offset:11264
ds_write_b128 v254, v[96:99] offset:12288
ds_write_b128 v254, v[100:103] offset:13312
ds_write_b128 v254, v[112:115] offset:14336
ds_write_b128 v254, v[116:119] offset:15360
v_lshlrev_b32 v255, 3, v209
v_add_u32 v255, 118784, v255
v_mov_b32 v212, v252
v_mov_b32 v213, v248
ds_write_b64 v255, v[212:213] offset:0
v_mov_b32 v214, v253
v_mov_b32 v215, v249
ds_write_b64 v255, v[214:215] offset:128
s_branch K2_PUBD
K2_PUBG:
s_lshl_b32 s60, s52, 7
s_lshl_b32 s61, s64, 5
s_add_u32 s60, s60, s61
s_cmp_lt_u32 s60, 4000
s_cbranch_scc0 K2_PUBD
s_lshl_b32 s60, s65, 2
s_add_u32 s60, s60, s64
s_lshl_b32 s60, s60, 2
s_add_u32 s60, s60, s53
s_lshl_b32 s61, s60, 14
v_lshlrev_b32 v255, 3, v209
v_mov_b32 v212, v252
v_mov_b32 v213, v248
v_mov_b32 v214, v253
v_mov_b32 v215, v249
v_readfirstlane_b32 s57, v241
s_nop 3
s_xor_b32 s57, s57, s3
s_cmp_eq_u32 s57, s63
s_cbranch_scc1 K2_PUBL
s_lshl_b32 s61, s60, 14
buffer_store_dwordx4 v[0:3], v247, s[16:19], s61 offen offset:0 sc1
buffer_store_dwordx4 v[4:7], v247, s[16:19], s61 offen offset:1024 sc1
buffer_store_dwordx4 v[16:19], v247, s[16:19], s61 offen offset:2048 sc1
buffer_store_dwordx4 v[20:23], v247, s[16:19], s61 offen offset:3072 sc1
s_add_u32 s61, s61, 4096
buffer_store_dwordx4 v[32:35], v247, s[16:19], s61 offen offset:0 sc1
buffer_store_dwordx4 v[36:39], v247, s[16:19], s61 offen offset:1024 sc1
buffer_store_dwordx4 v[48:51], v247, s[16:19], s61 offen offset:2048 sc1
buffer_store_dwordx4 v[52:55], v247, s[16:19], s61 offen offset:3072 sc1
s_add_u32 s61, s61, 4096
buffer_store_dwordx4 v[64:67], v247, s[16:19], s61 offen offset:0 sc1
buffer_store_dwordx4 v[68:71], v247, s[16:19], s61 offen offset:1024 sc1
buffer_store_dwordx4 v[80:83], v247, s[16:19], s61 offen offset:2048 sc1
buffer_store_dwordx4 v[84:87], v247, s[16:19], s61 offen offset:3072 sc1
s_add_u32 s61, s61, 4096
buffer_store_dwordx4 v[96:99], v247, s[16:19], s61 offen offset:0 sc1
buffer_store_dwordx4 v[100:103], v247, s[16:19], s61 offen offset:1024 sc1
buffer_store_dwordx4 v[112:115], v247, s[16:19], s61 offen offset:2048 sc1
buffer_store_dwordx4 v[116:119], v247, s[16:19], s61 offen offset:3072 sc1
s_lshl_b32 s61, s60, 8
v_cmp_gt_u32 vcc, 16, v208
s_and_saveexec_b64 s[70:71], vcc
buffer_store_dwordx2 v[212:213], v255, s[20:23], s61 offen offset:0 sc1
buffer_store_dwordx2 v[214:215], v255, s[20:23], s61 offen offset:128 sc1
s_mov_b64 exec, s[70:71]
s_branch K2_PUBD
K2_PUBL:
s_lshl_b32 s61, s60, 14
buffer_store_dwordx4 v[0:3], v247, s[16:19], s61 offen offset:0
buffer_store_dwordx4 v[4:7], v247, s[16:19], s61 offen offset:1024
buffer_store_dwordx4 v[16:19], v247, s[16:19], s61 offen offset:2048
buffer_store_dwordx4 v[20:23], v247, s[16:19], s61 offen offset:3072
s_add_u32 s61, s61, 4096
buffer_store_dwordx4 v[32:35], v247, s[16:19], s61 offen offset:0
buffer_store_dwordx4 v[36:39], v247, s[16:19], s61 offen offset:1024
buffer_store_dwordx4 v[48:51], v247, s[16:19], s61 offen offset:2048
buffer_store_dwordx4 v[52:55], v247, s[16:19], s61 offen offset:3072
s_add_u32 s61, s61, 4096
buffer_store_dwordx4 v[64:67], v247, s[16:19], s61 offen offset:0
buffer_store_dwordx4 v[68:71], v247, s[16:19], s61 offen offset:1024
buffer_store_dwordx4 v[80:83], v247, s[16:19], s61 offen offset:2048
buffer_store_dwordx4 v[84:87], v247, s[16:19], s61 offen offset:3072
s_add_u32 s61, s61, 4096
buffer_store_dwordx4 v[96:99], v247, s[16:19], s61 offen offset:0
buffer_store_dwordx4 v[100:103], v247, s[16:19], s61 offen offset:1024
buffer_store_dwordx4 v[112:115], v247, s[16:19], s61 offen offset:2048
buffer_store_dwordx4 v[116:119], v247, s[16:19], s61 offen offset:3072
s_lshl_b32 s61, s60, 8
v_cmp_gt_u32 vcc, 16, v208
s_and_saveexec_b64 s[70:71], vcc
buffer_store_dwordx2 v[212:213], v255, s[20:23], s61 offen offset:0
buffer_store_dwordx2 v[214:215], v255, s[20:23], s61 offen offset:128
s_mov_b64 exec, s[70:71]
K2_PUBD:
s_cmp_lt_u32 s62, 4000
s_cbranch_scc1 K2_VALID
s_waitcnt vmcnt(0) lgkmcnt(0)
s_barrier
s_cmp_eq_u32 s48, 0
s_cbranch_scc0 K2_NOATOM0
s_lshl_b32 s60, s65, 7
s_lshl_b32 s61, s53, 2
s_add_u32 s60, s60, s61
s_mov_b32 s61, s3
v_mov_b32 v215, s61
v_cmp_eq_u32 vcc, 0, v208
s_and_saveexec_b64 s[70:71], vcc
buffer_store_dword v215, off, s[44:47], s60 sc1
s_mov_b64 exec, s[70:71]
K2_NOATOM0:
s_branch K2_FIN
K2_VALID:
s_nop 1
v_lshlrev_b32 v0, 16, v192
v_and_b32 v1, 0xffff0000, v192
v_lshlrev_b32 v2, 16, v193
v_and_b32 v3, 0xffff0000, v193
v_lshlrev_b32 v4, 16, v194
v_and_b32 v5, 0xffff0000, v194
v_lshlrev_b32 v6, 16, v195
v_and_b32 v7, 0xffff0000, v195
v_lshlrev_b32 v8, 16, v196
v_and_b32 v9, 0xffff0000, v196
v_lshlrev_b32 v10, 16, v197
v_and_b32 v11, 0xffff0000, v197
v_lshlrev_b32 v12, 16, v198
v_and_b32 v13, 0xffff0000, v198
v_lshlrev_b32 v14, 16, v199
v_and_b32 v15, 0xffff0000, v199
v_lshlrev_b32 v16, 16, v200
v_and_b32 v17, 0xffff0000, v200
v_lshlrev_b32 v18, 16, v201
v_and_b32 v19, 0xffff0000, v201
v_lshlrev_b32 v20, 16, v202
v_and_b32 v21, 0xffff0000, v202
v_lshlrev_b32 v22, 16, v203
v_and_b32 v23, 0xffff0000, v203
buffer_load_dwordx4 a[136:139], v247, s[12:15], s66 offen offset:2048 sc1
v_lshlrev_b32 v24, 16, v204
v_and_b32 v25, 0xffff0000, v204
v_lshlrev_b32 v26, 16, v205
v_and_b32 v27, 0xffff0000, v205
v_lshlrev_b32 v28, 16, v206
v_and_b32 v29, 0xffff0000, v206
v_lshlrev_b32 v30, 16, v207
v_and_b32 v31, 0xffff0000, v207
v_lshlrev_b32 v32, 16, v232
v_and_b32 v33, 0xffff0000, v232
v_lshlrev_b32 v34, 16, v233
v_and_b32 v35, 0xffff0000, v233
v_lshlrev_b32 v36, 16, v234
v_and_b32 v37, 0xffff0000, v234
v_lshlrev_b32 v38, 16, v235
v_and_b32 v39, 0xffff0000, v235
v_lshlrev_b32 v72, 16, v128
v_and_b32 v73, 0xffff0000, v128
v_lshlrev_b32 v74, 16, v129
v_and_b32 v75, 0xffff0000, v129
v_lshlrev_b32 v76, 16, v130
v_and_b32 v77, 0xffff0000, v130
v_lshlrev_b32 v78, 16, v131
v_and_b32 v79, 0xffff0000, v131
v_pk_mul_f32 v[40:41], v[72:73], v[0:1]
v_pk_mul_f32 v[42:43], v[74:75], v[2:3]
v_pk_mul_f32 v[44:45], v[76:77], v[4:5]
v_pk_mul_f32 v[46:47], v[78:79], v[6:7]
buffer_load_dwordx4 a[168:171], v247, s[12:15], s67 offen offset:2048 sc1
v_lshlrev_b32 v80, 16, v132
v_and_b32 v81, 0xffff0000, v132
v_lshlrev_b32 v82, 16, v133
v_and_b32 v83, 0xffff0000, v133
v_lshlrev_b32 v84, 16, v134
v_and_b32 v85, 0xffff0000, v134
v_lshlrev_b32 v86, 16, v135
v_and_b32 v87, 0xffff0000, v135
v_pk_fma_f32 v[40:41], v[80:81], v[8:9], v[40:41]
v_pk_fma_f32 v[42:43], v[82:83], v[10:11], v[42:43]
v_pk_fma_f32 v[44:45], v[84:85], v[12:13], v[44:45]
v_pk_fma_f32 v[46:47], v[86:87], v[14:15], v[46:47]
v_pk_mul_f32 v[48:49], v[80:81], v[0:1]
v_pk_mul_f32 v[50:51], v[82:83], v[2:3]
v_pk_mul_f32 v[52:53], v[84:85], v[4:5]
v_pk_mul_f32 v[54:55], v[86:87], v[6:7]
v_lshlrev_b32 v72, 16, v136
v_and_b32 v73, 0xffff0000, v136
v_lshlrev_b32 v74, 16, v137
v_and_b32 v75, 0xffff0000, v137
v_lshlrev_b32 v76, 16, v138
v_and_b32 v77, 0xffff0000, v138
v_lshlrev_b32 v78, 16, v139
v_and_b32 v79, 0xffff0000, v139
v_pk_fma_f32 v[40:41], v[72:73], v[16:17], v[40:41]
v_pk_fma_f32 v[42:43], v[74:75], v[18:19], v[42:43]
v_pk_fma_f32 v[44:45], v[76:77], v[20:21], v[44:45]
v_pk_fma_f32 v[46:47], v[78:79], v[22:23], v[46:47]
buffer_load_dwordx4 a[200:203], v247, s[12:15], s68 offen offset:2048 sc1
v_pk_fma_f32 v[48:49], v[72:73], v[8:9], v[48:49]
v_pk_fma_f32 v[50:51], v[74:75], v[10:11], v[50:51]
v_pk_fma_f32 v[52:53], v[76:77], v[12:13], v[52:53]
v_pk_fma_f32 v[54:55], v[78:79], v[14:15], v[54:55]
v_pk_mul_f32 v[56:57], v[72:73], v[0:1]
v_pk_mul_f32 v[58:59], v[74:75], v[2:3]
v_pk_mul_f32 v[60:61], v[76:77], v[4:5]
v_pk_mul_f32 v[62:63], v[78:79], v[6:7]
v_lshlrev_b32 v80, 16, v140
v_and_b32 v81, 0xffff0000, v140
v_lshlrev_b32 v82, 16, v141
v_and_b32 v83, 0xffff0000, v141
v_lshlrev_b32 v84, 16, v142
v_and_b32 v85, 0xffff0000, v142
v_lshlrev_b32 v86, 16, v143
v_and_b32 v87, 0xffff0000, v143
v_pk_fma_f32 v[40:41], v[80:81], v[24:25], v[40:41]
v_pk_fma_f32 v[42:43], v[82:83], v[26:27], v[42:43]
v_pk_fma_f32 v[44:45], v[84:85], v[28:29], v[44:45]
v_pk_fma_f32 v[46:47], v[86:87], v[30:31], v[46:47]
buffer_load_dwordx4 a[232:235], v247, s[12:15], s69 offen offset:2048 sc1
v_pk_fma_f32 v[48:49], v[80:81], v[16:17], v[48:49]
v_pk_fma_f32 v[50:51], v[82:83], v[18:19], v[50:51]
v_pk_fma_f32 v[52:53], v[84:85], v[20:21], v[52:53]
v_pk_fma_f32 v[54:55], v[86:87], v[22:23], v[54:55]
v_pk_fma_f32 v[56:57], v[80:81], v[8:9], v[56:57]
v_pk_fma_f32 v[58:59], v[82:83], v[10:11], v[58:59]
v_pk_fma_f32 v[60:61], v[84:85], v[12:13], v[60:61]
v_pk_fma_f32 v[62:63], v[86:87], v[14:15], v[62:63]
v_pk_mul_f32 v[64:65], v[80:81], v[0:1]
v_pk_mul_f32 v[66:67], v[82:83], v[2:3]
v_pk_mul_f32 v[68:69], v[84:85], v[4:5]
v_pk_mul_f32 v[70:71], v[86:87], v[6:7]
buffer_load_dwordx4 a[140:143], v247, s[12:15], s66 offen offset:3072 sc1
s_waitcnt vmcnt(5) lgkmcnt(0)
s_barrier
s_cmp_eq_u32 s48, 0
s_cbranch_scc0 K2_NOATOM
s_lshl_b32 s60, s65, 7
s_lshl_b32 s61, s53, 2
s_add_u32 s60, s60, s61
s_mov_b32 s61, s3
v_mov_b32 v215, s61
v_cmp_eq_u32 vcc, 0, v208
s_and_saveexec_b64 s[70:71], vcc
buffer_store_dword v215, off, s[44:47], s60 sc1
s_mov_b64 exec, s[70:71]
K2_NOATOM:
v_lshlrev_b32 v72, 16, v144
v_and_b32 v73, 0xffff0000, v144
v_lshlrev_b32 v74, 16, v145
v_and_b32 v75, 0xffff0000, v145
v_lshlrev_b32 v76, 16, v146
v_and_b32 v77, 0xffff0000, v146
v_lshlrev_b32 v78, 16, v147
v_and_b32 v79, 0xffff0000, v147
v_pk_fma_f32 v[40:41], v[72:73], v[32:33], v[40:41]
v_pk_fma_f32 v[42:43], v[74:75], v[34:35], v[42:43]
v_pk_fma_f32 v[44:45], v[76:77], v[36:37], v[44:45]
v_pk_fma_f32 v[46:47], v[78:79], v[38:39], v[46:47]
v_pk_fma_f32 v[48:49], v[72:73], v[24:25], v[48:49]
v_pk_fma_f32 v[50:51], v[74:75], v[26:27], v[50:51]
v_pk_fma_f32 v[52:53], v[76:77], v[28:29], v[52:53]
v_pk_fma_f32 v[54:55], v[78:79], v[30:31], v[54:55]
v_pk_fma_f32 v[56:57], v[72:73], v[16:17], v[56:57]
v_pk_fma_f32 v[58:59], v[74:75], v[18:19], v[58:59]
v_pk_fma_f32 v[60:61], v[76:77], v[20:21], v[60:61]
v_pk_fma_f32 v[62:63], v[78:79], v[22:23], v[62:63]
buffer_load_dwordx4 a[172:175], v247, s[12:15], s67 offen offset:3072 sc1
v_pk_fma_f32 v[64:65], v[72:73], v[8:9], v[64:65]
v_pk_fma_f32 v[66:67], v[74:75], v[10:11], v[66:67]
v_pk_fma_f32 v[68:69], v[76:77], v[12:13], v[68:69]
v_pk_fma_f32 v[70:71], v[78:79], v[14:15], v[70:71]
v_lshlrev_b32 v80, 16, v148
v_and_b32 v81, 0xffff0000, v148
v_lshlrev_b32 v82, 16, v149
v_and_b32 v83, 0xffff0000, v149
v_lshlrev_b32 v84, 16, v150
v_and_b32 v85, 0xffff0000, v150
v_lshlrev_b32 v86, 16, v151
v_and_b32 v87, 0xffff0000, v151
v_pk_fma_f32 v[48:49], v[80:81], v[32:33], v[48:49]
v_pk_fma_f32 v[50:51], v[82:83], v[34:35], v[50:51]
v_pk_fma_f32 v[52:53], v[84:85], v[36:37], v[52:53]
v_pk_fma_f32 v[54:55], v[86:87], v[38:39], v[54:55]
v_pk_fma_f32 v[56:57], v[80:81], v[24:25], v[56:57]
v_pk_fma_f32 v[58:59], v[82:83], v[26:27], v[58:59]
v_pk_fma_f32 v[60:61], v[84:85], v[28:29], v[60:61]
v_pk_fma_f32 v[62:63], v[86:87], v[30:31], v[62:63]
buffer_load_dwordx4 a[204:207], v247, s[12:15], s68 offen offset:3072 sc1
v_pk_fma_f32 v[64:65], v[80:81], v[16:17], v[64:65]
v_pk_fma_f32 v[66:67], v[82:83], v[18:19], v[66:67]
v_pk_fma_f32 v[68:69], v[84:85], v[20:21], v[68:69]
v_pk_fma_f32 v[70:71], v[86:87], v[22:23], v[70:71]
v_lshlrev_b32 v72, 16, v152
v_and_b32 v73, 0xffff0000, v152
v_lshlrev_b32 v74, 16, v153
v_and_b32 v75, 0xffff0000, v153
v_lshlrev_b32 v76, 16, v154
v_and_b32 v77, 0xffff0000, v154
v_lshlrev_b32 v78, 16, v155
v_and_b32 v79, 0xffff0000, v155
v_pk_fma_f32 v[56:57], v[72:73], v[32:33], v[56:57]
v_pk_fma_f32 v[58:59], v[74:75], v[34:35], v[58:59]
v_pk_fma_f32 v[60:61], v[76:77], v[36:37], v[60:61]
v_pk_fma_f32 v[62:63], v[78:79], v[38:39], v[62:63]
v_pk_fma_f32 v[64:65], v[72:73], v[24:25], v[64:65]
v_pk_fma_f32 v[66:67], v[74:75], v[26:27], v[66:67]
v_pk_fma_f32 v[68:69], v[76:77], v[28:29], v[68:69]
v_pk_fma_f32 v[70:71], v[78:79], v[30:31], v[70:71]
buffer_load_dwordx4 a[236:239], v247, s[12:15], s69 offen offset:3072 sc1
v_lshlrev_b32 v80, 16, v156
v_and_b32 v81, 0xffff0000, v156
v_lshlrev_b32 v82, 16, v157
v_and_b32 v83, 0xffff0000, v157
v_lshlrev_b32 v84, 16, v158
v_and_b32 v85, 0xffff0000, v158
v_lshlrev_b32 v86, 16, v159
v_and_b32 v87, 0xffff0000, v159
v_pk_fma_f32 v[64:65], v[80:81], v[32:33], v[64:65]
v_pk_fma_f32 v[66:67], v[82:83], v[34:35], v[66:67]
v_pk_fma_f32 v[68:69], v[84:85], v[36:37], v[68:69]
v_pk_fma_f32 v[70:71], v[86:87], v[38:39], v[70:71]
v_and_b32 v212, 31, v208
v_lshrrev_b32 v213, 2, v212
v_and_b32 v214, 3, v212
v_and_b32 v215, 1, v213
v_lshl_or_b32 v215, v215, 2, v214
v_lshrrev_b32 v216, 5, v208
s_lshl_b32 s60, s48, 1
v_add_u32 v216, s60, v216
v_lshrrev_b32 v217, 2, v216
v_and_b32 v216, 3, v216
v_lshlrev_b32 v216, 2, v216
v_lshl_add_u32 v216, v214, 4, v216
v_lshl_add_u32 v213, v213, 1, v217
v_lshlrev_b32 v213, 10, v213
v_add_u32 v213, 16384, v213
v_mov_b32 v88, 0xc0135761
v_mov_b32 v90, 0xbdd2d3e8
v_mov_b32 v92, 1.0
v_lshlrev_b32 v72, 16, v160
v_and_b32 v73, 0xffff0000, v160
v_lshlrev_b32 v74, 16, v161
v_and_b32 v75, 0xffff0000, v161
v_lshlrev_b32 v76, 16, v162
v_and_b32 v77, 0xffff0000, v162
v_lshlrev_b32 v78, 16, v163
v_and_b32 v79, 0xffff0000, v163
v_pk_mul_f32 v[96:97], v[72:73], v[72:73]
v_pk_mul_f32 v[98:99], v[74:75], v[74:75]
v_pk_mul_f32 v[100:101], v[76:77], v[76:77]
v_pk_mul_f32 v[102:103], v[78:79], v[78:79]
v_pk_fma_f32 v[96:97], v[96:97], v[90:91], v[88:89] op_sel_hi:[1,0,0]
v_pk_fma_f32 v[98:99], v[98:99], v[90:91], v[88:89] op_sel_hi:[1,0,0]
v_pk_fma_f32 v[100:101], v[100:101], v[90:91], v[88:89] op_sel_hi:[1,0,0]
v_pk_fma_f32 v[102:103], v[102:103], v[90:91], v[88:89] op_sel_hi:[1,0,0]
v_pk_mul_f32 v[96:97], v[96:97], v[72:73]
v_pk_mul_f32 v[98:99], v[98:99], v[74:75]
v_pk_mul_f32 v[100:101], v[100:101], v[76:77]
v_pk_mul_f32 v[102:103], v[102:103], v[78:79]
v_exp_f32 v96, v96
v_exp_f32 v97, v97
v_exp_f32 v98, v98
v_exp_f32 v99, v99
v_exp_f32 v100, v100
v_exp_f32 v101, v101
v_exp_f32 v102, v102
v_exp_f32 v103, v103
s_lshl_b32 s66, s48, 16
s_add_u32 s66, s66, 4096
buffer_load_dwordx4 a[144:147], v247, s[12:15], s66 offen offset:0 sc1
v_pk_add_f32 v[96:97], v[96:97], v[92:93] op_sel_hi:[1,0]
v_pk_add_f32 v[98:99], v[98:99], v[92:93] op_sel_hi:[1,0]
v_pk_add_f32 v[100:101], v[100:101], v[92:93] op_sel_hi:[1,0]
v_pk_add_f32 v[102:103], v[102:103], v[92:93] op_sel_hi:[1,0]
v_rcp_f32 v96, v96
v_rcp_f32 v97, v97
v_rcp_f32 v98, v98
v_rcp_f32 v99, v99
v_rcp_f32 v100, v100
v_rcp_f32 v101, v101
v_rcp_f32 v102, v102
v_rcp_f32 v103, v103
v_pk_mul_f32 v[72:73], v[72:73], v[96:97]
v_pk_mul_f32 v[74:75], v[74:75], v[98:99]
v_pk_mul_f32 v[76:77], v[76:77], v[100:101]
v_pk_mul_f32 v[78:79], v[78:79], v[102:103]
v_pk_mul_f32 v[72:73], v[72:73], v[40:41]
v_pk_mul_f32 v[74:75], v[74:75], v[42:43]
v_pk_mul_f32 v[76:77], v[76:77], v[44:45]
v_pk_mul_f32 v[78:79], v[78:79], v[46:47]
v_cvt_pk_bf16_f32 v128, v72, v73
v_cvt_pk_bf16_f32 v129, v74, v75
v_cvt_pk_bf16_f32 v130, v76, v77
v_cvt_pk_bf16_f32 v131, v78, v79
v_add_u32 v218, 0, v216
v_xor_b32 v218, v218, v215
v_lshl_add_u32 v218, v218, 4, v213
ds_write_b128 v218, v[128:131]
v_lshlrev_b32 v80, 16, v164
v_and_b32 v81, 0xffff0000, v164
v_lshlrev_b32 v82, 16, v165
v_and_b32 v83, 0xffff0000, v165
v_lshlrev_b32 v84, 16, v166
v_and_b32 v85, 0xffff0000, v166
v_lshlrev_b32 v86, 16, v167
v_and_b32 v87, 0xffff0000, v167
v_pk_mul_f32 v[96:97], v[80:81], v[80:81]
v_pk_mul_f32 v[98:99], v[82:83], v[82:83]
v_pk_mul_f32 v[100:101], v[84:85], v[84:85]
v_pk_mul_f32 v[102:103], v[86:87], v[86:87]
v_pk_fma_f32 v[96:97], v[96:97], v[90:91], v[88:89] op_sel_hi:[1,0,0]
v_pk_fma_f32 v[98:99], v[98:99], v[90:91], v[88:89] op_sel_hi:[1,0,0]
v_pk_fma_f32 v[100:101], v[100:101], v[90:91], v[88:89] op_sel_hi:[1,0,0]
v_pk_fma_f32 v[102:103], v[102:103], v[90:91], v[88:89] op_sel_hi:[1,0,0]
s_lshl_b32 s67, s48, 16
s_add_u32 s67, s67, 20480
buffer_load_dwordx4 a[176:179], v247, s[12:15], s67 offen offset:0 sc1
v_pk_mul_f32 v[96:97], v[96:97], v[80:81]
v_pk_mul_f32 v[98:99], v[98:99], v[82:83]
v_pk_mul_f32 v[100:101], v[100:101], v[84:85]
v_pk_mul_f32 v[102:103], v[102:103], v[86:87]
v_exp_f32 v96, v96
v_exp_f32 v97, v97
v_exp_f32 v98, v98
v_exp_f32 v99, v99
v_exp_f32 v100, v100
v_exp_f32 v101, v101
v_exp_f32 v102, v102
v_exp_f32 v103, v103
v_pk_add_f32 v[96:97], v[96:97], v[92:93] op_sel_hi:[1,0]
v_pk_add_f32 v[98:99], v[98:99], v[92:93] op_sel_hi:[1,0]
v_pk_add_f32 v[100:101], v[100:101], v[92:93] op_sel_hi:[1,0]
v_pk_add_f32 v[102:103], v[102:103], v[92:93] op_sel_hi:[1,0]
v_rcp_f32 v96, v96
v_rcp_f32 v97, v97
v_rcp_f32 v98, v98
v_rcp_f32 v99, v99
v_rcp_f32 v100, v100
v_rcp_f32 v101, v101
v_rcp_f32 v102, v102
v_rcp_f32 v103, v103
v_pk_mul_f32 v[80:81], v[80:81], v[96:97]
v_pk_mul_f32 v[82:83], v[82:83], v[98:99]
v_pk_mul_f32 v[84:85], v[84:85], v[100:101]
v_pk_mul_f32 v[86:87], v[86:87], v[102:103]
v_pk_mul_f32 v[80:81], v[80:81], v[48:49]
v_pk_mul_f32 v[82:83], v[82:83], v[50:51]
v_pk_mul_f32 v[84:85], v[84:85], v[52:53]
v_pk_mul_f32 v[86:87], v[86:87], v[54:55]
v_cvt_pk_bf16_f32 v132, v80, v81
v_cvt_pk_bf16_f32 v133, v82, v83
v_cvt_pk_bf16_f32 v134, v84, v85
v_cvt_pk_bf16_f32 v135, v86, v87
v_add_u32 v218, 1, v216
v_xor_b32 v218, v218, v215
v_lshl_add_u32 v218, v218, 4, v213
ds_write_b128 v218, v[132:135]
s_lshl_b32 s68, s48, 16
s_add_u32 s68, s68, 36864
buffer_load_dwordx4 a[208:211], v247, s[12:15], s68 offen offset:0 sc1
v_lshlrev_b32 v72, 16, v168
v_and_b32 v73, 0xffff0000, v168
v_lshlrev_b32 v74, 16, v169
v_and_b32 v75, 0xffff0000, v169
v_lshlrev_b32 v76, 16, v170
v_and_b32 v77, 0xffff0000, v170
v_lshlrev_b32 v78, 16, v171
v_and_b32 v79, 0xffff0000, v171
v_pk_mul_f32 v[96:97], v[72:73], v[72:73]
v_pk_mul_f32 v[98:99], v[74:75], v[74:75]
v_pk_mul_f32 v[100:101], v[76:77], v[76:77]
v_pk_mul_f32 v[102:103], v[78:79], v[78:79]
v_pk_fma_f32 v[96:97], v[96:97], v[90:91], v[88:89] op_sel_hi:[1,0,0]
v_pk_fma_f32 v[98:99], v[98:99], v[90:91], v[88:89] op_sel_hi:[1,0,0]
v_pk_fma_f32 v[100:101], v[100:101], v[90:91], v[88:89] op_sel_hi:[1,0,0]
v_pk_fma_f32 v[102:103], v[102:103], v[90:91], v[88:89] op_sel_hi:[1,0,0]
v_pk_mul_f32 v[96:97], v[96:97], v[72:73]
v_pk_mul_f32 v[98:99], v[98:99], v[74:75]
v_pk_mul_f32 v[100:101], v[100:101], v[76:77]
v_pk_mul_f32 v[102:103], v[102:103], v[78:79]
v_exp_f32 v96, v96
v_exp_f32 v97, v97
v_exp_f32 v98, v98
v_exp_f32 v99, v99
v_exp_f32 v100, v100
v_exp_f32 v101, v101
v_exp_f32 v102, v102
v_exp_f32 v103, v103
v_pk_add_f32 v[96:97], v[96:97], v[92:93] op_sel_hi:[1,0]
v_pk_add_f32 v[98:99], v[98:99], v[92:93] op_sel_hi:[1,0]
v_pk_add_f32 v[100:101], v[100:101], v[92:93] op_sel_hi:[1,0]
v_pk_add_f32 v[102:103], v[102:103], v[92:93] op_sel_hi:[1,0]
v_rcp_f32 v96, v96
v_rcp_f32 v97, v97
v_rcp_f32 v98, v98
v_rcp_f32 v99, v99
v_rcp_f32 v100, v100
v_rcp_f32 v101, v101
v_rcp_f32 v102, v102
v_rcp_f32 v103, v103
s_lshl_b32 s69, s48, 16
s_add_u32 s69, s69, 53248
buffer_load_dwordx4 a[240:243], v247, s[12:15], s69 offen offset:0 sc1
v_pk_mul_f32 v[72:73], v[72:73], v[96:97]
v_pk_mul_f32 v[74:75], v[74:75], v[98:99]
v_pk_mul_f32 v[76:77], v[76:77], v[100:101]
v_pk_mul_f32 v[78:79], v[78:79], v[102:103]
v_pk_mul_f32 v[72:73], v[72:73], v[56:57]
v_pk_mul_f32 v[74:75], v[74:75], v[58:59]
v_pk_mul_f32 v[76:77], v[76:77], v[60:61]
v_pk_mul_f32 v[78:79], v[78:79], v[62:63]
v_cvt_pk_bf16_f32 v136, v72, v73
v_cvt_pk_bf16_f32 v137, v74, v75
v_cvt_pk_bf16_f32 v138, v76, v77
v_cvt_pk_bf16_f32 v139, v78, v79
v_add_u32 v218, 2, v216
v_xor_b32 v218, v218, v215
v_lshl_add_u32 v218, v218, 4, v213
ds_write_b128 v218, v[136:139]
s_lshl_b32 s57, s65, 7
buffer_load_dwordx4 v[232:235], off, s[44:47], s57 sc1
v_lshlrev_b32 v80, 16, v172
v_and_b32 v81, 0xffff0000, v172
v_lshlrev_b32 v82, 16, v173
v_and_b32 v83, 0xffff0000, v173
v_lshlrev_b32 v84, 16, v174
v_and_b32 v85, 0xffff0000, v174
v_lshlrev_b32 v86, 16, v175
v_and_b32 v87, 0xffff0000, v175
v_pk_mul_f32 v[96:97], v[80:81], v[80:81]
v_pk_mul_f32 v[98:99], v[82:83], v[82:83]
v_pk_mul_f32 v[100:101], v[84:85], v[84:85]
v_pk_mul_f32 v[102:103], v[86:87], v[86:87]
v_pk_fma_f32 v[96:97], v[96:97], v[90:91], v[88:89] op_sel_hi:[1,0,0]
v_pk_fma_f32 v[98:99], v[98:99], v[90:91], v[88:89] op_sel_hi:[1,0,0]
v_pk_fma_f32 v[100:101], v[100:101], v[90:91], v[88:89] op_sel_hi:[1,0,0]
v_pk_fma_f32 v[102:103], v[102:103], v[90:91], v[88:89] op_sel_hi:[1,0,0]
v_pk_mul_f32 v[96:97], v[96:97], v[80:81]
v_pk_mul_f32 v[98:99], v[98:99], v[82:83]
v_pk_mul_f32 v[100:101], v[100:101], v[84:85]
v_pk_mul_f32 v[102:103], v[102:103], v[86:87]
v_exp_f32 v96, v96
v_exp_f32 v97, v97
v_exp_f32 v98, v98
v_exp_f32 v99, v99
v_exp_f32 v100, v100
v_exp_f32 v101, v101
v_exp_f32 v102, v102
v_exp_f32 v103, v103
buffer_load_dwordx4 a[148:151], v247, s[12:15], s66 offen offset:1024 sc1
v_pk_add_f32 v[96:97], v[96:97], v[92:93] op_sel_hi:[1,0]
v_pk_add_f32 v[98:99], v[98:99], v[92:93] op_sel_hi:[1,0]
v_pk_add_f32 v[100:101], v[100:101], v[92:93] op_sel_hi:[1,0]
v_pk_add_f32 v[102:103], v[102:103], v[92:93] op_sel_hi:[1,0]
v_rcp_f32 v96, v96
v_rcp_f32 v97, v97
v_rcp_f32 v98, v98
v_rcp_f32 v99, v99
v_rcp_f32 v100, v100
v_rcp_f32 v101, v101
v_rcp_f32 v102, v102
v_rcp_f32 v103, v103
v_pk_mul_f32 v[80:81], v[80:81], v[96:97]
v_pk_mul_f32 v[82:83], v[82:83], v[98:99]
v_pk_mul_f32 v[84:85], v[84:85], v[100:101]
v_pk_mul_f32 v[86:87], v[86:87], v[102:103]
v_pk_mul_f32 v[80:81], v[80:81], v[64:65]
v_pk_mul_f32 v[82:83], v[82:83], v[66:67]
v_pk_mul_f32 v[84:85], v[84:85], v[68:69]
v_pk_mul_f32 v[86:87], v[86:87], v[70:71]
v_cvt_pk_bf16_f32 v140, v80, v81
v_cvt_pk_bf16_f32 v141, v82, v83
v_cvt_pk_bf16_f32 v142, v84, v85
v_cvt_pk_bf16_f32 v143, v86, v87
v_add_u32 v218, 3, v216
v_xor_b32 v218, v218, v215
v_lshl_add_u32 v218, v218, 4, v213
ds_write_b128 v218, v[140:143]
v_lshlrev_b32 v212, 4, v210
v_xor_b32 v212, v247, v212
v_xor_b32 v213, 64, v212
s_waitcnt lgkmcnt(0)
s_barrier
s_waitcnt vmcnt(1)
K2_POLL:
v_xor_b32 v232, s3, v232
v_xor_b32 v233, s3, v233
v_xor_b32 v234, s3, v234
v_xor_b32 v235, s3, v235
v_or_b32 v232, v232, v233
v_or_b32 v234, v234, v235
v_or_b32 v232, v232, v234
s_nop 0
v_readfirstlane_b32 s61, v232
s_nop 3
s_cmp_eq_u32 s61, 0
s_cbranch_scc1 K2_POLLD
s_sleep 1
buffer_load_dwordx4 v[232:235], off, s[44:47], s57 sc1
s_waitcnt vmcnt(0)
s_add_u32 s101, s101, 1
s_cmp_lt_u32 s101, 0x400000
s_cbranch_scc1 K2_POLL
K2_POLLD:
v_lshlrev_b32 v215, 3, v209
s_add_u32 s60, s53, 1
s_and_b32 s60, s60, 3
s_lshl_b32 s61, s65, 2
s_add_u32 s61, s61, s53
s_lshl_b32 s61, s61, 2
s_add_u32 s57, s61, s60
s_add_u32 s60, s53, 2
s_and_b32 s60, s60, 3
s_lshl_b32 s61, s65, 2
s_add_u32 s61, s61, s53
s_lshl_b32 s61, s61, 2
s_add_u32 s58, s61, s60
s_add_u32 s60, s53, 3
s_and_b32 s60, s60, 3
s_lshl_b32 s61, s65, 2
s_add_u32 s61, s61, s53
s_lshl_b32 s61, s61, 2
s_add_u32 s59, s61, s60
s_lshl_b32 s60, s57, 8
buffer_load_dwordx2 v[68:69], v215, s[20:23], s60 offen offset:0 sc1
s_lshl_b32 s60, s57, 8
buffer_load_dwordx2 v[70:71], v215, s[20:23], s60 offen offset:128 sc1
s_lshl_b32 s60, s58, 8
buffer_load_dwordx2 v[72:73], v215, s[20:23], s60 offen offset:0 sc1
s_lshl_b32 s60, s58, 8
buffer_load_dwordx2 v[74:75], v215, s[20:23], s60 offen offset:128 sc1
s_lshl_b32 s60, s59, 8
buffer_load_dwordx2 v[76:77], v215, s[20:23], s60 offen offset:0 sc1
s_lshl_b32 s60, s59, 8
buffer_load_dwordx2 v[78:79], v215, s[20:23], s60 offen offset:128 sc1
s_lshl_b32 s61, s57, 14
s_lshl_b32 s60, s48, 12
s_add_u32 s61, s61, s60
buffer_load_dwordx4 v[0:3], v247, s[16:19], s61 offen offset:0 sc1
buffer_load_dwordx4 v[4:7], v247, s[16:19], s61 offen offset:1024 sc1
ds_read_b128 v[216:219], v212 offset:16384
ds_read_b128 v[220:223], v212 offset:17408
s_waitcnt lgkmcnt(1)
v_mfma_f32_16x16x32_bf16 v[96:99], a[0:3], v[216:219], 0
ds_read_b128 v[224:227], v213 offset:18432
s_waitcnt lgkmcnt(1)
v_mfma_f32_16x16x32_bf16 v[100:103], a[0:3], v[220:223], 0
v_mfma_f32_16x16x32_bf16 v[104:107], a[32:35], v[216:219], 0
v_mfma_f32_16x16x32_bf16 v[108:111], a[32:35], v[220:223], 0
buffer_load_dwordx4 v[8:11], v247, s[16:19], s61 offen offset:2048 sc1
v_mfma_f32_16x16x32_bf16 v[112:115], a[64:67], v[216:219], 0
ds_read_b128 v[228:231], v213 offset:19456
v_mfma_f32_16x16x32_bf16 v[116:119], a[64:67], v[220:223], 0
v_mfma_f32_16x16x32_bf16 v[120:123], a[96:99], v[216:219], 0
v_mfma_f32_16x16x32_bf16 v[124:127], a[96:99], v[220:223], 0
buffer_load_dwordx4 v[12:15], v247, s[16:19], s61 offen offset:3072 sc1
s_waitcnt lgkmcnt(1)
v_mfma_f32_16x16x32_bf16 v[96:99], a[4:7], v[224:227], v[96:99]
ds_read_b128 v[216:219], v212 offset:20480
s_waitcnt lgkmcnt(1)
v_mfma_f32_16x16x32_bf16 v[100:103], a[4:7], v[228:231], v[100:103]
v_mfma_f32_16x16x32_bf16 v[104:107], a[36:39], v[224:227], v[104:107]
v_mfma_f32_16x16x32_bf16 v[108:111], a[36:39], v[228:231], v[108:111]
s_lshl_b32 s61, s58, 14
s_lshl_b32 s60, s48, 12
s_add_u32 s61, s61, s60
buffer_load_dwordx4 v[16:19], v247, s[16:19], s61 offen offset:0 sc1
v_mfma_f32_16x16x32_bf16 v[112:115], a[68:71], v[224:227], v[112:115]
ds_read_b128 v[220:223], v212 offset:21504
v_mfma_f32_16x16x32_bf16 v[116:119], a[68:71], v[228:231], v[116:119]
v_mfma_f32_16x16x32_bf16 v[120:123], a[100:103], v[224:227], v[120:123]
v_mfma_f32_16x16x32_bf16 v[124:127], a[100:103], v[228:231], v[124:127]
buffer_load_dwordx4 v[20:23], v247, s[16:19], s61 offen offset:1024 sc1
s_waitcnt lgkmcnt(1)
v_mfma_f32_16x16x32_bf16 v[96:99], a[8:11], v[216:219], v[96:99]
ds_read_b128 v[224:227], v213 offset:22528
s_waitcnt lgkmcnt(1)
v_mfma_f32_16x16x32_bf16 v[100:103], a[8:11], v[220:223], v[100:103]
v_mfma_f32_16x16x32_bf16 v[104:107], a[40:43], v[216:219], v[104:107]
v_mfma_f32_16x16x32_bf16 v[108:111], a[40:43], v[220:223], v[108:111]
buffer_load_dwordx4 v[24:27], v247, s[16:19], s61 offen offset:2048 sc1
v_mfma_f32_16x16x32_bf16 v[112:115], a[72:75], v[216:219], v[112:115]
ds_read_b128 v[228:231], v213 offset:23552
v_mfma_f32_16x16x32_bf16 v[116:119], a[72:75], v[220:223], v[116:119]
v_mfma_f32_16x16x32_bf16 v[120:123], a[104:107], v[216:219], v[120:123]
v_mfma_f32_16x16x32_bf16 v[124:127], a[104:107], v[220:223], v[124:127]
buffer_load_dwordx4 v[28:31], v247, s[16:19], s61 offen offset:3072 sc1
s_waitcnt lgkmcnt(1)
v_mfma_f32_16x16x32_bf16 v[96:99], a[12:15], v[224:227], v[96:99]
ds_read_b128 v[216:219], v212 offset:24576
s_waitcnt lgkmcnt(1)
v_mfma_f32_16x16x32_bf16 v[100:103], a[12:15], v[228:231], v[100:103]
v_mfma_f32_16x16x32_bf16 v[104:107], a[44:47], v[224:227], v[104:107]
v_mfma_f32_16x16x32_bf16 v[108:111], a[44:47], v[228:231], v[108:111]
s_lshl_b32 s61, s59, 14
s_lshl_b32 s60, s48, 12
s_add_u32 s61, s61, s60
buffer_load_dwordx4 v[32:35], v247, s[16:19], s61 offen offset:0 sc1
v_mfma_f32_16x16x32_bf16 v[112:115], a[76:79], v[224:227], v[112:115]
ds_read_b128 v[220:223], v212 offset:25600
v_mfma_f32_16x16x32_bf16 v[116:119], a[76:79], v[228:231], v[116:119]
v_mfma_f32_16x16x32_bf16 v[120:123], a[108:111], v[224:227], v[120:123]
v_mfma_f32_16x16x32_bf16 v[124:127], a[108:111], v[228:231], v[124:127]
buffer_load_dwordx4 v[36:39], v247, s[16:19], s61 offen offset:1024 sc1
s_waitcnt lgkmcnt(1)
v_mfma_f32_16x16x32_bf16 v[96:99], a[16:19], v[216:219], v[96:99]
ds_read_b128 v[224:227], v213 offset:26624
s_waitcnt lgkmcnt(1)
v_mfma_f32_16x16x32_bf16 v[100:103], a[16:19], v[220:223], v[100:103]
v_mfma_f32_16x16x32_bf16 v[104:107], a[48:51], v[216:219], v[104:107]
v_mfma_f32_16x16x32_bf16 v[108:111], a[48:51], v[220:223], v[108:111]
buffer_load_dwordx4 v[40:43], v247, s[16:19], s61 offen offset:2048 sc1
v_mfma_f32_16x16x32_bf16 v[112:115], a[80:83], v[216:219], v[112:115]
ds_read_b128 v[228:231], v213 offset:27648
v_mfma_f32_16x16x32_bf16 v[116:119], a[80:83], v[220:223], v[116:119]
v_mfma_f32_16x16x32_bf16 v[120:123], a[112:115], v[216:219], v[120:123]
v_mfma_f32_16x16x32_bf16 v[124:127], a[112:115], v[220:223], v[124:127]
buffer_load_dwordx4 v[44:47], v247, s[16:19], s61 offen offset:3072 sc1
s_waitcnt lgkmcnt(1)
v_mfma_f32_16x16x32_bf16 v[96:99], a[20:23], v[224:227], v[96:99]
ds_read_b128 v[216:219], v212 offset:28672
s_waitcnt lgkmcnt(1)
v_mfma_f32_16x16x32_bf16 v[100:103], a[20:23], v[228:231], v[100:103]
v_mfma_f32_16x16x32_bf16 v[104:107], a[52:55], v[224:227], v[104:107]
v_mfma_f32_16x16x32_bf16 v[108:111], a[52:55], v[228:231], v[108:111]
v_mfma_f32_16x16x32_bf16 v[112:115], a[84:87], v[224:227], v[112:115]
ds_read_b128 v[220:223], v212 offset:29696
v_mfma_f32_16x16x32_bf16 v[116:119], a[84:87], v[228:231], v[116:119]
v_mfma_f32_16x16x32_bf16 v[120:123], a[116:119], v[224:227], v[120:123]
v_mfma_f32_16x16x32_bf16 v[124:127], a[116:119], v[228:231], v[124:127]
s_waitcnt lgkmcnt(1)
v_mfma_f32_16x16x32_bf16 v[96:99], a[24:27], v[216:219], v[96:99]
ds_read_b128 v[224:227], v213 offset:30720
s_waitcnt lgkmcnt(1)
v_mfma_f32_16x16x32_bf16 v[100:103], a[24:27], v[220:223], v[100:103]
v_mfma_f32_16x16x32_bf16 v[104:107], a[56:59], v[216:219], v[104:107]
v_mfma_f32_16x16x32_bf16 v[108:111], a[56:59], v[220:223], v[108:111]
v_mfma_f32_16x16x32_bf16 v[112:115], a[88:91], v[216:219], v[112:115]
ds_read_b128 v[228:231], v213 offset:31744
v_mfma_f32_16x16x32_bf16 v[116:119], a[88:91], v[220:223], v[116:119]
v_mfma_f32_16x16x32_bf16 v[120:123], a[120:123], v[216:219], v[120:123]
v_mfma_f32_16x16x32_bf16 v[124:127], a[120:123], v[220:223], v[124:127]
s_waitcnt lgkmcnt(1)
v_mfma_f32_16x16x32_bf16 v[96:99], a[28:31], v[224:227], v[96:99]
s_waitcnt lgkmcnt(0)
v_mfma_f32_16x16x32_bf16 v[100:103], a[28:31], v[228:231], v[100:103]
v_mfma_f32_16x16x32_bf16 v[104:107], a[60:63], v[224:227], v[104:107]
v_mfma_f32_16x16x32_bf16 v[108:111], a[60:63], v[228:231], v[108:111]
v_mfma_f32_16x16x32_bf16 v[112:115], a[92:95], v[224:227], v[112:115]
v_mfma_f32_16x16x32_bf16 v[116:119], a[92:95], v[228:231], v[116:119]
v_mfma_f32_16x16x32_bf16 v[120:123], a[124:127], v[224:227], v[120:123]
v_mfma_f32_16x16x32_bf16 v[124:127], a[124:127], v[228:231], v[124:127]
v_add_u32 v216, 118784, v215
ds_read_b64 v[64:65], v216 offset:0
ds_read_b64 v[66:67], v216 offset:128
s_lshl_b32 s60, s48, 12
s_add_u32 s60, s60, 49152
v_add_u32 v216, s60, v247
ds_read_b128 v[48:51], v216 offset:0
ds_read_b128 v[52:55], v216 offset:1024
ds_read_b128 v[56:59], v216 offset:2048
ds_read_b128 v[60:63], v216 offset:3072
s_waitcnt vmcnt(12) lgkmcnt(0)
v_log_f32 v128, v65
v_log_f32 v129, v69
v_log_f32 v130, v73
v_log_f32 v131, v77
s_nop 0
v_add_f32 v128, v128, v64
v_add_f32 v129, v129, v68
v_add_f32 v130, v130, v72
v_add_f32 v131, v131, v76
v_max_f32 v132, v128, v129
v_max3_f32 v132, v132, v130, v131
v_sub_f32 v128, v128, v132
v_sub_f32 v129, v129, v132
v_sub_f32 v130, v130, v132
v_sub_f32 v131, v131, v132
v_exp_f32 v128, v128
v_exp_f32 v129, v129
v_exp_f32 v130, v130
v_exp_f32 v131, v131
v_sub_f32 v80, v64, v132
v_sub_f32 v84, v68, v132
v_sub_f32 v88, v72, v132
v_sub_f32 v92, v76, v132
v_add_f32 v128, v128, v129
v_add_f32 v130, v130, v131
v_exp_f32 v80, v80
v_exp_f32 v84, v84
v_exp_f32 v88, v88
v_exp_f32 v92, v92
v_add_f32 v128, v128, v130
v_rcp_f32 v128, v128
s_nop 0
v_mul_f32 v80, v80, v128
v_mul_f32 v84, v84, v128
v_mul_f32 v88, v88, v128
v_mul_f32 v92, v92, v128
v_log_f32 v128, v67
v_log_f32 v129, v71
v_log_f32 v130, v75
v_log_f32 v131, v79
s_nop 0
v_add_f32 v128, v128, v66
v_add_f32 v129, v129, v70
v_add_f32 v130, v130, v74
v_add_f32 v131, v131, v78
v_max_f32 v132, v128, v129
v_max3_f32 v132, v132, v130, v131
v_sub_f32 v128, v128, v132
v_sub_f32 v129, v129, v132
v_sub_f32 v130, v130, v132
v_sub_f32 v131, v131, v132
v_exp_f32 v128, v128
v_exp_f32 v129, v129
v_exp_f32 v130, v130
v_exp_f32 v131, v131
v_sub_f32 v82, v66, v132
v_sub_f32 v86, v70, v132
v_sub_f32 v90, v74, v132
v_sub_f32 v94, v78, v132
v_add_f32 v128, v128, v129
v_add_f32 v130, v130, v131
v_exp_f32 v82, v82
v_exp_f32 v86, v86
v_exp_f32 v90, v90
v_exp_f32 v94, v94
v_add_f32 v128, v128, v130
v_rcp_f32 v128, v128
s_nop 0
v_mul_f32 v82, v82, v128
v_mul_f32 v86, v86, v128
v_mul_f32 v90, v90, v128
v_mul_f32 v94, v94, v128
v_lshlrev_b32 v160, 16, v48
v_and_b32 v161, 0xffff0000, v48
v_pk_mul_f32 v[128:129], v[160:161], v[80:81] op_sel_hi:[1,0]
v_lshlrev_b32 v162, 16, v49
v_and_b32 v163, 0xffff0000, v49
v_pk_mul_f32 v[130:131], v[162:163], v[80:81] op_sel_hi:[1,0]
v_lshlrev_b32 v164, 16, v50
v_and_b32 v165, 0xffff0000, v50
v_pk_mul_f32 v[132:133], v[164:165], v[80:81] op_sel_hi:[1,0]
v_lshlrev_b32 v166, 16, v51
v_and_b32 v167, 0xffff0000, v51
v_pk_mul_f32 v[134:135], v[166:167], v[80:81] op_sel_hi:[1,0]
buffer_load_dwordx4 a[180:183], v247, s[12:15], s67 offen offset:1024 sc1
v_lshlrev_b32 v168, 16, v52
v_and_b32 v169, 0xffff0000, v52
v_pk_mul_f32 v[136:137], v[168:169], v[82:83] op_sel_hi:[1,0]
v_lshlrev_b32 v170, 16, v53
v_and_b32 v171, 0xffff0000, v53
v_pk_mul_f32 v[138:139], v[170:171], v[82:83] op_sel_hi:[1,0]
v_lshlrev_b32 v172, 16, v54
v_and_b32 v173, 0xffff0000, v54
v_pk_mul_f32 v[140:141], v[172:173], v[82:83] op_sel_hi:[1,0]
v_lshlrev_b32 v174, 16, v55
v_and_b32 v175, 0xffff0000, v55
v_pk_mul_f32 v[142:143], v[174:175], v[82:83] op_sel_hi:[1,0]
buffer_load_dwordx4 a[212:215], v247, s[12:15], s68 offen offset:1024 sc1
v_lshlrev_b32 v160, 16, v56
v_and_b32 v161, 0xffff0000, v56
v_pk_mul_f32 v[144:145], v[160:161], v[80:81] op_sel_hi:[1,0]
v_lshlrev_b32 v162, 16, v57
v_and_b32 v163, 0xffff0000, v57
v_pk_mul_f32 v[146:147], v[162:163], v[80:81] op_sel_hi:[1,0]
v_lshlrev_b32 v164, 16, v58
v_and_b32 v165, 0xffff0000, v58
v_pk_mul_f32 v[148:149], v[164:165], v[80:81] op_sel_hi:[1,0]
v_lshlrev_b32 v166, 16, v59
v_and_b32 v167, 0xffff0000, v59
v_pk_mul_f32 v[150:151], v[166:167], v[80:81] op_sel_hi:[1,0]
buffer_load_dwordx4 a[244:247], v247, s[12:15], s69 offen offset:1024 sc1
v_lshlrev_b32 v168, 16, v60
v_and_b32 v169, 0xffff0000, v60
v_pk_mul_f32 v[152:153], v[168:169], v[82:83] op_sel_hi:[1,0]
v_lshlrev_b32 v170, 16, v61
v_and_b32 v171, 0xffff0000, v61
v_pk_mul_f32 v[154:155], v[170:171], v[82:83] op_sel_hi:[1,0]
v_lshlrev_b32 v172, 16, v62
v_and_b32 v173, 0xffff0000, v62
v_pk_mul_f32 v[156:157], v[172:173], v[82:83] op_sel_hi:[1,0]
v_lshlrev_b32 v174, 16, v63
v_and_b32 v175, 0xffff0000, v63
v_pk_mul_f32 v[158:159], v[174:175], v[82:83] op_sel_hi:[1,0]
buffer_load_dwordx4 a[152:155], v247, s[12:15], s66 offen offset:2048 sc1
s_waitcnt vmcnt(15)
v_lshlrev_b32 v160, 16, v0
v_and_b32 v161, 0xffff0000, v0
v_pk_fma_f32 v[128:129], v[160:161], v[84:85], v[128:129] op_sel_hi:[1,0,1]
v_lshlrev_b32 v162, 16, v1
v_and_b32 v163, 0xffff0000, v1
v_pk_fma_f32 v[130:131], v[162:163], v[84:85], v[130:131] op_sel_hi:[1,0,1]
v_lshlrev_b32 v164, 16, v2
v_and_b32 v165, 0xffff0000, v2
v_pk_fma_f32 v[132:133], v[164:165], v[84:85], v[132:133] op_sel_hi:[1,0,1]
v_lshlrev_b32 v166, 16, v3
v_and_b32 v167, 0xffff0000, v3
v_pk_fma_f32 v[134:135], v[166:167], v[84:85], v[134:135] op_sel_hi:[1,0,1]
buffer_load_dwordx4 a[184:187], v247, s[12:15], s67 offen offset:2048 sc1
s_waitcnt vmcnt(15)
v_lshlrev_b32 v168, 16, v4
v_and_b32 v169, 0xffff0000, v4
v_pk_fma_f32 v[136:137], v[168:169], v[86:87], v[136:137] op_sel_hi:[1,0,1]
v_lshlrev_b32 v170, 16, v5
v_and_b32 v171, 0xffff0000, v5
v_pk_fma_f32 v[138:139], v[170:171], v[86:87], v[138:139] op_sel_hi:[1,0,1]
v_lshlrev_b32 v172, 16, v6
v_and_b32 v173, 0xffff0000, v6
v_pk_fma_f32 v[140:141], v[172:173], v[86:87], v[140:141] op_sel_hi:[1,0,1]
v_lshlrev_b32 v174, 16, v7
v_and_b32 v175, 0xffff0000, v7
v_pk_fma_f32 v[142:143], v[174:175], v[86:87], v[142:143] op_sel_hi:[1,0,1]
buffer_load_dwordx4 a[216:219], v247, s[12:15], s68 offen offset:2048 sc1
s_waitcnt vmcnt(15)
v_lshlrev_b32 v160, 16, v8
v_and_b32 v161, 0xffff0000, v8
v_pk_fma_f32 v[144:145], v[160:161], v[84:85], v[144:145] op_sel_hi:[1,0,1]
v_lshlrev_b32 v162, 16, v9
v_and_b32 v163, 0xffff0000, v9
v_pk_fma_f32 v[146:147], v[162:163], v[84:85], v[146:147] op_sel_hi:[1,0,1]
v_lshlrev_b32 v164, 16, v10
v_and_b32 v165, 0xffff0000, v10
v_pk_fma_f32 v[148:149], v[164:165], v[84:85], v[148:149] op_sel_hi:[1,0,1]
v_lshlrev_b32 v166, 16, v11
v_and_b32 v167, 0xffff0000, v11
v_pk_fma_f32 v[150:151], v[166:167], v[84:85], v[150:151] op_sel_hi:[1,0,1]
buffer_load_dwordx4 a[248:251], v247, s[12:15], s69 offen offset:2048 sc1
s_waitcnt vmcnt(15)
v_lshlrev_b32 v168, 16, v12
v_and_b32 v169, 0xffff0000, v12
v_pk_fma_f32 v[152:153], v[168:169], v[86:87], v[152:153] op_sel_hi:[1,0,1]
v_lshlrev_b32 v170, 16, v13
v_and_b32 v171, 0xffff0000, v13
v_pk_fma_f32 v[154:155], v[170:171], v[86:87], v[154:155] op_sel_hi:[1,0,1]
v_lshlrev_b32 v172, 16, v14
v_and_b32 v173, 0xffff0000, v14
v_pk_fma_f32 v[156:157], v[172:173], v[86:87], v[156:157] op_sel_hi:[1,0,1]
v_lshlrev_b32 v174, 16, v15
v_and_b32 v175, 0xffff0000, v15
v_pk_fma_f32 v[158:159], v[174:175], v[86:87], v[158:159] op_sel_hi:[1,0,1]
buffer_load_dwordx4 a[156:159], v247, s[12:15], s66 offen offset:3072 sc1
s_waitcnt vmcnt(15)
v_lshlrev_b32 v160, 16, v16
v_and_b32 v161, 0xffff0000, v16
v_pk_fma_f32 v[128:129], v[160:161], v[88:89], v[128:129] op_sel_hi:[1,0,1]
v_lshlrev_b32 v162, 16, v17
v_and_b32 v163, 0xffff0000, v17
v_pk_fma_f32 v[130:131], v[162:163], v[88:89], v[130:131] op_sel_hi:[1,0,1]
v_lshlrev_b32 v164, 16, v18
v_and_b32 v165, 0xffff0000, v18
v_pk_fma_f32 v[132:133], v[164:165], v[88:89], v[132:133] op_sel_hi:[1,0,1]
v_lshlrev_b32 v166, 16, v19
v_and_b32 v167, 0xffff0000, v19
v_pk_fma_f32 v[134:135], v[166:167], v[88:89], v[134:135] op_sel_hi:[1,0,1]
buffer_load_dwordx4 a[188:191], v247, s[12:15], s67 offen offset:3072 sc1
s_waitcnt vmcnt(15)
v_lshlrev_b32 v168, 16, v20
v_and_b32 v169, 0xffff0000, v20
v_pk_fma_f32 v[136:137], v[168:169], v[90:91], v[136:137] op_sel_hi:[1,0,1]
v_lshlrev_b32 v170, 16, v21
v_and_b32 v171, 0xffff0000, v21
v_pk_fma_f32 v[138:139], v[170:171], v[90:91], v[138:139] op_sel_hi:[1,0,1]
v_lshlrev_b32 v172, 16, v22
v_and_b32 v173, 0xffff0000, v22
v_pk_fma_f32 v[140:141], v[172:173], v[90:91], v[140:141] op_sel_hi:[1,0,1]
v_lshlrev_b32 v174, 16, v23
v_and_b32 v175, 0xffff0000, v23
v_pk_fma_f32 v[142:143], v[174:175], v[90:91], v[142:143] op_sel_hi:[1,0,1]
buffer_load_dwordx4 a[220:223], v247, s[12:15], s68 offen offset:3072 sc1
s_waitcnt vmcnt(15)
v_lshlrev_b32 v160, 16, v24
v_and_b32 v161, 0xffff0000, v24
v_pk_fma_f32 v[144:145], v[160:161], v[88:89], v[144:145] op_sel_hi:[1,0,1]
v_lshlrev_b32 v162, 16, v25
v_and_b32 v163, 0xffff0000, v25
v_pk_fma_f32 v[146:147], v[162:163], v[88:89], v[146:147] op_sel_hi:[1,0,1]
v_lshlrev_b32 v164, 16, v26
v_and_b32 v165, 0xffff0000, v26
v_pk_fma_f32 v[148:149], v[164:165], v[88:89], v[148:149] op_sel_hi:[1,0,1]
v_lshlrev_b32 v166, 16, v27
v_and_b32 v167, 0xffff0000, v27
v_pk_fma_f32 v[150:151], v[166:167], v[88:89], v[150:151] op_sel_hi:[1,0,1]
buffer_load_dwordx4 a[252:255], v247, s[12:15], s69 offen offset:3072 sc1
s_waitcnt vmcnt(15)
v_lshlrev_b32 v168, 16, v28
v_and_b32 v169, 0xffff0000, v28
v_pk_fma_f32 v[152:153], v[168:169], v[90:91], v[152:153] op_sel_hi:[1,0,1]
v_lshlrev_b32 v170, 16, v29
v_and_b32 v171, 0xffff0000, v29
v_pk_fma_f32 v[154:155], v[170:171], v[90:91], v[154:155] op_sel_hi:[1,0,1]
v_lshlrev_b32 v172, 16, v30
v_and_b32 v173, 0xffff0000, v30
v_pk_fma_f32 v[156:157], v[172:173], v[90:91], v[156:157] op_sel_hi:[1,0,1]
v_lshlrev_b32 v174, 16, v31
v_and_b32 v175, 0xffff0000, v31
v_pk_fma_f32 v[158:159], v[174:175], v[90:91], v[158:159] op_sel_hi:[1,0,1]
buffer_load_dwordx2 v[176:177], v242, s[36:39], 0 offen offset:0
s_waitcnt vmcnt(15)
v_lshlrev_b32 v160, 16, v32
v_and_b32 v161, 0xffff0000, v32
v_pk_fma_f32 v[128:129], v[160:161], v[92:93], v[128:129] op_sel_hi:[1,0,1]
v_lshlrev_b32 v162, 16, v33
v_and_b32 v163, 0xffff0000, v33
v_pk_fma_f32 v[130:131], v[162:163], v[92:93], v[130:131] op_sel_hi:[1,0,1]
v_lshlrev_b32 v164, 16, v34
v_and_b32 v165, 0xffff0000, v34
v_pk_fma_f32 v[132:133], v[164:165], v[92:93], v[132:133] op_sel_hi:[1,0,1]
v_lshlrev_b32 v166, 16, v35
v_and_b32 v167, 0xffff0000, v35
v_pk_fma_f32 v[134:135], v[166:167], v[92:93], v[134:135] op_sel_hi:[1,0,1]
buffer_load_dwordx2 v[178:179], v243, s[36:39], 0 offen offset:0
s_waitcnt vmcnt(15)
v_lshlrev_b32 v168, 16, v36
v_and_b32 v169, 0xffff0000, v36
v_pk_fma_f32 v[136:137], v[168:169], v[94:95], v[136:137] op_sel_hi:[1,0,1]
v_lshlrev_b32 v170, 16, v37
v_and_b32 v171, 0xffff0000, v37
v_pk_fma_f32 v[138:139], v[170:171], v[94:95], v[138:139] op_sel_hi:[1,0,1]
v_lshlrev_b32 v172, 16, v38
v_and_b32 v173, 0xffff0000, v38
v_pk_fma_f32 v[140:141], v[172:173], v[94:95], v[140:141] op_sel_hi:[1,0,1]
v_lshlrev_b32 v174, 16, v39
v_and_b32 v175, 0xffff0000, v39
v_pk_fma_f32 v[142:143], v[174:175], v[94:95], v[142:143] op_sel_hi:[1,0,1]
buffer_load_dwordx2 v[180:181], v242, s[36:39], 0 offen offset:32
s_waitcnt vmcnt(15)
v_lshlrev_b32 v160, 16, v40
v_and_b32 v161, 0xffff0000, v40
v_pk_fma_f32 v[144:145], v[160:161], v[92:93], v[144:145] op_sel_hi:[1,0,1]
v_lshlrev_b32 v162, 16, v41
v_and_b32 v163, 0xffff0000, v41
v_pk_fma_f32 v[146:147], v[162:163], v[92:93], v[146:147] op_sel_hi:[1,0,1]
v_lshlrev_b32 v164, 16, v42
v_and_b32 v165, 0xffff0000, v42
v_pk_fma_f32 v[148:149], v[164:165], v[92:93], v[148:149] op_sel_hi:[1,0,1]
v_lshlrev_b32 v166, 16, v43
v_and_b32 v167, 0xffff0000, v43
v_pk_fma_f32 v[150:151], v[166:167], v[92:93], v[150:151] op_sel_hi:[1,0,1]
buffer_load_dwordx2 v[182:183], v243, s[36:39], 0 offen offset:32
s_waitcnt vmcnt(15)
v_lshlrev_b32 v168, 16, v44
v_and_b32 v169, 0xffff0000, v44
v_pk_fma_f32 v[152:153], v[168:169], v[94:95], v[152:153] op_sel_hi:[1,0,1]
v_lshlrev_b32 v170, 16, v45
v_and_b32 v171, 0xffff0000, v45
v_pk_fma_f32 v[154:155], v[170:171], v[94:95], v[154:155] op_sel_hi:[1,0,1]
v_lshlrev_b32 v172, 16, v46
v_and_b32 v173, 0xffff0000, v46
v_pk_fma_f32 v[156:157], v[172:173], v[94:95], v[156:157] op_sel_hi:[1,0,1]
v_lshlrev_b32 v174, 16, v47
v_and_b32 v175, 0xffff0000, v47
v_pk_fma_f32 v[158:159], v[174:175], v[94:95], v[158:159] op_sel_hi:[1,0,1]
buffer_load_dwordx2 v[184:185], v242, s[36:39], 0 offen offset:64
buffer_load_dwordx2 v[186:187], v243, s[36:39], 0 offen offset:64
buffer_load_dwordx2 v[188:189], v242, s[36:39], 0 offen offset:96
buffer_load_dwordx2 v[190:191], v243, s[36:39], 0 offen offset:96
s_lshl_b32 s60, s48, 12
s_add_u32 s60, s60, 0
v_add_u32 v216, s60, v247
v_cvt_pk_bf16_f32 v0, v128, v129
v_cvt_pk_bf16_f32 v1, v130, v131
v_cvt_pk_bf16_f32 v2, v132, v133
v_cvt_pk_bf16_f32 v3, v134, v135
ds_write_b128 v216, v[0:3] offset:0
v_cvt_pk_bf16_f32 v4, v136, v137
v_cvt_pk_bf16_f32 v5, v138, v139
v_cvt_pk_bf16_f32 v6, v140, v141
v_cvt_pk_bf16_f32 v7, v142, v143
ds_write_b128 v216, v[4:7] offset:1024
v_cvt_pk_bf16_f32 v8, v144, v145
v_cvt_pk_bf16_f32 v9, v146, v147
v_cvt_pk_bf16_f32 v10, v148, v149
v_cvt_pk_bf16_f32 v11, v150, v151
ds_write_b128 v216, v[8:11] offset:2048
v_cvt_pk_bf16_f32 v12, v152, v153
v_cvt_pk_bf16_f32 v13, v154, v155
v_cvt_pk_bf16_f32 v14, v156, v157
v_cvt_pk_bf16_f32 v15, v158, v159
ds_write_b128 v216, v[12:15] offset:3072
s_waitcnt lgkmcnt(0)
s_barrier
ds_read_b128 v[216:219], v247 offset:0
ds_read_b128 v[220:223], v247 offset:1024
s_waitcnt lgkmcnt(1)
v_mfma_f32_16x16x32_bf16 v[96:99], a[128:131], v[216:219], v[96:99]
ds_read_b128 v[224:227], v247 offset:2048
s_waitcnt lgkmcnt(1)
v_mfma_f32_16x16x32_bf16 v[100:103], a[128:131], v[220:223], v[100:103]
v_mfma_f32_16x16x32_bf16 v[104:107], a[160:163], v[216:219], v[104:107]
v_mfma_f32_16x16x32_bf16 v[108:111], a[160:163], v[220:223], v[108:111]
v_mfma_f32_16x16x32_bf16 v[112:115], a[192:195], v[216:219], v[112:115]
ds_read_b128 v[228:231], v247 offset:3072
v_mfma_f32_16x16x32_bf16 v[116:119], a[192:195], v[220:223], v[116:119]
v_mfma_f32_16x16x32_bf16 v[120:123], a[224:227], v[216:219], v[120:123]
v_mfma_f32_16x16x32_bf16 v[124:127], a[224:227], v[220:223], v[124:127]
s_waitcnt lgkmcnt(1)
v_mfma_f32_16x16x32_bf16 v[96:99], a[132:135], v[224:227], v[96:99]
ds_read_b128 v[216:219], v247 offset:4096
s_waitcnt lgkmcnt(1)
v_mfma_f32_16x16x32_bf16 v[100:103], a[132:135], v[228:231], v[100:103]
v_mfma_f32_16x16x32_bf16 v[104:107], a[164:167], v[224:227], v[104:107]
v_mfma_f32_16x16x32_bf16 v[108:111], a[164:167], v[228:231], v[108:111]
v_mfma_f32_16x16x32_bf16 v[112:115], a[196:199], v[224:227], v[112:115]
ds_read_b128 v[220:223], v247 offset:5120
v_mfma_f32_16x16x32_bf16 v[116:119], a[196:199], v[228:231], v[116:119]
v_mfma_f32_16x16x32_bf16 v[120:123], a[228:231], v[224:227], v[120:123]
v_mfma_f32_16x16x32_bf16 v[124:127], a[228:231], v[228:231], v[124:127]
s_waitcnt lgkmcnt(1)
v_mfma_f32_16x16x32_bf16 v[96:99], a[136:139], v[216:219], v[96:99]
ds_read_b128 v[224:227], v247 offset:6144
s_waitcnt lgkmcnt(1)
v_mfma_f32_16x16x32_bf16 v[100:103], a[136:139], v[220:223], v[100:103]
v_mfma_f32_16x16x32_bf16 v[104:107], a[168:171], v[216:219], v[104:107]
v_mfma_f32_16x16x32_bf16 v[108:111], a[168:171], v[220:223], v[108:111]
v_mfma_f32_16x16x32_bf16 v[112:115], a[200:203], v[216:219], v[112:115]
ds_read_b128 v[228:231], v247 offset:7168
v_mfma_f32_16x16x32_bf16 v[116:119], a[200:203], v[220:223], v[116:119]
v_mfma_f32_16x16x32_bf16 v[120:123], a[232:235], v[216:219], v[120:123]
v_mfma_f32_16x16x32_bf16 v[124:127], a[232:235], v[220:223], v[124:127]
s_waitcnt lgkmcnt(1)
v_mfma_f32_16x16x32_bf16 v[96:99], a[140:143], v[224:227], v[96:99]
ds_read_b128 v[216:219], v247 offset:8192
s_waitcnt lgkmcnt(1)
v_mfma_f32_16x16x32_bf16 v[100:103], a[140:143], v[228:231], v[100:103]
v_mfma_f32_16x16x32_bf16 v[104:107], a[172:175], v[224:227], v[104:107]
v_mfma_f32_16x16x32_bf16 v[108:111], a[172:175], v[228:231], v[108:111]
v_mfma_f32_16x16x32_bf16 v[112:115], a[204:207], v[224:227], v[112:115]
ds_read_b128 v[220:223], v247 offset:9216
v_mfma_f32_16x16x32_bf16 v[116:119], a[204:207], v[228:231], v[116:119]
v_mfma_f32_16x16x32_bf16 v[120:123], a[236:239], v[224:227], v[120:123]
v_mfma_f32_16x16x32_bf16 v[124:127], a[236:239], v[228:231], v[124:127]
s_waitcnt lgkmcnt(1)
v_mfma_f32_16x16x32_bf16 v[96:99], a[144:147], v[216:219], v[96:99]
ds_read_b128 v[224:227], v247 offset:10240
s_waitcnt lgkmcnt(1)
v_mfma_f32_16x16x32_bf16 v[100:103], a[144:147], v[220:223], v[100:103]
v_mfma_f32_16x16x32_bf16 v[104:107], a[176:179], v[216:219], v[104:107]
v_mfma_f32_16x16x32_bf16 v[108:111], a[176:179], v[220:223], v[108:111]
v_mfma_f32_16x16x32_bf16 v[112:115], a[208:211], v[216:219], v[112:115]
ds_read_b128 v[228:231], v247 offset:11264
v_mfma_f32_16x16x32_bf16 v[116:119], a[208:211], v[220:223], v[116:119]
v_mfma_f32_16x16x32_bf16 v[120:123], a[240:243], v[216:219], v[120:123]
v_mfma_f32_16x16x32_bf16 v[124:127], a[240:243], v[220:223], v[124:127]
s_waitcnt lgkmcnt(1)
v_mfma_f32_16x16x32_bf16 v[96:99], a[148:151], v[224:227], v[96:99]
ds_read_b128 v[216:219], v247 offset:12288
s_waitcnt lgkmcnt(1)
v_mfma_f32_16x16x32_bf16 v[100:103], a[148:151], v[228:231], v[100:103]
s_waitcnt vmcnt(18)
v_mfma_f32_16x16x32_bf16 v[104:107], a[180:183], v[224:227], v[104:107]
v_mfma_f32_16x16x32_bf16 v[108:111], a[180:183], v[228:231], v[108:111]
s_waitcnt vmcnt(17)
v_mfma_f32_16x16x32_bf16 v[112:115], a[212:215], v[224:227], v[112:115]
ds_read_b128 v[220:223], v247 offset:13312
v_mfma_f32_16x16x32_bf16 v[116:119], a[212:215], v[228:231], v[116:119]
s_waitcnt vmcnt(16)
v_mfma_f32_16x16x32_bf16 v[120:123], a[244:247], v[224:227], v[120:123]
v_mfma_f32_16x16x32_bf16 v[124:127], a[244:247], v[228:231], v[124:127]
s_waitcnt vmcnt(15) lgkmcnt(1)
v_mfma_f32_16x16x32_bf16 v[96:99], a[152:155], v[216:219], v[96:99]
ds_read_b128 v[224:227], v247 offset:14336
s_waitcnt lgkmcnt(1)
v_mfma_f32_16x16x32_bf16 v[100:103], a[152:155], v[220:223], v[100:103]
s_waitcnt vmcnt(14)
v_mfma_f32_16x16x32_bf16 v[104:107], a[184:187], v[216:219], v[104:107]
v_mfma_f32_16x16x32_bf16 v[108:111], a[184:187], v[220:223], v[108:111]
s_waitcnt vmcnt(13)
v_mfma_f32_16x16x32_bf16 v[112:115], a[216:219], v[216:219], v[112:115]
ds_read_b128 v[228:231], v247 offset:15360
v_mfma_f32_16x16x32_bf16 v[116:119], a[216:219], v[220:223], v[116:119]
s_waitcnt vmcnt(12)
v_mfma_f32_16x16x32_bf16 v[120:123], a[248:251], v[216:219], v[120:123]
v_mfma_f32_16x16x32_bf16 v[124:127], a[248:251], v[220:223], v[124:127]
s_waitcnt vmcnt(11) lgkmcnt(1)
v_mfma_f32_16x16x32_bf16 v[96:99], a[156:159], v[224:227], v[96:99]
s_waitcnt lgkmcnt(0)
v_mfma_f32_16x16x32_bf16 v[100:103], a[156:159], v[228:231], v[100:103]
s_waitcnt vmcnt(10)
v_mfma_f32_16x16x32_bf16 v[104:107], a[188:191], v[224:227], v[104:107]
v_mfma_f32_16x16x32_bf16 v[108:111], a[188:191], v[228:231], v[108:111]
s_waitcnt vmcnt(9)
v_mfma_f32_16x16x32_bf16 v[112:115], a[220:223], v[224:227], v[112:115]
v_mfma_f32_16x16x32_bf16 v[116:119], a[220:223], v[228:231], v[116:119]
s_waitcnt vmcnt(8)
v_mfma_f32_16x16x32_bf16 v[120:123], a[252:255], v[224:227], v[120:123]
v_mfma_f32_16x16x32_bf16 v[124:127], a[252:255], v[228:231], v[124:127]
s_waitcnt vmcnt(0)
s_nop 7
v_lshlrev_b32 v128, 16, v176
v_and_b32 v129, 0xffff0000, v176
v_pk_add_f32 v[96:97], v[96:97], v[128:129]
v_lshlrev_b32 v130, 16, v177
v_and_b32 v131, 0xffff0000, v177
v_pk_add_f32 v[98:99], v[98:99], v[130:131]
v_cvt_pk_bf16_f32 v0, v96, v97
v_cvt_pk_bf16_f32 v1, v98, v99
buffer_store_dwordx2 v[0:1], v242, s[40:43], 0 offen offset:0
v_lshlrev_b32 v132, 16, v178
v_and_b32 v133, 0xffff0000, v178
v_pk_add_f32 v[100:101], v[100:101], v[132:133]
v_lshlrev_b32 v134, 16, v179
v_and_b32 v135, 0xffff0000, v179
v_pk_add_f32 v[102:103], v[102:103], v[134:135]
v_cvt_pk_bf16_f32 v2, v100, v101
v_cvt_pk_bf16_f32 v3, v102, v103
buffer_store_dwordx2 v[2:3], v243, s[40:43], 0 offen offset:0
v_lshlrev_b32 v136, 16, v180
v_and_b32 v137, 0xffff0000, v180
v_pk_add_f32 v[104:105], v[104:105], v[136:137]
v_lshlrev_b32 v138, 16, v181
v_and_b32 v139, 0xffff0000, v181
v_pk_add_f32 v[106:107], v[106:107], v[138:139]
v_cvt_pk_bf16_f32 v4, v104, v105
v_cvt_pk_bf16_f32 v5, v106, v107
buffer_store_dwordx2 v[4:5], v242, s[40:43], 0 offen offset:32
v_lshlrev_b32 v140, 16, v182
v_and_b32 v141, 0xffff0000, v182
v_pk_add_f32 v[108:109], v[108:109], v[140:141]
v_lshlrev_b32 v142, 16, v183
v_and_b32 v143, 0xffff0000, v183
v_pk_add_f32 v[110:111], v[110:111], v[142:143]
v_cvt_pk_bf16_f32 v6, v108, v109
v_cvt_pk_bf16_f32 v7, v110, v111
buffer_store_dwordx2 v[6:7], v243, s[40:43], 0 offen offset:32
v_lshlrev_b32 v128, 16, v184
v_and_b32 v129, 0xffff0000, v184
v_pk_add_f32 v[112:113], v[112:113], v[128:129]
v_lshlrev_b32 v130, 16, v185
v_and_b32 v131, 0xffff0000, v185
v_pk_add_f32 v[114:115], v[114:115], v[130:131]
v_cvt_pk_bf16_f32 v8, v112, v113
v_cvt_pk_bf16_f32 v9, v114, v115
buffer_store_dwordx2 v[8:9], v242, s[40:43], 0 offen offset:64
v_lshlrev_b32 v132, 16, v186
v_and_b32 v133, 0xffff0000, v186
v_pk_add_f32 v[116:117], v[116:117], v[132:133]
v_lshlrev_b32 v134, 16, v187
v_and_b32 v135, 0xffff0000, v187
v_pk_add_f32 v[118:119], v[118:119], v[134:135]
v_cvt_pk_bf16_f32 v10, v116, v117
v_cvt_pk_bf16_f32 v11, v118, v119
buffer_store_dwordx2 v[10:11], v243, s[40:43], 0 offen offset:64
v_lshlrev_b32 v136, 16, v188
v_and_b32 v137, 0xffff0000, v188
v_pk_add_f32 v[120:121], v[120:121], v[136:137]
v_lshlrev_b32 v138, 16, v189
v_and_b32 v139, 0xffff0000, v189
v_pk_add_f32 v[122:123], v[122:123], v[138:139]
v_cvt_pk_bf16_f32 v12, v120, v121
v_cvt_pk_bf16_f32 v13, v122, v123
buffer_store_dwordx2 v[12:13], v242, s[40:43], 0 offen offset:96
v_lshlrev_b32 v140, 16, v190
v_and_b32 v141, 0xffff0000, v190
v_pk_add_f32 v[124:125], v[124:125], v[140:141]
v_lshlrev_b32 v142, 16, v191
v_and_b32 v143, 0xffff0000, v191
v_pk_add_f32 v[126:127], v[126:127], v[142:143]
v_cvt_pk_bf16_f32 v14, v124, v125
v_cvt_pk_bf16_f32 v15, v126, v127
buffer_store_dwordx2 v[14:15], v243, s[40:43], 0 offen offset:96
K2_FIN:
s_branch K2_END
K2_SLOW:
s_mov_b32 s54, 1
s_waitcnt vmcnt(0) lgkmcnt(0)
s_barrier
v_mbcnt_lo_u32_b32 v131, -1, 0
v_mbcnt_hi_u32_b32 v131, -1, v131
v_and_b32 v132, 15, v131
v_lshrrev_b32 v133, 4, v131
v_lshrrev_b32 v134, 5, v131
v_and_b32 v135, 31, v131
s_lshl_b32 s60, s49, 13
v_add_u32 v136, 0, v134
v_lshlrev_b32 v136, 1, v136
v_xor_b32 v136, v135, v136
v_lshlrev_b32 v136, 4, v136
v_lshl_add_u32 v136, v134, 9, v136
v_add_u32 v244, s60, v136
v_add_u32 v136, 2, v134
v_lshlrev_b32 v136, 1, v136
v_xor_b32 v136, v135, v136
v_lshlrev_b32 v136, 4, v136
v_lshl_add_u32 v136, v134, 9, v136
v_add_u32 v245, s60, v136
v_add_u32 v136, 4, v134
v_lshlrev_b32 v136, 1, v136
v_xor_b32 v136, v135, v136
v_lshlrev_b32 v136, 4, v136
v_lshl_add_u32 v136, v134, 9, v136
v_add_u32 v246, s60, v136
v_add_u32 v136, 6, v134
v_lshlrev_b32 v136, 1, v136
v_xor_b32 v136, v135, v136
v_lshlrev_b32 v136, 4, v136
v_lshl_add_u32 v136, v134, 9, v136
v_add_u32 v247, s60, v136
s_mul_i32 s60, s51, 2048000
s_add_u32 s60, s60, 0x400000
s_add_u32 s12, s4, s60
s_addc_u32 s13, s5, 0
s_mov_b32 s14, 0x1f4000
s_mov_b32 s15, 0x20000
v_lshlrev_b32 v137, 4, v131
s_lshl_b32 s60, s52, 3
s_lshl_b32 s61, s48, 1
s_add_u32 s60, s60, s61
s_lshl_b32 s60, s60, 13
s_lshl_b32 s61, s48, 14
s_add_u32 s61, s61, 98304
s_cmp_eq_u32 s48, 0
s_cselect_b32 s61, 49152, s61
s_add_u32 m0, s61, 0
s_nop 0
buffer_load_dwordx4 v137, s[12:15], s60 offen offset:0 sc1 lds
buffer_load_dwordx4 v137, s[12:15], s60 offen offset:1024 sc1 lds
buffer_load_dwordx4 v137, s[12:15], s60 offen offset:2048 sc1 lds
buffer_load_dwordx4 v137, s[12:15], s60 offen offset:3072 sc1 lds
s_add_u32 m0, s61, 4096
s_add_u32 s60, s60, 4096
buffer_load_dwordx4 v137, s[12:15], s60 offen offset:0 sc1 lds
buffer_load_dwordx4 v137, s[12:15], s60 offen offset:1024 sc1 lds
buffer_load_dwordx4 v137, s[12:15], s60 offen offset:2048 sc1 lds
buffer_load_dwordx4 v137, s[12:15], s60 offen offset:3072 sc1 lds
s_add_u32 m0, s61, 8192
s_add_u32 s60, s60, 4096
buffer_load_dwordx4 v137, s[12:15], s60 offen offset:0 sc1 lds
buffer_load_dwordx4 v137, s[12:15], s60 offen offset:1024 sc1 lds
buffer_load_dwordx4 v137, s[12:15], s60 offen offset:2048 sc1 lds
buffer_load_dwordx4 v137, s[12:15], s60 offen offset:3072 sc1 lds
s_add_u32 m0, s61, 12288
s_add_u32 s60, s60, 4096
buffer_load_dwordx4 v137, s[12:15], s60 offen offset:0 sc1 lds
buffer_load_dwordx4 v137, s[12:15], s60 offen offset:1024 sc1 lds
buffer_load_dwordx4 v137, s[12:15], s60 offen offset:2048 sc1 lds
buffer_load_dwordx4 v137, s[12:15], s60 offen offset:3072 sc1 lds
v_and_b32 v136, 7, v132
v_lshlrev_b32 v136, 1, v136
v_lshlrev_b32 v138, 9, v132
s_lshl_b32 s60, s50, 16
v_add_u32 v138, s60, v138
v_add_u32 v139, 0, v133
v_xor_b32 v139, v139, v136
v_lshl_add_u32 v232, v139, 4, v138
v_add_u32 v139, 4, v133
v_xor_b32 v139, v139, v136
v_lshl_add_u32 v233, v139, 4, v138
v_add_u32 v139, 8, v133
v_xor_b32 v139, v139, v136
v_lshl_add_u32 v234, v139, 4, v138
v_add_u32 v139, 12, v133
v_xor_b32 v139, v139, v136
v_lshl_add_u32 v235, v139, 4, v138
v_lshrrev_b32 v136, 2, v132
v_lshl_add_u32 v136, v133, 2, v136
v_lshlrev_b32 v138, 9, v136
v_add_u32 v138, s60, v138
v_and_b32 v139, 1, v132
v_lshl_add_u32 v138, v139, 3, v138
v_and_b32 v136, 7, v136
v_lshlrev_b32 v136, 1, v136
v_bfe_u32 v139, v132, 1, 1
v_add_u32 v140, 0, v139
v_xor_b32 v140, v140, v136
v_lshl_add_u32 v236, v140, 4, v138
v_add_u32 v140, 2, v139
v_xor_b32 v140, v140, v136
v_lshl_add_u32 v237, v140, 4, v138
v_add_u32 v140, 4, v139
v_xor_b32 v140, v140, v136
v_lshl_add_u32 v238, v140, 4, v138
v_add_u32 v140, 6, v139
v_xor_b32 v140, v140, v136
v_lshl_add_u32 v239, v140, 4, v138
v_add_u32 v140, 8, v139
v_xor_b32 v140, v140, v136
v_lshl_add_u32 v240, v140, 4, v138
v_add_u32 v140, 10, v139
v_xor_b32 v140, v140, v136
v_lshl_add_u32 v241, v140, 4, v138
v_add_u32 v140, 12, v139
v_xor_b32 v140, v140, v136
v_lshl_add_u32 v242, v140, 4, v138
v_add_u32 v140, 14, v139
v_xor_b32 v140, v140, v136
v_lshl_add_u32 v243, v140, 4, v138
v_mov_b32 v0, 0
v_mov_b32 v1, 0
v_mov_b32 v2, 0
v_mov_b32 v3, 0
v_mov_b32 v4, 0
v_mov_b32 v5, 0
v_mov_b32 v6, 0
v_mov_b32 v7, 0
v_mov_b32 v8, 0
v_mov_b32 v9, 0
v_mov_b32 v10, 0
v_mov_b32 v11, 0
v_mov_b32 v12, 0
v_mov_b32 v13, 0
v_mov_b32 v14, 0
v_mov_b32 v15, 0
v_mov_b32 v16, 0
v_mov_b32 v17, 0
v_mov_b32 v18, 0
v_mov_b32 v19, 0
v_mov_b32 v20, 0
v_mov_b32 v21, 0
v_mov_b32 v22, 0
v_mov_b32 v23, 0
v_mov_b32 v24, 0
v_mov_b32 v25, 0
v_mov_b32 v26, 0
v_mov_b32 v27, 0
v_mov_b32 v28, 0
v_mov_b32 v29, 0
v_mov_b32 v30, 0
v_mov_b32 v31, 0
v_mov_b32 v32, 0
v_mov_b32 v33, 0
v_mov_b32 v34, 0
v_mov_b32 v35, 0
v_mov_b32 v36, 0
v_mov_b32 v37, 0
v_mov_b32 v38, 0
v_mov_b32 v39, 0
v_mov_b32 v40, 0
v_mov_b32 v41, 0
v_mov_b32 v42, 0
v_mov_b32 v43, 0
v_mov_b32 v44, 0
v_mov_b32 v45, 0
v_mov_b32 v46, 0
v_mov_b32 v47, 0
v_mov_b32 v48, 0
v_mov_b32 v49, 0
v_mov_b32 v50, 0
v_mov_b32 v51, 0
v_mov_b32 v52, 0
v_mov_b32 v53, 0
v_mov_b32 v54, 0
v_mov_b32 v55, 0
v_mov_b32 v56, 0
v_mov_b32 v57, 0
v_mov_b32 v58, 0
v_mov_b32 v59, 0
v_mov_b32 v60, 0
v_mov_b32 v61, 0
v_mov_b32 v62, 0
v_mov_b32 v63, 0
v_mov_b32 v64, 0
v_mov_b32 v65, 0
v_mov_b32 v66, 0
v_mov_b32 v67, 0
v_mov_b32 v68, 0
v_mov_b32 v69, 0
v_mov_b32 v70, 0
v_mov_b32 v71, 0
v_mov_b32 v72, 0
v_mov_b32 v73, 0
v_mov_b32 v74, 0
v_mov_b32 v75, 0
v_mov_b32 v76, 0
v_mov_b32 v77, 0
v_mov_b32 v78, 0
v_mov_b32 v79, 0
v_mov_b32 v80, 0
v_mov_b32 v81, 0
v_mov_b32 v82, 0
v_mov_b32 v83, 0
v_mov_b32 v84, 0
v_mov_b32 v85, 0
v_mov_b32 v86, 0
v_mov_b32 v87, 0
v_mov_b32 v88, 0
v_mov_b32 v89, 0
v_mov_b32 v90, 0
v_mov_b32 v91, 0
v_mov_b32 v92, 0
v_mov_b32 v93, 0
v_mov_b32 v94, 0
v_mov_b32 v95, 0
v_mov_b32 v96, 0
v_mov_b32 v97, 0
v_mov_b32 v98, 0
v_mov_b32 v99, 0
v_mov_b32 v100, 0
v_mov_b32 v101, 0
v_mov_b32 v102, 0
v_mov_b32 v103, 0
v_mov_b32 v104, 0
v_mov_b32 v105, 0
v_mov_b32 v106, 0
v_mov_b32 v107, 0
v_mov_b32 v108, 0
v_mov_b32 v109, 0
v_mov_b32 v110, 0
v_mov_b32 v111, 0
v_mov_b32 v112, 0
v_mov_b32 v113, 0
v_mov_b32 v114, 0
v_mov_b32 v115, 0
v_mov_b32 v116, 0
v_mov_b32 v117, 0
v_mov_b32 v118, 0
v_mov_b32 v119, 0
v_mov_b32 v120, 0
v_mov_b32 v121, 0
v_mov_b32 v122, 0
v_mov_b32 v123, 0
v_mov_b32 v124, 0
v_mov_b32 v125, 0
v_mov_b32 v126, 0
v_mov_b32 v127, 0
v_accvgpr_write_b32 a128, 0
v_accvgpr_write_b32 a129, 0
v_accvgpr_write_b32 a130, 0
v_accvgpr_write_b32 a131, 0
v_accvgpr_write_b32 a132, 0
v_accvgpr_write_b32 a133, 0
v_accvgpr_write_b32 a134, 0
v_accvgpr_write_b32 a135, 0
v_accvgpr_write_b32 a136, 0
v_accvgpr_write_b32 a137, 0
v_accvgpr_write_b32 a138, 0
v_accvgpr_write_b32 a139, 0
v_accvgpr_write_b32 a140, 0
v_accvgpr_write_b32 a141, 0
v_accvgpr_write_b32 a142, 0
v_accvgpr_write_b32 a143, 0
v_accvgpr_write_b32 a144, 0
v_accvgpr_write_b32 a145, 0
v_accvgpr_write_b32 a146, 0
v_accvgpr_write_b32 a147, 0
v_accvgpr_write_b32 a148, 0
v_accvgpr_write_b32 a149, 0
v_accvgpr_write_b32 a150, 0
v_accvgpr_write_b32 a151, 0
v_accvgpr_write_b32 a152, 0
v_accvgpr_write_b32 a153, 0
v_accvgpr_write_b32 a154, 0
v_accvgpr_write_b32 a155, 0
v_accvgpr_write_b32 a156, 0
v_accvgpr_write_b32 a157, 0
v_accvgpr_write_b32 a158, 0
v_accvgpr_write_b32 a159, 0
v_accvgpr_write_b32 a160, 0
v_accvgpr_write_b32 a161, 0
v_accvgpr_write_b32 a162, 0
v_accvgpr_write_b32 a163, 0
v_accvgpr_write_b32 a164, 0
v_accvgpr_write_b32 a165, 0
v_accvgpr_write_b32 a166, 0
v_accvgpr_write_b32 a167, 0
v_accvgpr_write_b32 a168, 0
v_accvgpr_write_b32 a169, 0
v_accvgpr_write_b32 a170, 0
v_accvgpr_write_b32 a171, 0
v_accvgpr_write_b32 a172, 0
v_accvgpr_write_b32 a173, 0
v_accvgpr_write_b32 a174, 0
v_accvgpr_write_b32 a175, 0
v_accvgpr_write_b32 a176, 0
v_accvgpr_write_b32 a177, 0
v_accvgpr_write_b32 a178, 0
v_accvgpr_write_b32 a179, 0
v_accvgpr_write_b32 a180, 0
v_accvgpr_write_b32 a181, 0
v_accvgpr_write_b32 a182, 0
v_accvgpr_write_b32 a183, 0
v_accvgpr_write_b32 a184, 0
v_accvgpr_write_b32 a185, 0
v_accvgpr_write_b32 a186, 0
v_accvgpr_write_b32 a187, 0
v_accvgpr_write_b32 a188, 0
v_accvgpr_write_b32 a189, 0
v_accvgpr_write_b32 a190, 0
v_accvgpr_write_b32 a191, 0
v_accvgpr_write_b32 a192, 0
v_accvgpr_write_b32 a193, 0
v_accvgpr_write_b32 a194, 0
v_accvgpr_write_b32 a195, 0
v_accvgpr_write_b32 a196, 0
v_accvgpr_write_b32 a197, 0
v_accvgpr_write_b32 a198, 0
v_accvgpr_write_b32 a199, 0
v_accvgpr_write_b32 a200, 0
v_accvgpr_write_b32 a201, 0
v_accvgpr_write_b32 a202, 0
v_accvgpr_write_b32 a203, 0
v_accvgpr_write_b32 a204, 0
v_accvgpr_write_b32 a205, 0
v_accvgpr_write_b32 a206, 0
v_accvgpr_write_b32 a207, 0
v_accvgpr_write_b32 a208, 0
v_accvgpr_write_b32 a209, 0
v_accvgpr_write_b32 a210, 0
v_accvgpr_write_b32 a211, 0
v_accvgpr_write_b32 a212, 0
v_accvgpr_write_b32 a213, 0
v_accvgpr_write_b32 a214, 0
v_accvgpr_write_b32 a215, 0
v_accvgpr_write_b32 a216, 0
v_accvgpr_write_b32 a217, 0
v_accvgpr_write_b32 a218, 0
v_accvgpr_write_b32 a219, 0
v_accvgpr_write_b32 a220, 0
v_accvgpr_write_b32 a221, 0
v_accvgpr_write_b32 a222, 0
v_accvgpr_write_b32 a223, 0
v_accvgpr_write_b32 a224, 0
v_accvgpr_write_b32 a225, 0
v_accvgpr_write_b32 a226, 0
v_accvgpr_write_b32 a227, 0
v_accvgpr_write_b32 a228, 0
v_accvgpr_write_b32 a229, 0
v_accvgpr_write_b32 a230, 0
v_accvgpr_write_b32 a231, 0
v_accvgpr_write_b32 a232, 0
v_accvgpr_write_b32 a233, 0
v_accvgpr_write_b32 a234, 0
v_accvgpr_write_b32 a235, 0
v_accvgpr_write_b32 a236, 0
v_accvgpr_write_b32 a237, 0
v_accvgpr_write_b32 a238, 0
v_accvgpr_write_b32 a239, 0
v_accvgpr_write_b32 a240, 0
v_accvgpr_write_b32 a241, 0
v_accvgpr_write_b32 a242, 0
v_accvgpr_write_b32 a243, 0
v_accvgpr_write_b32 a244, 0
v_accvgpr_write_b32 a245, 0
v_accvgpr_write_b32 a246, 0
v_accvgpr_write_b32 a247, 0
v_accvgpr_write_b32 a248, 0
v_accvgpr_write_b32 a249, 0
v_accvgpr_write_b32 a250, 0
v_accvgpr_write_b32 a251, 0
v_accvgpr_write_b32 a252, 0
v_accvgpr_write_b32 a253, 0
v_accvgpr_write_b32 a254, 0
v_accvgpr_write_b32 a255, 0
v_mov_b32 v248, 0
v_mov_b32 v192, 0xf149f2ca
v_mov_b32 v249, 0
v_mov_b32 v193, 0xf149f2ca
v_mov_b32 v250, 0
v_mov_b32 v194, 0xf149f2ca
v_mov_b32 v251, 0
v_mov_b32 v195, 0xf149f2ca
s_lshl_b32 s56, s50, 16
s_lshl_b32 s60, s49, 13
s_add_u32 s56, s56, s60
s_mov_b32 s57, 0
s_mov_b32 s58, 0
s_waitcnt vmcnt(0)
s_barrier
v_lshlrev_b32 v137, 4, v131
s_lshl_b32 s60, s50, 1
s_add_u32 s60, s60, 0
s_and_b32 s60, s60, 3
s_lshl_b32 s61, s49, 2
s_add_u32 s60, s60, s61
s_lshr_b32 s61, s60, 1
s_lshl_b32 s62, s61, 14
s_add_u32 s62, s62, 98304
s_cmp_eq_u32 s61, 0
s_cselect_b32 s62, 49152, s62
s_and_b32 s60, s60, 1
s_lshl_b32 s60, s60, 13
s_add_u32 s62, s62, s60
v_add_u32 v140, s62, v137
s_lshl_b32 s60, s50, 1
s_add_u32 s60, s60, 1
s_and_b32 s60, s60, 3
s_lshl_b32 s61, s49, 2
s_add_u32 s60, s60, s61
s_lshr_b32 s61, s60, 1
s_lshl_b32 s62, s61, 14
s_add_u32 s62, s62, 98304
s_cmp_eq_u32 s61, 0
s_cselect_b32 s62, 49152, s62
s_and_b32 s60, s60, 1
s_lshl_b32 s60, s60, 13
s_add_u32 s62, s62, s60
v_add_u32 v141, s62, v137
s_lshl_b32 s60, s50, 1
s_add_u32 s60, s60, 2
s_and_b32 s60, s60, 3
s_lshl_b32 s61, s49, 2
s_add_u32 s60, s60, s61
s_lshr_b32 s61, s60, 1
s_lshl_b32 s62, s61, 14
s_add_u32 s62, s62, 98304
s_cmp_eq_u32 s61, 0
s_cselect_b32 s62, 49152, s62
s_and_b32 s60, s60, 1
s_lshl_b32 s60, s60, 13
s_add_u32 s62, s62, s60
v_add_u32 v142, s62, v137
s_lshl_b32 s60, s50, 1
s_add_u32 s60, s60, 3
s_and_b32 s60, s60, 3
s_lshl_b32 s61, s49, 2
s_add_u32 s60, s60, s61
s_lshr_b32 s61, s60, 1
s_lshl_b32 s62, s61, 14
s_add_u32 s62, s62, 98304
s_cmp_eq_u32 s61, 0
s_cselect_b32 s62, 49152, s62
s_and_b32 s60, s60, 1
s_lshl_b32 s60, s60, 13
s_add_u32 s62, s62, s60
v_add_u32 v143, s62, v137
ds_read_b128 a[0:3], v140 offset:0
ds_read_b128 a[32:35], v141 offset:0
ds_read_b128 a[64:67], v142 offset:0
ds_read_b128 a[96:99], v143 offset:0
ds_read_b128 a[4:7], v140 offset:1024
ds_read_b128 a[36:39], v141 offset:1024
ds_read_b128 a[68:71], v142 offset:1024
ds_read_b128 a[100:103], v143 offset:1024
ds_read_b128 a[8:11], v140 offset:2048
ds_read_b128 a[40:43], v141 offset:2048
ds_read_b128 a[72:75], v142 offset:2048
ds_read_b128 a[104:107], v143 offset:2048
ds_read_b128 a[12:15], v140 offset:3072
ds_read_b128 a[44:47], v141 offset:3072
ds_read_b128 a[76:79], v142 offset:3072
ds_read_b128 a[108:111], v143 offset:3072
ds_read_b128 a[16:19], v140 offset:4096
ds_read_b128 a[48:51], v141 offset:4096
ds_read_b128 a[80:83], v142 offset:4096
ds_read_b128 a[112:115], v143 offset:4096
ds_read_b128 a[20:23], v140 offset:5120
ds_read_b128 a[52:55], v141 offset:5120
ds_read_b128 a[84:87], v142 offset:5120
ds_read_b128 a[116:119], v143 offset:5120
ds_read_b128 a[24:27], v140 offset:6144
ds_read_b128 a[56:59], v141 offset:6144
ds_read_b128 a[88:91], v142 offset:6144
ds_read_b128 a[120:123], v143 offset:6144
ds_read_b128 a[28:31], v140 offset:7168
ds_read_b128 a[60:63], v141 offset:7168
ds_read_b128 a[92:95], v142 offset:7168
ds_read_b128 a[124:127], v143 offset:7168
s_waitcnt lgkmcnt(0)
K2_SL_LOOP:
s_barrier
s_add_u32 m0, s56, 0x0
s_nop 0
buffer_load_dwordx4 v244, s[8:11], s57 offen offset:0 sc1 lds
buffer_load_dwordx4 v245, s[8:11], s57 offen offset:1024 sc1 lds
buffer_load_dwordx4 v246, s[8:11], s57 offen offset:2048 sc1 lds
buffer_load_dwordx4 v247, s[8:11], s57 offen offset:3072 sc1 lds
s_add_u32 m0, s56, 0x1000
s_add_u32 s57, s57, 4096
buffer_load_dwordx4 v244, s[8:11], s57 offen offset:0 sc1 lds
buffer_load_dwordx4 v245, s[8:11], s57 offen offset:1024 sc1 lds
buffer_load_dwordx4 v246, s[8:11], s57 offen offset:2048 sc1 lds
buffer_load_dwordx4 v247, s[8:11], s57 offen offset:3072 sc1 lds
s_add_u32 s57, s57, 12288
s_waitcnt vmcnt(0)
s_barrier
s_lshl_b32 s60, s58, 14
s_cmp_lt_u32 s60, s55
s_cbranch_scc0 K2_SL_NEXT
ds_read_b128 v[208:211], v232 offset:0
s_waitcnt lgkmcnt(0)
v_mfma_f32_16x16x32_bf16 v[128:131], v[208:211], a[0:3], 0
v_mfma_f32_16x16x32_bf16 v[132:135], v[208:211], a[32:35], 0
v_mfma_f32_16x16x32_bf16 v[136:139], v[208:211], a[64:67], 0
v_mfma_f32_16x16x32_bf16 v[140:143], v[208:211], a[96:99], 0
s_nop 3
ds_read_b128 v[208:211], v233 offset:0
s_waitcnt lgkmcnt(0)
v_mfma_f32_16x16x32_bf16 v[128:131], v[208:211], a[4:7], v[128:131]
v_mfma_f32_16x16x32_bf16 v[132:135], v[208:211], a[36:39], v[132:135]
v_mfma_f32_16x16x32_bf16 v[136:139], v[208:211], a[68:71], v[136:139]
v_mfma_f32_16x16x32_bf16 v[140:143], v[208:211], a[100:103], v[140:143]
s_nop 3
ds_read_b128 v[208:211], v234 offset:0
s_waitcnt lgkmcnt(0)
v_mfma_f32_16x16x32_bf16 v[128:131], v[208:211], a[8:11], v[128:131]
v_mfma_f32_16x16x32_bf16 v[132:135], v[208:211], a[40:43], v[132:135]
v_mfma_f32_16x16x32_bf16 v[136:139], v[208:211], a[72:75], v[136:139]
v_mfma_f32_16x16x32_bf16 v[140:143], v[208:211], a[104:107], v[140:143]
s_nop 3
ds_read_b128 v[208:211], v235 offset:0
s_waitcnt lgkmcnt(0)
v_mfma_f32_16x16x32_bf16 v[128:131], v[208:211], a[12:15], v[128:131]
v_mfma_f32_16x16x32_bf16 v[132:135], v[208:211], a[44:47], v[132:135]
v_mfma_f32_16x16x32_bf16 v[136:139], v[208:211], a[76:79], v[136:139]
v_mfma_f32_16x16x32_bf16 v[140:143], v[208:211], a[108:111], v[140:143]
s_nop 3
ds_read_b128 v[208:211], v232 offset:256
s_waitcnt lgkmcnt(0)
v_mfma_f32_16x16x32_bf16 v[128:131], v[208:211], a[16:19], v[128:131]
v_mfma_f32_16x16x32_bf16 v[132:135], v[208:211], a[48:51], v[132:135]
v_mfma_f32_16x16x32_bf16 v[136:139], v[208:211], a[80:83], v[136:139]
v_mfma_f32_16x16x32_bf16 v[140:143], v[208:211], a[112:115], v[140:143]
s_nop 3
ds_read_b128 v[208:211], v233 offset:256
s_waitcnt lgkmcnt(0)
v_mfma_f32_16x16x32_bf16 v[128:131], v[208:211], a[20:23], v[128:131]
v_mfma_f32_16x16x32_bf16 v[132:135], v[208:211], a[52:55], v[132:135]
v_mfma_f32_16x16x32_bf16 v[136:139], v[208:211], a[84:87], v[136:139]
v_mfma_f32_16x16x32_bf16 v[140:143], v[208:211], a[116:119], v[140:143]
s_nop 3
ds_read_b128 v[208:211], v234 offset:256
s_waitcnt lgkmcnt(0)
v_mfma_f32_16x16x32_bf16 v[128:131], v[208:211], a[24:27], v[128:131]
v_mfma_f32_16x16x32_bf16 v[132:135], v[208:211], a[56:59], v[132:135]
v_mfma_f32_16x16x32_bf16 v[136:139], v[208:211], a[88:91], v[136:139]
v_mfma_f32_16x16x32_bf16 v[140:143], v[208:211], a[120:123], v[140:143]
s_nop 3
ds_read_b128 v[208:211], v235 offset:256
s_waitcnt lgkmcnt(0)
v_mfma_f32_16x16x32_bf16 v[128:131], v[208:211], a[28:31], v[128:131]
v_mfma_f32_16x16x32_bf16 v[132:135], v[208:211], a[60:63], v[132:135]
v_mfma_f32_16x16x32_bf16 v[136:139], v[208:211], a[92:95], v[136:139]
v_mfma_f32_16x16x32_bf16 v[140:143], v[208:211], a[124:127], v[140:143]
s_nop 3
ds_read_b128 v[208:211], v232 offset:8192
s_waitcnt lgkmcnt(0)
v_mfma_f32_16x16x32_bf16 v[144:147], v[208:211], a[0:3], 0
v_mfma_f32_16x16x32_bf16 v[148:151], v[208:211], a[32:35], 0
v_mfma_f32_16x16x32_bf16 v[152:155], v[208:211], a[64:67], 0
v_mfma_f32_16x16x32_bf16 v[156:159], v[208:211], a[96:99], 0
s_nop 3
ds_read_b128 v[208:211], v233 offset:8192
s_waitcnt lgkmcnt(0)
v_mfma_f32_16x16x32_bf16 v[144:147], v[208:211], a[4:7], v[144:147]
v_mfma_f32_16x16x32_bf16 v[148:151], v[208:211], a[36:39], v[148:151]
v_mfma_f32_16x16x32_bf16 v[152:155], v[208:211], a[68:71], v[152:155]
v_mfma_f32_16x16x32_bf16 v[156:159], v[208:211], a[100:103], v[156:159]
s_nop 3
ds_read_b128 v[208:211], v234 offset:8192
s_waitcnt lgkmcnt(0)
v_mfma_f32_16x16x32_bf16 v[144:147], v[208:211], a[8:11], v[144:147]
v_mfma_f32_16x16x32_bf16 v[148:151], v[208:211], a[40:43], v[148:151]
v_mfma_f32_16x16x32_bf16 v[152:155], v[208:211], a[72:75], v[152:155]
v_mfma_f32_16x16x32_bf16 v[156:159], v[208:211], a[104:107], v[156:159]
s_nop 3
ds_read_b128 v[208:211], v235 offset:8192
s_waitcnt lgkmcnt(0)
v_mfma_f32_16x16x32_bf16 v[144:147], v[208:211], a[12:15], v[144:147]
v_mfma_f32_16x16x32_bf16 v[148:151], v[208:211], a[44:47], v[148:151]
v_mfma_f32_16x16x32_bf16 v[152:155], v[208:211], a[76:79], v[152:155]
v_mfma_f32_16x16x32_bf16 v[156:159], v[208:211], a[108:111], v[156:159]
s_nop 3
ds_read_b128 v[208:211], v232 offset:8448
s_waitcnt lgkmcnt(0)
v_mfma_f32_16x16x32_bf16 v[144:147], v[208:211], a[16:19], v[144:147]
v_mfma_f32_16x16x32_bf16 v[148:151], v[208:211], a[48:51], v[148:151]
v_mfma_f32_16x16x32_bf16 v[152:155], v[208:211], a[80:83], v[152:155]
v_mfma_f32_16x16x32_bf16 v[156:159], v[208:211], a[112:115], v[156:159]
s_nop 3
ds_read_b128 v[208:211], v233 offset:8448
s_waitcnt lgkmcnt(0)
v_mfma_f32_16x16x32_bf16 v[144:147], v[208:211], a[20:23], v[144:147]
v_mfma_f32_16x16x32_bf16 v[148:151], v[208:211], a[52:55], v[148:151]
v_mfma_f32_16x16x32_bf16 v[152:155], v[208:211], a[84:87], v[152:155]
v_mfma_f32_16x16x32_bf16 v[156:159], v[208:211], a[116:119], v[156:159]
s_nop 3
ds_read_b128 v[208:211], v234 offset:8448
s_waitcnt lgkmcnt(0)
v_mfma_f32_16x16x32_bf16 v[144:147], v[208:211], a[24:27], v[144:147]
v_mfma_f32_16x16x32_bf16 v[148:151], v[208:211], a[56:59], v[148:151]
v_mfma_f32_16x16x32_bf16 v[152:155], v[208:211], a[88:91], v[152:155]
v_mfma_f32_16x16x32_bf16 v[156:159], v[208:211], a[120:123], v[156:159]
s_nop 3
ds_read_b128 v[208:211], v235 offset:8448
s_waitcnt lgkmcnt(0)
v_mfma_f32_16x16x32_bf16 v[144:147], v[208:211], a[28:31], v[144:147]
v_mfma_f32_16x16x32_bf16 v[148:151], v[208:211], a[60:63], v[148:151]
v_mfma_f32_16x16x32_bf16 v[152:155], v[208:211], a[92:95], v[152:155]
v_mfma_f32_16x16x32_bf16 v[156:159], v[208:211], a[124:127], v[156:159]
s_nop 3
s_nop 7
v_max3_f32 v196, v128, v129, v130
v_max3_f32 v196, v196, v131, v144
v_max3_f32 v196, v196, v145, v146
v_max3_f32 v196, v196, v147, v192
v_max3_f32 v197, v132, v133, v134
v_max3_f32 v197, v197, v135, v148
v_max3_f32 v197, v197, v149, v150
v_max3_f32 v197, v197, v151, v193
v_max3_f32 v198, v136, v137, v138
v_max3_f32 v198, v198, v139, v152
v_max3_f32 v198, v198, v153, v154
v_max3_f32 v198, v198, v155, v194
v_max3_f32 v199, v140, v141, v142
v_max3_f32 v199, v199, v143, v156
v_max3_f32 v199, v199, v157, v158
v_max3_f32 v199, v199, v159, v195
v_mov_b32 v200, v196
v_mov_b32 v201, v197
v_mov_b32 v202, v198
v_mov_b32 v203, v199
s_nop 1
v_permlane16_swap_b32 v196, v200
v_permlane16_swap_b32 v197, v201
v_permlane16_swap_b32 v198, v202
v_permlane16_swap_b32 v199, v203
s_nop 1
v_max_f32 v196, v196, v200
v_max_f32 v197, v197, v201
v_max_f32 v198, v198, v202
v_max_f32 v199, v199, v203
v_mov_b32 v200, v196
v_mov_b32 v201, v197
v_mov_b32 v202, v198
v_mov_b32 v203, v199
s_nop 1
v_permlane32_swap_b32 v196, v200
v_permlane32_swap_b32 v197, v201
v_permlane32_swap_b32 v198, v202
v_permlane32_swap_b32 v199, v203
s_nop 1
v_max_f32 v196, v196, v200
v_max_f32 v197, v197, v201
v_max_f32 v198, v198, v202
v_max_f32 v199, v199, v203
v_sub_f32 v200, v192, v196
v_exp_f32 v200, v200
v_mov_b32 v192, v196
v_sub_f32 v201, v193, v197
v_exp_f32 v201, v201
v_mov_b32 v193, v197
v_sub_f32 v202, v194, v198
v_exp_f32 v202, v202
v_mov_b32 v194, v198
v_sub_f32 v203, v195, v199
v_exp_f32 v203, v203
v_mov_b32 v195, v199
s_nop 0
v_mul_f32 v248, v248, v200
v_sub_f32 v128, v128, v192
v_exp_f32 v128, v128
s_nop 0
v_add_f32 v248, v248, v128
v_sub_f32 v129, v129, v192
v_exp_f32 v129, v129
s_nop 0
v_add_f32 v248, v248, v129
v_sub_f32 v130, v130, v192
v_exp_f32 v130, v130
s_nop 0
v_add_f32 v248, v248, v130
v_sub_f32 v131, v131, v192
v_exp_f32 v131, v131
s_nop 0
v_add_f32 v248, v248, v131
v_cvt_pk_bf16_f32 v160, v128, v129
v_cvt_pk_bf16_f32 v161, v130, v131
v_sub_f32 v144, v144, v192
v_exp_f32 v144, v144
s_nop 0
v_add_f32 v248, v248, v144
v_sub_f32 v145, v145, v192
v_exp_f32 v145, v145
s_nop 0
v_add_f32 v248, v248, v145
v_sub_f32 v146, v146, v192
v_exp_f32 v146, v146
s_nop 0
v_add_f32 v248, v248, v146
v_sub_f32 v147, v147, v192
v_exp_f32 v147, v147
s_nop 0
v_add_f32 v248, v248, v147
v_cvt_pk_bf16_f32 v162, v144, v145
v_cvt_pk_bf16_f32 v163, v146, v147
v_mul_f32 v249, v249, v201
v_sub_f32 v132, v132, v193
v_exp_f32 v132, v132
s_nop 0
v_add_f32 v249, v249, v132
v_sub_f32 v133, v133, v193
v_exp_f32 v133, v133
s_nop 0
v_add_f32 v249, v249, v133
v_sub_f32 v134, v134, v193
v_exp_f32 v134, v134
s_nop 0
v_add_f32 v249, v249, v134
v_sub_f32 v135, v135, v193
v_exp_f32 v135, v135
s_nop 0
v_add_f32 v249, v249, v135
v_cvt_pk_bf16_f32 v164, v132, v133
v_cvt_pk_bf16_f32 v165, v134, v135
v_sub_f32 v148, v148, v193
v_exp_f32 v148, v148
s_nop 0
v_add_f32 v249, v249, v148
v_sub_f32 v149, v149, v193
v_exp_f32 v149, v149
s_nop 0
v_add_f32 v249, v249, v149
v_sub_f32 v150, v150, v193
v_exp_f32 v150, v150
s_nop 0
v_add_f32 v249, v249, v150
v_sub_f32 v151, v151, v193
v_exp_f32 v151, v151
s_nop 0
v_add_f32 v249, v249, v151
v_cvt_pk_bf16_f32 v166, v148, v149
v_cvt_pk_bf16_f32 v167, v150, v151
v_mul_f32 v250, v250, v202
v_sub_f32 v136, v136, v194
v_exp_f32 v136, v136
s_nop 0
v_add_f32 v250, v250, v136
v_sub_f32 v137, v137, v194
v_exp_f32 v137, v137
s_nop 0
v_add_f32 v250, v250, v137
v_sub_f32 v138, v138, v194
v_exp_f32 v138, v138
s_nop 0
v_add_f32 v250, v250, v138
v_sub_f32 v139, v139, v194
v_exp_f32 v139, v139
s_nop 0
v_add_f32 v250, v250, v139
v_cvt_pk_bf16_f32 v168, v136, v137
v_cvt_pk_bf16_f32 v169, v138, v139
v_sub_f32 v152, v152, v194
v_exp_f32 v152, v152
s_nop 0
v_add_f32 v250, v250, v152
v_sub_f32 v153, v153, v194
v_exp_f32 v153, v153
s_nop 0
v_add_f32 v250, v250, v153
v_sub_f32 v154, v154, v194
v_exp_f32 v154, v154
s_nop 0
v_add_f32 v250, v250, v154
v_sub_f32 v155, v155, v194
v_exp_f32 v155, v155
s_nop 0
v_add_f32 v250, v250, v155
v_cvt_pk_bf16_f32 v170, v152, v153
v_cvt_pk_bf16_f32 v171, v154, v155
v_mul_f32 v251, v251, v203
v_sub_f32 v140, v140, v195
v_exp_f32 v140, v140
s_nop 0
v_add_f32 v251, v251, v140
v_sub_f32 v141, v141, v195
v_exp_f32 v141, v141
s_nop 0
v_add_f32 v251, v251, v141
v_sub_f32 v142, v142, v195
v_exp_f32 v142, v142
s_nop 0
v_add_f32 v251, v251, v142
v_sub_f32 v143, v143, v195
v_exp_f32 v143, v143
s_nop 0
v_add_f32 v251, v251, v143
v_cvt_pk_bf16_f32 v172, v140, v141
v_cvt_pk_bf16_f32 v173, v142, v143
v_sub_f32 v156, v156, v195
v_exp_f32 v156, v156
s_nop 0
v_add_f32 v251, v251, v156
v_sub_f32 v157, v157, v195
v_exp_f32 v157, v157
s_nop 0
v_add_f32 v251, v251, v157
v_sub_f32 v158, v158, v195
v_exp_f32 v158, v158
s_nop 0
v_add_f32 v251, v251, v158
v_sub_f32 v159, v159, v195
v_exp_f32 v159, v159
s_nop 0
v_add_f32 v251, v251, v159
v_cvt_pk_bf16_f32 v174, v156, v157
v_cvt_pk_bf16_f32 v175, v158, v159
v_mul_f32 v0, v0, v200
v_mul_f32 v1, v1, v200
v_mul_f32 v2, v2, v200
v_mul_f32 v3, v3, v200
v_accvgpr_read_b32 v204, a128
v_accvgpr_read_b32 v205, a129
v_accvgpr_read_b32 v206, a130
v_accvgpr_read_b32 v207, a131
v_mul_f32 v204, v204, v202
v_mul_f32 v205, v205, v202
v_mul_f32 v206, v206, v202
v_mul_f32 v207, v207, v202
v_accvgpr_write_b32 a128, v204
v_accvgpr_write_b32 a129, v205
v_accvgpr_write_b32 a130, v206
v_accvgpr_write_b32 a131, v207
v_mul_f32 v4, v4, v201
v_mul_f32 v5, v5, v201
v_mul_f32 v6, v6, v201
v_mul_f32 v7, v7, v201
v_accvgpr_read_b32 v204, a132
v_accvgpr_read_b32 v205, a133
v_accvgpr_read_b32 v206, a134
v_accvgpr_read_b32 v207, a135
v_mul_f32 v204, v204, v203
v_mul_f32 v205, v205, v203
v_mul_f32 v206, v206, v203
v_mul_f32 v207, v207, v203
v_accvgpr_write_b32 a132, v204
v_accvgpr_write_b32 a133, v205
v_accvgpr_write_b32 a134, v206
v_accvgpr_write_b32 a135, v207
v_mul_f32 v8, v8, v200
v_mul_f32 v9, v9, v200
v_mul_f32 v10, v10, v200
v_mul_f32 v11, v11, v200
v_accvgpr_read_b32 v204, a136
v_accvgpr_read_b32 v205, a137
v_accvgpr_read_b32 v206, a138
v_accvgpr_read_b32 v207, a139
v_mul_f32 v204, v204, v202
v_mul_f32 v205, v205, v202
v_mul_f32 v206, v206, v202
v_mul_f32 v207, v207, v202
v_accvgpr_write_b32 a136, v204
v_accvgpr_write_b32 a137, v205
v_accvgpr_write_b32 a138, v206
v_accvgpr_write_b32 a139, v207
v_mul_f32 v12, v12, v201
v_mul_f32 v13, v13, v201
v_mul_f32 v14, v14, v201
v_mul_f32 v15, v15, v201
v_accvgpr_read_b32 v204, a140
v_accvgpr_read_b32 v205, a141
v_accvgpr_read_b32 v206, a142
v_accvgpr_read_b32 v207, a143
v_mul_f32 v204, v204, v203
v_mul_f32 v205, v205, v203
v_mul_f32 v206, v206, v203
v_mul_f32 v207, v207, v203
v_accvgpr_write_b32 a140, v204
v_accvgpr_write_b32 a141, v205
v_accvgpr_write_b32 a142, v206
v_accvgpr_write_b32 a143, v207
v_mul_f32 v16, v16, v200
v_mul_f32 v17, v17, v200
v_mul_f32 v18, v18, v200
v_mul_f32 v19, v19, v200
v_accvgpr_read_b32 v204, a144
v_accvgpr_read_b32 v205, a145
v_accvgpr_read_b32 v206, a146
v_accvgpr_read_b32 v207, a147
v_mul_f32 v204, v204, v202
v_mul_f32 v205, v205, v202
v_mul_f32 v206, v206, v202
v_mul_f32 v207, v207, v202
v_accvgpr_write_b32 a144, v204
v_accvgpr_write_b32 a145, v205
v_accvgpr_write_b32 a146, v206
v_accvgpr_write_b32 a147, v207
v_mul_f32 v20, v20, v201
v_mul_f32 v21, v21, v201
v_mul_f32 v22, v22, v201
v_mul_f32 v23, v23, v201
v_accvgpr_read_b32 v204, a148
v_accvgpr_read_b32 v205, a149
v_accvgpr_read_b32 v206, a150
v_accvgpr_read_b32 v207, a151
v_mul_f32 v204, v204, v203
v_mul_f32 v205, v205, v203
v_mul_f32 v206, v206, v203
v_mul_f32 v207, v207, v203
v_accvgpr_write_b32 a148, v204
v_accvgpr_write_b32 a149, v205
v_accvgpr_write_b32 a150, v206
v_accvgpr_write_b32 a151, v207
v_mul_f32 v24, v24, v200
v_mul_f32 v25, v25, v200
v_mul_f32 v26, v26, v200
v_mul_f32 v27, v27, v200
v_accvgpr_read_b32 v204, a152
v_accvgpr_read_b32 v205, a153
v_accvgpr_read_b32 v206, a154
v_accvgpr_read_b32 v207, a155
v_mul_f32 v204, v204, v202
v_mul_f32 v205, v205, v202
v_mul_f32 v206, v206, v202
v_mul_f32 v207, v207, v202
v_accvgpr_write_b32 a152, v204
v_accvgpr_write_b32 a153, v205
v_accvgpr_write_b32 a154, v206
v_accvgpr_write_b32 a155, v207
v_mul_f32 v28, v28, v201
v_mul_f32 v29, v29, v201
v_mul_f32 v30, v30, v201
v_mul_f32 v31, v31, v201
v_accvgpr_read_b32 v204, a156
v_accvgpr_read_b32 v205, a157
v_accvgpr_read_b32 v206, a158
v_accvgpr_read_b32 v207, a159
v_mul_f32 v204, v204, v203
v_mul_f32 v205, v205, v203
v_mul_f32 v206, v206, v203
v_mul_f32 v207, v207, v203
v_accvgpr_write_b32 a156, v204
v_accvgpr_write_b32 a157, v205
v_accvgpr_write_b32 a158, v206
v_accvgpr_write_b32 a159, v207
v_mul_f32 v32, v32, v200
v_mul_f32 v33, v33, v200
v_mul_f32 v34, v34, v200
v_mul_f32 v35, v35, v200
v_accvgpr_read_b32 v204, a160
v_accvgpr_read_b32 v205, a161
v_accvgpr_read_b32 v206, a162
v_accvgpr_read_b32 v207, a163
v_mul_f32 v204, v204, v202
v_mul_f32 v205, v205, v202
v_mul_f32 v206, v206, v202
v_mul_f32 v207, v207, v202
v_accvgpr_write_b32 a160, v204
v_accvgpr_write_b32 a161, v205
v_accvgpr_write_b32 a162, v206
v_accvgpr_write_b32 a163, v207
v_mul_f32 v36, v36, v201
v_mul_f32 v37, v37, v201
v_mul_f32 v38, v38, v201
v_mul_f32 v39, v39, v201
v_accvgpr_read_b32 v204, a164
v_accvgpr_read_b32 v205, a165
v_accvgpr_read_b32 v206, a166
v_accvgpr_read_b32 v207, a167
v_mul_f32 v204, v204, v203
v_mul_f32 v205, v205, v203
v_mul_f32 v206, v206, v203
v_mul_f32 v207, v207, v203
v_accvgpr_write_b32 a164, v204
v_accvgpr_write_b32 a165, v205
v_accvgpr_write_b32 a166, v206
v_accvgpr_write_b32 a167, v207
v_mul_f32 v40, v40, v200
v_mul_f32 v41, v41, v200
v_mul_f32 v42, v42, v200
v_mul_f32 v43, v43, v200
v_accvgpr_read_b32 v204, a168
v_accvgpr_read_b32 v205, a169
v_accvgpr_read_b32 v206, a170
v_accvgpr_read_b32 v207, a171
v_mul_f32 v204, v204, v202
v_mul_f32 v205, v205, v202
v_mul_f32 v206, v206, v202
v_mul_f32 v207, v207, v202
v_accvgpr_write_b32 a168, v204
v_accvgpr_write_b32 a169, v205
v_accvgpr_write_b32 a170, v206
v_accvgpr_write_b32 a171, v207
v_mul_f32 v44, v44, v201
v_mul_f32 v45, v45, v201
v_mul_f32 v46, v46, v201
v_mul_f32 v47, v47, v201
v_accvgpr_read_b32 v204, a172
v_accvgpr_read_b32 v205, a173
v_accvgpr_read_b32 v206, a174
v_accvgpr_read_b32 v207, a175
v_mul_f32 v204, v204, v203
v_mul_f32 v205, v205, v203
v_mul_f32 v206, v206, v203
v_mul_f32 v207, v207, v203
v_accvgpr_write_b32 a172, v204
v_accvgpr_write_b32 a173, v205
v_accvgpr_write_b32 a174, v206
v_accvgpr_write_b32 a175, v207
v_mul_f32 v48, v48, v200
v_mul_f32 v49, v49, v200
v_mul_f32 v50, v50, v200
v_mul_f32 v51, v51, v200
v_accvgpr_read_b32 v204, a176
v_accvgpr_read_b32 v205, a177
v_accvgpr_read_b32 v206, a178
v_accvgpr_read_b32 v207, a179
v_mul_f32 v204, v204, v202
v_mul_f32 v205, v205, v202
v_mul_f32 v206, v206, v202
v_mul_f32 v207, v207, v202
v_accvgpr_write_b32 a176, v204
v_accvgpr_write_b32 a177, v205
v_accvgpr_write_b32 a178, v206
v_accvgpr_write_b32 a179, v207
v_mul_f32 v52, v52, v201
v_mul_f32 v53, v53, v201
v_mul_f32 v54, v54, v201
v_mul_f32 v55, v55, v201
v_accvgpr_read_b32 v204, a180
v_accvgpr_read_b32 v205, a181
v_accvgpr_read_b32 v206, a182
v_accvgpr_read_b32 v207, a183
v_mul_f32 v204, v204, v203
v_mul_f32 v205, v205, v203
v_mul_f32 v206, v206, v203
v_mul_f32 v207, v207, v203
v_accvgpr_write_b32 a180, v204
v_accvgpr_write_b32 a181, v205
v_accvgpr_write_b32 a182, v206
v_accvgpr_write_b32 a183, v207
v_mul_f32 v56, v56, v200
v_mul_f32 v57, v57, v200
v_mul_f32 v58, v58, v200
v_mul_f32 v59, v59, v200
v_accvgpr_read_b32 v204, a184
v_accvgpr_read_b32 v205, a185
v_accvgpr_read_b32 v206, a186
v_accvgpr_read_b32 v207, a187
v_mul_f32 v204, v204, v202
v_mul_f32 v205, v205, v202
v_mul_f32 v206, v206, v202
v_mul_f32 v207, v207, v202
v_accvgpr_write_b32 a184, v204
v_accvgpr_write_b32 a185, v205
v_accvgpr_write_b32 a186, v206
v_accvgpr_write_b32 a187, v207
v_mul_f32 v60, v60, v201
v_mul_f32 v61, v61, v201
v_mul_f32 v62, v62, v201
v_mul_f32 v63, v63, v201
v_accvgpr_read_b32 v204, a188
v_accvgpr_read_b32 v205, a189
v_accvgpr_read_b32 v206, a190
v_accvgpr_read_b32 v207, a191
v_mul_f32 v204, v204, v203
v_mul_f32 v205, v205, v203
v_mul_f32 v206, v206, v203
v_mul_f32 v207, v207, v203
v_accvgpr_write_b32 a188, v204
v_accvgpr_write_b32 a189, v205
v_accvgpr_write_b32 a190, v206
v_accvgpr_write_b32 a191, v207
v_mul_f32 v64, v64, v200
v_mul_f32 v65, v65, v200
v_mul_f32 v66, v66, v200
v_mul_f32 v67, v67, v200
v_accvgpr_read_b32 v204, a192
v_accvgpr_read_b32 v205, a193
v_accvgpr_read_b32 v206, a194
v_accvgpr_read_b32 v207, a195
v_mul_f32 v204, v204, v202
v_mul_f32 v205, v205, v202
v_mul_f32 v206, v206, v202
v_mul_f32 v207, v207, v202
v_accvgpr_write_b32 a192, v204
v_accvgpr_write_b32 a193, v205
v_accvgpr_write_b32 a194, v206
v_accvgpr_write_b32 a195, v207
v_mul_f32 v68, v68, v201
v_mul_f32 v69, v69, v201
v_mul_f32 v70, v70, v201
v_mul_f32 v71, v71, v201
v_accvgpr_read_b32 v204, a196
v_accvgpr_read_b32 v205, a197
v_accvgpr_read_b32 v206, a198
v_accvgpr_read_b32 v207, a199
v_mul_f32 v204, v204, v203
v_mul_f32 v205, v205, v203
v_mul_f32 v206, v206, v203
v_mul_f32 v207, v207, v203
v_accvgpr_write_b32 a196, v204
v_accvgpr_write_b32 a197, v205
v_accvgpr_write_b32 a198, v206
v_accvgpr_write_b32 a199, v207
v_mul_f32 v72, v72, v200
v_mul_f32 v73, v73, v200
v_mul_f32 v74, v74, v200
v_mul_f32 v75, v75, v200
v_accvgpr_read_b32 v204, a200
v_accvgpr_read_b32 v205, a201
v_accvgpr_read_b32 v206, a202
v_accvgpr_read_b32 v207, a203
v_mul_f32 v204, v204, v202
v_mul_f32 v205, v205, v202
v_mul_f32 v206, v206, v202
v_mul_f32 v207, v207, v202
v_accvgpr_write_b32 a200, v204
v_accvgpr_write_b32 a201, v205
v_accvgpr_write_b32 a202, v206
v_accvgpr_write_b32 a203, v207
v_mul_f32 v76, v76, v201
v_mul_f32 v77, v77, v201
v_mul_f32 v78, v78, v201
v_mul_f32 v79, v79, v201
v_accvgpr_read_b32 v204, a204
v_accvgpr_read_b32 v205, a205
v_accvgpr_read_b32 v206, a206
v_accvgpr_read_b32 v207, a207
v_mul_f32 v204, v204, v203
v_mul_f32 v205, v205, v203
v_mul_f32 v206, v206, v203
v_mul_f32 v207, v207, v203
v_accvgpr_write_b32 a204, v204
v_accvgpr_write_b32 a205, v205
v_accvgpr_write_b32 a206, v206
v_accvgpr_write_b32 a207, v207
v_mul_f32 v80, v80, v200
v_mul_f32 v81, v81, v200
v_mul_f32 v82, v82, v200
v_mul_f32 v83, v83, v200
v_accvgpr_read_b32 v204, a208
v_accvgpr_read_b32 v205, a209
v_accvgpr_read_b32 v206, a210
v_accvgpr_read_b32 v207, a211
v_mul_f32 v204, v204, v202
v_mul_f32 v205, v205, v202
v_mul_f32 v206, v206, v202
v_mul_f32 v207, v207, v202
v_accvgpr_write_b32 a208, v204
v_accvgpr_write_b32 a209, v205
v_accvgpr_write_b32 a210, v206
v_accvgpr_write_b32 a211, v207
v_mul_f32 v84, v84, v201
v_mul_f32 v85, v85, v201
v_mul_f32 v86, v86, v201
v_mul_f32 v87, v87, v201
v_accvgpr_read_b32 v204, a212
v_accvgpr_read_b32 v205, a213
v_accvgpr_read_b32 v206, a214
v_accvgpr_read_b32 v207, a215
v_mul_f32 v204, v204, v203
v_mul_f32 v205, v205, v203
v_mul_f32 v206, v206, v203
v_mul_f32 v207, v207, v203
v_accvgpr_write_b32 a212, v204
v_accvgpr_write_b32 a213, v205
v_accvgpr_write_b32 a214, v206
v_accvgpr_write_b32 a215, v207
v_mul_f32 v88, v88, v200
v_mul_f32 v89, v89, v200
v_mul_f32 v90, v90, v200
v_mul_f32 v91, v91, v200
v_accvgpr_read_b32 v204, a216
v_accvgpr_read_b32 v205, a217
v_accvgpr_read_b32 v206, a218
v_accvgpr_read_b32 v207, a219
v_mul_f32 v204, v204, v202
v_mul_f32 v205, v205, v202
v_mul_f32 v206, v206, v202
v_mul_f32 v207, v207, v202
v_accvgpr_write_b32 a216, v204
v_accvgpr_write_b32 a217, v205
v_accvgpr_write_b32 a218, v206
v_accvgpr_write_b32 a219, v207
v_mul_f32 v92, v92, v201
v_mul_f32 v93, v93, v201
v_mul_f32 v94, v94, v201
v_mul_f32 v95, v95, v201
v_accvgpr_read_b32 v204, a220
v_accvgpr_read_b32 v205, a221
v_accvgpr_read_b32 v206, a222
v_accvgpr_read_b32 v207, a223
v_mul_f32 v204, v204, v203
v_mul_f32 v205, v205, v203
v_mul_f32 v206, v206, v203
v_mul_f32 v207, v207, v203
v_accvgpr_write_b32 a220, v204
v_accvgpr_write_b32 a221, v205
v_accvgpr_write_b32 a222, v206
v_accvgpr_write_b32 a223, v207
v_mul_f32 v96, v96, v200
v_mul_f32 v97, v97, v200
v_mul_f32 v98, v98, v200
v_mul_f32 v99, v99, v200
v_accvgpr_read_b32 v204, a224
v_accvgpr_read_b32 v205, a225
v_accvgpr_read_b32 v206, a226
v_accvgpr_read_b32 v207, a227
v_mul_f32 v204, v204, v202
v_mul_f32 v205, v205, v202
v_mul_f32 v206, v206, v202
v_mul_f32 v207, v207, v202
v_accvgpr_write_b32 a224, v204
v_accvgpr_write_b32 a225, v205
v_accvgpr_write_b32 a226, v206
v_accvgpr_write_b32 a227, v207
v_mul_f32 v100, v100, v201
v_mul_f32 v101, v101, v201
v_mul_f32 v102, v102, v201
v_mul_f32 v103, v103, v201
v_accvgpr_read_b32 v204, a228
v_accvgpr_read_b32 v205, a229
v_accvgpr_read_b32 v206, a230
v_accvgpr_read_b32 v207, a231
v_mul_f32 v204, v204, v203
v_mul_f32 v205, v205, v203
v_mul_f32 v206, v206, v203
v_mul_f32 v207, v207, v203
v_accvgpr_write_b32 a228, v204
v_accvgpr_write_b32 a229, v205
v_accvgpr_write_b32 a230, v206
v_accvgpr_write_b32 a231, v207
v_mul_f32 v104, v104, v200
v_mul_f32 v105, v105, v200
v_mul_f32 v106, v106, v200
v_mul_f32 v107, v107, v200
v_accvgpr_read_b32 v204, a232
v_accvgpr_read_b32 v205, a233
v_accvgpr_read_b32 v206, a234
v_accvgpr_read_b32 v207, a235
v_mul_f32 v204, v204, v202
v_mul_f32 v205, v205, v202
v_mul_f32 v206, v206, v202
v_mul_f32 v207, v207, v202
v_accvgpr_write_b32 a232, v204
v_accvgpr_write_b32 a233, v205
v_accvgpr_write_b32 a234, v206
v_accvgpr_write_b32 a235, v207
v_mul_f32 v108, v108, v201
v_mul_f32 v109, v109, v201
v_mul_f32 v110, v110, v201
v_mul_f32 v111, v111, v201
v_accvgpr_read_b32 v204, a236
v_accvgpr_read_b32 v205, a237
v_accvgpr_read_b32 v206, a238
v_accvgpr_read_b32 v207, a239
v_mul_f32 v204, v204, v203
v_mul_f32 v205, v205, v203
v_mul_f32 v206, v206, v203
v_mul_f32 v207, v207, v203
v_accvgpr_write_b32 a236, v204
v_accvgpr_write_b32 a237, v205
v_accvgpr_write_b32 a238, v206
v_accvgpr_write_b32 a239, v207
v_mul_f32 v112, v112, v200
v_mul_f32 v113, v113, v200
v_mul_f32 v114, v114, v200
v_mul_f32 v115, v115, v200
v_accvgpr_read_b32 v204, a240
v_accvgpr_read_b32 v205, a241
v_accvgpr_read_b32 v206, a242
v_accvgpr_read_b32 v207, a243
v_mul_f32 v204, v204, v202
v_mul_f32 v205, v205, v202
v_mul_f32 v206, v206, v202
v_mul_f32 v207, v207, v202
v_accvgpr_write_b32 a240, v204
v_accvgpr_write_b32 a241, v205
v_accvgpr_write_b32 a242, v206
v_accvgpr_write_b32 a243, v207
v_mul_f32 v116, v116, v201
v_mul_f32 v117, v117, v201
v_mul_f32 v118, v118, v201
v_mul_f32 v119, v119, v201
v_accvgpr_read_b32 v204, a244
v_accvgpr_read_b32 v205, a245
v_accvgpr_read_b32 v206, a246
v_accvgpr_read_b32 v207, a247
v_mul_f32 v204, v204, v203
v_mul_f32 v205, v205, v203
v_mul_f32 v206, v206, v203
v_mul_f32 v207, v207, v203
v_accvgpr_write_b32 a244, v204
v_accvgpr_write_b32 a245, v205
v_accvgpr_write_b32 a246, v206
v_accvgpr_write_b32 a247, v207
v_mul_f32 v120, v120, v200
v_mul_f32 v121, v121, v200
v_mul_f32 v122, v122, v200
v_mul_f32 v123, v123, v200
v_accvgpr_read_b32 v204, a248
v_accvgpr_read_b32 v205, a249
v_accvgpr_read_b32 v206, a250
v_accvgpr_read_b32 v207, a251
v_mul_f32 v204, v204, v202
v_mul_f32 v205, v205, v202
v_mul_f32 v206, v206, v202
v_mul_f32 v207, v207, v202
v_accvgpr_write_b32 a248, v204
v_accvgpr_write_b32 a249, v205
v_accvgpr_write_b32 a250, v206
v_accvgpr_write_b32 a251, v207
v_mul_f32 v124, v124, v201
v_mul_f32 v125, v125, v201
v_mul_f32 v126, v126, v201
v_mul_f32 v127, v127, v201
v_accvgpr_read_b32 v204, a252
v_accvgpr_read_b32 v205, a253
v_accvgpr_read_b32 v206, a254
v_accvgpr_read_b32 v207, a255
v_mul_f32 v204, v204, v203
v_mul_f32 v205, v205, v203
v_mul_f32 v206, v206, v203
v_mul_f32 v207, v207, v203
v_accvgpr_write_b32 a252, v204
v_accvgpr_write_b32 a253, v205
v_accvgpr_write_b32 a254, v206
v_accvgpr_write_b32 a255, v207
s_nop 1
ds_read_b64_tr_b16 v[208:209], v236 offset:0
ds_read_b64_tr_b16 v[210:211], v236 offset:8192
s_waitcnt lgkmcnt(0)
v_mfma_f32_16x16x32_bf16 v[0:3], v[208:211], v[160:163], v[0:3]
v_mfma_f32_16x16x32_bf16 v[4:7], v[208:211], v[164:167], v[4:7]
v_mfma_f32_16x16x32_bf16 a[128:131], v[208:211], v[168:171], a[128:131]
v_mfma_f32_16x16x32_bf16 a[132:135], v[208:211], v[172:175], a[132:135]
s_nop 3
ds_read_b64_tr_b16 v[208:209], v237 offset:0
ds_read_b64_tr_b16 v[210:211], v237 offset:8192
s_waitcnt lgkmcnt(0)
v_mfma_f32_16x16x32_bf16 v[8:11], v[208:211], v[160:163], v[8:11]
v_mfma_f32_16x16x32_bf16 v[12:15], v[208:211], v[164:167], v[12:15]
v_mfma_f32_16x16x32_bf16 a[136:139], v[208:211], v[168:171], a[136:139]
v_mfma_f32_16x16x32_bf16 a[140:143], v[208:211], v[172:175], a[140:143]
s_nop 3
ds_read_b64_tr_b16 v[208:209], v238 offset:0
ds_read_b64_tr_b16 v[210:211], v238 offset:8192
s_waitcnt lgkmcnt(0)
v_mfma_f32_16x16x32_bf16 v[16:19], v[208:211], v[160:163], v[16:19]
v_mfma_f32_16x16x32_bf16 v[20:23], v[208:211], v[164:167], v[20:23]
v_mfma_f32_16x16x32_bf16 a[144:147], v[208:211], v[168:171], a[144:147]
v_mfma_f32_16x16x32_bf16 a[148:151], v[208:211], v[172:175], a[148:151]
s_nop 3
ds_read_b64_tr_b16 v[208:209], v239 offset:0
ds_read_b64_tr_b16 v[210:211], v239 offset:8192
s_waitcnt lgkmcnt(0)
v_mfma_f32_16x16x32_bf16 v[24:27], v[208:211], v[160:163], v[24:27]
v_mfma_f32_16x16x32_bf16 v[28:31], v[208:211], v[164:167], v[28:31]
v_mfma_f32_16x16x32_bf16 a[152:155], v[208:211], v[168:171], a[152:155]
v_mfma_f32_16x16x32_bf16 a[156:159], v[208:211], v[172:175], a[156:159]
s_nop 3
ds_read_b64_tr_b16 v[208:209], v240 offset:0
ds_read_b64_tr_b16 v[210:211], v240 offset:8192
s_waitcnt lgkmcnt(0)
v_mfma_f32_16x16x32_bf16 v[32:35], v[208:211], v[160:163], v[32:35]
v_mfma_f32_16x16x32_bf16 v[36:39], v[208:211], v[164:167], v[36:39]
v_mfma_f32_16x16x32_bf16 a[160:163], v[208:211], v[168:171], a[160:163]
v_mfma_f32_16x16x32_bf16 a[164:167], v[208:211], v[172:175], a[164:167]
s_nop 3
ds_read_b64_tr_b16 v[208:209], v241 offset:0
ds_read_b64_tr_b16 v[210:211], v241 offset:8192
s_waitcnt lgkmcnt(0)
v_mfma_f32_16x16x32_bf16 v[40:43], v[208:211], v[160:163], v[40:43]
v_mfma_f32_16x16x32_bf16 v[44:47], v[208:211], v[164:167], v[44:47]
v_mfma_f32_16x16x32_bf16 a[168:171], v[208:211], v[168:171], a[168:171]
v_mfma_f32_16x16x32_bf16 a[172:175], v[208:211], v[172:175], a[172:175]
s_nop 3
ds_read_b64_tr_b16 v[208:209], v242 offset:0
ds_read_b64_tr_b16 v[210:211], v242 offset:8192
s_waitcnt lgkmcnt(0)
v_mfma_f32_16x16x32_bf16 v[48:51], v[208:211], v[160:163], v[48:51]
v_mfma_f32_16x16x32_bf16 v[52:55], v[208:211], v[164:167], v[52:55]
v_mfma_f32_16x16x32_bf16 a[176:179], v[208:211], v[168:171], a[176:179]
v_mfma_f32_16x16x32_bf16 a[180:183], v[208:211], v[172:175], a[180:183]
s_nop 3
ds_read_b64_tr_b16 v[208:209], v243 offset:0
ds_read_b64_tr_b16 v[210:211], v243 offset:8192
s_waitcnt lgkmcnt(0)
v_mfma_f32_16x16x32_bf16 v[56:59], v[208:211], v[160:163], v[56:59]
v_mfma_f32_16x16x32_bf16 v[60:63], v[208:211], v[164:167], v[60:63]
v_mfma_f32_16x16x32_bf16 a[184:187], v[208:211], v[168:171], a[184:187]
v_mfma_f32_16x16x32_bf16 a[188:191], v[208:211], v[172:175], a[188:191]
s_nop 3
ds_read_b64_tr_b16 v[208:209], v236 offset:256
ds_read_b64_tr_b16 v[210:211], v236 offset:8448
s_waitcnt lgkmcnt(0)
v_mfma_f32_16x16x32_bf16 v[64:67], v[208:211], v[160:163], v[64:67]
v_mfma_f32_16x16x32_bf16 v[68:71], v[208:211], v[164:167], v[68:71]
v_mfma_f32_16x16x32_bf16 a[192:195], v[208:211], v[168:171], a[192:195]
v_mfma_f32_16x16x32_bf16 a[196:199], v[208:211], v[172:175], a[196:199]
s_nop 3
ds_read_b64_tr_b16 v[208:209], v237 offset:256
ds_read_b64_tr_b16 v[210:211], v237 offset:8448
s_waitcnt lgkmcnt(0)
v_mfma_f32_16x16x32_bf16 v[72:75], v[208:211], v[160:163], v[72:75]
v_mfma_f32_16x16x32_bf16 v[76:79], v[208:211], v[164:167], v[76:79]
v_mfma_f32_16x16x32_bf16 a[200:203], v[208:211], v[168:171], a[200:203]
v_mfma_f32_16x16x32_bf16 a[204:207], v[208:211], v[172:175], a[204:207]
s_nop 3
ds_read_b64_tr_b16 v[208:209], v238 offset:256
ds_read_b64_tr_b16 v[210:211], v238 offset:8448
s_waitcnt lgkmcnt(0)
v_mfma_f32_16x16x32_bf16 v[80:83], v[208:211], v[160:163], v[80:83]
v_mfma_f32_16x16x32_bf16 v[84:87], v[208:211], v[164:167], v[84:87]
v_mfma_f32_16x16x32_bf16 a[208:211], v[208:211], v[168:171], a[208:211]
v_mfma_f32_16x16x32_bf16 a[212:215], v[208:211], v[172:175], a[212:215]
s_nop 3
ds_read_b64_tr_b16 v[208:209], v239 offset:256
ds_read_b64_tr_b16 v[210:211], v239 offset:8448
s_waitcnt lgkmcnt(0)
v_mfma_f32_16x16x32_bf16 v[88:91], v[208:211], v[160:163], v[88:91]
v_mfma_f32_16x16x32_bf16 v[92:95], v[208:211], v[164:167], v[92:95]
v_mfma_f32_16x16x32_bf16 a[216:219], v[208:211], v[168:171], a[216:219]
v_mfma_f32_16x16x32_bf16 a[220:223], v[208:211], v[172:175], a[220:223]
s_nop 3
ds_read_b64_tr_b16 v[208:209], v240 offset:256
ds_read_b64_tr_b16 v[210:211], v240 offset:8448
s_waitcnt lgkmcnt(0)
v_mfma_f32_16x16x32_bf16 v[96:99], v[208:211], v[160:163], v[96:99]
v_mfma_f32_16x16x32_bf16 v[100:103], v[208:211], v[164:167], v[100:103]
v_mfma_f32_16x16x32_bf16 a[224:227], v[208:211], v[168:171], a[224:227]
v_mfma_f32_16x16x32_bf16 a[228:231], v[208:211], v[172:175], a[228:231]
s_nop 3
ds_read_b64_tr_b16 v[208:209], v241 offset:256
ds_read_b64_tr_b16 v[210:211], v241 offset:8448
s_waitcnt lgkmcnt(0)
v_mfma_f32_16x16x32_bf16 v[104:107], v[208:211], v[160:163], v[104:107]
v_mfma_f32_16x16x32_bf16 v[108:111], v[208:211], v[164:167], v[108:111]
v_mfma_f32_16x16x32_bf16 a[232:235], v[208:211], v[168:171], a[232:235]
v_mfma_f32_16x16x32_bf16 a[236:239], v[208:211], v[172:175], a[236:239]
s_nop 3
ds_read_b64_tr_b16 v[208:209], v242 offset:256
ds_read_b64_tr_b16 v[210:211], v242 offset:8448
s_waitcnt lgkmcnt(0)
v_mfma_f32_16x16x32_bf16 v[112:115], v[208:211], v[160:163], v[112:115]
v_mfma_f32_16x16x32_bf16 v[116:119], v[208:211], v[164:167], v[116:119]
v_mfma_f32_16x16x32_bf16 a[240:243], v[208:211], v[168:171], a[240:243]
v_mfma_f32_16x16x32_bf16 a[244:247], v[208:211], v[172:175], a[244:247]
s_nop 3
ds_read_b64_tr_b16 v[208:209], v243 offset:256
ds_read_b64_tr_b16 v[210:211], v243 offset:8448
s_waitcnt lgkmcnt(0)
v_mfma_f32_16x16x32_bf16 v[120:123], v[208:211], v[160:163], v[120:123]
v_mfma_f32_16x16x32_bf16 v[124:127], v[208:211], v[164:167], v[124:127]
v_mfma_f32_16x16x32_bf16 a[248:251], v[208:211], v[168:171], a[248:251]
v_mfma_f32_16x16x32_bf16 a[252:255], v[208:211], v[172:175], a[252:255]
s_nop 3
s_nop 7
K2_SL_NEXT:
s_add_u32 s58, s58, 1
s_cmp_lt_u32 s58, 16
s_cbranch_scc1 K2_SL_LOOP
s_barrier
v_mbcnt_lo_u32_b32 v254, -1, 0
v_mbcnt_hi_u32_b32 v254, -1, v254
v_lshlrev_b32 v254, 4, v254
s_lshl_b32 s60, s48, 10
s_add_u32 s60, s60, 131072
v_add_u32 v255, s60, v254
ds_write_b128 v255, v[192:195]
s_xor_b32 s60, s60, 2048
v_add_u32 v255, s60, v254
s_waitcnt lgkmcnt(0)
s_barrier
ds_read_b128 v[196:199], v255
s_waitcnt lgkmcnt(0)
v_max_f32 v208, v192, v198
v_max_f32 v209, v193, v199
v_max_f32 v210, v194, v196
v_max_f32 v211, v195, v197
v_sub_f32 v200, v192, v208
v_exp_f32 v200, v200
v_sub_f32 v201, v193, v209
v_exp_f32 v201, v201
v_sub_f32 v202, v194, v210
v_exp_f32 v202, v202
v_sub_f32 v203, v195, v211
v_exp_f32 v203, v203
s_nop 0
v_mul_f32 v248, v248, v200
v_mul_f32 v249, v249, v201
v_mul_f32 v250, v250, v202
v_mul_f32 v251, v251, v203
v_mov_b32 v252, v208
v_mov_b32 v253, v209
v_mul_f32 v0, v0, v200
v_mul_f32 v1, v1, v200
v_mul_f32 v2, v2, v200
v_mul_f32 v3, v3, v200
v_accvgpr_read_b32 v204, a128
v_accvgpr_read_b32 v205, a129
v_accvgpr_read_b32 v206, a130
v_accvgpr_read_b32 v207, a131
v_mul_f32 v204, v204, v202
v_mul_f32 v205, v205, v202
v_mul_f32 v206, v206, v202
v_mul_f32 v207, v207, v202
v_accvgpr_write_b32 a128, v204
v_accvgpr_write_b32 a129, v205
v_accvgpr_write_b32 a130, v206
v_accvgpr_write_b32 a131, v207
v_mul_f32 v4, v4, v201
v_mul_f32 v5, v5, v201
v_mul_f32 v6, v6, v201
v_mul_f32 v7, v7, v201
v_accvgpr_read_b32 v204, a132
v_accvgpr_read_b32 v205, a133
v_accvgpr_read_b32 v206, a134
v_accvgpr_read_b32 v207, a135
v_mul_f32 v204, v204, v203
v_mul_f32 v205, v205, v203
v_mul_f32 v206, v206, v203
v_mul_f32 v207, v207, v203
v_accvgpr_write_b32 a132, v204
v_accvgpr_write_b32 a133, v205
v_accvgpr_write_b32 a134, v206
v_accvgpr_write_b32 a135, v207
v_mul_f32 v8, v8, v200
v_mul_f32 v9, v9, v200
v_mul_f32 v10, v10, v200
v_mul_f32 v11, v11, v200
v_accvgpr_read_b32 v204, a136
v_accvgpr_read_b32 v205, a137
v_accvgpr_read_b32 v206, a138
v_accvgpr_read_b32 v207, a139
v_mul_f32 v204, v204, v202
v_mul_f32 v205, v205, v202
v_mul_f32 v206, v206, v202
v_mul_f32 v207, v207, v202
v_accvgpr_write_b32 a136, v204
v_accvgpr_write_b32 a137, v205
v_accvgpr_write_b32 a138, v206
v_accvgpr_write_b32 a139, v207
v_mul_f32 v12, v12, v201
v_mul_f32 v13, v13, v201
v_mul_f32 v14, v14, v201
v_mul_f32 v15, v15, v201
v_accvgpr_read_b32 v204, a140
v_accvgpr_read_b32 v205, a141
v_accvgpr_read_b32 v206, a142
v_accvgpr_read_b32 v207, a143
v_mul_f32 v204, v204, v203
v_mul_f32 v205, v205, v203
v_mul_f32 v206, v206, v203
v_mul_f32 v207, v207, v203
v_accvgpr_write_b32 a140, v204
v_accvgpr_write_b32 a141, v205
v_accvgpr_write_b32 a142, v206
v_accvgpr_write_b32 a143, v207
v_mul_f32 v16, v16, v200
v_mul_f32 v17, v17, v200
v_mul_f32 v18, v18, v200
v_mul_f32 v19, v19, v200
v_accvgpr_read_b32 v204, a144
v_accvgpr_read_b32 v205, a145
v_accvgpr_read_b32 v206, a146
v_accvgpr_read_b32 v207, a147
v_mul_f32 v204, v204, v202
v_mul_f32 v205, v205, v202
v_mul_f32 v206, v206, v202
v_mul_f32 v207, v207, v202
v_accvgpr_write_b32 a144, v204
v_accvgpr_write_b32 a145, v205
v_accvgpr_write_b32 a146, v206
v_accvgpr_write_b32 a147, v207
v_mul_f32 v20, v20, v201
v_mul_f32 v21, v21, v201
v_mul_f32 v22, v22, v201
v_mul_f32 v23, v23, v201
v_accvgpr_read_b32 v204, a148
v_accvgpr_read_b32 v205, a149
v_accvgpr_read_b32 v206, a150
v_accvgpr_read_b32 v207, a151
v_mul_f32 v204, v204, v203
v_mul_f32 v205, v205, v203
v_mul_f32 v206, v206, v203
v_mul_f32 v207, v207, v203
v_accvgpr_write_b32 a148, v204
v_accvgpr_write_b32 a149, v205
v_accvgpr_write_b32 a150, v206
v_accvgpr_write_b32 a151, v207
v_mul_f32 v24, v24, v200
v_mul_f32 v25, v25, v200
v_mul_f32 v26, v26, v200
v_mul_f32 v27, v27, v200
v_accvgpr_read_b32 v204, a152
v_accvgpr_read_b32 v205, a153
v_accvgpr_read_b32 v206, a154
v_accvgpr_read_b32 v207, a155
v_mul_f32 v204, v204, v202
v_mul_f32 v205, v205, v202
v_mul_f32 v206, v206, v202
v_mul_f32 v207, v207, v202
v_accvgpr_write_b32 a152, v204
v_accvgpr_write_b32 a153, v205
v_accvgpr_write_b32 a154, v206
v_accvgpr_write_b32 a155, v207
v_mul_f32 v28, v28, v201
v_mul_f32 v29, v29, v201
v_mul_f32 v30, v30, v201
v_mul_f32 v31, v31, v201
v_accvgpr_read_b32 v204, a156
v_accvgpr_read_b32 v205, a157
v_accvgpr_read_b32 v206, a158
v_accvgpr_read_b32 v207, a159
v_mul_f32 v204, v204, v203
v_mul_f32 v205, v205, v203
v_mul_f32 v206, v206, v203
v_mul_f32 v207, v207, v203
v_accvgpr_write_b32 a156, v204
v_accvgpr_write_b32 a157, v205
v_accvgpr_write_b32 a158, v206
v_accvgpr_write_b32 a159, v207
v_mul_f32 v32, v32, v200
v_mul_f32 v33, v33, v200
v_mul_f32 v34, v34, v200
v_mul_f32 v35, v35, v200
v_accvgpr_read_b32 v204, a160
v_accvgpr_read_b32 v205, a161
v_accvgpr_read_b32 v206, a162
v_accvgpr_read_b32 v207, a163
v_mul_f32 v204, v204, v202
v_mul_f32 v205, v205, v202
v_mul_f32 v206, v206, v202
v_mul_f32 v207, v207, v202
v_accvgpr_write_b32 a160, v204
v_accvgpr_write_b32 a161, v205
v_accvgpr_write_b32 a162, v206
v_accvgpr_write_b32 a163, v207
v_mul_f32 v36, v36, v201
v_mul_f32 v37, v37, v201
v_mul_f32 v38, v38, v201
v_mul_f32 v39, v39, v201
v_accvgpr_read_b32 v204, a164
v_accvgpr_read_b32 v205, a165
v_accvgpr_read_b32 v206, a166
v_accvgpr_read_b32 v207, a167
v_mul_f32 v204, v204, v203
v_mul_f32 v205, v205, v203
v_mul_f32 v206, v206, v203
v_mul_f32 v207, v207, v203
v_accvgpr_write_b32 a164, v204
v_accvgpr_write_b32 a165, v205
v_accvgpr_write_b32 a166, v206
v_accvgpr_write_b32 a167, v207
v_mul_f32 v40, v40, v200
v_mul_f32 v41, v41, v200
v_mul_f32 v42, v42, v200
v_mul_f32 v43, v43, v200
v_accvgpr_read_b32 v204, a168
v_accvgpr_read_b32 v205, a169
v_accvgpr_read_b32 v206, a170
v_accvgpr_read_b32 v207, a171
v_mul_f32 v204, v204, v202
v_mul_f32 v205, v205, v202
v_mul_f32 v206, v206, v202
v_mul_f32 v207, v207, v202
v_accvgpr_write_b32 a168, v204
v_accvgpr_write_b32 a169, v205
v_accvgpr_write_b32 a170, v206
v_accvgpr_write_b32 a171, v207
v_mul_f32 v44, v44, v201
v_mul_f32 v45, v45, v201
v_mul_f32 v46, v46, v201
v_mul_f32 v47, v47, v201
v_accvgpr_read_b32 v204, a172
v_accvgpr_read_b32 v205, a173
v_accvgpr_read_b32 v206, a174
v_accvgpr_read_b32 v207, a175
v_mul_f32 v204, v204, v203
v_mul_f32 v205, v205, v203
v_mul_f32 v206, v206, v203
v_mul_f32 v207, v207, v203
v_accvgpr_write_b32 a172, v204
v_accvgpr_write_b32 a173, v205
v_accvgpr_write_b32 a174, v206
v_accvgpr_write_b32 a175, v207
v_mul_f32 v48, v48, v200
v_mul_f32 v49, v49, v200
v_mul_f32 v50, v50, v200
v_mul_f32 v51, v51, v200
v_accvgpr_read_b32 v204, a176
v_accvgpr_read_b32 v205, a177
v_accvgpr_read_b32 v206, a178
v_accvgpr_read_b32 v207, a179
v_mul_f32 v204, v204, v202
v_mul_f32 v205, v205, v202
v_mul_f32 v206, v206, v202
v_mul_f32 v207, v207, v202
v_accvgpr_write_b32 a176, v204
v_accvgpr_write_b32 a177, v205
v_accvgpr_write_b32 a178, v206
v_accvgpr_write_b32 a179, v207
v_mul_f32 v52, v52, v201
v_mul_f32 v53, v53, v201
v_mul_f32 v54, v54, v201
v_mul_f32 v55, v55, v201
v_accvgpr_read_b32 v204, a180
v_accvgpr_read_b32 v205, a181
v_accvgpr_read_b32 v206, a182
v_accvgpr_read_b32 v207, a183
v_mul_f32 v204, v204, v203
v_mul_f32 v205, v205, v203
v_mul_f32 v206, v206, v203
v_mul_f32 v207, v207, v203
v_accvgpr_write_b32 a180, v204
v_accvgpr_write_b32 a181, v205
v_accvgpr_write_b32 a182, v206
v_accvgpr_write_b32 a183, v207
v_mul_f32 v56, v56, v200
v_mul_f32 v57, v57, v200
v_mul_f32 v58, v58, v200
v_mul_f32 v59, v59, v200
v_accvgpr_read_b32 v204, a184
v_accvgpr_read_b32 v205, a185
v_accvgpr_read_b32 v206, a186
v_accvgpr_read_b32 v207, a187
v_mul_f32 v204, v204, v202
v_mul_f32 v205, v205, v202
v_mul_f32 v206, v206, v202
v_mul_f32 v207, v207, v202
v_accvgpr_write_b32 a184, v204
v_accvgpr_write_b32 a185, v205
v_accvgpr_write_b32 a186, v206
v_accvgpr_write_b32 a187, v207
v_mul_f32 v60, v60, v201
v_mul_f32 v61, v61, v201
v_mul_f32 v62, v62, v201
v_mul_f32 v63, v63, v201
v_accvgpr_read_b32 v204, a188
v_accvgpr_read_b32 v205, a189
v_accvgpr_read_b32 v206, a190
v_accvgpr_read_b32 v207, a191
v_mul_f32 v204, v204, v203
v_mul_f32 v205, v205, v203
v_mul_f32 v206, v206, v203
v_mul_f32 v207, v207, v203
v_accvgpr_write_b32 a188, v204
v_accvgpr_write_b32 a189, v205
v_accvgpr_write_b32 a190, v206
v_accvgpr_write_b32 a191, v207
v_mul_f32 v64, v64, v200
v_mul_f32 v65, v65, v200
v_mul_f32 v66, v66, v200
v_mul_f32 v67, v67, v200
v_accvgpr_read_b32 v204, a192
v_accvgpr_read_b32 v205, a193
v_accvgpr_read_b32 v206, a194
v_accvgpr_read_b32 v207, a195
v_mul_f32 v204, v204, v202
v_mul_f32 v205, v205, v202
v_mul_f32 v206, v206, v202
v_mul_f32 v207, v207, v202
v_accvgpr_write_b32 a192, v204
v_accvgpr_write_b32 a193, v205
v_accvgpr_write_b32 a194, v206
v_accvgpr_write_b32 a195, v207
v_mul_f32 v68, v68, v201
v_mul_f32 v69, v69, v201
v_mul_f32 v70, v70, v201
v_mul_f32 v71, v71, v201
v_accvgpr_read_b32 v204, a196
v_accvgpr_read_b32 v205, a197
v_accvgpr_read_b32 v206, a198
v_accvgpr_read_b32 v207, a199
v_mul_f32 v204, v204, v203
v_mul_f32 v205, v205, v203
v_mul_f32 v206, v206, v203
v_mul_f32 v207, v207, v203
v_accvgpr_write_b32 a196, v204
v_accvgpr_write_b32 a197, v205
v_accvgpr_write_b32 a198, v206
v_accvgpr_write_b32 a199, v207
v_mul_f32 v72, v72, v200
v_mul_f32 v73, v73, v200
v_mul_f32 v74, v74, v200
v_mul_f32 v75, v75, v200
v_accvgpr_read_b32 v204, a200
v_accvgpr_read_b32 v205, a201
v_accvgpr_read_b32 v206, a202
v_accvgpr_read_b32 v207, a203
v_mul_f32 v204, v204, v202
v_mul_f32 v205, v205, v202
v_mul_f32 v206, v206, v202
v_mul_f32 v207, v207, v202
v_accvgpr_write_b32 a200, v204
v_accvgpr_write_b32 a201, v205
v_accvgpr_write_b32 a202, v206
v_accvgpr_write_b32 a203, v207
v_mul_f32 v76, v76, v201
v_mul_f32 v77, v77, v201
v_mul_f32 v78, v78, v201
v_mul_f32 v79, v79, v201
v_accvgpr_read_b32 v204, a204
v_accvgpr_read_b32 v205, a205
v_accvgpr_read_b32 v206, a206
v_accvgpr_read_b32 v207, a207
v_mul_f32 v204, v204, v203
v_mul_f32 v205, v205, v203
v_mul_f32 v206, v206, v203
v_mul_f32 v207, v207, v203
v_accvgpr_write_b32 a204, v204
v_accvgpr_write_b32 a205, v205
v_accvgpr_write_b32 a206, v206
v_accvgpr_write_b32 a207, v207
v_mul_f32 v80, v80, v200
v_mul_f32 v81, v81, v200
v_mul_f32 v82, v82, v200
v_mul_f32 v83, v83, v200
v_accvgpr_read_b32 v204, a208
v_accvgpr_read_b32 v205, a209
v_accvgpr_read_b32 v206, a210
v_accvgpr_read_b32 v207, a211
v_mul_f32 v204, v204, v202
v_mul_f32 v205, v205, v202
v_mul_f32 v206, v206, v202
v_mul_f32 v207, v207, v202
v_accvgpr_write_b32 a208, v204
v_accvgpr_write_b32 a209, v205
v_accvgpr_write_b32 a210, v206
v_accvgpr_write_b32 a211, v207
v_mul_f32 v84, v84, v201
v_mul_f32 v85, v85, v201
v_mul_f32 v86, v86, v201
v_mul_f32 v87, v87, v201
v_accvgpr_read_b32 v204, a212
v_accvgpr_read_b32 v205, a213
v_accvgpr_read_b32 v206, a214
v_accvgpr_read_b32 v207, a215
v_mul_f32 v204, v204, v203
v_mul_f32 v205, v205, v203
v_mul_f32 v206, v206, v203
v_mul_f32 v207, v207, v203
v_accvgpr_write_b32 a212, v204
v_accvgpr_write_b32 a213, v205
v_accvgpr_write_b32 a214, v206
v_accvgpr_write_b32 a215, v207
v_mul_f32 v88, v88, v200
v_mul_f32 v89, v89, v200
v_mul_f32 v90, v90, v200
v_mul_f32 v91, v91, v200
v_accvgpr_read_b32 v204, a216
v_accvgpr_read_b32 v205, a217
v_accvgpr_read_b32 v206, a218
v_accvgpr_read_b32 v207, a219
v_mul_f32 v204, v204, v202
v_mul_f32 v205, v205, v202
v_mul_f32 v206, v206, v202
v_mul_f32 v207, v207, v202
v_accvgpr_write_b32 a216, v204
v_accvgpr_write_b32 a217, v205
v_accvgpr_write_b32 a218, v206
v_accvgpr_write_b32 a219, v207
v_mul_f32 v92, v92, v201
v_mul_f32 v93, v93, v201
v_mul_f32 v94, v94, v201
v_mul_f32 v95, v95, v201
v_accvgpr_read_b32 v204, a220
v_accvgpr_read_b32 v205, a221
v_accvgpr_read_b32 v206, a222
v_accvgpr_read_b32 v207, a223
v_mul_f32 v204, v204, v203
v_mul_f32 v205, v205, v203
v_mul_f32 v206, v206, v203
v_mul_f32 v207, v207, v203
v_accvgpr_write_b32 a220, v204
v_accvgpr_write_b32 a221, v205
v_accvgpr_write_b32 a222, v206
v_accvgpr_write_b32 a223, v207
v_mul_f32 v96, v96, v200
v_mul_f32 v97, v97, v200
v_mul_f32 v98, v98, v200
v_mul_f32 v99, v99, v200
v_accvgpr_read_b32 v204, a224
v_accvgpr_read_b32 v205, a225
v_accvgpr_read_b32 v206, a226
v_accvgpr_read_b32 v207, a227
v_mul_f32 v204, v204, v202
v_mul_f32 v205, v205, v202
v_mul_f32 v206, v206, v202
v_mul_f32 v207, v207, v202
v_accvgpr_write_b32 a224, v204
v_accvgpr_write_b32 a225, v205
v_accvgpr_write_b32 a226, v206
v_accvgpr_write_b32 a227, v207
v_mul_f32 v100, v100, v201
v_mul_f32 v101, v101, v201
v_mul_f32 v102, v102, v201
v_mul_f32 v103, v103, v201
v_accvgpr_read_b32 v204, a228
v_accvgpr_read_b32 v205, a229
v_accvgpr_read_b32 v206, a230
v_accvgpr_read_b32 v207, a231
v_mul_f32 v204, v204, v203
v_mul_f32 v205, v205, v203
v_mul_f32 v206, v206, v203
v_mul_f32 v207, v207, v203
v_accvgpr_write_b32 a228, v204
v_accvgpr_write_b32 a229, v205
v_accvgpr_write_b32 a230, v206
v_accvgpr_write_b32 a231, v207
v_mul_f32 v104, v104, v200
v_mul_f32 v105, v105, v200
v_mul_f32 v106, v106, v200
v_mul_f32 v107, v107, v200
v_accvgpr_read_b32 v204, a232
v_accvgpr_read_b32 v205, a233
v_accvgpr_read_b32 v206, a234
v_accvgpr_read_b32 v207, a235
v_mul_f32 v204, v204, v202
v_mul_f32 v205, v205, v202
v_mul_f32 v206, v206, v202
v_mul_f32 v207, v207, v202
v_accvgpr_write_b32 a232, v204
v_accvgpr_write_b32 a233, v205
v_accvgpr_write_b32 a234, v206
v_accvgpr_write_b32 a235, v207
v_mul_f32 v108, v108, v201
v_mul_f32 v109, v109, v201
v_mul_f32 v110, v110, v201
v_mul_f32 v111, v111, v201
v_accvgpr_read_b32 v204, a236
v_accvgpr_read_b32 v205, a237
v_accvgpr_read_b32 v206, a238
v_accvgpr_read_b32 v207, a239
v_mul_f32 v204, v204, v203
v_mul_f32 v205, v205, v203
v_mul_f32 v206, v206, v203
v_mul_f32 v207, v207, v203
v_accvgpr_write_b32 a236, v204
v_accvgpr_write_b32 a237, v205
v_accvgpr_write_b32 a238, v206
v_accvgpr_write_b32 a239, v207
v_mul_f32 v112, v112, v200
v_mul_f32 v113, v113, v200
v_mul_f32 v114, v114, v200
v_mul_f32 v115, v115, v200
v_accvgpr_read_b32 v204, a240
v_accvgpr_read_b32 v205, a241
v_accvgpr_read_b32 v206, a242
v_accvgpr_read_b32 v207, a243
v_mul_f32 v204, v204, v202
v_mul_f32 v205, v205, v202
v_mul_f32 v206, v206, v202
v_mul_f32 v207, v207, v202
v_accvgpr_write_b32 a240, v204
v_accvgpr_write_b32 a241, v205
v_accvgpr_write_b32 a242, v206
v_accvgpr_write_b32 a243, v207
v_mul_f32 v116, v116, v201
v_mul_f32 v117, v117, v201
v_mul_f32 v118, v118, v201
v_mul_f32 v119, v119, v201
v_accvgpr_read_b32 v204, a244
v_accvgpr_read_b32 v205, a245
v_accvgpr_read_b32 v206, a246
v_accvgpr_read_b32 v207, a247
v_mul_f32 v204, v204, v203
v_mul_f32 v205, v205, v203
v_mul_f32 v206, v206, v203
v_mul_f32 v207, v207, v203
v_accvgpr_write_b32 a244, v204
v_accvgpr_write_b32 a245, v205
v_accvgpr_write_b32 a246, v206
v_accvgpr_write_b32 a247, v207
v_mul_f32 v120, v120, v200
v_mul_f32 v121, v121, v200
v_mul_f32 v122, v122, v200
v_mul_f32 v123, v123, v200
v_accvgpr_read_b32 v204, a248
v_accvgpr_read_b32 v205, a249
v_accvgpr_read_b32 v206, a250
v_accvgpr_read_b32 v207, a251
v_mul_f32 v204, v204, v202
v_mul_f32 v205, v205, v202
v_mul_f32 v206, v206, v202
v_mul_f32 v207, v207, v202
v_accvgpr_write_b32 a248, v204
v_accvgpr_write_b32 a249, v205
v_accvgpr_write_b32 a250, v206
v_accvgpr_write_b32 a251, v207
v_mul_f32 v124, v124, v201
v_mul_f32 v125, v125, v201
v_mul_f32 v126, v126, v201
v_mul_f32 v127, v127, v201
v_accvgpr_read_b32 v204, a252
v_accvgpr_read_b32 v205, a253
v_accvgpr_read_b32 v206, a254
v_accvgpr_read_b32 v207, a255
v_mul_f32 v204, v204, v203
v_mul_f32 v205, v205, v203
v_mul_f32 v206, v206, v203
v_mul_f32 v207, v207, v203
v_accvgpr_write_b32 a252, v204
v_accvgpr_write_b32 a253, v205
v_accvgpr_write_b32 a254, v206
v_accvgpr_write_b32 a255, v207
s_barrier
s_add_u32 s12, s4, 0x1000000
s_addc_u32 s13, s5, 0
s_mov_b32 s14, 0x40000
s_mov_b32 s15, 0x20000
s_mul_i32 s60, s51, 2048000
s_add_u32 s61, s60, 0xc00000
s_add_u32 s24, s4, s61
s_addc_u32 s25, s5, 0
s_mov_b32 s26, 0x1f4000
s_mov_b32 s27, 0x20000
s_add_u32 s61, s60, 0x800000
s_add_u32 s28, s4, s61
s_addc_u32 s29, s5, 0
s_mov_b32 s30, 0x1f4000
s_mov_b32 s31, 0x20000
s_mov_b32 s34, 2560
s_mov_b32 s35, 0x20000
s_mov_b32 s38, 4096000
s_mov_b32 s39, 0x20000
s_mov_b32 s42, 4096000
s_mov_b32 s43, 0x20000
s_add_u32 s16, s4, 0x1400000
s_addc_u32 s17, s5, 0
s_mov_b32 s18, 0x1000000
s_mov_b32 s19, 0x20000
s_add_u32 s20, s4, 0x1100000
s_addc_u32 s21, s5, 0
s_mov_b32 s22, 0x40000
s_mov_b32 s23, 0x20000
s_lshl_b32 s62, s52, 7
s_lshl_b32 s60, s53, 5
s_add_u32 s62, s62, s60
s_lshl_b32 s64, s49, 1
s_add_u32 s64, s64, s50
v_mbcnt_lo_u32_b32 v254, -1, 0
v_mbcnt_hi_u32_b32 v254, -1, v254
v_lshlrev_b32 v247, 4, v254
v_and_b32 v246, 31, v254
v_lshlrev_b32 v246, 4, v246
v_lshrrev_b32 v255, 5, v254
s_lshl_b32 s60, s48, 1
v_add_u32 v255, s60, v255
v_lshlrev_b32 v255, 2, v255
v_add_u32 v255, s62, v255
v_lshl_add_u32 v244, v255, 9, v246
v_subrev_u32 v245, 1024, v244
s_lshl_b32 s60, s48, 15
v_add_u32 v254, s60, v247
s_add_u32 s61, s60, 16384
s_lshl_b32 s66, s50, 14
s_add_u32 s66, s66, 131072
s_cmp_eq_u32 s49, 1
s_cselect_b32 s61, s66, s61
v_add_u32 v255, s61, v247
s_lshl_b32 s66, s48, 16
s_add_u32 s66, s66, 8192
buffer_load_dwordx4 a[0:3], v247, s[12:15], s66 offen offset:0 sc1
s_lshl_b32 s67, s48, 16
s_add_u32 s67, s67, 24576
buffer_load_dwordx4 a[32:35], v247, s[12:15], s67 offen offset:0 sc1
s_lshl_b32 s68, s48, 16
s_add_u32 s68, s68, 40960
buffer_load_dwordx4 a[64:67], v247, s[12:15], s68 offen offset:0 sc1
s_lshl_b32 s69, s48, 16
s_add_u32 s69, s69, 57344
buffer_load_dwordx4 a[96:99], v247, s[12:15], s69 offen offset:0 sc1
buffer_load_dwordx4 a[4:7], v247, s[12:15], s66 offen offset:1024 sc1
buffer_load_dwordx4 a[36:39], v247, s[12:15], s67 offen offset:1024 sc1
buffer_load_dwordx4 a[68:71], v247, s[12:15], s68 offen offset:1024 sc1
buffer_load_dwordx4 a[100:103], v247, s[12:15], s69 offen offset:1024 sc1
buffer_load_dwordx4 a[8:11], v247, s[12:15], s66 offen offset:2048 sc1
buffer_load_dwordx4 a[40:43], v247, s[12:15], s67 offen offset:2048 sc1
buffer_load_dwordx4 a[72:75], v247, s[12:15], s68 offen offset:2048 sc1
buffer_load_dwordx4 a[104:107], v247, s[12:15], s69 offen offset:2048 sc1
buffer_load_dwordx4 a[12:15], v247, s[12:15], s66 offen offset:3072 sc1
buffer_load_dwordx4 a[44:47], v247, s[12:15], s67 offen offset:3072 sc1
buffer_load_dwordx4 a[76:79], v247, s[12:15], s68 offen offset:3072 sc1
buffer_load_dwordx4 a[108:111], v247, s[12:15], s69 offen offset:3072 sc1
s_lshl_b32 s66, s48, 16
s_add_u32 s66, s66, 12288
buffer_load_dwordx4 a[16:19], v247, s[12:15], s66 offen offset:0 sc1
s_lshl_b32 s67, s48, 16
s_add_u32 s67, s67, 28672
buffer_load_dwordx4 a[48:51], v247, s[12:15], s67 offen offset:0 sc1
s_lshl_b32 s68, s48, 16
s_add_u32 s68, s68, 45056
buffer_load_dwordx4 a[80:83], v247, s[12:15], s68 offen offset:0 sc1
s_lshl_b32 s69, s48, 16
s_add_u32 s69, s69, 61440
buffer_load_dwordx4 a[112:115], v247, s[12:15], s69 offen offset:0 sc1
buffer_load_dwordx4 a[20:23], v247, s[12:15], s66 offen offset:1024 sc1
buffer_load_dwordx4 a[52:55], v247, s[12:15], s67 offen offset:1024 sc1
buffer_load_dwordx4 a[84:87], v247, s[12:15], s68 offen offset:1024 sc1
buffer_load_dwordx4 a[116:119], v247, s[12:15], s69 offen offset:1024 sc1
buffer_load_dwordx4 a[24:27], v247, s[12:15], s66 offen offset:2048 sc1
buffer_load_dwordx4 a[56:59], v247, s[12:15], s67 offen offset:2048 sc1
buffer_load_dwordx4 a[88:91], v247, s[12:15], s68 offen offset:2048 sc1
buffer_load_dwordx4 a[120:123], v247, s[12:15], s69 offen offset:2048 sc1
buffer_load_dwordx4 a[28:31], v247, s[12:15], s66 offen offset:3072 sc1
buffer_load_dwordx4 a[60:63], v247, s[12:15], s67 offen offset:3072 sc1
buffer_load_dwordx4 a[92:95], v247, s[12:15], s68 offen offset:3072 sc1
buffer_load_dwordx4 a[124:127], v247, s[12:15], s69 offen offset:3072 sc1
buffer_load_dwordx4 v[128:131], v245, s[24:27], 0 offen offset:0 sc1
buffer_load_dwordx4 v[132:135], v245, s[24:27], 0 offen offset:512 sc1
buffer_load_dwordx4 v[136:139], v244, s[24:27], 0 offen offset:0 sc1
buffer_load_dwordx4 v[140:143], v244, s[24:27], 0 offen offset:512 sc1
buffer_load_dwordx4 v[144:147], v244, s[24:27], 0 offen offset:1024 sc1
buffer_load_dwordx4 v[148:151], v244, s[24:27], 0 offen offset:1536 sc1
buffer_load_dwordx4 v[152:155], v244, s[24:27], 0 offen offset:2048 sc1
buffer_load_dwordx4 v[156:159], v244, s[24:27], 0 offen offset:2560 sc1
buffer_load_dwordx4 v[160:163], v244, s[28:31], 0 offen offset:0 sc1
buffer_load_dwordx4 v[164:167], v244, s[28:31], 0 offen offset:512 sc1
buffer_load_dwordx4 v[168:171], v244, s[28:31], 0 offen offset:1024 sc1
buffer_load_dwordx4 v[172:175], v244, s[28:31], 0 offen offset:1536 sc1
buffer_load_dwordx4 v[192:195], v246, s[32:35], 0 offen offset:0
buffer_load_dwordx4 v[196:199], v246, s[32:35], 0 offen offset:512
buffer_load_dwordx4 v[200:203], v246, s[32:35], 0 offen offset:1024
buffer_load_dwordx4 v[204:207], v246, s[32:35], 0 offen offset:1536
buffer_load_dwordx4 v[232:235], v246, s[32:35], 0 offen offset:2048
v_mov_b32 v236, v248
v_mov_b32 v237, v249
v_mov_b32 v238, v250
v_mov_b32 v239, v251
s_nop 1
v_permlane16_swap_b32 v248, v236
v_permlane16_swap_b32 v249, v237
v_permlane16_swap_b32 v250, v238
v_permlane16_swap_b32 v251, v239
s_nop 1
v_add_f32 v248, v248, v236
v_add_f32 v249, v249, v237
v_add_f32 v250, v250, v238
v_add_f32 v251, v251, v239
v_mov_b32 v236, v248
v_mov_b32 v237, v249
v_mov_b32 v238, v250
v_mov_b32 v239, v251
s_nop 1
v_permlane32_swap_b32 v248, v236
v_permlane32_swap_b32 v249, v237
v_permlane32_swap_b32 v250, v238
v_permlane32_swap_b32 v251, v239
s_nop 1
v_add_f32 v248, v248, v236
v_add_f32 v249, v249, v237
v_add_f32 v250, v250, v238
v_add_f32 v251, v251, v239
s_nop 7
ds_write_b128 v254, a[128:131] offset:0
ds_write_b128 v254, a[132:135] offset:1024
ds_write_b128 v254, a[136:139] offset:2048
ds_write_b128 v254, a[140:143] offset:3072
ds_write_b128 v254, a[144:147] offset:4096
ds_write_b128 v254, a[148:151] offset:5120
ds_write_b128 v254, a[152:155] offset:6144
ds_write_b128 v254, a[156:159] offset:7168
ds_write_b128 v254, a[160:163] offset:8192
ds_write_b128 v254, a[164:167] offset:9216
ds_write_b128 v254, a[168:171] offset:10240
ds_write_b128 v254, a[172:175] offset:11264
ds_write_b128 v254, a[176:179] offset:12288
ds_write_b128 v254, a[180:183] offset:13312
ds_write_b128 v254, a[184:187] offset:14336
ds_write_b128 v254, a[188:191] offset:15360
ds_write_b128 v255, a[192:195] offset:0
ds_write_b128 v255, a[196:199] offset:1024
ds_write_b128 v255, a[200:203] offset:2048
ds_write_b128 v255, a[204:207] offset:3072
ds_write_b128 v255, a[208:211] offset:4096
ds_write_b128 v255, a[212:215] offset:5120
ds_write_b128 v255, a[216:219] offset:6144
ds_write_b128 v255, a[220:223] offset:7168
ds_write_b128 v255, a[224:227] offset:8192
ds_write_b128 v255, a[228:231] offset:9216
ds_write_b128 v255, a[232:235] offset:10240
ds_write_b128 v255, a[236:239] offset:11264
ds_write_b128 v255, a[240:243] offset:12288
ds_write_b128 v255, a[244:247] offset:13312
ds_write_b128 v255, a[248:251] offset:14336
ds_write_b128 v255, a[252:255] offset:15360
s_branch K2_POSTB
K2_END:
s_endpgm
.section .rodata,"a"
.p2align 6
.amdhsa_kernel standalone__conformer_family_branchformer__speech_kernel
  .amdhsa_next_free_vgpr 512
  .amdhsa_next_free_sgpr 102
  .amdhsa_accum_offset 256
  .amdhsa_group_segment_fixed_size 0
  .amdhsa_kernarg_size 96
  .amdhsa_user_sgpr_count 2
  .amdhsa_user_sgpr_kernarg_segment_ptr 1
  .amdhsa_system_sgpr_workgroup_id_x 1
  .amdhsa_float_denorm_mode_32 3
.end_amdhsa_kernel
```
